```python
import torch

def _softmax(x, axis=-1):
    return torch.softmax(x, dim=axis)

def _gelu(x):
    return torch.nn.functional.gelu(x, approximate='tanh')

def _silu(x):
    return torch.nn.functional.silu(x)

def _sigmoid(x):
    return torch.sigmoid(x)

def _layernorm(x, axis=-1, eps=1e-05):
    m = x.mean(dim=axis, keepdim=True)
    v = x.var(dim=axis, keepdim=True, unbiased=False)
    return (x - m) / torch.sqrt(v + eps)

def _scatter_add(tgt, idx, src, axis=0):
    return tgt.clone().index_add_(axis, idx, src)

def _segment_sum(src, seg, n):
    out = torch.zeros((n,) + src.shape[1:], dtype=src.dtype)
    return out.index_add_(0, seg, src)

def _pad(x, pw):
    flat = tuple((v for pair in reversed(pw) for v in pair))
    return torch.nn.functional.pad(x, flat)
kernel_name = 'adaLN_cond__compressed_kv_cla__dense_activation_relu__prompt'

def setup_inputs():

    _w = lambda a: (lambda t: t.to(torch.bfloat16) if t.is_floating_point() else t)(torch.as_tensor(a))

    def _A_setup():
        B, H, Sq, Sk, D, M = (1, 32, 2048, 2048, 128, 1024)
        Dc = 4 * D
        return {'x': _w((lambda *s: torch.randn(*s, dtype=torch.bfloat16) * 0.05)(B, Sq, M)), 'c_kv': _w((lambda *s: torch.randn(*s, dtype=torch.bfloat16) * 1.6)(B, Sk, Dc)), 'w_q': _w((lambda *s: torch.randn(*s, dtype=torch.bfloat16) * 0.8)(M, H, D) * M ** (-0.5)), 'w_uk': _w((lambda *s: torch.randn(*s, dtype=torch.bfloat16) * 0.8)(Dc, H, D) * Dc ** (-0.5)), 'w_uv': _w((lambda *s: torch.randn(*s, dtype=torch.bfloat16) * 1.6)(Dc, H, D) * Dc ** (-0.5)), 'w_o': _w((lambda *s: torch.randn(*s, dtype=torch.bfloat16) * 1.6)(H, D, M) * (H * D) ** (-0.5))}
    _A_in = _A_setup()

    def _B_setup():
        B, S, D, Dff = (1, 2048, 1024, 3584)
        return {'x': _w((lambda *s: torch.randn(*s, dtype=torch.bfloat16) * 0.05)(B, S, D)), 'w1': _w((lambda *s: torch.randn(*s, dtype=torch.bfloat16) * 0.05)(D, Dff)), 'w2': _w((lambda *s: torch.randn(*s, dtype=torch.bfloat16) * 0.05)(Dff, D))}
    _B_in = _B_setup()
    return {'A_x': _A_in['x'], 'A_c_kv': _A_in['c_kv'], 'A_w_q': _A_in['w_q'], 'A_w_uk': _A_in['w_uk'], 'A_w_uv': _A_in['w_uv'], 'A_w_o': _A_in['w_o'], 'B_x': _B_in['x'], 'B_w1': _B_in['w1'], 'B_w2': _B_in['w2'], 'c': _w((lambda *s: torch.randn(*s, dtype=torch.bfloat16) * 0.1)(1, 1024) * 8.0), 'w_mod': _w((lambda *s: torch.randn(*s, dtype=torch.bfloat16) * 0.1)(1024, 6 * 1024) * 1024 ** (-0.5) * 8.0)}

def reference(A_x, A_c_kv, A_w_q, A_w_uk, A_w_uv, A_w_o, B_x, B_w1, B_w2, c, w_mod):

    def _A_ref(x, c_kv, w_q, w_uk, w_uv, w_o):
        B, Sq, M = (x.shape[0], x.shape[1], x.shape[2])
        Sk = c_kv.shape[1]
        H, D = (w_q.shape[1], w_q.shape[2])
        q = torch.einsum('bqm,mhd->bhqd', x, w_q)
        k = torch.einsum('bkc,chd->bhkd', c_kv, w_uk)
        v = torch.einsum('bkc,chd->bhkd', c_kv, w_uv)
        scores = torch.einsum('bhqd,bhkd->bhqk', q, k) * D ** (-0.5)
        off = Sk - Sq
        qi = torch.arange(Sq)[:, None]
        kj = torch.arange(Sk)[None, :]
        cmask = kj <= qi + off
        scores = torch.where(cmask[None, None], scores, -1000000000.0)
        p = _softmax(scores, axis=-1)
        ctx = torch.einsum('bhqk,bhkd->bhqd', p, v)
        return torch.einsum('bhqd,hdm->bqm', ctx, w_o)

    def _B_ref(x, w1, w2):
        h = torch.einsum('bsd,df->bsf', x, w1)
        zero = torch.zeros_like(h)
        h = torch.maximum(h, zero)
        return torch.einsum('bsf,fd->bsd', h, w2)
    x = A_x
    mod = (_silu(c) @ w_mod).reshape(c.shape[0], 6, 1, -1)
    sa, ca, ga, sb, cb, gb = (mod[:, 0].clone(), mod[:, 1].clone(), mod[:, 2].clone(), mod[:, 3].clone(), mod[:, 4].clone(), mod[:, 5].clone())
    h = _layernorm(x, axis=-1) * (1 + ca) + sa
    x = x + ga * _A_ref(h, A_c_kv, A_w_q, A_w_uk, A_w_uv, A_w_o)
    h = _layernorm(x, axis=-1) * (1 + cb) + sb
    x = x + gb * _B_ref(h, B_w1, B_w2)
    return x
```

```asm
; @launch grid=(256,1,1) block=(256,1,1) lds=163840
.amdgcn_target "amdgcn-amd-amdhsa--gfx950"
.text
.globl adaLN_cond__compressed_kv_cla__dense_activation_relu__prompt_kernel
.p2align 8
.type adaLN_cond__compressed_kv_cla__dense_activation_relu__prompt_kernel,@function
adaLN_cond__compressed_kv_cla__dense_activation_relu__prompt_kernel:
  s_cmp_ge_u32 s2, 256
  s_cbranch_scc1 adaLN_cond__compressed_kv_cla__dense_activation_relu__prompt_kernel_end
  s_load_dwordx16 s[4:19], s[0:1], 0
  s_load_dwordx8 s[84:91], s[0:1], 64
  s_load_dwordx4 s[92:95], s[0:1], 96
  v_and_b32 v1, 63, v0
  v_lshrrev_b32 v2, 6, v0
  s_nop 0
  v_readfirstlane_b32 s3, v2
  s_and_b32 s24, s2, 7
  s_lshr_b32 s25, s2, 3
  s_and_b32 s26, s25, 3
  s_lshl_b32 s27, s24, 2
  s_add_u32 s26, s26, s27
  s_lshr_b32 s27, s25, 2
  s_lshl_b32 s28, s24, 5
  s_add_u32 s28, s28, s25
  s_waitcnt lgkmcnt(0)
  s_mov_b32 s22, s94
  s_mov_b32 s23, s95
  s_mov_b32 s97, 0
  s_add_u32 s68, s22, 0
  s_addc_u32 s69, s23, 0
  s_and_b32 s69, s69, 0xffff
  s_mov_b32 s70, 100663296
  s_mov_b32 s71, 0x20000
  s_add_u32 s52, s88, 0
  s_addc_u32 s53, s89, 0
  s_and_b32 s53, s53, 0xffff
  s_mov_b32 s54, 12582912
  s_mov_b32 s55, 0x20000
  s_add_u32 s56, s86, 0
  s_addc_u32 s57, s87, 0
  s_and_b32 s57, s57, 0xffff
  s_mov_b32 s58, 2048
  s_mov_b32 s59, 0x20000
  s_sub_u32 s40, s10, 4096
  s_subb_u32 s41, s11, 0
  s_and_b32 s41, s41, 0xffff
  s_mov_b32 s42, 4198400
  s_mov_b32 s43, 0x20000
  s_sub_u32 s44, s12, 4096
  s_subb_u32 s45, s13, 0
  s_and_b32 s45, s45, 0xffff
  s_mov_b32 s46, 4198400
  s_mov_b32 s47, 0x20000
  s_add_u32 s48, s6, 0
  s_addc_u32 s49, s7, 0
  s_and_b32 s49, s49, 0xffff
  s_mov_b32 s50, 2097152
  s_mov_b32 s51, 0x20000
  v_bfe_u32 v2, v1, 2, 2
  v_lshlrev_b32 v6, 7, v2
  v_bfe_u32 v2, v1, 3, 1
  v_lshl_add_u32 v6, v2, 6, v6
  v_bfe_u32 v2, v1, 4, 1
  v_lshl_add_u32 v6, v2, 5, v6
  v_and_b32 v2, 3, v1
  v_lshl_add_u32 v6, v2, 3, v6
  v_lshrrev_b32 v2, 5, v1
  v_mul_u32_u24 v2, 4096, v2
  v_add_u32 v6, v6, v2
  v_add_u32 v6, 65536, v6
  v_xor_b32 v7, 64, v6
  v_lshrrev_b32 v2, 3, v1
  v_mul_u32_u24 v2, 8192, v2
  v_bfe_u32 v3, v1, 4, 1
  v_lshlrev_b32 v3, 2, v3
  v_and_b32 v4, 7, v1
  v_xor_b32 v3, v3, v4
  v_lshl_add_u32 v2, v3, 4, v2
  s_mul_i32 s31, s3, 131072
  v_add_u32 v2, s31, v2
  v_add_u32 v8, 4096, v2
  v_add_u32 v9, 3200, v2
  v_add_u32 v10, 2048, v2
  v_add_u32 v11, 1152, v2
  v_add_u32 v12, 69632, v2
  v_add_u32 v13, 68736, v2
  v_add_u32 v14, 67584, v2
  v_add_u32 v15, 66688, v2
  s_mul_i32 s31, s3, 8192
  s_add_u32 s31, s31, 65536
  s_lshl_b32 s30, s26, 8
  v_lshrrev_b32 v2, 3, v1
  v_lshlrev_b32 v2, 10, v2
  v_lshrrev_b32 v3, 4, v1
  v_and_b32 v4, 7, v1
  v_xor_b32 v5, v3, v4
  v_lshl_add_u32 v16, v5, 4, v2
  v_xor_b32 v5, 4, v5
  v_lshl_add_u32 v17, v5, 4, v2
  v_add_u32 v23, 54272, v17
  v_add_u32 v22, 47104, v16
  v_add_u32 v21, 39936, v17
  v_add_u32 v20, 32768, v16
  v_add_u32 v19, 21504, v17
  v_add_u32 v18, 14336, v16
  v_add_u32 v17, 7168, v17
  s_lshl_b32 s32, s27, 18
  s_lshl_b32 s33, s3, 16
  s_add_u32 s32, s32, s33
  s_lshl_b32 s33, s3, 13
  s_add_u32 m0, s33, 0
  s_nop 0
  buffer_load_dwordx4 v16, s[48:51], s32 offen offset:0 lds
  buffer_load_dwordx4 v17, s[48:51], s32 offen offset:1024 lds
  buffer_load_dwordx4 v18, s[48:51], s32 offen offset:2048 lds
  buffer_load_dwordx4 v19, s[48:51], s32 offen offset:3072 lds
  s_add_u32 m0, s33, 4096
  s_nop 0
  buffer_load_dwordx4 v20, s[48:51], s32 offen offset:0 lds
  buffer_load_dwordx4 v21, s[48:51], s32 offen offset:1024 lds
  buffer_load_dwordx4 v22, s[48:51], s32 offen offset:2048 lds
  buffer_load_dwordx4 v23, s[48:51], s32 offen offset:3072 lds
  s_add_u32 s32, s32, 128
  s_add_u32 m0, s31, 0
  s_nop 0
  buffer_load_dwordx4 v8, s[40:43], s30 offen offset:0 lds
  buffer_load_dwordx4 v9, s[40:43], s30 offen offset:1024 lds
  buffer_load_dwordx4 v10, s[44:47], s30 offen offset:2048 lds
  buffer_load_dwordx4 v11, s[44:47], s30 offen offset:3072 lds
  s_add_u32 m0, s31, 4096
  s_nop 0
  buffer_load_dwordx4 v12, s[40:43], s30 offen offset:0 lds
  buffer_load_dwordx4 v13, s[40:43], s30 offen offset:1024 lds
  buffer_load_dwordx4 v14, s[44:47], s30 offen offset:2048 lds
  buffer_load_dwordx4 v15, s[44:47], s30 offen offset:3072 lds
  s_add_u32 s30, s30, 524288
  v_cmp_gt_u32 vcc, 8, v0
  v_mov_b32 v3, 2130706432
  v_lshlrev_b32 v2, 7, v0
  v_cndmask_b32 v2, v3, v2, vcc
  v_mov_b32 v3, 0
  s_lshl_b32 s34, s2, 10
  s_add_u32 s34, s34, 524288
  buffer_store_dword v3, v2, s[68:71], s34 offen sc0 sc1
  s_and_b32 s29, s28, 3
  s_lshl_b32 s34, s29, 9
  v_lshrrev_b32 v3, 2, v0
  v_lshlrev_b32 v2, 1, v3
  v_mul_u32_u24 v3, 12288, v3
  v_and_b32 v4, 3, v0
  v_lshl_add_u32 v3, v4, 4, v3
  buffer_load_ushort v224, v2, s[56:59], s34 offen offset:0
  buffer_load_ushort v225, v2, s[56:59], s34 offen offset:128
  buffer_load_ushort v226, v2, s[56:59], s34 offen offset:256
  buffer_load_ushort v227, v2, s[56:59], s34 offen offset:384
  s_mul_i32 s34, s29, 3145728
  s_lshr_b32 s35, s28, 2
  s_lshl_b32 s35, s35, 6
  s_add_u32 s34, s34, s35
  buffer_load_dwordx4 v[160:163], v3, s[52:55], s34 offen
  s_add_u32 s34, s34, 786432
  buffer_load_dwordx4 v[164:167], v3, s[52:55], s34 offen
  s_add_u32 s34, s34, 786432
  buffer_load_dwordx4 v[168:171], v3, s[52:55], s34 offen
  s_add_u32 s34, s34, 786432
  buffer_load_dwordx4 v[172:175], v3, s[52:55], s34 offen
  s_add_u32 s34, s34, 786432
  s_lshl_b32 s29, s29, 13
  s_lshl_b32 s35, s35, 1
  s_add_u32 s29, s29, s35
  s_add_u32 s29, s29, 65536
  s_add_u32 m0, s33, 32768
  s_nop 0
  buffer_load_dwordx4 v16, s[48:51], s32 offen offset:0 lds
  buffer_load_dwordx4 v17, s[48:51], s32 offen offset:1024 lds
  buffer_load_dwordx4 v18, s[48:51], s32 offen offset:2048 lds
  buffer_load_dwordx4 v19, s[48:51], s32 offen offset:3072 lds
  s_add_u32 m0, s33, 36864
  s_nop 0
  buffer_load_dwordx4 v20, s[48:51], s32 offen offset:0 lds
  buffer_load_dwordx4 v21, s[48:51], s32 offen offset:1024 lds
  buffer_load_dwordx4 v22, s[48:51], s32 offen offset:2048 lds
  buffer_load_dwordx4 v23, s[48:51], s32 offen offset:3072 lds
  s_add_u32 s32, s32, 128
  s_add_u32 m0, s31, 32768
  s_nop 0
  buffer_load_dwordx4 v8, s[40:43], s30 offen offset:0 lds
  buffer_load_dwordx4 v9, s[40:43], s30 offen offset:1024 lds
  buffer_load_dwordx4 v10, s[44:47], s30 offen offset:2048 lds
  buffer_load_dwordx4 v11, s[44:47], s30 offen offset:3072 lds
  s_add_u32 m0, s31, 36864
  s_nop 0
  buffer_load_dwordx4 v12, s[40:43], s30 offen offset:0 lds
  buffer_load_dwordx4 v13, s[40:43], s30 offen offset:1024 lds
  buffer_load_dwordx4 v14, s[44:47], s30 offen offset:2048 lds
  buffer_load_dwordx4 v15, s[44:47], s30 offen offset:3072 lds
  s_add_u32 s30, s30, 524288
  s_getpc_b64 s[0:1]
kn_cb:
  v_and_b32 v2, 31, v0
  v_lshlrev_b32 v2, 7, v2
  s_mul_i32 s21, s25, 4096
  s_add_u32 s21, s21, kn_cb-kn_cb
  v_add_u32 v2, s21, v2
  v_min_u32 v2, kn_ce-kn_cb-4, v2
  global_load_dword v29, v2, s[0:1]
  v_lshlrev_b32 v31, 10, v1
  s_lshl_b32 s21, s25, 16
  s_lshl_b32 s34, s3, 7
  s_add_u32 s21, s21, s34
  v_lshrrev_b32 v2, 4, v1
  v_lshlrev_b32 v2, 19, v2
  v_bfe_u32 v3, v1, 3, 1
  v_lshl_add_u32 v2, v3, 13, v2
  v_and_b32 v3, 7, v1
  v_lshl_add_u32 v2, v3, 7, v2
  s_and_b32 s34, s3, 1
  s_lshl_b32 s34, s34, 21
  s_lshl_b32 s35, s25, 14
  s_add_u32 s34, s34, s35
  s_lshl_b32 s35, s24, 10
  s_add_u32 s34, s34, s35
  s_add_u32 s34, s34, 4096
  s_cmp_lt_u32 s3, 2
  s_cselect_b32 s76, s40, s44
  s_cselect_b32 s77, s41, s45
  s_mov_b32 s78, s42
  s_mov_b32 s79, s43
  v_mov_b32 v30, v2
  s_bitcmp1_b32 s3, 0
  s_cselect_b32 s96, s34, 2130706432
  s_cselect_b32 s34, 2130706432, s34
  s_mov_b32 s37, s34
  v_and_b32 v2, 31, v1
  v_lshlrev_b32 v3, 7, v2
  v_add_u32 v3, s33, v3
  v_bfe_u32 v2, v1, 1, 3
  v_lshrrev_b32 v4, 5, v1
  v_xor_b32 v2, v2, v4
  v_xor_b32 v4, 0, v2
  v_lshl_add_u32 v24, v4, 4, v3
  v_xor_b32 v4, 2, v2
  v_lshl_add_u32 v25, v4, 4, v3
  v_xor_b32 v4, 4, v2
  v_lshl_add_u32 v26, v4, 4, v3
  v_xor_b32 v4, 6, v2
  v_lshl_add_u32 v27, v4, 4, v3
  s_add_u32 s60, s4, 0
  s_addc_u32 s61, s5, 0
  s_and_b32 s61, s61, 0xffff
  s_mov_b32 s62, 4194304
  s_mov_b32 s63, 0x20000
  s_add_u32 s64, s92, 0
  s_addc_u32 s65, s93, 0
  s_and_b32 s65, s65, 0xffff
  s_mov_b32 s66, 256
  s_mov_b32 s67, 0x20000
  s_sub_u32 s72, s8, 4096
  s_subb_u32 s73, s9, 0
  s_and_b32 s73, s73, 0xffff
  s_mov_b32 s74, 8392704
  s_mov_b32 s75, 0x20000
  s_lshl_b32 s35, s28, 3
  s_lshl_b32 s36, s3, 1
  s_add_u32 s35, s35, s36
  v_lshlrev_b32 v28, 5, v1
  v_lshlrev_b32 v5, 4, v1
  s_waitcnt vmcnt(26)
  s_barrier
  ds_read_b128 v[128:131], v24 offset:0
  ds_read_b128 v[132:135], v24 offset:4096
  ds_read_b64_tr_b16 v[64:65], v6 offset:0
  ds_read_b64_tr_b16 v[66:67], v6 offset:512
  ds_read_b64_tr_b16 v[68:69], v7 offset:0
  ds_read_b64_tr_b16 v[70:71], v7 offset:512
  ds_read_b64_tr_b16 v[72:73], v6 offset:1024
  ds_read_b64_tr_b16 v[74:75], v6 offset:1536
  ds_read_b64_tr_b16 v[76:77], v7 offset:1024
  ds_read_b64_tr_b16 v[78:79], v7 offset:1536
  ds_read_b64_tr_b16 v[80:81], v6 offset:2048
  ds_read_b64_tr_b16 v[82:83], v6 offset:2560
  ds_read_b64_tr_b16 v[84:85], v7 offset:2048
  ds_read_b64_tr_b16 v[86:87], v7 offset:2560
  ds_read_b64_tr_b16 v[88:89], v6 offset:3072
  ds_read_b64_tr_b16 v[90:91], v6 offset:3584
  ds_read_b64_tr_b16 v[92:93], v7 offset:3072
  ds_read_b64_tr_b16 v[94:95], v7 offset:3584
  s_waitcnt lgkmcnt(0)
  v_mfma_f32_32x32x16_bf16 a[0:15], v[64:67], v[128:131], 0
  ds_read_b128 v[136:139], v25 offset:0
  ds_read_b128 v[140:143], v25 offset:4096
  buffer_load_dword v29, v31, s[48:51], s21 offen
  v_mfma_f32_32x32x16_bf16 a[128:143], v[64:67], v[132:135], 0
  ds_read_b64_tr_b16 v[96:97], v6 offset:8192
  v_mfma_f32_32x32x16_bf16 a[16:31], v[68:71], v[128:131], 0
  ds_read_b64_tr_b16 v[98:99], v6 offset:8704
  ds_read_b64_tr_b16 v[100:101], v7 offset:8192
  v_mfma_f32_32x32x16_bf16 a[144:159], v[68:71], v[132:135], 0
  ds_read_b64_tr_b16 v[102:103], v7 offset:8704
  v_mfma_f32_32x32x16_bf16 a[32:47], v[72:75], v[128:131], 0
  ds_read_b64_tr_b16 v[104:105], v6 offset:9216
  ds_read_b64_tr_b16 v[106:107], v6 offset:9728
  buffer_load_dword v29, v30, s[76:79], s37 offen
  v_mfma_f32_32x32x16_bf16 a[160:175], v[72:75], v[132:135], 0
  ds_read_b64_tr_b16 v[108:109], v7 offset:9216
  v_mfma_f32_32x32x16_bf16 a[48:63], v[76:79], v[128:131], 0
  ds_read_b64_tr_b16 v[110:111], v7 offset:9728
  ds_read_b64_tr_b16 v[112:113], v6 offset:10240
  v_mfma_f32_32x32x16_bf16 a[176:191], v[76:79], v[132:135], 0
  ds_read_b64_tr_b16 v[114:115], v6 offset:10752
  v_mfma_f32_32x32x16_bf16 a[64:79], v[128:131], v[80:83], 0
  ds_read_b64_tr_b16 v[116:117], v7 offset:10240
  ds_read_b64_tr_b16 v[118:119], v7 offset:10752
  s_add_u32 s21, s21, 512
  buffer_load_dword v29, v31, s[48:51], s21 offen
  v_mfma_f32_32x32x16_bf16 a[192:207], v[132:135], v[80:83], 0
  ds_read_b64_tr_b16 v[120:121], v6 offset:11264
  v_mfma_f32_32x32x16_bf16 a[80:95], v[128:131], v[84:87], 0
  ds_read_b64_tr_b16 v[122:123], v6 offset:11776
  ds_read_b64_tr_b16 v[124:125], v7 offset:11264
  v_mfma_f32_32x32x16_bf16 a[208:223], v[132:135], v[84:87], 0
  ds_read_b64_tr_b16 v[126:127], v7 offset:11776
  v_mfma_f32_32x32x16_bf16 a[96:111], v[128:131], v[88:91], 0
  buffer_load_dword v29, v30, s[76:79], s96 offen
  v_mfma_f32_32x32x16_bf16 a[224:239], v[132:135], v[88:91], 0
  v_mfma_f32_32x32x16_bf16 a[112:127], v[128:131], v[92:95], 0
  v_mfma_f32_32x32x16_bf16 a[240:255], v[132:135], v[92:95], 0
  s_waitcnt lgkmcnt(0)
  v_mfma_f32_32x32x16_bf16 a[0:15], v[96:99], v[136:139], a[0:15]
  ds_read_b128 v[128:131], v26 offset:0
  ds_read_b128 v[132:135], v26 offset:4096
  s_waitcnt vmcnt(21)
  v_lshlrev_b32 v224, 16, v224
  v_mul_f32 v2, 0xbfb8aa3b, v224
  v_exp_f32 v2, v2
  v_mfma_f32_32x32x16_bf16 a[128:143], v[96:99], v[140:143], a[128:143]
  ds_read_b64_tr_b16 v[64:65], v6 offset:16384
  s_nop 0
  v_add_f32 v2, 1.0, v2
  v_rcp_f32 v2, v2
  s_nop 0
  v_mfma_f32_32x32x16_bf16 a[16:31], v[100:103], v[136:139], a[16:31]
  ds_read_b64_tr_b16 v[66:67], v6 offset:16896
  ds_read_b64_tr_b16 v[68:69], v7 offset:16384
  v_mul_f32 v224, v224, v2
  v_cvt_pk_bf16_f32 v224, v224, v224
  v_and_b32 v224, 0xffff0000, v224
  v_lshlrev_b32 v2, 16, v160
  v_mfma_f32_32x32x16_bf16 a[144:159], v[100:103], v[140:143], a[144:159]
  ds_read_b64_tr_b16 v[70:71], v7 offset:16896
  v_and_b32 v3, 0xffff0000, v160
  v_mul_f32 v228, v2, v224
  v_mul_f32 v229, v3, v224
  v_lshlrev_b32 v2, 16, v161
  v_mfma_f32_32x32x16_bf16 a[32:47], v[104:107], v[136:139], a[32:47]
  ds_read_b64_tr_b16 v[72:73], v6 offset:17408
  ds_read_b64_tr_b16 v[74:75], v6 offset:17920
  v_and_b32 v3, 0xffff0000, v161
  v_mul_f32 v230, v2, v224
  v_mul_f32 v231, v3, v224
  v_lshlrev_b32 v2, 16, v162
  v_mfma_f32_32x32x16_bf16 a[160:175], v[104:107], v[140:143], a[160:175]
  ds_read_b64_tr_b16 v[76:77], v7 offset:17408
  v_and_b32 v3, 0xffff0000, v162
  v_mul_f32 v232, v2, v224
  v_mul_f32 v233, v3, v224
  v_lshlrev_b32 v2, 16, v163
  v_mfma_f32_32x32x16_bf16 a[48:63], v[108:111], v[136:139], a[48:63]
  ds_read_b64_tr_b16 v[78:79], v7 offset:17920
  ds_read_b64_tr_b16 v[80:81], v6 offset:18432
  v_and_b32 v3, 0xffff0000, v163
  v_mul_f32 v234, v2, v224
  v_mul_f32 v235, v3, v224
  v_lshlrev_b32 v225, 16, v225
  v_mfma_f32_32x32x16_bf16 a[176:191], v[108:111], v[140:143], a[176:191]
  ds_read_b64_tr_b16 v[82:83], v6 offset:18944
  v_mul_f32 v2, 0xbfb8aa3b, v225
  v_exp_f32 v2, v2
  s_nop 0
  v_add_f32 v2, 1.0, v2
  v_mfma_f32_32x32x16_bf16 a[64:79], v[136:139], v[112:115], a[64:79]
  ds_read_b64_tr_b16 v[84:85], v7 offset:18432
  ds_read_b64_tr_b16 v[86:87], v7 offset:18944
  v_rcp_f32 v2, v2
  s_nop 0
  v_mul_f32 v225, v225, v2
  v_cvt_pk_bf16_f32 v225, v225, v225
  v_mfma_f32_32x32x16_bf16 a[192:207], v[140:143], v[112:115], a[192:207]
  ds_read_b64_tr_b16 v[88:89], v6 offset:19456
  v_and_b32 v225, 0xffff0000, v225
  v_lshlrev_b32 v2, 16, v164
  v_and_b32 v3, 0xffff0000, v164
  v_fmac_f32 v228, v2, v225
  v_mfma_f32_32x32x16_bf16 a[80:95], v[136:139], v[116:119], a[80:95]
  ds_read_b64_tr_b16 v[90:91], v6 offset:19968
  ds_read_b64_tr_b16 v[92:93], v7 offset:19456
  v_fmac_f32 v229, v3, v225
  v_lshlrev_b32 v2, 16, v165
  v_and_b32 v3, 0xffff0000, v165
  v_fmac_f32 v230, v2, v225
  v_mfma_f32_32x32x16_bf16 a[208:223], v[140:143], v[116:119], a[208:223]
  ds_read_b64_tr_b16 v[94:95], v7 offset:19968
  v_fmac_f32 v231, v3, v225
  v_lshlrev_b32 v2, 16, v166
  v_and_b32 v3, 0xffff0000, v166
  v_fmac_f32 v232, v2, v225
  v_mfma_f32_32x32x16_bf16 a[96:111], v[136:139], v[120:123], a[96:111]
  v_fmac_f32 v233, v3, v225
  v_lshlrev_b32 v2, 16, v167
  v_and_b32 v3, 0xffff0000, v167
  v_fmac_f32 v234, v2, v225
  v_mfma_f32_32x32x16_bf16 a[224:239], v[140:143], v[120:123], a[224:239]
  v_fmac_f32 v235, v3, v225
  v_lshlrev_b32 v226, 16, v226
  v_mul_f32 v2, 0xbfb8aa3b, v226
  v_exp_f32 v2, v2
  v_mfma_f32_32x32x16_bf16 a[112:127], v[136:139], v[124:127], a[112:127]
  s_nop 0
  v_add_f32 v2, 1.0, v2
  v_rcp_f32 v2, v2
  s_nop 0
  v_mfma_f32_32x32x16_bf16 a[240:255], v[140:143], v[124:127], a[240:255]
  v_mul_f32 v226, v226, v2
  v_cvt_pk_bf16_f32 v226, v226, v226
  v_and_b32 v226, 0xffff0000, v226
  v_lshlrev_b32 v2, 16, v168
  s_waitcnt lgkmcnt(0)
  v_mfma_f32_32x32x16_bf16 a[0:15], v[64:67], v[128:131], a[0:15]
  ds_read_b128 v[136:139], v27 offset:0
  ds_read_b128 v[140:143], v27 offset:4096
  v_and_b32 v3, 0xffff0000, v168
  v_fmac_f32 v228, v2, v226
  v_fmac_f32 v229, v3, v226
  v_lshlrev_b32 v2, 16, v169
  v_mfma_f32_32x32x16_bf16 a[128:143], v[64:67], v[132:135], a[128:143]
  ds_read_b64_tr_b16 v[96:97], v6 offset:24576
  v_and_b32 v3, 0xffff0000, v169
  v_fmac_f32 v230, v2, v226
  v_fmac_f32 v231, v3, v226
  v_lshlrev_b32 v2, 16, v170
  v_mfma_f32_32x32x16_bf16 a[16:31], v[68:71], v[128:131], a[16:31]
  ds_read_b64_tr_b16 v[98:99], v6 offset:25088
  ds_read_b64_tr_b16 v[100:101], v7 offset:24576
  v_and_b32 v3, 0xffff0000, v170
  v_fmac_f32 v232, v2, v226
  v_fmac_f32 v233, v3, v226
  v_lshlrev_b32 v2, 16, v171
  v_mfma_f32_32x32x16_bf16 a[144:159], v[68:71], v[132:135], a[144:159]
  ds_read_b64_tr_b16 v[102:103], v7 offset:25088
  v_and_b32 v3, 0xffff0000, v171
  v_fmac_f32 v234, v2, v226
  v_fmac_f32 v235, v3, v226
  v_lshlrev_b32 v227, 16, v227
  v_mfma_f32_32x32x16_bf16 a[32:47], v[72:75], v[128:131], a[32:47]
  ds_read_b64_tr_b16 v[104:105], v6 offset:25600
  ds_read_b64_tr_b16 v[106:107], v6 offset:26112
  v_mul_f32 v2, 0xbfb8aa3b, v227
  v_exp_f32 v2, v2
  s_nop 0
  v_add_f32 v2, 1.0, v2
  v_mfma_f32_32x32x16_bf16 a[160:175], v[72:75], v[132:135], a[160:175]
  ds_read_b64_tr_b16 v[108:109], v7 offset:25600
  v_rcp_f32 v2, v2
  s_nop 0
  v_mul_f32 v227, v227, v2
  v_cvt_pk_bf16_f32 v227, v227, v227
  v_mfma_f32_32x32x16_bf16 a[48:63], v[76:79], v[128:131], a[48:63]
  ds_read_b64_tr_b16 v[110:111], v7 offset:26112
  ds_read_b64_tr_b16 v[112:113], v6 offset:26624
  v_and_b32 v227, 0xffff0000, v227
  v_lshlrev_b32 v2, 16, v172
  v_and_b32 v3, 0xffff0000, v172
  v_fmac_f32 v228, v2, v227
  v_mfma_f32_32x32x16_bf16 a[176:191], v[76:79], v[132:135], a[176:191]
  ds_read_b64_tr_b16 v[114:115], v6 offset:27136
  v_fmac_f32 v229, v3, v227
  v_lshlrev_b32 v2, 16, v173
  v_and_b32 v3, 0xffff0000, v173
  v_fmac_f32 v230, v2, v227
  v_mfma_f32_32x32x16_bf16 a[64:79], v[128:131], v[80:83], a[64:79]
  ds_read_b64_tr_b16 v[116:117], v7 offset:26624
  ds_read_b64_tr_b16 v[118:119], v7 offset:27136
  v_fmac_f32 v231, v3, v227
  v_lshlrev_b32 v2, 16, v174
  v_and_b32 v3, 0xffff0000, v174
  v_fmac_f32 v232, v2, v227
  v_mfma_f32_32x32x16_bf16 a[192:207], v[132:135], v[80:83], a[192:207]
  ds_read_b64_tr_b16 v[120:121], v6 offset:27648
  v_fmac_f32 v233, v3, v227
  v_lshlrev_b32 v2, 16, v175
  v_and_b32 v3, 0xffff0000, v175
  v_fmac_f32 v234, v2, v227
  v_mfma_f32_32x32x16_bf16 a[80:95], v[128:131], v[84:87], a[80:95]
  ds_read_b64_tr_b16 v[122:123], v6 offset:28160
  ds_read_b64_tr_b16 v[124:125], v7 offset:27648
  v_fmac_f32 v235, v3, v227
  v_add_f32_dpp v228, v228, v228 row_ror:4 row_mask:0xf bank_mask:0xf
  v_add_f32_dpp v229, v229, v229 row_ror:4 row_mask:0xf bank_mask:0xf
  v_add_f32_dpp v230, v230, v230 row_ror:4 row_mask:0xf bank_mask:0xf
  v_mfma_f32_32x32x16_bf16 a[208:223], v[132:135], v[84:87], a[208:223]
  ds_read_b64_tr_b16 v[126:127], v7 offset:28160
  v_add_f32_dpp v231, v231, v231 row_ror:4 row_mask:0xf bank_mask:0xf
  v_add_f32_dpp v232, v232, v232 row_ror:4 row_mask:0xf bank_mask:0xf
  v_add_f32_dpp v233, v233, v233 row_ror:4 row_mask:0xf bank_mask:0xf
  v_add_f32_dpp v234, v234, v234 row_ror:4 row_mask:0xf bank_mask:0xf
  v_mfma_f32_32x32x16_bf16 a[96:111], v[128:131], v[88:91], a[96:111]
  v_add_f32_dpp v235, v235, v235 row_ror:4 row_mask:0xf bank_mask:0xf
  v_add_f32_dpp v228, v228, v228 row_ror:8 row_mask:0xf bank_mask:0xf
  v_add_f32_dpp v229, v229, v229 row_ror:8 row_mask:0xf bank_mask:0xf
  v_add_f32_dpp v230, v230, v230 row_ror:8 row_mask:0xf bank_mask:0xf
  v_mfma_f32_32x32x16_bf16 a[224:239], v[132:135], v[88:91], a[224:239]
  v_add_f32_dpp v231, v231, v231 row_ror:8 row_mask:0xf bank_mask:0xf
  v_add_f32_dpp v232, v232, v232 row_ror:8 row_mask:0xf bank_mask:0xf
  v_add_f32_dpp v233, v233, v233 row_ror:8 row_mask:0xf bank_mask:0xf
  v_add_f32_dpp v234, v234, v234 row_ror:8 row_mask:0xf bank_mask:0xf
  v_mfma_f32_32x32x16_bf16 a[112:127], v[128:131], v[92:95], a[112:127]
  v_add_f32_dpp v235, v235, v235 row_ror:8 row_mask:0xf bank_mask:0xf
  v_lshrrev_b32 v2, 4, v0
  v_and_b32 v3, 3, v0
  v_mul_u32_u24 v2, 128, v2
  v_mfma_f32_32x32x16_bf16 a[240:255], v[132:135], v[92:95], a[240:255]
  v_lshl_add_u32 v2, v3, 5, v2
  v_add_u32 v2, 131072, v2
  ds_write_b128 v2, v[228:231]
  ds_write_b128 v2, v[232:235] offset:16
  s_waitcnt vmcnt(5) lgkmcnt(0)
  s_barrier
  v_mfma_f32_32x32x16_bf16 a[0:15], v[96:99], v[136:139], a[0:15]
  ds_read_b128 v[128:131], v24 offset:32768
  ds_read_b128 v[132:135], v24 offset:36864
  s_add_u32 m0, s31, 0
  s_nop 0
  buffer_load_dwordx4 v8, s[40:43], s30 offen offset:0 lds
  buffer_load_dwordx4 v9, s[40:43], s30 offen offset:1024 lds
  v_lshlrev_b32 v2, 2, v1
  v_add_u32 v2, 131072, v2
  v_mfma_f32_32x32x16_bf16 a[128:143], v[96:99], v[140:143], a[128:143]
  ds_read_b64_tr_b16 v[64:65], v6 offset:32768
  buffer_load_dwordx4 v10, s[44:47], s30 offen offset:2048 lds
  ds_read_b32 v160, v2 offset:0
  v_mfma_f32_32x32x16_bf16 a[16:31], v[100:103], v[136:139], a[16:31]
  ds_read_b64_tr_b16 v[66:67], v6 offset:33280
  ds_read_b64_tr_b16 v[68:69], v7 offset:32768
  buffer_load_dwordx4 v11, s[44:47], s30 offen offset:3072 lds
  ds_read_b32 v161, v2 offset:128
  v_mfma_f32_32x32x16_bf16 a[144:159], v[100:103], v[140:143], a[144:159]
  ds_read_b64_tr_b16 v[70:71], v7 offset:33280
  s_add_u32 m0, s31, 4096
  s_nop 0
  buffer_load_dwordx4 v12, s[40:43], s30 offen offset:0 lds
  ds_read_b32 v162, v2 offset:256
  v_mfma_f32_32x32x16_bf16 a[32:47], v[104:107], v[136:139], a[32:47]
  ds_read_b64_tr_b16 v[72:73], v6 offset:33792
  ds_read_b64_tr_b16 v[74:75], v6 offset:34304
  buffer_load_dwordx4 v13, s[40:43], s30 offen offset:1024 lds
  ds_read_b32 v163, v2 offset:384
  v_mfma_f32_32x32x16_bf16 a[160:175], v[104:107], v[140:143], a[160:175]
  ds_read_b64_tr_b16 v[76:77], v7 offset:33792
  buffer_load_dwordx4 v14, s[44:47], s30 offen offset:2048 lds
  buffer_load_dwordx4 v15, s[44:47], s30 offen offset:3072 lds
  ds_read_b32 v164, v2 offset:512
  v_mfma_f32_32x32x16_bf16 a[48:63], v[108:111], v[136:139], a[48:63]
  ds_read_b64_tr_b16 v[78:79], v7 offset:34304
  ds_read_b64_tr_b16 v[80:81], v6 offset:34816
  s_add_u32 s30, s30, 524288
  ds_read_b32 v165, v2 offset:640
  v_mfma_f32_32x32x16_bf16 a[176:191], v[108:111], v[140:143], a[176:191]
  ds_read_b64_tr_b16 v[82:83], v6 offset:35328
  s_add_u32 m0, s33, 0
  s_nop 0
  buffer_load_dwordx4 v16, s[48:51], s32 offen offset:0 lds
  ds_read_b32 v166, v2 offset:768
  v_mfma_f32_32x32x16_bf16 a[64:79], v[136:139], v[112:115], a[64:79]
  ds_read_b64_tr_b16 v[84:85], v7 offset:34816
  ds_read_b64_tr_b16 v[86:87], v7 offset:35328
  buffer_load_dwordx4 v17, s[48:51], s32 offen offset:1024 lds
  ds_read_b32 v167, v2 offset:896
  ds_read_b32 v168, v2 offset:1024
  v_mfma_f32_32x32x16_bf16 a[192:207], v[140:143], v[112:115], a[192:207]
  ds_read_b64_tr_b16 v[88:89], v6 offset:35840
  buffer_load_dwordx4 v18, s[48:51], s32 offen offset:2048 lds
  ds_read_b32 v169, v2 offset:1152
  v_mfma_f32_32x32x16_bf16 a[80:95], v[136:139], v[116:119], a[80:95]
  ds_read_b64_tr_b16 v[90:91], v6 offset:36352
  ds_read_b64_tr_b16 v[92:93], v7 offset:35840
  buffer_load_dwordx4 v19, s[48:51], s32 offen offset:3072 lds
  s_add_u32 m0, s33, 4096
  s_nop 0
  buffer_load_dwordx4 v20, s[48:51], s32 offen offset:0 lds
  ds_read_b32 v170, v2 offset:1280
  v_mfma_f32_32x32x16_bf16 a[208:223], v[140:143], v[116:119], a[208:223]
  ds_read_b64_tr_b16 v[94:95], v7 offset:36352
  buffer_load_dwordx4 v21, s[48:51], s32 offen offset:1024 lds
  ds_read_b32 v171, v2 offset:1408
  v_mfma_f32_32x32x16_bf16 a[96:111], v[136:139], v[120:123], a[96:111]
  buffer_load_dwordx4 v22, s[48:51], s32 offen offset:2048 lds
  ds_read_b32 v172, v2 offset:1536
  v_mfma_f32_32x32x16_bf16 a[224:239], v[140:143], v[120:123], a[224:239]
  buffer_load_dwordx4 v23, s[48:51], s32 offen offset:3072 lds
  ds_read_b32 v173, v2 offset:1664
  v_mfma_f32_32x32x16_bf16 a[112:127], v[136:139], v[124:127], a[112:127]
  s_add_u32 s32, s32, 128
  ds_read_b32 v174, v2 offset:1792
  v_mfma_f32_32x32x16_bf16 a[240:255], v[140:143], v[124:127], a[240:255]
  ds_read_b32 v175, v2 offset:1920
  s_waitcnt lgkmcnt(0)
  v_mfma_f32_32x32x16_bf16 a[0:15], v[64:67], v[128:131], a[0:15]
  ds_read_b128 v[136:139], v25 offset:32768
  ds_read_b128 v[140:143], v25 offset:36864
  v_add_f32 v160, v160, v162
  v_add_f32 v161, v161, v163
  v_mfma_f32_32x32x16_bf16 a[128:143], v[64:67], v[132:135], a[128:143]
  ds_read_b64_tr_b16 v[96:97], v6 offset:40960
  v_add_f32 v160, v160, v164
  v_mfma_f32_32x32x16_bf16 a[16:31], v[68:71], v[128:131], a[16:31]
  ds_read_b64_tr_b16 v[98:99], v6 offset:41472
  ds_read_b64_tr_b16 v[100:101], v7 offset:40960
  v_add_f32 v161, v161, v165
  v_add_f32 v160, v160, v166
  v_mfma_f32_32x32x16_bf16 a[144:159], v[68:71], v[132:135], a[144:159]
  ds_read_b64_tr_b16 v[102:103], v7 offset:41472
  v_add_f32 v161, v161, v167
  v_mfma_f32_32x32x16_bf16 a[32:47], v[72:75], v[128:131], a[32:47]
  ds_read_b64_tr_b16 v[104:105], v6 offset:41984
  ds_read_b64_tr_b16 v[106:107], v6 offset:42496
  v_add_f32 v160, v160, v168
  v_mfma_f32_32x32x16_bf16 a[160:175], v[72:75], v[132:135], a[160:175]
  ds_read_b64_tr_b16 v[108:109], v7 offset:41984
  v_add_f32 v161, v161, v169
  v_add_f32 v160, v160, v170
  v_mfma_f32_32x32x16_bf16 a[48:63], v[76:79], v[128:131], a[48:63]
  ds_read_b64_tr_b16 v[110:111], v7 offset:42496
  ds_read_b64_tr_b16 v[112:113], v6 offset:43008
  v_add_f32 v161, v161, v171
  v_mfma_f32_32x32x16_bf16 a[176:191], v[76:79], v[132:135], a[176:191]
  ds_read_b64_tr_b16 v[114:115], v6 offset:43520
  v_add_f32 v160, v160, v172
  v_mfma_f32_32x32x16_bf16 a[64:79], v[128:131], v[80:83], a[64:79]
  ds_read_b64_tr_b16 v[116:117], v7 offset:43008
  ds_read_b64_tr_b16 v[118:119], v7 offset:43520
  v_add_f32 v161, v161, v173
  v_add_f32 v160, v160, v174
  v_mfma_f32_32x32x16_bf16 a[192:207], v[132:135], v[80:83], a[192:207]
  ds_read_b64_tr_b16 v[120:121], v6 offset:44032
  v_add_f32 v161, v161, v175
  v_mfma_f32_32x32x16_bf16 a[80:95], v[128:131], v[84:87], a[80:95]
  ds_read_b64_tr_b16 v[122:123], v6 offset:44544
  ds_read_b64_tr_b16 v[124:125], v7 offset:44032
  v_add_f32 v160, v160, v161
  v_lshlrev_b32 v2, 2, v0
  v_mfma_f32_32x32x16_bf16 a[208:223], v[132:135], v[84:87], a[208:223]
  ds_read_b64_tr_b16 v[126:127], v7 offset:44544
  v_cmp_gt_u32 vcc, 32, v0
  v_mfma_f32_32x32x16_bf16 a[96:111], v[128:131], v[88:91], a[96:111]
  v_mov_b32 v3, 2130706432
  v_mfma_f32_32x32x16_bf16 a[224:239], v[132:135], v[88:91], a[224:239]
  s_nop 0
  v_cndmask_b32 v2, v3, v2, vcc
  v_mfma_f32_32x32x16_bf16 a[112:127], v[128:131], v[92:95], a[112:127]
  buffer_store_dword v160, v2, s[68:71], s29 offen sc0 sc1
  v_mfma_f32_32x32x16_bf16 a[240:255], v[132:135], v[92:95], a[240:255]
  s_waitcnt lgkmcnt(0)
  v_mfma_f32_32x32x16_bf16 a[0:15], v[96:99], v[136:139], a[0:15]
  ds_read_b128 v[128:131], v26 offset:32768
  ds_read_b128 v[132:135], v26 offset:36864
  s_lshl_b32 s34, s35, 11
  buffer_load_dwordx4 v[144:147], v28, s[60:63], s34 offen offset:0
  buffer_load_dwordx4 v[148:151], v28, s[60:63], s34 offen offset:16
  buffer_load_dwordx4 v[152:155], v28, s[60:63], s34 offen offset:2048
  buffer_load_dwordx4 v[156:159], v28, s[60:63], s34 offen offset:2064
  v_mfma_f32_32x32x16_bf16 a[128:143], v[96:99], v[140:143], a[128:143]
  ds_read_b64_tr_b16 v[64:65], v6 offset:49152
  v_mfma_f32_32x32x16_bf16 a[16:31], v[100:103], v[136:139], a[16:31]
  ds_read_b64_tr_b16 v[66:67], v6 offset:49664
  ds_read_b64_tr_b16 v[68:69], v7 offset:49152
  v_mfma_f32_32x32x16_bf16 a[144:159], v[100:103], v[140:143], a[144:159]
  ds_read_b64_tr_b16 v[70:71], v7 offset:49664
  v_mfma_f32_32x32x16_bf16 a[32:47], v[104:107], v[136:139], a[32:47]
  ds_read_b64_tr_b16 v[72:73], v6 offset:50176
  ds_read_b64_tr_b16 v[74:75], v6 offset:50688
  v_mfma_f32_32x32x16_bf16 a[160:175], v[104:107], v[140:143], a[160:175]
  ds_read_b64_tr_b16 v[76:77], v7 offset:50176
  v_mfma_f32_32x32x16_bf16 a[48:63], v[108:111], v[136:139], a[48:63]
  ds_read_b64_tr_b16 v[78:79], v7 offset:50688
  ds_read_b64_tr_b16 v[80:81], v6 offset:51200
  v_mfma_f32_32x32x16_bf16 a[176:191], v[108:111], v[140:143], a[176:191]
  ds_read_b64_tr_b16 v[82:83], v6 offset:51712
  v_mfma_f32_32x32x16_bf16 a[64:79], v[136:139], v[112:115], a[64:79]
  ds_read_b64_tr_b16 v[84:85], v7 offset:51200
  ds_read_b64_tr_b16 v[86:87], v7 offset:51712
  v_mfma_f32_32x32x16_bf16 a[192:207], v[140:143], v[112:115], a[192:207]
  ds_read_b64_tr_b16 v[88:89], v6 offset:52224
  v_mfma_f32_32x32x16_bf16 a[80:95], v[136:139], v[116:119], a[80:95]
  ds_read_b64_tr_b16 v[90:91], v6 offset:52736
  ds_read_b64_tr_b16 v[92:93], v7 offset:52224
  v_mfma_f32_32x32x16_bf16 a[208:223], v[140:143], v[116:119], a[208:223]
  ds_read_b64_tr_b16 v[94:95], v7 offset:52736
  v_mfma_f32_32x32x16_bf16 a[96:111], v[136:139], v[120:123], a[96:111]
  v_mfma_f32_32x32x16_bf16 a[224:239], v[140:143], v[120:123], a[224:239]
  v_mfma_f32_32x32x16_bf16 a[112:127], v[136:139], v[124:127], a[112:127]
  v_mfma_f32_32x32x16_bf16 a[240:255], v[140:143], v[124:127], a[240:255]
  s_waitcnt lgkmcnt(0)
  v_mfma_f32_32x32x16_bf16 a[0:15], v[64:67], v[128:131], a[0:15]
  ds_read_b128 v[136:139], v27 offset:32768
  ds_read_b128 v[140:143], v27 offset:36864
  s_waitcnt vmcnt(4)
  v_cmp_eq_u32 vcc, 0, v0
  v_mov_b32 v252, 2130706432
  v_mov_b32 v253, 1
  v_cndmask_b32 v252, v252, v0, vcc
  buffer_store_byte v253, v252, s[64:67], s2 offen sc0 sc1
  v_mfma_f32_32x32x16_bf16 a[128:143], v[64:67], v[132:135], a[128:143]
  ds_read_b64_tr_b16 v[96:97], v6 offset:57344
  v_mfma_f32_32x32x16_bf16 a[16:31], v[68:71], v[128:131], a[16:31]
  ds_read_b64_tr_b16 v[98:99], v6 offset:57856
  ds_read_b64_tr_b16 v[100:101], v7 offset:57344
  v_mfma_f32_32x32x16_bf16 a[144:159], v[68:71], v[132:135], a[144:159]
  ds_read_b64_tr_b16 v[102:103], v7 offset:57856
  v_mfma_f32_32x32x16_bf16 a[32:47], v[72:75], v[128:131], a[32:47]
  ds_read_b64_tr_b16 v[104:105], v6 offset:58368
  ds_read_b64_tr_b16 v[106:107], v6 offset:58880
  v_mfma_f32_32x32x16_bf16 a[160:175], v[72:75], v[132:135], a[160:175]
  ds_read_b64_tr_b16 v[108:109], v7 offset:58368
  v_mfma_f32_32x32x16_bf16 a[48:63], v[76:79], v[128:131], a[48:63]
  ds_read_b64_tr_b16 v[110:111], v7 offset:58880
  ds_read_b64_tr_b16 v[112:113], v6 offset:59392
  v_mfma_f32_32x32x16_bf16 a[176:191], v[76:79], v[132:135], a[176:191]
  ds_read_b64_tr_b16 v[114:115], v6 offset:59904
  v_mfma_f32_32x32x16_bf16 a[64:79], v[128:131], v[80:83], a[64:79]
  ds_read_b64_tr_b16 v[116:117], v7 offset:59392
  ds_read_b64_tr_b16 v[118:119], v7 offset:59904
  v_mfma_f32_32x32x16_bf16 a[192:207], v[132:135], v[80:83], a[192:207]
  ds_read_b64_tr_b16 v[120:121], v6 offset:60416
  v_mfma_f32_32x32x16_bf16 a[80:95], v[128:131], v[84:87], a[80:95]
  ds_read_b64_tr_b16 v[122:123], v6 offset:60928
  ds_read_b64_tr_b16 v[124:125], v7 offset:60416
  v_mfma_f32_32x32x16_bf16 a[208:223], v[132:135], v[84:87], a[208:223]
  ds_read_b64_tr_b16 v[126:127], v7 offset:60928
  v_mfma_f32_32x32x16_bf16 a[96:111], v[128:131], v[88:91], a[96:111]
  v_mfma_f32_32x32x16_bf16 a[224:239], v[132:135], v[88:91], a[224:239]
  v_mfma_f32_32x32x16_bf16 a[112:127], v[128:131], v[92:95], a[112:127]
  v_mfma_f32_32x32x16_bf16 a[240:255], v[132:135], v[92:95], a[240:255]
  s_waitcnt vmcnt(6) lgkmcnt(0)
  s_barrier
  v_mfma_f32_32x32x16_bf16 a[0:15], v[96:99], v[136:139], a[0:15]
  ds_read_b128 v[128:131], v24 offset:0
  ds_read_b128 v[132:135], v24 offset:4096
  s_add_u32 m0, s31, 32768
  s_nop 0
  buffer_load_dwordx4 v8, s[40:43], s30 offen offset:0 lds
  buffer_load_dwordx4 v9, s[40:43], s30 offen offset:1024 lds
  v_mfma_f32_32x32x16_bf16 a[128:143], v[96:99], v[140:143], a[128:143]
  ds_read_b64_tr_b16 v[64:65], v6 offset:0
  buffer_load_dwordx4 v10, s[44:47], s30 offen offset:2048 lds
  v_mfma_f32_32x32x16_bf16 a[16:31], v[100:103], v[136:139], a[16:31]
  ds_read_b64_tr_b16 v[66:67], v6 offset:512
  ds_read_b64_tr_b16 v[68:69], v7 offset:0
  buffer_load_dwordx4 v11, s[44:47], s30 offen offset:3072 lds
  v_mfma_f32_32x32x16_bf16 a[144:159], v[100:103], v[140:143], a[144:159]
  ds_read_b64_tr_b16 v[70:71], v7 offset:512
  s_add_u32 m0, s31, 36864
  s_nop 0
  buffer_load_dwordx4 v12, s[40:43], s30 offen offset:0 lds
  v_mfma_f32_32x32x16_bf16 a[32:47], v[104:107], v[136:139], a[32:47]
  ds_read_b64_tr_b16 v[72:73], v6 offset:1024
  ds_read_b64_tr_b16 v[74:75], v6 offset:1536
  buffer_load_dwordx4 v13, s[40:43], s30 offen offset:1024 lds
  v_mfma_f32_32x32x16_bf16 a[160:175], v[104:107], v[140:143], a[160:175]
  ds_read_b64_tr_b16 v[76:77], v7 offset:1024
  buffer_load_dwordx4 v14, s[44:47], s30 offen offset:2048 lds
  buffer_load_dwordx4 v15, s[44:47], s30 offen offset:3072 lds
  v_mfma_f32_32x32x16_bf16 a[48:63], v[108:111], v[136:139], a[48:63]
  ds_read_b64_tr_b16 v[78:79], v7 offset:1536
  ds_read_b64_tr_b16 v[80:81], v6 offset:2048
  s_add_u32 s30, s30, 524288
  v_mfma_f32_32x32x16_bf16 a[176:191], v[108:111], v[140:143], a[176:191]
  ds_read_b64_tr_b16 v[82:83], v6 offset:2560
  s_add_u32 m0, s33, 32768
  s_nop 0
  buffer_load_dwordx4 v16, s[48:51], s32 offen offset:0 lds
  v_mfma_f32_32x32x16_bf16 a[64:79], v[136:139], v[112:115], a[64:79]
  ds_read_b64_tr_b16 v[84:85], v7 offset:2048
  ds_read_b64_tr_b16 v[86:87], v7 offset:2560
  buffer_load_dwordx4 v17, s[48:51], s32 offen offset:1024 lds
  v_mfma_f32_32x32x16_bf16 a[192:207], v[140:143], v[112:115], a[192:207]
  ds_read_b64_tr_b16 v[88:89], v6 offset:3072
  buffer_load_dwordx4 v18, s[48:51], s32 offen offset:2048 lds
  v_mfma_f32_32x32x16_bf16 a[80:95], v[136:139], v[116:119], a[80:95]
  ds_read_b64_tr_b16 v[90:91], v6 offset:3584
  ds_read_b64_tr_b16 v[92:93], v7 offset:3072
  buffer_load_dwordx4 v19, s[48:51], s32 offen offset:3072 lds
  s_add_u32 m0, s33, 36864
  s_nop 0
  buffer_load_dwordx4 v20, s[48:51], s32 offen offset:0 lds
  v_mfma_f32_32x32x16_bf16 a[208:223], v[140:143], v[116:119], a[208:223]
  ds_read_b64_tr_b16 v[94:95], v7 offset:3584
  buffer_load_dwordx4 v21, s[48:51], s32 offen offset:1024 lds
  v_mfma_f32_32x32x16_bf16 a[96:111], v[136:139], v[120:123], a[96:111]
  buffer_load_dwordx4 v22, s[48:51], s32 offen offset:2048 lds
  v_mfma_f32_32x32x16_bf16 a[224:239], v[140:143], v[120:123], a[224:239]
  buffer_load_dwordx4 v23, s[48:51], s32 offen offset:3072 lds
  v_mfma_f32_32x32x16_bf16 a[112:127], v[136:139], v[124:127], a[112:127]
  s_add_u32 s32, s32, 128
  v_mfma_f32_32x32x16_bf16 a[240:255], v[140:143], v[124:127], a[240:255]
  s_waitcnt lgkmcnt(0)
  v_mfma_f32_32x32x16_bf16 a[0:15], v[64:67], v[128:131], a[0:15]
  ds_read_b128 v[136:139], v25 offset:0
  ds_read_b128 v[140:143], v25 offset:4096
  s_waitcnt vmcnt(17)
  v_lshlrev_b32 v192, 16, v144
  v_and_b32 v193, 0xffff0000, v144
  v_mfma_f32_32x32x16_bf16 a[128:143], v[64:67], v[132:135], a[128:143]
  ds_read_b64_tr_b16 v[96:97], v6 offset:8192
  v_lshlrev_b32 v194, 16, v145
  v_and_b32 v195, 0xffff0000, v145
  v_mfma_f32_32x32x16_bf16 a[16:31], v[68:71], v[128:131], a[16:31]
  ds_read_b64_tr_b16 v[98:99], v6 offset:8704
  ds_read_b64_tr_b16 v[100:101], v7 offset:8192
  v_lshlrev_b32 v196, 16, v146
  v_and_b32 v197, 0xffff0000, v146
  v_lshlrev_b32 v198, 16, v147
  v_mfma_f32_32x32x16_bf16 a[144:159], v[68:71], v[132:135], a[144:159]
  ds_read_b64_tr_b16 v[102:103], v7 offset:8704
  v_and_b32 v199, 0xffff0000, v147
  v_lshlrev_b32 v200, 16, v148
  v_mfma_f32_32x32x16_bf16 a[32:47], v[72:75], v[128:131], a[32:47]
  ds_read_b64_tr_b16 v[104:105], v6 offset:9216
  ds_read_b64_tr_b16 v[106:107], v6 offset:9728
  v_and_b32 v201, 0xffff0000, v148
  v_lshlrev_b32 v202, 16, v149
  v_mfma_f32_32x32x16_bf16 a[160:175], v[72:75], v[132:135], a[160:175]
  ds_read_b64_tr_b16 v[108:109], v7 offset:9216
  v_and_b32 v203, 0xffff0000, v149
  v_lshlrev_b32 v204, 16, v150
  v_and_b32 v205, 0xffff0000, v150
  v_mfma_f32_32x32x16_bf16 a[48:63], v[76:79], v[128:131], a[48:63]
  ds_read_b64_tr_b16 v[110:111], v7 offset:9728
  ds_read_b64_tr_b16 v[112:113], v6 offset:10240
  v_lshlrev_b32 v206, 16, v151
  v_and_b32 v207, 0xffff0000, v151
  v_mfma_f32_32x32x16_bf16 a[176:191], v[76:79], v[132:135], a[176:191]
  ds_read_b64_tr_b16 v[114:115], v6 offset:10752
  v_lshlrev_b32 v208, 16, v152
  v_and_b32 v209, 0xffff0000, v152
  v_mfma_f32_32x32x16_bf16 a[64:79], v[128:131], v[80:83], a[64:79]
  ds_read_b64_tr_b16 v[116:117], v7 offset:10240
  ds_read_b64_tr_b16 v[118:119], v7 offset:10752
  v_lshlrev_b32 v210, 16, v153
  v_and_b32 v211, 0xffff0000, v153
  v_lshlrev_b32 v212, 16, v154
  v_mfma_f32_32x32x16_bf16 a[192:207], v[132:135], v[80:83], a[192:207]
  ds_read_b64_tr_b16 v[120:121], v6 offset:11264
  v_and_b32 v213, 0xffff0000, v154
  v_lshlrev_b32 v214, 16, v155
  v_mfma_f32_32x32x16_bf16 a[80:95], v[128:131], v[84:87], a[80:95]
  ds_read_b64_tr_b16 v[122:123], v6 offset:11776
  ds_read_b64_tr_b16 v[124:125], v7 offset:11264
  v_and_b32 v215, 0xffff0000, v155
  v_lshlrev_b32 v216, 16, v156
  v_and_b32 v217, 0xffff0000, v156
  v_mfma_f32_32x32x16_bf16 a[208:223], v[132:135], v[84:87], a[208:223]
  ds_read_b64_tr_b16 v[126:127], v7 offset:11776
  v_lshlrev_b32 v218, 16, v157
  v_and_b32 v219, 0xffff0000, v157
  v_mfma_f32_32x32x16_bf16 a[96:111], v[128:131], v[88:91], a[96:111]
  v_lshlrev_b32 v220, 16, v158
  v_and_b32 v221, 0xffff0000, v158
  v_mfma_f32_32x32x16_bf16 a[224:239], v[132:135], v[88:91], a[224:239]
  v_lshlrev_b32 v222, 16, v159
  v_and_b32 v223, 0xffff0000, v159
  v_add_f32 v244, v193, v192
  v_mfma_f32_32x32x16_bf16 a[112:127], v[128:131], v[92:95], a[112:127]
  v_add_f32 v245, v209, v208
  v_add_f32 v244, v194, v244
  v_mfma_f32_32x32x16_bf16 a[240:255], v[132:135], v[92:95], a[240:255]
  v_add_f32 v245, v210, v245
  v_add_f32 v244, v195, v244
  s_waitcnt lgkmcnt(0)
  v_mfma_f32_32x32x16_bf16 a[0:15], v[96:99], v[136:139], a[0:15]
  ds_read_b128 v[128:131], v26 offset:0
  ds_read_b128 v[132:135], v26 offset:4096
  v_add_f32 v245, v211, v245
  v_add_f32 v244, v196, v244
  v_add_f32 v245, v212, v245
  v_mfma_f32_32x32x16_bf16 a[128:143], v[96:99], v[140:143], a[128:143]
  ds_read_b64_tr_b16 v[64:65], v6 offset:16384
  v_add_f32 v244, v197, v244
  v_add_f32 v245, v213, v245
  v_mfma_f32_32x32x16_bf16 a[16:31], v[100:103], v[136:139], a[16:31]
  ds_read_b64_tr_b16 v[66:67], v6 offset:16896
  ds_read_b64_tr_b16 v[68:69], v7 offset:16384
  v_add_f32 v244, v198, v244
  v_add_f32 v245, v214, v245
  v_mfma_f32_32x32x16_bf16 a[144:159], v[100:103], v[140:143], a[144:159]
  ds_read_b64_tr_b16 v[70:71], v7 offset:16896
  v_add_f32 v244, v199, v244
  v_add_f32 v245, v215, v245
  v_add_f32 v244, v200, v244
  v_mfma_f32_32x32x16_bf16 a[32:47], v[104:107], v[136:139], a[32:47]
  ds_read_b64_tr_b16 v[72:73], v6 offset:17408
  ds_read_b64_tr_b16 v[74:75], v6 offset:17920
  v_add_f32 v245, v216, v245
  v_add_f32 v244, v201, v244
  v_mfma_f32_32x32x16_bf16 a[160:175], v[104:107], v[140:143], a[160:175]
  ds_read_b64_tr_b16 v[76:77], v7 offset:17408
  v_add_f32 v245, v217, v245
  v_add_f32 v244, v202, v244
  v_mfma_f32_32x32x16_bf16 a[48:63], v[108:111], v[136:139], a[48:63]
  ds_read_b64_tr_b16 v[78:79], v7 offset:17920
  ds_read_b64_tr_b16 v[80:81], v6 offset:18432
  v_add_f32 v245, v218, v245
  v_add_f32 v244, v203, v244
  v_add_f32 v245, v219, v245
  v_mfma_f32_32x32x16_bf16 a[176:191], v[108:111], v[140:143], a[176:191]
  ds_read_b64_tr_b16 v[82:83], v6 offset:18944
  v_add_f32 v244, v204, v244
  v_add_f32 v245, v220, v245
  v_mfma_f32_32x32x16_bf16 a[64:79], v[136:139], v[112:115], a[64:79]
  ds_read_b64_tr_b16 v[84:85], v7 offset:18432
  ds_read_b64_tr_b16 v[86:87], v7 offset:18944
  v_add_f32 v244, v205, v244
  v_add_f32 v245, v221, v245
  v_mfma_f32_32x32x16_bf16 a[192:207], v[140:143], v[112:115], a[192:207]
  ds_read_b64_tr_b16 v[88:89], v6 offset:19456
  v_add_f32 v244, v206, v244
  v_add_f32 v245, v222, v245
  v_add_f32 v244, v207, v244
  v_mfma_f32_32x32x16_bf16 a[80:95], v[136:139], v[116:119], a[80:95]
  ds_read_b64_tr_b16 v[90:91], v6 offset:19968
  ds_read_b64_tr_b16 v[92:93], v7 offset:19456
  v_add_f32 v245, v223, v245
  s_nop 0
  v_mfma_f32_32x32x16_bf16 a[208:223], v[140:143], v[116:119], a[208:223]
  ds_read_b64_tr_b16 v[94:95], v7 offset:19968
  v_add_f32_dpp v244, v244, v244 row_ror:1 row_mask:0xf bank_mask:0xf
  v_add_f32_dpp v245, v245, v245 row_ror:1 row_mask:0xf bank_mask:0xf
  v_mfma_f32_32x32x16_bf16 a[96:111], v[136:139], v[120:123], a[96:111]
  s_nop 0
  v_add_f32_dpp v244, v244, v244 row_ror:2 row_mask:0xf bank_mask:0xf
  v_add_f32_dpp v245, v245, v245 row_ror:2 row_mask:0xf bank_mask:0xf
  v_mfma_f32_32x32x16_bf16 a[224:239], v[140:143], v[120:123], a[224:239]
  s_nop 0
  v_add_f32_dpp v244, v244, v244 row_ror:4 row_mask:0xf bank_mask:0xf
  v_mfma_f32_32x32x16_bf16 a[112:127], v[136:139], v[124:127], a[112:127]
  v_add_f32_dpp v245, v245, v245 row_ror:4 row_mask:0xf bank_mask:0xf
  s_nop 0
  v_mfma_f32_32x32x16_bf16 a[240:255], v[140:143], v[124:127], a[240:255]
  v_add_f32_dpp v244, v244, v244 row_ror:8 row_mask:0xf bank_mask:0xf
  v_add_f32_dpp v245, v245, v245 row_ror:8 row_mask:0xf bank_mask:0xf
  s_waitcnt lgkmcnt(0)
  v_mfma_f32_32x32x16_bf16 a[0:15], v[64:67], v[128:131], a[0:15]
  ds_read_b128 v[136:139], v27 offset:0
  ds_read_b128 v[140:143], v27 offset:4096
  v_mov_b32 v246, v244
  v_mov_b32 v247, v245
  s_nop 1
  v_mfma_f32_32x32x16_bf16 a[128:143], v[64:67], v[132:135], a[128:143]
  ds_read_b64_tr_b16 v[96:97], v6 offset:24576
  v_permlane16_swap_b32 v244, v246
  v_permlane16_swap_b32 v245, v247
  v_mfma_f32_32x32x16_bf16 a[16:31], v[68:71], v[128:131], a[16:31]
  ds_read_b64_tr_b16 v[98:99], v6 offset:25088
  ds_read_b64_tr_b16 v[100:101], v7 offset:24576
  s_nop 1
  v_add_f32 v244, v244, v246
  v_mfma_f32_32x32x16_bf16 a[144:159], v[68:71], v[132:135], a[144:159]
  ds_read_b64_tr_b16 v[102:103], v7 offset:25088
  v_add_f32 v245, v245, v247
  v_mov_b32 v246, v244
  v_mov_b32 v247, v245
  v_mfma_f32_32x32x16_bf16 a[32:47], v[72:75], v[128:131], a[32:47]
  ds_read_b64_tr_b16 v[104:105], v6 offset:25600
  ds_read_b64_tr_b16 v[106:107], v6 offset:26112
  s_nop 1
  v_permlane32_swap_b32 v244, v246
  v_mfma_f32_32x32x16_bf16 a[160:175], v[72:75], v[132:135], a[160:175]
  ds_read_b64_tr_b16 v[108:109], v7 offset:25600
  v_permlane32_swap_b32 v245, v247
  s_nop 1
  v_mfma_f32_32x32x16_bf16 a[48:63], v[76:79], v[128:131], a[48:63]
  ds_read_b64_tr_b16 v[110:111], v7 offset:26112
  ds_read_b64_tr_b16 v[112:113], v6 offset:26624
  v_add_f32 v244, v244, v246
  v_add_f32 v245, v245, v247
  v_mul_f32 v244, 0x3a800000, v244
  v_mfma_f32_32x32x16_bf16 a[176:191], v[76:79], v[132:135], a[176:191]
  ds_read_b64_tr_b16 v[114:115], v6 offset:27136
  v_mul_f32 v245, 0x3a800000, v245
  v_sub_f32 v192, v192, v244
  v_mfma_f32_32x32x16_bf16 a[64:79], v[128:131], v[80:83], a[64:79]
  ds_read_b64_tr_b16 v[116:117], v7 offset:26624
  ds_read_b64_tr_b16 v[118:119], v7 offset:27136
  v_sub_f32 v208, v208, v245
  v_sub_f32 v193, v193, v244
  v_mfma_f32_32x32x16_bf16 a[192:207], v[132:135], v[80:83], a[192:207]
  ds_read_b64_tr_b16 v[120:121], v6 offset:27648
  v_sub_f32 v209, v209, v245
  v_sub_f32 v194, v194, v244
  v_sub_f32 v210, v210, v245
  v_mfma_f32_32x32x16_bf16 a[80:95], v[128:131], v[84:87], a[80:95]
  ds_read_b64_tr_b16 v[122:123], v6 offset:28160
  ds_read_b64_tr_b16 v[124:125], v7 offset:27648
  v_sub_f32 v195, v195, v244
  v_sub_f32 v211, v211, v245
  v_mfma_f32_32x32x16_bf16 a[208:223], v[132:135], v[84:87], a[208:223]
  ds_read_b64_tr_b16 v[126:127], v7 offset:28160
  v_sub_f32 v196, v196, v244
  v_sub_f32 v212, v212, v245
  v_mfma_f32_32x32x16_bf16 a[96:111], v[128:131], v[88:91], a[96:111]
  v_sub_f32 v197, v197, v244
  v_sub_f32 v213, v213, v245
  v_sub_f32 v198, v198, v244
  v_mfma_f32_32x32x16_bf16 a[224:239], v[132:135], v[88:91], a[224:239]
  v_sub_f32 v214, v214, v245
  v_sub_f32 v199, v199, v244
  v_mfma_f32_32x32x16_bf16 a[112:127], v[128:131], v[92:95], a[112:127]
  v_sub_f32 v215, v215, v245
  v_sub_f32 v200, v200, v244
  v_mfma_f32_32x32x16_bf16 a[240:255], v[132:135], v[92:95], a[240:255]
  v_sub_f32 v216, v216, v245
  v_sub_f32 v201, v201, v244
  s_waitcnt vmcnt(0) lgkmcnt(0)
  s_barrier
  v_mfma_f32_32x32x16_bf16 a[0:15], v[96:99], v[136:139], a[0:15]
  ds_read_b128 v[128:131], v24 offset:32768
  ds_read_b128 v[132:135], v24 offset:36864
  s_add_u32 m0, s31, 0
  s_nop 0
  buffer_load_dwordx4 v8, s[40:43], s30 offen offset:0 lds
  buffer_load_dwordx4 v9, s[40:43], s30 offen offset:1024 lds
  v_sub_f32 v217, v217, v245
  v_sub_f32 v202, v202, v244
  v_sub_f32 v218, v218, v245
  v_mfma_f32_32x32x16_bf16 a[128:143], v[96:99], v[140:143], a[128:143]
  ds_read_b64_tr_b16 v[64:65], v6 offset:32768
  buffer_load_dwordx4 v10, s[44:47], s30 offen offset:2048 lds
  v_sub_f32 v203, v203, v244
  v_sub_f32 v219, v219, v245
  v_mfma_f32_32x32x16_bf16 a[16:31], v[100:103], v[136:139], a[16:31]
  ds_read_b64_tr_b16 v[66:67], v6 offset:33280
  ds_read_b64_tr_b16 v[68:69], v7 offset:32768
  buffer_load_dwordx4 v11, s[44:47], s30 offen offset:3072 lds
  v_sub_f32 v204, v204, v244
  v_sub_f32 v220, v220, v245
  v_mfma_f32_32x32x16_bf16 a[144:159], v[100:103], v[140:143], a[144:159]
  ds_read_b64_tr_b16 v[70:71], v7 offset:33280
  s_add_u32 m0, s31, 4096
  s_nop 0
  buffer_load_dwordx4 v12, s[40:43], s30 offen offset:0 lds
  v_sub_f32 v205, v205, v244
  v_sub_f32 v221, v221, v245
  v_sub_f32 v206, v206, v244
  v_mfma_f32_32x32x16_bf16 a[32:47], v[104:107], v[136:139], a[32:47]
  ds_read_b64_tr_b16 v[72:73], v6 offset:33792
  ds_read_b64_tr_b16 v[74:75], v6 offset:34304
  buffer_load_dwordx4 v13, s[40:43], s30 offen offset:1024 lds
  v_sub_f32 v222, v222, v245
  v_sub_f32 v207, v207, v244
  v_mfma_f32_32x32x16_bf16 a[160:175], v[104:107], v[140:143], a[160:175]
  ds_read_b64_tr_b16 v[76:77], v7 offset:33792
  buffer_load_dwordx4 v14, s[44:47], s30 offen offset:2048 lds
  buffer_load_dwordx4 v15, s[44:47], s30 offen offset:3072 lds
  v_sub_f32 v223, v223, v245
  v_mul_f32 v248, v192, v192
  v_mfma_f32_32x32x16_bf16 a[48:63], v[108:111], v[136:139], a[48:63]
  ds_read_b64_tr_b16 v[78:79], v7 offset:34304
  ds_read_b64_tr_b16 v[80:81], v6 offset:34816
  s_add_u32 s30, s30, 524288
  v_mul_f32 v249, v208, v208
  v_fmac_f32 v248, v193, v193
  v_fmac_f32 v249, v209, v209
  v_mfma_f32_32x32x16_bf16 a[176:191], v[108:111], v[140:143], a[176:191]
  ds_read_b64_tr_b16 v[82:83], v6 offset:35328
  s_add_u32 m0, s33, 0
  s_nop 0
  buffer_load_dwordx4 v16, s[48:51], s32 offen offset:0 lds
  v_fmac_f32 v248, v194, v194
  v_fmac_f32 v249, v210, v210
  v_mfma_f32_32x32x16_bf16 a[64:79], v[136:139], v[112:115], a[64:79]
  ds_read_b64_tr_b16 v[84:85], v7 offset:34816
  ds_read_b64_tr_b16 v[86:87], v7 offset:35328
  buffer_load_dwordx4 v17, s[48:51], s32 offen offset:1024 lds
  v_fmac_f32 v248, v195, v195
  v_fmac_f32 v249, v211, v211
  v_mfma_f32_32x32x16_bf16 a[192:207], v[140:143], v[112:115], a[192:207]
  ds_read_b64_tr_b16 v[88:89], v6 offset:35840
  buffer_load_dwordx4 v18, s[48:51], s32 offen offset:2048 lds
  v_fmac_f32 v248, v196, v196
  v_fmac_f32 v249, v212, v212
  v_fmac_f32 v248, v197, v197
  v_mfma_f32_32x32x16_bf16 a[80:95], v[136:139], v[116:119], a[80:95]
  ds_read_b64_tr_b16 v[90:91], v6 offset:36352
  ds_read_b64_tr_b16 v[92:93], v7 offset:35840
  buffer_load_dwordx4 v19, s[48:51], s32 offen offset:3072 lds
  s_add_u32 m0, s33, 4096
  s_nop 0
  buffer_load_dwordx4 v20, s[48:51], s32 offen offset:0 lds
  v_fmac_f32 v249, v213, v213
  v_fmac_f32 v248, v198, v198
  v_mfma_f32_32x32x16_bf16 a[208:223], v[140:143], v[116:119], a[208:223]
  ds_read_b64_tr_b16 v[94:95], v7 offset:36352
  buffer_load_dwordx4 v21, s[48:51], s32 offen offset:1024 lds
  v_fmac_f32 v249, v214, v214
  v_fmac_f32 v248, v199, v199
  v_mfma_f32_32x32x16_bf16 a[96:111], v[136:139], v[120:123], a[96:111]
  buffer_load_dwordx4 v22, s[48:51], s32 offen offset:2048 lds
  v_fmac_f32 v249, v215, v215
  v_fmac_f32 v248, v200, v200
  v_fmac_f32 v249, v216, v216
  v_mfma_f32_32x32x16_bf16 a[224:239], v[140:143], v[120:123], a[224:239]
  buffer_load_dwordx4 v23, s[48:51], s32 offen offset:3072 lds
  v_fmac_f32 v248, v201, v201
  v_fmac_f32 v249, v217, v217
  v_mfma_f32_32x32x16_bf16 a[112:127], v[136:139], v[124:127], a[112:127]
  s_add_u32 s32, s32, 128
  v_fmac_f32 v248, v202, v202
  v_fmac_f32 v249, v218, v218
  v_mfma_f32_32x32x16_bf16 a[240:255], v[140:143], v[124:127], a[240:255]
  v_fmac_f32 v248, v203, v203
  v_fmac_f32 v249, v219, v219
  s_waitcnt lgkmcnt(0)
  v_mfma_f32_32x32x16_bf16 a[0:15], v[64:67], v[128:131], a[0:15]
  ds_read_b128 v[136:139], v25 offset:32768
  ds_read_b128 v[140:143], v25 offset:36864
  v_lshrrev_b32 v252, 3, v0
  v_lshlrev_b32 v252, 13, v252
  v_and_b32 v253, 7, v0
  v_lshl_add_u32 v252, v253, 7, v252
  s_lshl_b32 s34, s25, 18
  s_lshl_b32 s36, s24, 10
  s_add_u32 s34, s34, s36
  s_add_u32 s34, s34, 4096
  s_cmp_lt_u32 s3, 2
  s_cselect_b32 s96, 2130706432, s34
  s_cselect_b32 s34, s34, 2130706432
  buffer_load_dword v29, v252, s[72:75], s34 offen
  v_fmac_f32 v248, v204, v204
  v_mfma_f32_32x32x16_bf16 a[128:143], v[64:67], v[132:135], a[128:143]
  ds_read_b64_tr_b16 v[96:97], v6 offset:40960
  v_fmac_f32 v249, v220, v220
  v_fmac_f32 v248, v205, v205
  v_mfma_f32_32x32x16_bf16 a[16:31], v[68:71], v[128:131], a[16:31]
  ds_read_b64_tr_b16 v[98:99], v6 offset:41472
  ds_read_b64_tr_b16 v[100:101], v7 offset:40960
  v_fmac_f32 v249, v221, v221
  v_fmac_f32 v248, v206, v206
  v_fmac_f32 v249, v222, v222
  v_mfma_f32_32x32x16_bf16 a[144:159], v[68:71], v[132:135], a[144:159]
  ds_read_b64_tr_b16 v[102:103], v7 offset:41472
  v_fmac_f32 v248, v207, v207
  v_fmac_f32 v249, v223, v223
  v_mfma_f32_32x32x16_bf16 a[32:47], v[72:75], v[128:131], a[32:47]
  ds_read_b64_tr_b16 v[104:105], v6 offset:41984
  ds_read_b64_tr_b16 v[106:107], v6 offset:42496
  s_nop 0
  v_add_f32_dpp v248, v248, v248 row_ror:1 row_mask:0xf bank_mask:0xf
  v_add_f32_dpp v249, v249, v249 row_ror:1 row_mask:0xf bank_mask:0xf
  v_mfma_f32_32x32x16_bf16 a[160:175], v[72:75], v[132:135], a[160:175]
  ds_read_b64_tr_b16 v[108:109], v7 offset:41984
  s_nop 0
  v_add_f32_dpp v248, v248, v248 row_ror:2 row_mask:0xf bank_mask:0xf
  v_mfma_f32_32x32x16_bf16 a[48:63], v[76:79], v[128:131], a[48:63]
  ds_read_b64_tr_b16 v[110:111], v7 offset:42496
  ds_read_b64_tr_b16 v[112:113], v6 offset:43008
  v_add_f32_dpp v249, v249, v249 row_ror:2 row_mask:0xf bank_mask:0xf
  s_nop 0
  v_add_f32_dpp v248, v248, v248 row_ror:4 row_mask:0xf bank_mask:0xf
  v_mfma_f32_32x32x16_bf16 a[176:191], v[76:79], v[132:135], a[176:191]
  ds_read_b64_tr_b16 v[114:115], v6 offset:43520
  v_add_f32_dpp v249, v249, v249 row_ror:4 row_mask:0xf bank_mask:0xf
  s_nop 0
  v_mfma_f32_32x32x16_bf16 a[64:79], v[128:131], v[80:83], a[64:79]
  ds_read_b64_tr_b16 v[116:117], v7 offset:43008
  ds_read_b64_tr_b16 v[118:119], v7 offset:43520
  v_add_f32_dpp v248, v248, v248 row_ror:8 row_mask:0xf bank_mask:0xf
  v_add_f32_dpp v249, v249, v249 row_ror:8 row_mask:0xf bank_mask:0xf
  v_mfma_f32_32x32x16_bf16 a[192:207], v[132:135], v[80:83], a[192:207]
  ds_read_b64_tr_b16 v[120:121], v6 offset:44032
  v_mov_b32 v246, v248
  v_mov_b32 v247, v249
  s_nop 1
  v_mfma_f32_32x32x16_bf16 a[80:95], v[128:131], v[84:87], a[80:95]
  ds_read_b64_tr_b16 v[122:123], v6 offset:44544
  ds_read_b64_tr_b16 v[124:125], v7 offset:44032
  v_permlane16_swap_b32 v248, v246
  v_permlane16_swap_b32 v249, v247
  v_mfma_f32_32x32x16_bf16 a[208:223], v[132:135], v[84:87], a[208:223]
  ds_read_b64_tr_b16 v[126:127], v7 offset:44544
  s_nop 1
  v_add_f32 v248, v248, v246
  v_add_f32 v249, v249, v247
  v_mfma_f32_32x32x16_bf16 a[96:111], v[128:131], v[88:91], a[96:111]
  v_mov_b32 v246, v248
  v_mov_b32 v247, v249
  v_mfma_f32_32x32x16_bf16 a[224:239], v[132:135], v[88:91], a[224:239]
  s_nop 1
  v_permlane32_swap_b32 v248, v246
  v_permlane32_swap_b32 v249, v247
  v_mfma_f32_32x32x16_bf16 a[112:127], v[128:131], v[92:95], a[112:127]
  s_nop 1
  v_add_f32 v248, v248, v246
  v_mfma_f32_32x32x16_bf16 a[240:255], v[132:135], v[92:95], a[240:255]
  v_add_f32 v249, v249, v247
  v_mov_b32 v244, 0x3727c5ac
  s_waitcnt lgkmcnt(0)
  v_mfma_f32_32x32x16_bf16 a[0:15], v[96:99], v[136:139], a[0:15]
  ds_read_b128 v[128:131], v26 offset:32768
  ds_read_b128 v[132:135], v26 offset:36864
  v_mov_b32 v245, 0x3727c5ac
  v_fmac_f32 v244, 0x3a800000, v248
  v_fmac_f32 v245, 0x3a800000, v249
  v_mfma_f32_32x32x16_bf16 a[128:143], v[96:99], v[140:143], a[128:143]
  ds_read_b64_tr_b16 v[64:65], v6 offset:49152
  v_rsq_f32 v244, v244
  v_rsq_f32 v245, v245
  v_mfma_f32_32x32x16_bf16 a[16:31], v[100:103], v[136:139], a[16:31]
  ds_read_b64_tr_b16 v[66:67], v6 offset:49664
  ds_read_b64_tr_b16 v[68:69], v7 offset:49152
  s_nop 0
  v_mul_f32 v192, v192, v244
  v_mul_f32 v208, v208, v245
  v_mfma_f32_32x32x16_bf16 a[144:159], v[100:103], v[140:143], a[144:159]
  ds_read_b64_tr_b16 v[70:71], v7 offset:49664
  v_mul_f32 v193, v193, v244
  v_mul_f32 v209, v209, v245
  v_mfma_f32_32x32x16_bf16 a[32:47], v[104:107], v[136:139], a[32:47]
  ds_read_b64_tr_b16 v[72:73], v6 offset:50176
  ds_read_b64_tr_b16 v[74:75], v6 offset:50688
  v_mul_f32 v194, v194, v244
  v_mul_f32 v210, v210, v245
  v_mfma_f32_32x32x16_bf16 a[160:175], v[104:107], v[140:143], a[160:175]
  ds_read_b64_tr_b16 v[76:77], v7 offset:50176
  v_mul_f32 v195, v195, v244
  v_mul_f32 v211, v211, v245
  v_mul_f32 v196, v196, v244
  v_mfma_f32_32x32x16_bf16 a[48:63], v[108:111], v[136:139], a[48:63]
  ds_read_b64_tr_b16 v[78:79], v7 offset:50688
  ds_read_b64_tr_b16 v[80:81], v6 offset:51200
  v_mul_f32 v212, v212, v245
  v_mul_f32 v197, v197, v244
  v_mfma_f32_32x32x16_bf16 a[176:191], v[108:111], v[140:143], a[176:191]
  ds_read_b64_tr_b16 v[82:83], v6 offset:51712
  v_mul_f32 v213, v213, v245
  v_mul_f32 v198, v198, v244
  v_mfma_f32_32x32x16_bf16 a[64:79], v[136:139], v[112:115], a[64:79]
  ds_read_b64_tr_b16 v[84:85], v7 offset:51200
  ds_read_b64_tr_b16 v[86:87], v7 offset:51712
  v_mul_f32 v214, v214, v245
  v_mul_f32 v199, v199, v244
  v_mul_f32 v215, v215, v245
  v_mfma_f32_32x32x16_bf16 a[192:207], v[140:143], v[112:115], a[192:207]
  ds_read_b64_tr_b16 v[88:89], v6 offset:52224
  v_mul_f32 v200, v200, v244
  v_mul_f32 v216, v216, v245
  v_mfma_f32_32x32x16_bf16 a[80:95], v[136:139], v[116:119], a[80:95]
  ds_read_b64_tr_b16 v[90:91], v6 offset:52736
  ds_read_b64_tr_b16 v[92:93], v7 offset:52224
  v_mul_f32 v201, v201, v244
  v_mul_f32 v217, v217, v245
  v_mul_f32 v202, v202, v244
  v_mfma_f32_32x32x16_bf16 a[208:223], v[140:143], v[116:119], a[208:223]
  ds_read_b64_tr_b16 v[94:95], v7 offset:52736
  v_mul_f32 v218, v218, v245
  v_mul_f32 v203, v203, v244
  v_mfma_f32_32x32x16_bf16 a[96:111], v[136:139], v[120:123], a[96:111]
  v_mul_f32 v219, v219, v245
  v_mul_f32 v204, v204, v244
  v_mfma_f32_32x32x16_bf16 a[224:239], v[140:143], v[120:123], a[224:239]
  v_mul_f32 v220, v220, v245
  v_mul_f32 v205, v205, v244
  v_mul_f32 v221, v221, v245
  v_mfma_f32_32x32x16_bf16 a[112:127], v[136:139], v[124:127], a[112:127]
  v_mul_f32 v206, v206, v244
  v_mul_f32 v222, v222, v245
  v_mfma_f32_32x32x16_bf16 a[240:255], v[140:143], v[124:127], a[240:255]
  v_mul_f32 v207, v207, v244
  v_mul_f32 v223, v223, v245
  s_waitcnt lgkmcnt(0)
  v_mfma_f32_32x32x16_bf16 a[0:15], v[64:67], v[128:131], a[0:15]
  ds_read_b128 v[136:139], v27 offset:32768
  ds_read_b128 v[140:143], v27 offset:36864
  v_lshlrev_b32 v31, 2, v1
  buffer_load_dword v250, v31, s[64:67], 0 offen sc1
  v_mfma_f32_32x32x16_bf16 a[128:143], v[64:67], v[132:135], a[128:143]
  ds_read_b64_tr_b16 v[96:97], v6 offset:57344
  v_mfma_f32_32x32x16_bf16 a[16:31], v[68:71], v[128:131], a[16:31]
  ds_read_b64_tr_b16 v[98:99], v6 offset:57856
  ds_read_b64_tr_b16 v[100:101], v7 offset:57344
  v_mfma_f32_32x32x16_bf16 a[144:159], v[68:71], v[132:135], a[144:159]
  ds_read_b64_tr_b16 v[102:103], v7 offset:57856
  v_mfma_f32_32x32x16_bf16 a[32:47], v[72:75], v[128:131], a[32:47]
  ds_read_b64_tr_b16 v[104:105], v6 offset:58368
  ds_read_b64_tr_b16 v[106:107], v6 offset:58880
  v_mfma_f32_32x32x16_bf16 a[160:175], v[72:75], v[132:135], a[160:175]
  ds_read_b64_tr_b16 v[108:109], v7 offset:58368
  v_mfma_f32_32x32x16_bf16 a[48:63], v[76:79], v[128:131], a[48:63]
  ds_read_b64_tr_b16 v[110:111], v7 offset:58880
  ds_read_b64_tr_b16 v[112:113], v6 offset:59392
  v_mfma_f32_32x32x16_bf16 a[176:191], v[76:79], v[132:135], a[176:191]
  ds_read_b64_tr_b16 v[114:115], v6 offset:59904
  v_mfma_f32_32x32x16_bf16 a[64:79], v[128:131], v[80:83], a[64:79]
  ds_read_b64_tr_b16 v[116:117], v7 offset:59392
  ds_read_b64_tr_b16 v[118:119], v7 offset:59904
  v_mfma_f32_32x32x16_bf16 a[192:207], v[132:135], v[80:83], a[192:207]
  ds_read_b64_tr_b16 v[120:121], v6 offset:60416
  v_mfma_f32_32x32x16_bf16 a[80:95], v[128:131], v[84:87], a[80:95]
  ds_read_b64_tr_b16 v[122:123], v6 offset:60928
  ds_read_b64_tr_b16 v[124:125], v7 offset:60416
  v_mfma_f32_32x32x16_bf16 a[208:223], v[132:135], v[84:87], a[208:223]
  ds_read_b64_tr_b16 v[126:127], v7 offset:60928
  v_mfma_f32_32x32x16_bf16 a[96:111], v[128:131], v[88:91], a[96:111]
  v_mfma_f32_32x32x16_bf16 a[224:239], v[132:135], v[88:91], a[224:239]
  v_mfma_f32_32x32x16_bf16 a[112:127], v[128:131], v[92:95], a[112:127]
  v_mfma_f32_32x32x16_bf16 a[240:255], v[132:135], v[92:95], a[240:255]
  s_waitcnt vmcnt(2) lgkmcnt(0)
  s_barrier
  v_mfma_f32_32x32x16_bf16 a[0:15], v[96:99], v[136:139], a[0:15]
  ds_read_b128 v[128:131], v24 offset:0
  ds_read_b128 v[132:135], v24 offset:4096
  s_add_u32 m0, s31, 32768
  s_nop 0
  buffer_load_dwordx4 v8, s[40:43], s30 offen offset:0 lds
  buffer_load_dwordx4 v9, s[40:43], s30 offen offset:1024 lds
  s_waitcnt vmcnt(2)
  v_cmp_ne_u32 vcc, 0x01010101, v250
  s_cbranch_vccnz kv_m_sp
kv_m_ok:
  v_mfma_f32_32x32x16_bf16 a[128:143], v[96:99], v[140:143], a[128:143]
  ds_read_b64_tr_b16 v[64:65], v6 offset:0
  buffer_load_dwordx4 v10, s[44:47], s30 offen offset:2048 lds
  v_lshlrev_b32 v2, 5, v0
  s_mov_b32 s34, 65536
  v_mfma_f32_32x32x16_bf16 a[16:31], v[100:103], v[136:139], a[16:31]
  ds_read_b64_tr_b16 v[66:67], v6 offset:512
  ds_read_b64_tr_b16 v[68:69], v7 offset:0
  buffer_load_dwordx4 v11, s[44:47], s30 offen offset:3072 lds
  buffer_load_dwordx4 v[32:35], v2, s[68:71], s34 offen sc1
  v_mfma_f32_32x32x16_bf16 a[144:159], v[100:103], v[140:143], a[144:159]
  ds_read_b64_tr_b16 v[70:71], v7 offset:512
  s_add_u32 m0, s31, 36864
  s_nop 0
  buffer_load_dwordx4 v12, s[40:43], s30 offen offset:0 lds
  v_mfma_f32_32x32x16_bf16 a[32:47], v[104:107], v[136:139], a[32:47]
  ds_read_b64_tr_b16 v[72:73], v6 offset:1024
  ds_read_b64_tr_b16 v[74:75], v6 offset:1536
  buffer_load_dwordx4 v13, s[40:43], s30 offen offset:1024 lds
  buffer_load_dwordx4 v[36:39], v2, s[68:71], s34 offen offset:16 sc1
  s_add_u32 s34, s34, 8192
  v_mfma_f32_32x32x16_bf16 a[160:175], v[104:107], v[140:143], a[160:175]
  ds_read_b64_tr_b16 v[76:77], v7 offset:1024
  buffer_load_dwordx4 v14, s[44:47], s30 offen offset:2048 lds
  buffer_load_dwordx4 v15, s[44:47], s30 offen offset:3072 lds
  buffer_load_dwordx4 v[40:43], v2, s[68:71], s34 offen sc1
  v_mfma_f32_32x32x16_bf16 a[48:63], v[108:111], v[136:139], a[48:63]
  ds_read_b64_tr_b16 v[78:79], v7 offset:1536
  ds_read_b64_tr_b16 v[80:81], v6 offset:2048
  s_add_u32 s30, s30, 524288
  v_mfma_f32_32x32x16_bf16 a[176:191], v[108:111], v[140:143], a[176:191]
  ds_read_b64_tr_b16 v[82:83], v6 offset:2560
  s_add_u32 m0, s33, 32768
  s_nop 0
  buffer_load_dwordx4 v16, s[48:51], s32 offen offset:0 lds
  buffer_load_dwordx4 v[44:47], v2, s[68:71], s34 offen offset:16 sc1
  s_add_u32 s34, s34, 8192
  v_mfma_f32_32x32x16_bf16 a[64:79], v[136:139], v[112:115], a[64:79]
  ds_read_b64_tr_b16 v[84:85], v7 offset:2048
  ds_read_b64_tr_b16 v[86:87], v7 offset:2560
  buffer_load_dwordx4 v17, s[48:51], s32 offen offset:1024 lds
  buffer_load_dwordx4 v[48:51], v2, s[68:71], s34 offen sc1
  v_mfma_f32_32x32x16_bf16 a[192:207], v[140:143], v[112:115], a[192:207]
  ds_read_b64_tr_b16 v[88:89], v6 offset:3072
  buffer_load_dwordx4 v18, s[48:51], s32 offen offset:2048 lds
  v_mfma_f32_32x32x16_bf16 a[80:95], v[136:139], v[116:119], a[80:95]
  ds_read_b64_tr_b16 v[90:91], v6 offset:3584
  ds_read_b64_tr_b16 v[92:93], v7 offset:3072
  buffer_load_dwordx4 v19, s[48:51], s32 offen offset:3072 lds
  s_add_u32 m0, s33, 36864
  s_nop 0
  buffer_load_dwordx4 v20, s[48:51], s32 offen offset:0 lds
  buffer_load_dwordx4 v[52:55], v2, s[68:71], s34 offen offset:16 sc1
  s_add_u32 s34, s34, 8192
  v_mfma_f32_32x32x16_bf16 a[208:223], v[140:143], v[116:119], a[208:223]
  ds_read_b64_tr_b16 v[94:95], v7 offset:3584
  buffer_load_dwordx4 v21, s[48:51], s32 offen offset:1024 lds
  buffer_load_dwordx4 v[56:59], v2, s[68:71], s34 offen sc1
  v_mfma_f32_32x32x16_bf16 a[96:111], v[136:139], v[120:123], a[96:111]
  buffer_load_dwordx4 v22, s[48:51], s32 offen offset:2048 lds
  v_mfma_f32_32x32x16_bf16 a[224:239], v[140:143], v[120:123], a[224:239]
  buffer_load_dwordx4 v23, s[48:51], s32 offen offset:3072 lds
  buffer_load_dwordx4 v[60:63], v2, s[68:71], s34 offen offset:16 sc1
  s_add_u32 s34, s34, 8192
  v_mfma_f32_32x32x16_bf16 a[112:127], v[136:139], v[124:127], a[112:127]
  s_add_u32 s32, s32, 128
  v_mfma_f32_32x32x16_bf16 a[240:255], v[140:143], v[124:127], a[240:255]
  s_waitcnt lgkmcnt(0)
  v_mfma_f32_32x32x16_bf16 a[0:15], v[64:67], v[128:131], a[0:15]
  ds_read_b128 v[136:139], v25 offset:0
  ds_read_b128 v[140:143], v25 offset:4096
  buffer_load_dword v29, v252, s[72:75], s96 offen
  v_mfma_f32_32x32x16_bf16 a[128:143], v[64:67], v[132:135], a[128:143]
  ds_read_b64_tr_b16 v[96:97], v6 offset:8192
  v_mfma_f32_32x32x16_bf16 a[16:31], v[68:71], v[128:131], a[16:31]
  ds_read_b64_tr_b16 v[98:99], v6 offset:8704
  ds_read_b64_tr_b16 v[100:101], v7 offset:8192
  v_mfma_f32_32x32x16_bf16 a[144:159], v[68:71], v[132:135], a[144:159]
  ds_read_b64_tr_b16 v[102:103], v7 offset:8704
  v_mfma_f32_32x32x16_bf16 a[32:47], v[72:75], v[128:131], a[32:47]
  ds_read_b64_tr_b16 v[104:105], v6 offset:9216
  ds_read_b64_tr_b16 v[106:107], v6 offset:9728
  v_mfma_f32_32x32x16_bf16 a[160:175], v[72:75], v[132:135], a[160:175]
  ds_read_b64_tr_b16 v[108:109], v7 offset:9216
  v_mfma_f32_32x32x16_bf16 a[48:63], v[76:79], v[128:131], a[48:63]
  ds_read_b64_tr_b16 v[110:111], v7 offset:9728
  ds_read_b64_tr_b16 v[112:113], v6 offset:10240
  v_mfma_f32_32x32x16_bf16 a[176:191], v[76:79], v[132:135], a[176:191]
  ds_read_b64_tr_b16 v[114:115], v6 offset:10752
  v_mfma_f32_32x32x16_bf16 a[64:79], v[128:131], v[80:83], a[64:79]
  ds_read_b64_tr_b16 v[116:117], v7 offset:10240
  ds_read_b64_tr_b16 v[118:119], v7 offset:10752
  v_mfma_f32_32x32x16_bf16 a[192:207], v[132:135], v[80:83], a[192:207]
  ds_read_b64_tr_b16 v[120:121], v6 offset:11264
  v_mfma_f32_32x32x16_bf16 a[80:95], v[128:131], v[84:87], a[80:95]
  ds_read_b64_tr_b16 v[122:123], v6 offset:11776
  ds_read_b64_tr_b16 v[124:125], v7 offset:11264
  v_mfma_f32_32x32x16_bf16 a[208:223], v[132:135], v[84:87], a[208:223]
  ds_read_b64_tr_b16 v[126:127], v7 offset:11776
  v_mfma_f32_32x32x16_bf16 a[96:111], v[128:131], v[88:91], a[96:111]
  v_mfma_f32_32x32x16_bf16 a[224:239], v[132:135], v[88:91], a[224:239]
  v_mfma_f32_32x32x16_bf16 a[112:127], v[128:131], v[92:95], a[112:127]
  v_mfma_f32_32x32x16_bf16 a[240:255], v[132:135], v[92:95], a[240:255]
  s_waitcnt lgkmcnt(0)
  v_mfma_f32_32x32x16_bf16 a[0:15], v[96:99], v[136:139], a[0:15]
  ds_read_b128 v[128:131], v26 offset:0
  ds_read_b128 v[132:135], v26 offset:4096
  s_waitcnt vmcnt(1)
  s_cmp_ge_u32 s3, 2
  s_cselect_b32 s34, 1.0, 0
  v_add_f32 v32, v32, v40
  v_mfma_f32_32x32x16_bf16 a[128:143], v[96:99], v[140:143], a[128:143]
  ds_read_b64_tr_b16 v[64:65], v6 offset:16384
  v_add_f32 v33, v33, v41
  v_add_f32 v34, v34, v42
  v_mfma_f32_32x32x16_bf16 a[16:31], v[100:103], v[136:139], a[16:31]
  ds_read_b64_tr_b16 v[66:67], v6 offset:16896
  ds_read_b64_tr_b16 v[68:69], v7 offset:16384
  v_add_f32 v35, v35, v43
  v_add_f32 v36, v36, v44
  v_add_f32 v37, v37, v45
  v_mfma_f32_32x32x16_bf16 a[144:159], v[100:103], v[140:143], a[144:159]
  ds_read_b64_tr_b16 v[70:71], v7 offset:16896
  v_add_f32 v38, v38, v46
  v_add_f32 v39, v39, v47
  v_mfma_f32_32x32x16_bf16 a[32:47], v[104:107], v[136:139], a[32:47]
  ds_read_b64_tr_b16 v[72:73], v6 offset:17408
  ds_read_b64_tr_b16 v[74:75], v6 offset:17920
  v_add_f32 v32, v32, v48
  v_add_f32 v33, v33, v49
  v_add_f32 v34, v34, v50
  v_mfma_f32_32x32x16_bf16 a[160:175], v[104:107], v[140:143], a[160:175]
  ds_read_b64_tr_b16 v[76:77], v7 offset:17408
  v_add_f32 v35, v35, v51
  v_add_f32 v36, v36, v52
  v_mfma_f32_32x32x16_bf16 a[48:63], v[108:111], v[136:139], a[48:63]
  ds_read_b64_tr_b16 v[78:79], v7 offset:17920
  ds_read_b64_tr_b16 v[80:81], v6 offset:18432
  v_add_f32 v37, v37, v53
  v_add_f32 v38, v38, v54
  v_add_f32 v39, v39, v55
  v_mfma_f32_32x32x16_bf16 a[176:191], v[108:111], v[140:143], a[176:191]
  ds_read_b64_tr_b16 v[82:83], v6 offset:18944
  v_add_f32 v32, v32, v56
  v_add_f32 v33, v33, v57
  v_mfma_f32_32x32x16_bf16 a[64:79], v[136:139], v[112:115], a[64:79]
  ds_read_b64_tr_b16 v[84:85], v7 offset:18432
  ds_read_b64_tr_b16 v[86:87], v7 offset:18944
  v_add_f32 v34, v34, v58
  v_add_f32 v35, v35, v59
  v_mfma_f32_32x32x16_bf16 a[192:207], v[140:143], v[112:115], a[192:207]
  ds_read_b64_tr_b16 v[88:89], v6 offset:19456
  v_add_f32 v36, v36, v60
  v_add_f32 v37, v37, v61
  v_add_f32 v38, v38, v62
  v_mfma_f32_32x32x16_bf16 a[80:95], v[136:139], v[116:119], a[80:95]
  ds_read_b64_tr_b16 v[90:91], v6 offset:19968
  ds_read_b64_tr_b16 v[92:93], v7 offset:19456
  v_add_f32 v39, v39, v63
  v_cvt_pk_bf16_f32 v32, v32, v32
  v_mfma_f32_32x32x16_bf16 a[208:223], v[140:143], v[116:119], a[208:223]
  ds_read_b64_tr_b16 v[94:95], v7 offset:19968
  v_cvt_pk_bf16_f32 v33, v33, v33
  v_cvt_pk_bf16_f32 v34, v34, v34
  v_cvt_pk_bf16_f32 v35, v35, v35
  v_mfma_f32_32x32x16_bf16 a[96:111], v[136:139], v[120:123], a[96:111]
  v_cvt_pk_bf16_f32 v36, v36, v36
  v_cvt_pk_bf16_f32 v37, v37, v37
  v_mfma_f32_32x32x16_bf16 a[224:239], v[140:143], v[120:123], a[224:239]
  v_cvt_pk_bf16_f32 v38, v38, v38
  v_cvt_pk_bf16_f32 v39, v39, v39
  v_and_b32 v32, 0xffff0000, v32
  v_mfma_f32_32x32x16_bf16 a[112:127], v[136:139], v[124:127], a[112:127]
  v_and_b32 v33, 0xffff0000, v33
  v_and_b32 v34, 0xffff0000, v34
  v_mfma_f32_32x32x16_bf16 a[240:255], v[140:143], v[124:127], a[240:255]
  v_and_b32 v35, 0xffff0000, v35
  v_and_b32 v36, 0xffff0000, v36
  s_waitcnt lgkmcnt(0)
  v_mfma_f32_32x32x16_bf16 a[0:15], v[64:67], v[128:131], a[0:15]
  ds_read_b128 v[136:139], v27 offset:0
  ds_read_b128 v[140:143], v27 offset:4096
  v_and_b32 v37, 0xffff0000, v37
  v_and_b32 v38, 0xffff0000, v38
  v_and_b32 v39, 0xffff0000, v39
  v_mfma_f32_32x32x16_bf16 a[128:143], v[64:67], v[132:135], a[128:143]
  ds_read_b64_tr_b16 v[96:97], v6 offset:24576
  v_add_f32 v32, s34, v32
  v_add_f32 v33, s34, v33
  v_mfma_f32_32x32x16_bf16 a[16:31], v[68:71], v[128:131], a[16:31]
  ds_read_b64_tr_b16 v[98:99], v6 offset:25088
  ds_read_b64_tr_b16 v[100:101], v7 offset:24576
  v_add_f32 v34, s34, v34
  v_add_f32 v35, s34, v35
  v_add_f32 v36, s34, v36
  v_mfma_f32_32x32x16_bf16 a[144:159], v[68:71], v[132:135], a[144:159]
  ds_read_b64_tr_b16 v[102:103], v7 offset:25088
  v_add_f32 v37, s34, v37
  v_add_f32 v38, s34, v38
  v_mfma_f32_32x32x16_bf16 a[32:47], v[72:75], v[128:131], a[32:47]
  ds_read_b64_tr_b16 v[104:105], v6 offset:25600
  ds_read_b64_tr_b16 v[106:107], v6 offset:26112
  v_add_f32 v39, s34, v39
  v_cvt_pk_bf16_f32 v32, v32, v32
  v_cvt_pk_bf16_f32 v33, v33, v33
  v_mfma_f32_32x32x16_bf16 a[160:175], v[72:75], v[132:135], a[160:175]
  ds_read_b64_tr_b16 v[108:109], v7 offset:25600
  v_cvt_pk_bf16_f32 v34, v34, v34
  v_cvt_pk_bf16_f32 v35, v35, v35
  v_mfma_f32_32x32x16_bf16 a[48:63], v[76:79], v[128:131], a[48:63]
  ds_read_b64_tr_b16 v[110:111], v7 offset:26112
  ds_read_b64_tr_b16 v[112:113], v6 offset:26624
  v_cvt_pk_bf16_f32 v36, v36, v36
  v_cvt_pk_bf16_f32 v37, v37, v37
  v_cvt_pk_bf16_f32 v38, v38, v38
  v_mfma_f32_32x32x16_bf16 a[176:191], v[76:79], v[132:135], a[176:191]
  ds_read_b64_tr_b16 v[114:115], v6 offset:27136
  v_cvt_pk_bf16_f32 v39, v39, v39
  v_and_b32 v32, 0xffff0000, v32
  v_mfma_f32_32x32x16_bf16 a[64:79], v[128:131], v[80:83], a[64:79]
  ds_read_b64_tr_b16 v[116:117], v7 offset:26624
  ds_read_b64_tr_b16 v[118:119], v7 offset:27136
  v_and_b32 v33, 0xffff0000, v33
  v_and_b32 v34, 0xffff0000, v34
  v_mfma_f32_32x32x16_bf16 a[192:207], v[132:135], v[80:83], a[192:207]
  ds_read_b64_tr_b16 v[120:121], v6 offset:27648
  v_and_b32 v35, 0xffff0000, v35
  v_and_b32 v36, 0xffff0000, v36
  v_and_b32 v37, 0xffff0000, v37
  v_mfma_f32_32x32x16_bf16 a[80:95], v[128:131], v[84:87], a[80:95]
  ds_read_b64_tr_b16 v[122:123], v6 offset:28160
  ds_read_b64_tr_b16 v[124:125], v7 offset:27648
  v_and_b32 v38, 0xffff0000, v38
  v_and_b32 v39, 0xffff0000, v39
  v_mfma_f32_32x32x16_bf16 a[208:223], v[132:135], v[84:87], a[208:223]
  ds_read_b64_tr_b16 v[126:127], v7 offset:28160
  v_mul_f32 v32, 0x3e0293ee, v32
  v_mul_f32 v33, 0x3e0293ee, v33
  v_mul_f32 v34, 0x3e0293ee, v34
  v_mfma_f32_32x32x16_bf16 a[96:111], v[128:131], v[88:91], a[96:111]
  v_mul_f32 v35, 0x3e0293ee, v35
  v_mul_f32 v36, 0x3e0293ee, v36
  v_mfma_f32_32x32x16_bf16 a[224:239], v[132:135], v[88:91], a[224:239]
  v_mul_f32 v37, 0x3e0293ee, v37
  v_mul_f32 v38, 0x3e0293ee, v38
  v_mul_f32 v39, 0x3e0293ee, v39
  v_mfma_f32_32x32x16_bf16 a[112:127], v[128:131], v[92:95], a[112:127]
  v_lshlrev_b32 v2, 5, v0
  v_add_u32 v2, 133120, v2
  v_mfma_f32_32x32x16_bf16 a[240:255], v[132:135], v[92:95], a[240:255]
  ds_write_b128 v2, v[32:35]
  ds_write_b128 v2, v[36:39] offset:16
  s_waitcnt vmcnt(1) lgkmcnt(0)
  s_barrier
  v_mfma_f32_32x32x16_bf16 a[0:15], v[96:99], v[136:139], a[0:15]
  ds_read_b128 v[128:131], v24 offset:32768
  ds_read_b128 v[132:135], v24 offset:36864
  s_add_u32 m0, s31, 0
  s_nop 0
  buffer_load_dwordx4 v8, s[40:43], s30 offen offset:0 lds
  buffer_load_dwordx4 v9, s[40:43], s30 offen offset:1024 lds
  v_lshlrev_b32 v2, 6, v1
  v_mfma_f32_32x32x16_bf16 a[128:143], v[96:99], v[140:143], a[128:143]
  ds_read_b64_tr_b16 v[64:65], v6 offset:32768
  buffer_load_dwordx4 v10, s[44:47], s30 offen offset:2048 lds
  v_add_u32 v2, 133120, v2
  v_mfma_f32_32x32x16_bf16 a[16:31], v[100:103], v[136:139], a[16:31]
  ds_read_b64_tr_b16 v[66:67], v6 offset:33280
  ds_read_b64_tr_b16 v[68:69], v7 offset:32768
  buffer_load_dwordx4 v11, s[44:47], s30 offen offset:3072 lds
  v_mfma_f32_32x32x16_bf16 a[144:159], v[100:103], v[140:143], a[144:159]
  ds_read_b64_tr_b16 v[70:71], v7 offset:33280
  s_add_u32 m0, s31, 4096
  s_nop 0
  buffer_load_dwordx4 v12, s[40:43], s30 offen offset:0 lds
  ds_read_b128 v[32:35], v2 offset:0
  v_mfma_f32_32x32x16_bf16 a[32:47], v[104:107], v[136:139], a[32:47]
  ds_read_b64_tr_b16 v[72:73], v6 offset:33792
  ds_read_b64_tr_b16 v[74:75], v6 offset:34304
  buffer_load_dwordx4 v13, s[40:43], s30 offen offset:1024 lds
  ds_read_b128 v[36:39], v2 offset:16
  v_mfma_f32_32x32x16_bf16 a[160:175], v[104:107], v[140:143], a[160:175]
  ds_read_b64_tr_b16 v[76:77], v7 offset:33792
  buffer_load_dwordx4 v14, s[44:47], s30 offen offset:2048 lds
  buffer_load_dwordx4 v15, s[44:47], s30 offen offset:3072 lds
  v_mfma_f32_32x32x16_bf16 a[48:63], v[108:111], v[136:139], a[48:63]
  ds_read_b64_tr_b16 v[78:79], v7 offset:34304
  ds_read_b64_tr_b16 v[80:81], v6 offset:34816
  s_add_u32 s30, s30, 524288
  ds_read_b128 v[40:43], v2 offset:32
  v_mfma_f32_32x32x16_bf16 a[176:191], v[108:111], v[140:143], a[176:191]
  ds_read_b64_tr_b16 v[82:83], v6 offset:35328
  s_add_u32 m0, s33, 0
  s_nop 0
  buffer_load_dwordx4 v16, s[48:51], s32 offen offset:0 lds
  v_mfma_f32_32x32x16_bf16 a[64:79], v[136:139], v[112:115], a[64:79]
  ds_read_b64_tr_b16 v[84:85], v7 offset:34816
  ds_read_b64_tr_b16 v[86:87], v7 offset:35328
  buffer_load_dwordx4 v17, s[48:51], s32 offen offset:1024 lds
  ds_read_b128 v[44:47], v2 offset:48
  v_mfma_f32_32x32x16_bf16 a[192:207], v[140:143], v[112:115], a[192:207]
  ds_read_b64_tr_b16 v[88:89], v6 offset:35840
  buffer_load_dwordx4 v18, s[48:51], s32 offen offset:2048 lds
  ds_read_b128 v[48:51], v2 offset:4096
  v_mfma_f32_32x32x16_bf16 a[80:95], v[136:139], v[116:119], a[80:95]
  ds_read_b64_tr_b16 v[90:91], v6 offset:36352
  ds_read_b64_tr_b16 v[92:93], v7 offset:35840
  buffer_load_dwordx4 v19, s[48:51], s32 offen offset:3072 lds
  s_add_u32 m0, s33, 4096
  s_nop 0
  buffer_load_dwordx4 v20, s[48:51], s32 offen offset:0 lds
  v_mfma_f32_32x32x16_bf16 a[208:223], v[140:143], v[116:119], a[208:223]
  ds_read_b64_tr_b16 v[94:95], v7 offset:36352
  buffer_load_dwordx4 v21, s[48:51], s32 offen offset:1024 lds
  ds_read_b128 v[52:55], v2 offset:4112
  v_mfma_f32_32x32x16_bf16 a[96:111], v[136:139], v[120:123], a[96:111]
  buffer_load_dwordx4 v22, s[48:51], s32 offen offset:2048 lds
  ds_read_b128 v[56:59], v2 offset:4128
  v_mfma_f32_32x32x16_bf16 a[224:239], v[140:143], v[120:123], a[224:239]
  buffer_load_dwordx4 v23, s[48:51], s32 offen offset:3072 lds
  v_mfma_f32_32x32x16_bf16 a[112:127], v[136:139], v[124:127], a[112:127]
  s_add_u32 s32, s32, 128
  ds_read_b128 v[60:63], v2 offset:4144
  v_mfma_f32_32x32x16_bf16 a[240:255], v[140:143], v[124:127], a[240:255]
  s_waitcnt lgkmcnt(0)
  v_mfma_f32_32x32x16_bf16 a[0:15], v[64:67], v[128:131], a[0:15]
  ds_read_b128 v[136:139], v25 offset:32768
  ds_read_b128 v[140:143], v25 offset:36864
  v_fma_f32 v192, v192, v48, v32
  v_fma_f32 v193, v193, v49, v33
  v_mfma_f32_32x32x16_bf16 a[128:143], v[64:67], v[132:135], a[128:143]
  ds_read_b64_tr_b16 v[96:97], v6 offset:40960
  v_fma_f32 v194, v194, v50, v34
  v_mfma_f32_32x32x16_bf16 a[16:31], v[68:71], v[128:131], a[16:31]
  ds_read_b64_tr_b16 v[98:99], v6 offset:41472
  ds_read_b64_tr_b16 v[100:101], v7 offset:40960
  v_fma_f32 v195, v195, v51, v35
  v_mfma_f32_32x32x16_bf16 a[144:159], v[68:71], v[132:135], a[144:159]
  ds_read_b64_tr_b16 v[102:103], v7 offset:41472
  v_fma_f32 v196, v196, v52, v36
  v_fma_f32 v197, v197, v53, v37
  v_mfma_f32_32x32x16_bf16 a[32:47], v[72:75], v[128:131], a[32:47]
  ds_read_b64_tr_b16 v[104:105], v6 offset:41984
  ds_read_b64_tr_b16 v[106:107], v6 offset:42496
  v_fma_f32 v198, v198, v54, v38
  v_mfma_f32_32x32x16_bf16 a[160:175], v[72:75], v[132:135], a[160:175]
  ds_read_b64_tr_b16 v[108:109], v7 offset:41984
  v_fma_f32 v199, v199, v55, v39
  v_mfma_f32_32x32x16_bf16 a[48:63], v[76:79], v[128:131], a[48:63]
  ds_read_b64_tr_b16 v[110:111], v7 offset:42496
  ds_read_b64_tr_b16 v[112:113], v6 offset:43008
  v_fma_f32 v200, v200, v56, v40
  v_fma_f32 v201, v201, v57, v41
  v_mfma_f32_32x32x16_bf16 a[176:191], v[76:79], v[132:135], a[176:191]
  ds_read_b64_tr_b16 v[114:115], v6 offset:43520
  v_fma_f32 v202, v202, v58, v42
  v_mfma_f32_32x32x16_bf16 a[64:79], v[128:131], v[80:83], a[64:79]
  ds_read_b64_tr_b16 v[116:117], v7 offset:43008
  ds_read_b64_tr_b16 v[118:119], v7 offset:43520
  v_fma_f32 v203, v203, v59, v43
  v_mfma_f32_32x32x16_bf16 a[192:207], v[132:135], v[80:83], a[192:207]
  ds_read_b64_tr_b16 v[120:121], v6 offset:44032
  v_fma_f32 v204, v204, v60, v44
  v_fma_f32 v205, v205, v61, v45
  v_mfma_f32_32x32x16_bf16 a[80:95], v[128:131], v[84:87], a[80:95]
  ds_read_b64_tr_b16 v[122:123], v6 offset:44544
  ds_read_b64_tr_b16 v[124:125], v7 offset:44032
  v_fma_f32 v206, v206, v62, v46
  v_mfma_f32_32x32x16_bf16 a[208:223], v[132:135], v[84:87], a[208:223]
  ds_read_b64_tr_b16 v[126:127], v7 offset:44544
  v_fma_f32 v207, v207, v63, v47
  v_mfma_f32_32x32x16_bf16 a[96:111], v[128:131], v[88:91], a[96:111]
  v_cvt_pk_bf16_f32 v144, v192, v193
  v_cvt_pk_bf16_f32 v145, v194, v195
  v_mfma_f32_32x32x16_bf16 a[224:239], v[132:135], v[88:91], a[224:239]
  v_cvt_pk_bf16_f32 v146, v200, v201
  v_mfma_f32_32x32x16_bf16 a[112:127], v[128:131], v[92:95], a[112:127]
  v_cvt_pk_bf16_f32 v147, v202, v203
  v_mfma_f32_32x32x16_bf16 a[240:255], v[132:135], v[92:95], a[240:255]
  v_cvt_pk_bf16_f32 v148, v196, v197
  s_waitcnt lgkmcnt(0)
  v_mfma_f32_32x32x16_bf16 a[0:15], v[96:99], v[136:139], a[0:15]
  ds_read_b128 v[128:131], v26 offset:32768
  ds_read_b128 v[132:135], v26 offset:36864
  v_cvt_pk_bf16_f32 v149, v198, v199
  v_cvt_pk_bf16_f32 v150, v204, v205
  v_mfma_f32_32x32x16_bf16 a[128:143], v[96:99], v[140:143], a[128:143]
  ds_read_b64_tr_b16 v[64:65], v6 offset:49152
  v_cvt_pk_bf16_f32 v151, v206, v207
  v_mfma_f32_32x32x16_bf16 a[16:31], v[100:103], v[136:139], a[16:31]
  ds_read_b64_tr_b16 v[66:67], v6 offset:49664
  ds_read_b64_tr_b16 v[68:69], v7 offset:49152
  v_fma_f32 v208, v208, v48, v32
  v_mfma_f32_32x32x16_bf16 a[144:159], v[100:103], v[140:143], a[144:159]
  ds_read_b64_tr_b16 v[70:71], v7 offset:49664
  v_fma_f32 v209, v209, v49, v33
  v_fma_f32 v210, v210, v50, v34
  v_mfma_f32_32x32x16_bf16 a[32:47], v[104:107], v[136:139], a[32:47]
  ds_read_b64_tr_b16 v[72:73], v6 offset:50176
  ds_read_b64_tr_b16 v[74:75], v6 offset:50688
  v_fma_f32 v211, v211, v51, v35
  v_mfma_f32_32x32x16_bf16 a[160:175], v[104:107], v[140:143], a[160:175]
  ds_read_b64_tr_b16 v[76:77], v7 offset:50176
  v_fma_f32 v212, v212, v52, v36
  v_mfma_f32_32x32x16_bf16 a[48:63], v[108:111], v[136:139], a[48:63]
  ds_read_b64_tr_b16 v[78:79], v7 offset:50688
  ds_read_b64_tr_b16 v[80:81], v6 offset:51200
  v_fma_f32 v213, v213, v53, v37
  v_fma_f32 v214, v214, v54, v38
  v_mfma_f32_32x32x16_bf16 a[176:191], v[108:111], v[140:143], a[176:191]
  ds_read_b64_tr_b16 v[82:83], v6 offset:51712
  v_fma_f32 v215, v215, v55, v39
  v_mfma_f32_32x32x16_bf16 a[64:79], v[136:139], v[112:115], a[64:79]
  ds_read_b64_tr_b16 v[84:85], v7 offset:51200
  ds_read_b64_tr_b16 v[86:87], v7 offset:51712
  v_fma_f32 v216, v216, v56, v40
  v_mfma_f32_32x32x16_bf16 a[192:207], v[140:143], v[112:115], a[192:207]
  ds_read_b64_tr_b16 v[88:89], v6 offset:52224
  v_fma_f32 v217, v217, v57, v41
  v_fma_f32 v218, v218, v58, v42
  v_mfma_f32_32x32x16_bf16 a[80:95], v[136:139], v[116:119], a[80:95]
  ds_read_b64_tr_b16 v[90:91], v6 offset:52736
  ds_read_b64_tr_b16 v[92:93], v7 offset:52224
  v_fma_f32 v219, v219, v59, v43
  v_mfma_f32_32x32x16_bf16 a[208:223], v[140:143], v[116:119], a[208:223]
  ds_read_b64_tr_b16 v[94:95], v7 offset:52736
  v_fma_f32 v220, v220, v60, v44
  v_mfma_f32_32x32x16_bf16 a[96:111], v[136:139], v[120:123], a[96:111]
  v_fma_f32 v221, v221, v61, v45
  v_fma_f32 v222, v222, v62, v46
  v_mfma_f32_32x32x16_bf16 a[224:239], v[140:143], v[120:123], a[224:239]
  v_fma_f32 v223, v223, v63, v47
  v_mfma_f32_32x32x16_bf16 a[112:127], v[136:139], v[124:127], a[112:127]
  v_cvt_pk_bf16_f32 v152, v208, v209
  v_mfma_f32_32x32x16_bf16 a[240:255], v[140:143], v[124:127], a[240:255]
  v_cvt_pk_bf16_f32 v153, v210, v211
  s_waitcnt lgkmcnt(0)
  v_mfma_f32_32x32x16_bf16 a[0:15], v[64:67], v[128:131], a[0:15]
  ds_read_b128 v[136:139], v27 offset:32768
  ds_read_b128 v[140:143], v27 offset:36864
  v_cvt_pk_bf16_f32 v154, v216, v217
  v_cvt_pk_bf16_f32 v155, v218, v219
  v_mfma_f32_32x32x16_bf16 a[128:143], v[64:67], v[132:135], a[128:143]
  ds_read_b64_tr_b16 v[96:97], v6 offset:57344
  v_cvt_pk_bf16_f32 v156, v212, v213
  v_mfma_f32_32x32x16_bf16 a[16:31], v[68:71], v[128:131], a[16:31]
  ds_read_b64_tr_b16 v[98:99], v6 offset:57856
  ds_read_b64_tr_b16 v[100:101], v7 offset:57344
  v_cvt_pk_bf16_f32 v157, v214, v215
  v_mfma_f32_32x32x16_bf16 a[144:159], v[68:71], v[132:135], a[144:159]
  ds_read_b64_tr_b16 v[102:103], v7 offset:57856
  v_cvt_pk_bf16_f32 v158, v220, v221
  v_cvt_pk_bf16_f32 v159, v222, v223
  v_mfma_f32_32x32x16_bf16 a[32:47], v[72:75], v[128:131], a[32:47]
  ds_read_b64_tr_b16 v[104:105], v6 offset:58368
  ds_read_b64_tr_b16 v[106:107], v6 offset:58880
  s_lshl_b32 s34, s3, 1
  v_and_b32 v3, 15, v1
  v_lshlrev_b32 v2, 8, v1
  v_mfma_f32_32x32x16_bf16 a[160:175], v[72:75], v[132:135], a[160:175]
  ds_read_b64_tr_b16 v[108:109], v7 offset:58368
  v_xor_b32 v3, s34, v3
  v_mfma_f32_32x32x16_bf16 a[48:63], v[76:79], v[128:131], a[48:63]
  ds_read_b64_tr_b16 v[110:111], v7 offset:58880
  ds_read_b64_tr_b16 v[112:113], v6 offset:59392
  v_add_u32 v2, 141312, v2
  v_xor_b32 v4, 0, v3
  v_mfma_f32_32x32x16_bf16 a[176:191], v[76:79], v[132:135], a[176:191]
  ds_read_b64_tr_b16 v[114:115], v6 offset:59904
  v_lshl_add_u32 v4, v4, 4, v2
  v_mfma_f32_32x32x16_bf16 a[64:79], v[128:131], v[80:83], a[64:79]
  ds_read_b64_tr_b16 v[116:117], v7 offset:59392
  ds_read_b64_tr_b16 v[118:119], v7 offset:59904
  ds_write_b128 v4, v[144:147]
  v_mfma_f32_32x32x16_bf16 a[192:207], v[132:135], v[80:83], a[192:207]
  ds_read_b64_tr_b16 v[120:121], v6 offset:60416
  v_xor_b32 v4, 8, v3
  v_lshl_add_u32 v4, v4, 4, v2
  v_mfma_f32_32x32x16_bf16 a[80:95], v[128:131], v[84:87], a[80:95]
  ds_read_b64_tr_b16 v[122:123], v6 offset:60928
  ds_read_b64_tr_b16 v[124:125], v7 offset:60416
  ds_write_b128 v4, v[148:151]
  v_mfma_f32_32x32x16_bf16 a[208:223], v[132:135], v[84:87], a[208:223]
  ds_read_b64_tr_b16 v[126:127], v7 offset:60928
  v_xor_b32 v4, 1, v3
  v_mfma_f32_32x32x16_bf16 a[96:111], v[128:131], v[88:91], a[96:111]
  v_lshl_add_u32 v4, v4, 4, v2
  ds_write_b128 v4, v[152:155]
  v_mfma_f32_32x32x16_bf16 a[224:239], v[132:135], v[88:91], a[224:239]
  v_xor_b32 v4, 9, v3
  v_mfma_f32_32x32x16_bf16 a[112:127], v[128:131], v[92:95], a[112:127]
  v_lshl_add_u32 v4, v4, 4, v2
  v_mfma_f32_32x32x16_bf16 a[240:255], v[132:135], v[92:95], a[240:255]
  ds_write_b128 v4, v[156:159]
  s_waitcnt vmcnt(0) lgkmcnt(0)
  s_barrier
  v_mfma_f32_32x32x16_bf16 a[0:15], v[96:99], v[136:139], a[0:15]
  ds_read_b128 v[128:131], v24 offset:0
  ds_read_b128 v[132:135], v24 offset:4096
  s_add_u32 m0, s31, 32768
  s_nop 0
  buffer_load_dwordx4 v8, s[40:43], s30 offen offset:0 lds
  buffer_load_dwordx4 v9, s[40:43], s30 offen offset:1024 lds
  v_lshrrev_b32 v2, 4, v0
  v_mfma_f32_32x32x16_bf16 a[128:143], v[96:99], v[140:143], a[128:143]
  ds_read_b64_tr_b16 v[64:65], v6 offset:0
  buffer_load_dwordx4 v10, s[44:47], s30 offen offset:2048 lds
  v_mfma_f32_32x32x16_bf16 a[16:31], v[100:103], v[136:139], a[16:31]
  ds_read_b64_tr_b16 v[66:67], v6 offset:512
  ds_read_b64_tr_b16 v[68:69], v7 offset:0
  buffer_load_dwordx4 v11, s[44:47], s30 offen offset:3072 lds
  v_xor_b32 v2, v2, v0
  v_mfma_f32_32x32x16_bf16 a[144:159], v[100:103], v[140:143], a[144:159]
  ds_read_b64_tr_b16 v[70:71], v7 offset:512
  s_add_u32 m0, s31, 36864
  s_nop 0
  buffer_load_dwordx4 v12, s[40:43], s30 offen offset:0 lds
  v_mfma_f32_32x32x16_bf16 a[32:47], v[104:107], v[136:139], a[32:47]
  ds_read_b64_tr_b16 v[72:73], v6 offset:1024
  ds_read_b64_tr_b16 v[74:75], v6 offset:1536
  buffer_load_dwordx4 v13, s[40:43], s30 offen offset:1024 lds
  v_lshlrev_b32 v2, 4, v2
  v_mfma_f32_32x32x16_bf16 a[160:175], v[104:107], v[140:143], a[160:175]
  ds_read_b64_tr_b16 v[76:77], v7 offset:1024
  buffer_load_dwordx4 v14, s[44:47], s30 offen offset:2048 lds
  buffer_load_dwordx4 v15, s[44:47], s30 offen offset:3072 lds
  v_mfma_f32_32x32x16_bf16 a[48:63], v[108:111], v[136:139], a[48:63]
  ds_read_b64_tr_b16 v[78:79], v7 offset:1536
  ds_read_b64_tr_b16 v[80:81], v6 offset:2048
  s_add_u32 s30, s30, 524288
  v_add_u32 v2, 141312, v2
  v_mfma_f32_32x32x16_bf16 a[176:191], v[108:111], v[140:143], a[176:191]
  ds_read_b64_tr_b16 v[82:83], v6 offset:2560
  s_add_u32 m0, s33, 32768
  s_nop 0
  buffer_load_dwordx4 v16, s[48:51], s32 offen offset:0 lds
  v_mfma_f32_32x32x16_bf16 a[64:79], v[136:139], v[112:115], a[64:79]
  ds_read_b64_tr_b16 v[84:85], v7 offset:2048
  ds_read_b64_tr_b16 v[86:87], v7 offset:2560
  buffer_load_dwordx4 v17, s[48:51], s32 offen offset:1024 lds
  ds_read_b128 v[144:147], v2 offset:0
  v_mfma_f32_32x32x16_bf16 a[192:207], v[140:143], v[112:115], a[192:207]
  ds_read_b64_tr_b16 v[88:89], v6 offset:3072
  buffer_load_dwordx4 v18, s[48:51], s32 offen offset:2048 lds
  v_mfma_f32_32x32x16_bf16 a[80:95], v[136:139], v[116:119], a[80:95]
  ds_read_b64_tr_b16 v[90:91], v6 offset:3584
  ds_read_b64_tr_b16 v[92:93], v7 offset:3072
  buffer_load_dwordx4 v19, s[48:51], s32 offen offset:3072 lds
  s_add_u32 m0, s33, 36864
  s_nop 0
  buffer_load_dwordx4 v20, s[48:51], s32 offen offset:0 lds
  ds_read_b128 v[148:151], v2 offset:4096
  v_mfma_f32_32x32x16_bf16 a[208:223], v[140:143], v[116:119], a[208:223]
  ds_read_b64_tr_b16 v[94:95], v7 offset:3584
  buffer_load_dwordx4 v21, s[48:51], s32 offen offset:1024 lds
  v_mfma_f32_32x32x16_bf16 a[96:111], v[136:139], v[120:123], a[96:111]
  buffer_load_dwordx4 v22, s[48:51], s32 offen offset:2048 lds
  ds_read_b128 v[152:155], v2 offset:8192
  v_mfma_f32_32x32x16_bf16 a[224:239], v[140:143], v[120:123], a[224:239]
  buffer_load_dwordx4 v23, s[48:51], s32 offen offset:3072 lds
  v_mfma_f32_32x32x16_bf16 a[112:127], v[136:139], v[124:127], a[112:127]
  s_add_u32 s32, s32, 128
  ds_read_b128 v[156:159], v2 offset:12288
  v_mfma_f32_32x32x16_bf16 a[240:255], v[140:143], v[124:127], a[240:255]
  s_waitcnt lgkmcnt(0)
  v_mfma_f32_32x32x16_bf16 a[0:15], v[64:67], v[128:131], a[0:15]
  ds_read_b128 v[136:139], v25 offset:0
  ds_read_b128 v[140:143], v25 offset:4096
  s_lshr_b32 s36, s28, 2
  s_lshl_b32 s36, s36, 16
  s_and_b32 s37, s28, 3
  s_lshl_b32 s37, s37, 7
  v_mfma_f32_32x32x16_bf16 a[128:143], v[64:67], v[132:135], a[128:143]
  ds_read_b64_tr_b16 v[96:97], v6 offset:8192
  v_mfma_f32_32x32x16_bf16 a[16:31], v[68:71], v[128:131], a[16:31]
  ds_read_b64_tr_b16 v[98:99], v6 offset:8704
  ds_read_b64_tr_b16 v[100:101], v7 offset:8192
  s_add_u32 s36, s36, s37
  s_add_u32 s36, s36, 1048576
  v_mfma_f32_32x32x16_bf16 a[144:159], v[68:71], v[132:135], a[144:159]
  ds_read_b64_tr_b16 v[102:103], v7 offset:8704
  v_mfma_f32_32x32x16_bf16 a[32:47], v[72:75], v[128:131], a[32:47]
  ds_read_b64_tr_b16 v[104:105], v6 offset:9216
  ds_read_b64_tr_b16 v[106:107], v6 offset:9728
  v_lshrrev_b32 v2, 3, v0
  v_lshlrev_b32 v2, 9, v2
  v_and_b32 v3, 7, v0
  v_lshl_add_u32 v2, v3, 4, v2
  v_mfma_f32_32x32x16_bf16 a[160:175], v[72:75], v[132:135], a[160:175]
  ds_read_b64_tr_b16 v[108:109], v7 offset:9216
  v_mfma_f32_32x32x16_bf16 a[48:63], v[76:79], v[128:131], a[48:63]
  ds_read_b64_tr_b16 v[110:111], v7 offset:9728
  ds_read_b64_tr_b16 v[112:113], v6 offset:10240
  buffer_store_dwordx4 v[144:147], v2, s[68:71], s36 offen sc1
  s_add_u32 s36, s36, 16384
  v_mfma_f32_32x32x16_bf16 a[176:191], v[76:79], v[132:135], a[176:191]
  ds_read_b64_tr_b16 v[114:115], v6 offset:10752
  v_mfma_f32_32x32x16_bf16 a[64:79], v[128:131], v[80:83], a[64:79]
  ds_read_b64_tr_b16 v[116:117], v7 offset:10240
  ds_read_b64_tr_b16 v[118:119], v7 offset:10752
  buffer_store_dwordx4 v[148:151], v2, s[68:71], s36 offen sc1
  s_add_u32 s36, s36, 16384
  v_mfma_f32_32x32x16_bf16 a[192:207], v[132:135], v[80:83], a[192:207]
  ds_read_b64_tr_b16 v[120:121], v6 offset:11264
  v_mfma_f32_32x32x16_bf16 a[80:95], v[128:131], v[84:87], a[80:95]
  ds_read_b64_tr_b16 v[122:123], v6 offset:11776
  ds_read_b64_tr_b16 v[124:125], v7 offset:11264
  buffer_store_dwordx4 v[152:155], v2, s[68:71], s36 offen sc1
  s_add_u32 s36, s36, 16384
  v_mfma_f32_32x32x16_bf16 a[208:223], v[132:135], v[84:87], a[208:223]
  ds_read_b64_tr_b16 v[126:127], v7 offset:11776
  v_mfma_f32_32x32x16_bf16 a[96:111], v[128:131], v[88:91], a[96:111]
  buffer_store_dwordx4 v[156:159], v2, s[68:71], s36 offen sc1
  s_add_u32 s36, s36, 16384
  v_mfma_f32_32x32x16_bf16 a[224:239], v[132:135], v[88:91], a[224:239]
  v_mfma_f32_32x32x16_bf16 a[112:127], v[128:131], v[92:95], a[112:127]
  v_mfma_f32_32x32x16_bf16 a[240:255], v[132:135], v[92:95], a[240:255]
  s_waitcnt lgkmcnt(0)
  v_mfma_f32_32x32x16_bf16 a[0:15], v[96:99], v[136:139], a[0:15]
  ds_read_b128 v[128:131], v26 offset:0
  ds_read_b128 v[132:135], v26 offset:4096
  v_mfma_f32_32x32x16_bf16 a[128:143], v[96:99], v[140:143], a[128:143]
  ds_read_b64_tr_b16 v[64:65], v6 offset:16384
  v_mfma_f32_32x32x16_bf16 a[16:31], v[100:103], v[136:139], a[16:31]
  ds_read_b64_tr_b16 v[66:67], v6 offset:16896
  ds_read_b64_tr_b16 v[68:69], v7 offset:16384
  v_mfma_f32_32x32x16_bf16 a[144:159], v[100:103], v[140:143], a[144:159]
  ds_read_b64_tr_b16 v[70:71], v7 offset:16896
  v_mfma_f32_32x32x16_bf16 a[32:47], v[104:107], v[136:139], a[32:47]
  ds_read_b64_tr_b16 v[72:73], v6 offset:17408
  ds_read_b64_tr_b16 v[74:75], v6 offset:17920
  v_mfma_f32_32x32x16_bf16 a[160:175], v[104:107], v[140:143], a[160:175]
  ds_read_b64_tr_b16 v[76:77], v7 offset:17408
  v_mfma_f32_32x32x16_bf16 a[48:63], v[108:111], v[136:139], a[48:63]
  ds_read_b64_tr_b16 v[78:79], v7 offset:17920
  ds_read_b64_tr_b16 v[80:81], v6 offset:18432
  v_mfma_f32_32x32x16_bf16 a[176:191], v[108:111], v[140:143], a[176:191]
  ds_read_b64_tr_b16 v[82:83], v6 offset:18944
  v_mfma_f32_32x32x16_bf16 a[64:79], v[136:139], v[112:115], a[64:79]
  ds_read_b64_tr_b16 v[84:85], v7 offset:18432
  ds_read_b64_tr_b16 v[86:87], v7 offset:18944
  v_mfma_f32_32x32x16_bf16 a[192:207], v[140:143], v[112:115], a[192:207]
  ds_read_b64_tr_b16 v[88:89], v6 offset:19456
  v_mfma_f32_32x32x16_bf16 a[80:95], v[136:139], v[116:119], a[80:95]
  ds_read_b64_tr_b16 v[90:91], v6 offset:19968
  ds_read_b64_tr_b16 v[92:93], v7 offset:19456
  v_mfma_f32_32x32x16_bf16 a[208:223], v[140:143], v[116:119], a[208:223]
  ds_read_b64_tr_b16 v[94:95], v7 offset:19968
  v_mfma_f32_32x32x16_bf16 a[96:111], v[136:139], v[120:123], a[96:111]
  v_mfma_f32_32x32x16_bf16 a[224:239], v[140:143], v[120:123], a[224:239]
  v_mfma_f32_32x32x16_bf16 a[112:127], v[136:139], v[124:127], a[112:127]
  v_mfma_f32_32x32x16_bf16 a[240:255], v[140:143], v[124:127], a[240:255]
  s_waitcnt lgkmcnt(0)
  v_mfma_f32_32x32x16_bf16 a[0:15], v[64:67], v[128:131], a[0:15]
  ds_read_b128 v[136:139], v27 offset:0
  ds_read_b128 v[140:143], v27 offset:4096
  v_mfma_f32_32x32x16_bf16 a[128:143], v[64:67], v[132:135], a[128:143]
  ds_read_b64_tr_b16 v[96:97], v6 offset:24576
  v_mfma_f32_32x32x16_bf16 a[16:31], v[68:71], v[128:131], a[16:31]
  ds_read_b64_tr_b16 v[98:99], v6 offset:25088
  ds_read_b64_tr_b16 v[100:101], v7 offset:24576
  v_mfma_f32_32x32x16_bf16 a[144:159], v[68:71], v[132:135], a[144:159]
  ds_read_b64_tr_b16 v[102:103], v7 offset:25088
  v_mfma_f32_32x32x16_bf16 a[32:47], v[72:75], v[128:131], a[32:47]
  ds_read_b64_tr_b16 v[104:105], v6 offset:25600
  ds_read_b64_tr_b16 v[106:107], v6 offset:26112
  v_mfma_f32_32x32x16_bf16 a[160:175], v[72:75], v[132:135], a[160:175]
  ds_read_b64_tr_b16 v[108:109], v7 offset:25600
  v_mfma_f32_32x32x16_bf16 a[48:63], v[76:79], v[128:131], a[48:63]
  ds_read_b64_tr_b16 v[110:111], v7 offset:26112
  ds_read_b64_tr_b16 v[112:113], v6 offset:26624
  v_mfma_f32_32x32x16_bf16 a[176:191], v[76:79], v[132:135], a[176:191]
  ds_read_b64_tr_b16 v[114:115], v6 offset:27136
  v_mfma_f32_32x32x16_bf16 a[64:79], v[128:131], v[80:83], a[64:79]
  ds_read_b64_tr_b16 v[116:117], v7 offset:26624
  ds_read_b64_tr_b16 v[118:119], v7 offset:27136
  v_mfma_f32_32x32x16_bf16 a[192:207], v[132:135], v[80:83], a[192:207]
  ds_read_b64_tr_b16 v[120:121], v6 offset:27648
  v_mfma_f32_32x32x16_bf16 a[80:95], v[128:131], v[84:87], a[80:95]
  ds_read_b64_tr_b16 v[122:123], v6 offset:28160
  ds_read_b64_tr_b16 v[124:125], v7 offset:27648
  v_mfma_f32_32x32x16_bf16 a[208:223], v[132:135], v[84:87], a[208:223]
  ds_read_b64_tr_b16 v[126:127], v7 offset:28160
  v_mfma_f32_32x32x16_bf16 a[96:111], v[128:131], v[88:91], a[96:111]
  v_mfma_f32_32x32x16_bf16 a[224:239], v[132:135], v[88:91], a[224:239]
  v_mfma_f32_32x32x16_bf16 a[112:127], v[128:131], v[92:95], a[112:127]
  v_mfma_f32_32x32x16_bf16 a[240:255], v[132:135], v[92:95], a[240:255]
  s_waitcnt vmcnt(0) lgkmcnt(0)
  s_barrier
  v_mfma_f32_32x32x16_bf16 a[0:15], v[96:99], v[136:139], a[0:15]
  ds_read_b128 v[128:131], v24 offset:32768
  ds_read_b128 v[132:135], v24 offset:36864
  s_lshr_b32 s36, s28, 2
  s_lshl_b32 s36, s36, 7
  s_and_b32 s37, s28, 3
  s_add_u32 s36, s36, s37
  s_add_u32 s36, s36, 524288
  v_cmp_eq_u32 vcc, 0, v0
  v_mov_b32 v2, 2130706432
  v_mov_b32 v3, 1
  v_cndmask_b32 v2, v2, v0, vcc
  buffer_store_byte v3, v2, s[68:71], s36 offen sc0 sc1
  v_mfma_f32_32x32x16_bf16 a[128:143], v[96:99], v[140:143], a[128:143]
  ds_read_b64_tr_b16 v[64:65], v6 offset:32768
  v_mfma_f32_32x32x16_bf16 a[16:31], v[100:103], v[136:139], a[16:31]
  ds_read_b64_tr_b16 v[66:67], v6 offset:33280
  ds_read_b64_tr_b16 v[68:69], v7 offset:32768
  v_mfma_f32_32x32x16_bf16 a[144:159], v[100:103], v[140:143], a[144:159]
  ds_read_b64_tr_b16 v[70:71], v7 offset:33280
  v_mfma_f32_32x32x16_bf16 a[32:47], v[104:107], v[136:139], a[32:47]
  ds_read_b64_tr_b16 v[72:73], v6 offset:33792
  ds_read_b64_tr_b16 v[74:75], v6 offset:34304
  v_mfma_f32_32x32x16_bf16 a[160:175], v[104:107], v[140:143], a[160:175]
  ds_read_b64_tr_b16 v[76:77], v7 offset:33792
  v_mfma_f32_32x32x16_bf16 a[48:63], v[108:111], v[136:139], a[48:63]
  ds_read_b64_tr_b16 v[78:79], v7 offset:34304
  ds_read_b64_tr_b16 v[80:81], v6 offset:34816
  v_mfma_f32_32x32x16_bf16 a[176:191], v[108:111], v[140:143], a[176:191]
  ds_read_b64_tr_b16 v[82:83], v6 offset:35328
  v_mfma_f32_32x32x16_bf16 a[64:79], v[136:139], v[112:115], a[64:79]
  ds_read_b64_tr_b16 v[84:85], v7 offset:34816
  ds_read_b64_tr_b16 v[86:87], v7 offset:35328
  v_mfma_f32_32x32x16_bf16 a[192:207], v[140:143], v[112:115], a[192:207]
  ds_read_b64_tr_b16 v[88:89], v6 offset:35840
  v_mfma_f32_32x32x16_bf16 a[80:95], v[136:139], v[116:119], a[80:95]
  ds_read_b64_tr_b16 v[90:91], v6 offset:36352
  ds_read_b64_tr_b16 v[92:93], v7 offset:35840
  v_mfma_f32_32x32x16_bf16 a[208:223], v[140:143], v[116:119], a[208:223]
  ds_read_b64_tr_b16 v[94:95], v7 offset:36352
  v_mfma_f32_32x32x16_bf16 a[96:111], v[136:139], v[120:123], a[96:111]
  v_mfma_f32_32x32x16_bf16 a[224:239], v[140:143], v[120:123], a[224:239]
  v_mfma_f32_32x32x16_bf16 a[112:127], v[136:139], v[124:127], a[112:127]
  v_mfma_f32_32x32x16_bf16 a[240:255], v[140:143], v[124:127], a[240:255]
  s_waitcnt lgkmcnt(0)
  v_mfma_f32_32x32x16_bf16 a[0:15], v[64:67], v[128:131], a[0:15]
  ds_read_b128 v[136:139], v25 offset:32768
  ds_read_b128 v[140:143], v25 offset:36864
  v_mfma_f32_32x32x16_bf16 a[128:143], v[64:67], v[132:135], a[128:143]
  ds_read_b64_tr_b16 v[96:97], v6 offset:40960
  v_mfma_f32_32x32x16_bf16 a[16:31], v[68:71], v[128:131], a[16:31]
  ds_read_b64_tr_b16 v[98:99], v6 offset:41472
  ds_read_b64_tr_b16 v[100:101], v7 offset:40960
  v_mfma_f32_32x32x16_bf16 a[144:159], v[68:71], v[132:135], a[144:159]
  ds_read_b64_tr_b16 v[102:103], v7 offset:41472
  v_mfma_f32_32x32x16_bf16 a[32:47], v[72:75], v[128:131], a[32:47]
  ds_read_b64_tr_b16 v[104:105], v6 offset:41984
  ds_read_b64_tr_b16 v[106:107], v6 offset:42496
  v_mfma_f32_32x32x16_bf16 a[160:175], v[72:75], v[132:135], a[160:175]
  ds_read_b64_tr_b16 v[108:109], v7 offset:41984
  v_mfma_f32_32x32x16_bf16 a[48:63], v[76:79], v[128:131], a[48:63]
  ds_read_b64_tr_b16 v[110:111], v7 offset:42496
  ds_read_b64_tr_b16 v[112:113], v6 offset:43008
  v_mfma_f32_32x32x16_bf16 a[176:191], v[76:79], v[132:135], a[176:191]
  ds_read_b64_tr_b16 v[114:115], v6 offset:43520
  v_mfma_f32_32x32x16_bf16 a[64:79], v[128:131], v[80:83], a[64:79]
  ds_read_b64_tr_b16 v[116:117], v7 offset:43008
  ds_read_b64_tr_b16 v[118:119], v7 offset:43520
  v_mfma_f32_32x32x16_bf16 a[192:207], v[132:135], v[80:83], a[192:207]
  ds_read_b64_tr_b16 v[120:121], v6 offset:44032
  v_mfma_f32_32x32x16_bf16 a[80:95], v[128:131], v[84:87], a[80:95]
  ds_read_b64_tr_b16 v[122:123], v6 offset:44544
  ds_read_b64_tr_b16 v[124:125], v7 offset:44032
  v_mfma_f32_32x32x16_bf16 a[208:223], v[132:135], v[84:87], a[208:223]
  ds_read_b64_tr_b16 v[126:127], v7 offset:44544
  v_mfma_f32_32x32x16_bf16 a[96:111], v[128:131], v[88:91], a[96:111]
  v_mfma_f32_32x32x16_bf16 a[224:239], v[132:135], v[88:91], a[224:239]
  v_mfma_f32_32x32x16_bf16 a[112:127], v[128:131], v[92:95], a[112:127]
  v_mfma_f32_32x32x16_bf16 a[240:255], v[132:135], v[92:95], a[240:255]
  s_waitcnt lgkmcnt(0)
  v_mfma_f32_32x32x16_bf16 a[0:15], v[96:99], v[136:139], a[0:15]
  ds_read_b128 v[128:131], v26 offset:32768
  ds_read_b128 v[132:135], v26 offset:36864
  v_mfma_f32_32x32x16_bf16 a[128:143], v[96:99], v[140:143], a[128:143]
  ds_read_b64_tr_b16 v[64:65], v6 offset:49152
  v_mfma_f32_32x32x16_bf16 a[16:31], v[100:103], v[136:139], a[16:31]
  ds_read_b64_tr_b16 v[66:67], v6 offset:49664
  ds_read_b64_tr_b16 v[68:69], v7 offset:49152
  v_mfma_f32_32x32x16_bf16 a[144:159], v[100:103], v[140:143], a[144:159]
  ds_read_b64_tr_b16 v[70:71], v7 offset:49664
  v_mfma_f32_32x32x16_bf16 a[32:47], v[104:107], v[136:139], a[32:47]
  ds_read_b64_tr_b16 v[72:73], v6 offset:50176
  ds_read_b64_tr_b16 v[74:75], v6 offset:50688
  v_mfma_f32_32x32x16_bf16 a[160:175], v[104:107], v[140:143], a[160:175]
  ds_read_b64_tr_b16 v[76:77], v7 offset:50176
  v_mfma_f32_32x32x16_bf16 a[48:63], v[108:111], v[136:139], a[48:63]
  ds_read_b64_tr_b16 v[78:79], v7 offset:50688
  ds_read_b64_tr_b16 v[80:81], v6 offset:51200
  v_mfma_f32_32x32x16_bf16 a[176:191], v[108:111], v[140:143], a[176:191]
  ds_read_b64_tr_b16 v[82:83], v6 offset:51712
  v_mfma_f32_32x32x16_bf16 a[64:79], v[136:139], v[112:115], a[64:79]
  ds_read_b64_tr_b16 v[84:85], v7 offset:51200
  ds_read_b64_tr_b16 v[86:87], v7 offset:51712
  v_mfma_f32_32x32x16_bf16 a[192:207], v[140:143], v[112:115], a[192:207]
  ds_read_b64_tr_b16 v[88:89], v6 offset:52224
  v_mfma_f32_32x32x16_bf16 a[80:95], v[136:139], v[116:119], a[80:95]
  ds_read_b64_tr_b16 v[90:91], v6 offset:52736
  ds_read_b64_tr_b16 v[92:93], v7 offset:52224
  v_mfma_f32_32x32x16_bf16 a[208:223], v[140:143], v[116:119], a[208:223]
  ds_read_b64_tr_b16 v[94:95], v7 offset:52736
  v_mfma_f32_32x32x16_bf16 a[96:111], v[136:139], v[120:123], a[96:111]
  v_mfma_f32_32x32x16_bf16 a[224:239], v[140:143], v[120:123], a[224:239]
  v_mfma_f32_32x32x16_bf16 a[112:127], v[136:139], v[124:127], a[112:127]
  v_mfma_f32_32x32x16_bf16 a[240:255], v[140:143], v[124:127], a[240:255]
  s_waitcnt lgkmcnt(0)
  v_mfma_f32_32x32x16_bf16 a[0:15], v[64:67], v[128:131], a[0:15]
  ds_read_b128 v[136:139], v27 offset:32768
  ds_read_b128 v[140:143], v27 offset:36864
  v_mfma_f32_32x32x16_bf16 a[128:143], v[64:67], v[132:135], a[128:143]
  ds_read_b64_tr_b16 v[96:97], v6 offset:57344
  v_mfma_f32_32x32x16_bf16 a[16:31], v[68:71], v[128:131], a[16:31]
  ds_read_b64_tr_b16 v[98:99], v6 offset:57856
  ds_read_b64_tr_b16 v[100:101], v7 offset:57344
  v_mfma_f32_32x32x16_bf16 a[144:159], v[68:71], v[132:135], a[144:159]
  ds_read_b64_tr_b16 v[102:103], v7 offset:57856
  v_mfma_f32_32x32x16_bf16 a[32:47], v[72:75], v[128:131], a[32:47]
  ds_read_b64_tr_b16 v[104:105], v6 offset:58368
  ds_read_b64_tr_b16 v[106:107], v6 offset:58880
  v_mfma_f32_32x32x16_bf16 a[160:175], v[72:75], v[132:135], a[160:175]
  ds_read_b64_tr_b16 v[108:109], v7 offset:58368
  v_mfma_f32_32x32x16_bf16 a[48:63], v[76:79], v[128:131], a[48:63]
  ds_read_b64_tr_b16 v[110:111], v7 offset:58880
  ds_read_b64_tr_b16 v[112:113], v6 offset:59392
  v_mfma_f32_32x32x16_bf16 a[176:191], v[76:79], v[132:135], a[176:191]
  ds_read_b64_tr_b16 v[114:115], v6 offset:59904
  v_mfma_f32_32x32x16_bf16 a[64:79], v[128:131], v[80:83], a[64:79]
  ds_read_b64_tr_b16 v[116:117], v7 offset:59392
  ds_read_b64_tr_b16 v[118:119], v7 offset:59904
  v_mfma_f32_32x32x16_bf16 a[192:207], v[132:135], v[80:83], a[192:207]
  ds_read_b64_tr_b16 v[120:121], v6 offset:60416
  v_mfma_f32_32x32x16_bf16 a[80:95], v[128:131], v[84:87], a[80:95]
  ds_read_b64_tr_b16 v[122:123], v6 offset:60928
  ds_read_b64_tr_b16 v[124:125], v7 offset:60416
  v_mfma_f32_32x32x16_bf16 a[208:223], v[132:135], v[84:87], a[208:223]
  ds_read_b64_tr_b16 v[126:127], v7 offset:60928
  v_mfma_f32_32x32x16_bf16 a[96:111], v[128:131], v[88:91], a[96:111]
  v_mfma_f32_32x32x16_bf16 a[224:239], v[132:135], v[88:91], a[224:239]
  v_mfma_f32_32x32x16_bf16 a[112:127], v[128:131], v[92:95], a[112:127]
  v_mfma_f32_32x32x16_bf16 a[240:255], v[132:135], v[92:95], a[240:255]
  s_waitcnt lgkmcnt(0)
  v_mfma_f32_32x32x16_bf16 a[0:15], v[96:99], v[136:139], a[0:15]
  s_sub_u32 s28, 15, s27
  s_lshl_b32 s28, s28, 2
  s_add_u32 s28, s28, s3
  s_lshl_b32 s29, s27, 2
  s_add_u32 s29, s29, s3
  v_mfma_f32_32x32x16_bf16 a[128:143], v[96:99], v[140:143], a[128:143]
  v_mfma_f32_32x32x16_bf16 a[16:31], v[100:103], v[136:139], a[16:31]
  v_mfma_f32_32x32x16_bf16 a[144:159], v[100:103], v[140:143], a[144:159]
  v_mfma_f32_32x32x16_bf16 a[32:47], v[104:107], v[136:139], a[32:47]
  v_mfma_f32_32x32x16_bf16 a[160:175], v[104:107], v[140:143], a[160:175]
  v_mov_b32 v2, s28
  v_mov_b32 v3, s29
  v_and_b32 v4, 1, v1
  v_cmp_eq_u32 vcc, 0, v4
  s_nop 1
  v_mfma_f32_32x32x16_bf16 a[48:63], v[108:111], v[136:139], a[48:63]
  v_mfma_f32_32x32x16_bf16 a[176:191], v[108:111], v[140:143], a[176:191]
  v_mfma_f32_32x32x16_bf16 a[64:79], v[136:139], v[112:115], a[64:79]
  v_mfma_f32_32x32x16_bf16 a[192:207], v[140:143], v[112:115], a[192:207]
  v_mfma_f32_32x32x16_bf16 a[80:95], v[136:139], v[116:119], a[80:95]
  v_cndmask_b32 v2, v3, v2, vcc
  v_lshlrev_b32 v2, 7, v2
  v_add_u32 v251, 524288, v2
  buffer_load_dword v250, v251, s[68:71], 0 offen sc1
  v_mfma_f32_32x32x16_bf16 a[208:223], v[140:143], v[116:119], a[208:223]
  v_mfma_f32_32x32x16_bf16 a[96:111], v[136:139], v[120:123], a[96:111]
  v_mfma_f32_32x32x16_bf16 a[224:239], v[140:143], v[120:123], a[224:239]
  v_mfma_f32_32x32x16_bf16 a[112:127], v[136:139], v[124:127], a[112:127]
  v_mfma_f32_32x32x16_bf16 a[240:255], v[140:143], v[124:127], a[240:255]
  s_barrier
  v_bfe_u32 v2, v1, 2, 2
  v_lshlrev_b32 v6, 7, v2
  v_bfe_u32 v2, v1, 3, 1
  v_lshl_add_u32 v6, v2, 6, v6
  v_bfe_u32 v2, v1, 4, 1
  v_lshl_add_u32 v6, v2, 5, v6
  v_and_b32 v2, 3, v1
  v_lshl_add_u32 v6, v2, 3, v6
  v_lshrrev_b32 v2, 5, v1
  v_mul_u32_u24 v2, 512, v2
  v_add_u32 v6, v6, v2
  v_add_u32 v6, 98304, v6
  v_xor_b32 v7, 64, v6
  v_lshrrev_b32 v2, 3, v1
  v_mul_u32_u24 v2, 8192, v2
  v_bfe_u32 v3, v1, 4, 1
  v_lshlrev_b32 v3, 2, v3
  v_and_b32 v4, 7, v1
  v_xor_b32 v3, v3, v4
  v_lshl_add_u32 v2, v3, 4, v2
  s_mul_i32 s31, s3, 131072
  v_add_u32 v2, s31, v2
  v_add_u32 v8, 4096, v2
  v_add_u32 v9, 3200, v2
  v_add_u32 v10, 67584, v2
  v_add_u32 v11, 66688, v2
  s_mul_i32 s31, s3, 4096
  s_add_u32 s31, s31, 98304
  s_lshl_b32 s30, s26, 8
  s_mov_b32 s32, 1048576
  s_add_u32 m0, s31, 0
  s_nop 0
  buffer_load_dwordx4 v8, s[72:75], s30 offen offset:0 lds
  buffer_load_dwordx4 v9, s[72:75], s30 offen offset:1024 lds
  buffer_load_dwordx4 v10, s[72:75], s30 offen offset:2048 lds
  buffer_load_dwordx4 v11, s[72:75], s30 offen offset:3072 lds
  s_add_u32 s30, s30, 524288
  s_add_u32 m0, s31, 16384
  s_nop 0
  buffer_load_dwordx4 v8, s[72:75], s30 offen offset:0 lds
  buffer_load_dwordx4 v9, s[72:75], s30 offen offset:1024 lds
  buffer_load_dwordx4 v10, s[72:75], s30 offen offset:2048 lds
  buffer_load_dwordx4 v11, s[72:75], s30 offen offset:3072 lds
  s_add_u32 s30, s30, 524288
  s_add_u32 m0, s31, 32768
  s_nop 0
  buffer_load_dwordx4 v8, s[72:75], s30 offen offset:0 lds
  buffer_load_dwordx4 v9, s[72:75], s30 offen offset:1024 lds
  buffer_load_dwordx4 v10, s[72:75], s30 offen offset:2048 lds
  buffer_load_dwordx4 v11, s[72:75], s30 offen offset:3072 lds
  s_add_u32 s30, s30, 524288
  s_add_u32 m0, s31, 49152
  s_nop 0
  buffer_load_dwordx4 v8, s[72:75], s30 offen offset:0 lds
  buffer_load_dwordx4 v9, s[72:75], s30 offen offset:1024 lds
  buffer_load_dwordx4 v10, s[72:75], s30 offen offset:2048 lds
  buffer_load_dwordx4 v11, s[72:75], s30 offen offset:3072 lds
  s_add_u32 s30, s30, 524288
  v_mov_b32 v14, v5
  s_lshl_b32 s33, s28, 16
  v_add_u32 v12, s33, v5
  s_lshl_b32 s33, s29, 16
  v_add_u32 v13, s33, v5
  s_lshl_b32 s36, s26, 19
  s_lshl_b32 s37, s27, 16
  s_add_u32 s36, s36, s37
  s_lshl_b32 s37, s3, 14
  s_add_u32 s36, s36, s37
  s_sub_u32 s48, s14, 4096
  s_subb_u32 s49, s15, 0
  s_and_b32 s49, s49, 0xffff
  s_mov_b32 s50, 8392704
  s_mov_b32 s51, 0x20000
  s_sub_u32 s52, s18, 4096
  s_subb_u32 s53, s19, 0
  s_and_b32 s53, s53, 0xffff
  s_mov_b32 s54, 7344128
  s_mov_b32 s55, 0x20000
  s_sub_u32 s56, s84, 4096
  s_subb_u32 s57, s85, 0
  s_and_b32 s57, s57, 0xffff
  s_mov_b32 s58, 7344128
  s_mov_b32 s59, 0x20000
  v_accvgpr_read_b32 v16, a128
  v_accvgpr_read_b32 v17, a129
  v_accvgpr_read_b32 v18, a130
  v_accvgpr_read_b32 v19, a131
  v_accvgpr_read_b32 v20, a132
  v_accvgpr_read_b32 v21, a133
  v_accvgpr_read_b32 v22, a134
  v_accvgpr_read_b32 v23, a135
  v_cvt_pk_bf16_f32 v208, v16, v17
  v_cvt_pk_bf16_f32 v209, v18, v19
  v_cvt_pk_bf16_f32 v210, v20, v21
  v_cvt_pk_bf16_f32 v211, v22, v23
  v_accvgpr_read_b32 v24, a136
  v_accvgpr_read_b32 v25, a137
  v_accvgpr_read_b32 v26, a138
  v_accvgpr_read_b32 v27, a139
  v_accvgpr_read_b32 v28, a140
  v_accvgpr_read_b32 v29, a141
  v_accvgpr_read_b32 v30, a142
  v_accvgpr_read_b32 v31, a143
  v_cvt_pk_bf16_f32 v212, v24, v25
  v_cvt_pk_bf16_f32 v213, v26, v27
  v_cvt_pk_bf16_f32 v214, v28, v29
  v_cvt_pk_bf16_f32 v215, v30, v31
  v_accvgpr_read_b32 v16, a144
  v_accvgpr_read_b32 v17, a145
  v_accvgpr_read_b32 v18, a146
  v_accvgpr_read_b32 v19, a147
  v_accvgpr_read_b32 v20, a148
  v_accvgpr_read_b32 v21, a149
  v_accvgpr_read_b32 v22, a150
  v_accvgpr_read_b32 v23, a151
  v_cvt_pk_bf16_f32 v216, v16, v17
  v_cvt_pk_bf16_f32 v217, v18, v19
  v_cvt_pk_bf16_f32 v218, v20, v21
  v_cvt_pk_bf16_f32 v219, v22, v23
  v_accvgpr_read_b32 v24, a152
  v_accvgpr_read_b32 v25, a153
  v_accvgpr_read_b32 v26, a154
  v_accvgpr_read_b32 v27, a155
  v_accvgpr_read_b32 v28, a156
  v_accvgpr_read_b32 v29, a157
  v_accvgpr_read_b32 v30, a158
  v_accvgpr_read_b32 v31, a159
  v_cvt_pk_bf16_f32 v220, v24, v25
  v_cvt_pk_bf16_f32 v221, v26, v27
  v_cvt_pk_bf16_f32 v222, v28, v29
  v_cvt_pk_bf16_f32 v223, v30, v31
  s_waitcnt vmcnt(16)
  v_cmp_ne_u32 vcc, 0x01010101, v250
  s_cbranch_vccnz at_h_sp
at_h_ok:
  buffer_load_dwordx4 a[128:131], v12, s[68:71], s32 offen offset:0 sc1
  buffer_load_dwordx4 a[132:135], v13, s[68:71], s32 offen offset:0 sc1
  buffer_load_dwordx4 a[136:139], v12, s[68:71], s32 offen offset:1024 sc1
  buffer_load_dwordx4 a[140:143], v13, s[68:71], s32 offen offset:1024 sc1
  buffer_load_dwordx4 a[144:147], v12, s[68:71], s32 offen offset:2048 sc1
  buffer_load_dwordx4 a[148:151], v13, s[68:71], s32 offen offset:2048 sc1
  buffer_load_dwordx4 a[152:155], v12, s[68:71], s32 offen offset:3072 sc1
  buffer_load_dwordx4 a[156:159], v13, s[68:71], s32 offen offset:3072 sc1
  s_add_u32 s32, s32, 4096
  v_accvgpr_read_b32 v16, a160
  v_accvgpr_read_b32 v17, a161
  v_accvgpr_read_b32 v18, a162
  v_accvgpr_read_b32 v19, a163
  v_accvgpr_read_b32 v20, a164
  v_accvgpr_read_b32 v21, a165
  v_accvgpr_read_b32 v22, a166
  v_accvgpr_read_b32 v23, a167
  v_cvt_pk_bf16_f32 v224, v16, v17
  v_cvt_pk_bf16_f32 v225, v18, v19
  v_cvt_pk_bf16_f32 v226, v20, v21
  v_cvt_pk_bf16_f32 v227, v22, v23
  v_accvgpr_read_b32 v24, a168
  v_accvgpr_read_b32 v25, a169
  v_accvgpr_read_b32 v26, a170
  v_accvgpr_read_b32 v27, a171
  v_accvgpr_read_b32 v28, a172
  v_accvgpr_read_b32 v29, a173
  v_accvgpr_read_b32 v30, a174
  v_accvgpr_read_b32 v31, a175
  v_cvt_pk_bf16_f32 v228, v24, v25
  v_cvt_pk_bf16_f32 v229, v26, v27
  v_cvt_pk_bf16_f32 v230, v28, v29
  v_cvt_pk_bf16_f32 v231, v30, v31
  v_accvgpr_read_b32 v16, a176
  v_accvgpr_read_b32 v17, a177
  v_accvgpr_read_b32 v18, a178
  v_accvgpr_read_b32 v19, a179
  v_accvgpr_read_b32 v20, a180
  v_accvgpr_read_b32 v21, a181
  v_accvgpr_read_b32 v22, a182
  v_accvgpr_read_b32 v23, a183
  v_cvt_pk_bf16_f32 v232, v16, v17
  v_cvt_pk_bf16_f32 v233, v18, v19
  v_cvt_pk_bf16_f32 v234, v20, v21
  v_cvt_pk_bf16_f32 v235, v22, v23
  v_accvgpr_read_b32 v24, a184
  v_accvgpr_read_b32 v25, a185
  v_accvgpr_read_b32 v26, a186
  v_accvgpr_read_b32 v27, a187
  v_accvgpr_read_b32 v28, a188
  v_accvgpr_read_b32 v29, a189
  v_accvgpr_read_b32 v30, a190
  v_accvgpr_read_b32 v31, a191
  v_cvt_pk_bf16_f32 v236, v24, v25
  v_cvt_pk_bf16_f32 v237, v26, v27
  v_cvt_pk_bf16_f32 v238, v28, v29
  v_cvt_pk_bf16_f32 v239, v30, v31
  buffer_load_dwordx4 a[160:163], v12, s[68:71], s32 offen offset:0 sc1
  buffer_load_dwordx4 a[164:167], v13, s[68:71], s32 offen offset:0 sc1
  buffer_load_dwordx4 a[168:171], v12, s[68:71], s32 offen offset:1024 sc1
  buffer_load_dwordx4 a[172:175], v13, s[68:71], s32 offen offset:1024 sc1
  buffer_load_dwordx4 a[176:179], v12, s[68:71], s32 offen offset:2048 sc1
  buffer_load_dwordx4 a[180:183], v13, s[68:71], s32 offen offset:2048 sc1
  buffer_load_dwordx4 a[184:187], v12, s[68:71], s32 offen offset:3072 sc1
  buffer_load_dwordx4 a[188:191], v13, s[68:71], s32 offen offset:3072 sc1
  s_add_u32 s32, s32, 4096
  v_accvgpr_read_b32 v16, a192
  v_accvgpr_read_b32 v17, a193
  v_accvgpr_read_b32 v18, a194
  v_accvgpr_read_b32 v19, a195
  v_accvgpr_read_b32 v20, a196
  v_accvgpr_read_b32 v21, a197
  v_accvgpr_read_b32 v22, a198
  v_accvgpr_read_b32 v23, a199
  v_cvt_pk_bf16_f32 v240, v16, v17
  v_cvt_pk_bf16_f32 v241, v18, v19
  v_cvt_pk_bf16_f32 v242, v20, v21
  v_cvt_pk_bf16_f32 v243, v22, v23
  v_accvgpr_read_b32 v24, a200
  v_accvgpr_read_b32 v25, a201
  v_accvgpr_read_b32 v26, a202
  v_accvgpr_read_b32 v27, a203
  v_accvgpr_read_b32 v28, a204
  v_accvgpr_read_b32 v29, a205
  v_accvgpr_read_b32 v30, a206
  v_accvgpr_read_b32 v31, a207
  v_cvt_pk_bf16_f32 v244, v24, v25
  v_cvt_pk_bf16_f32 v245, v26, v27
  v_cvt_pk_bf16_f32 v246, v28, v29
  v_cvt_pk_bf16_f32 v247, v30, v31
  v_accvgpr_read_b32 v16, a208
  v_accvgpr_read_b32 v17, a209
  v_accvgpr_read_b32 v18, a210
  v_accvgpr_read_b32 v19, a211
  v_accvgpr_read_b32 v20, a212
  v_accvgpr_read_b32 v21, a213
  v_accvgpr_read_b32 v22, a214
  v_accvgpr_read_b32 v23, a215
  v_cvt_pk_bf16_f32 v100, v16, v17
  v_cvt_pk_bf16_f32 v101, v18, v19
  v_cvt_pk_bf16_f32 v102, v20, v21
  v_cvt_pk_bf16_f32 v103, v22, v23
  v_accvgpr_read_b32 v24, a216
  v_accvgpr_read_b32 v25, a217
  v_accvgpr_read_b32 v26, a218
  v_accvgpr_read_b32 v27, a219
  v_accvgpr_read_b32 v28, a220
  v_accvgpr_read_b32 v29, a221
  v_accvgpr_read_b32 v30, a222
  v_accvgpr_read_b32 v31, a223
  v_cvt_pk_bf16_f32 v104, v24, v25
  v_cvt_pk_bf16_f32 v105, v26, v27
  v_cvt_pk_bf16_f32 v106, v28, v29
  v_cvt_pk_bf16_f32 v107, v30, v31
  buffer_load_dwordx4 a[192:195], v12, s[68:71], s32 offen offset:0 sc1
  buffer_load_dwordx4 a[196:199], v13, s[68:71], s32 offen offset:0 sc1
  buffer_load_dwordx4 a[200:203], v12, s[68:71], s32 offen offset:1024 sc1
  buffer_load_dwordx4 a[204:207], v13, s[68:71], s32 offen offset:1024 sc1
  buffer_load_dwordx4 a[208:211], v12, s[68:71], s32 offen offset:2048 sc1
  buffer_load_dwordx4 a[212:215], v13, s[68:71], s32 offen offset:2048 sc1
  buffer_load_dwordx4 a[216:219], v12, s[68:71], s32 offen offset:3072 sc1
  buffer_load_dwordx4 a[220:223], v13, s[68:71], s32 offen offset:3072 sc1
  s_add_u32 s32, s32, 4096
  v_accvgpr_read_b32 v16, a224
  v_accvgpr_read_b32 v17, a225
  v_accvgpr_read_b32 v18, a226
  v_accvgpr_read_b32 v19, a227
  v_accvgpr_read_b32 v20, a228
  v_accvgpr_read_b32 v21, a229
  v_accvgpr_read_b32 v22, a230
  v_accvgpr_read_b32 v23, a231
  v_cvt_pk_bf16_f32 v108, v16, v17
  v_cvt_pk_bf16_f32 v109, v18, v19
  v_cvt_pk_bf16_f32 v110, v20, v21
  v_cvt_pk_bf16_f32 v111, v22, v23
  v_accvgpr_read_b32 v24, a232
  v_accvgpr_read_b32 v25, a233
  v_accvgpr_read_b32 v26, a234
  v_accvgpr_read_b32 v27, a235
  v_accvgpr_read_b32 v28, a236
  v_accvgpr_read_b32 v29, a237
  v_accvgpr_read_b32 v30, a238
  v_accvgpr_read_b32 v31, a239
  v_cvt_pk_bf16_f32 v112, v24, v25
  v_cvt_pk_bf16_f32 v113, v26, v27
  v_cvt_pk_bf16_f32 v114, v28, v29
  v_cvt_pk_bf16_f32 v115, v30, v31
  v_accvgpr_read_b32 v16, a240
  v_accvgpr_read_b32 v17, a241
  v_accvgpr_read_b32 v18, a242
  v_accvgpr_read_b32 v19, a243
  v_accvgpr_read_b32 v20, a244
  v_accvgpr_read_b32 v21, a245
  v_accvgpr_read_b32 v22, a246
  v_accvgpr_read_b32 v23, a247
  v_cvt_pk_bf16_f32 v116, v16, v17
  v_cvt_pk_bf16_f32 v117, v18, v19
  v_cvt_pk_bf16_f32 v118, v20, v21
  v_cvt_pk_bf16_f32 v119, v22, v23
  v_accvgpr_read_b32 v24, a248
  v_accvgpr_read_b32 v25, a249
  v_accvgpr_read_b32 v26, a250
  v_accvgpr_read_b32 v27, a251
  v_accvgpr_read_b32 v28, a252
  v_accvgpr_read_b32 v29, a253
  v_accvgpr_read_b32 v30, a254
  v_accvgpr_read_b32 v31, a255
  v_cvt_pk_bf16_f32 v120, v24, v25
  v_cvt_pk_bf16_f32 v121, v26, v27
  v_cvt_pk_bf16_f32 v122, v28, v29
  v_cvt_pk_bf16_f32 v123, v30, v31
  buffer_load_dwordx4 a[224:227], v12, s[68:71], s32 offen offset:0 sc1
  buffer_load_dwordx4 a[228:231], v13, s[68:71], s32 offen offset:0 sc1
  buffer_load_dwordx4 a[232:235], v12, s[68:71], s32 offen offset:1024 sc1
  buffer_load_dwordx4 a[236:239], v13, s[68:71], s32 offen offset:1024 sc1
  s_add_u32 s37, s36, 25175040
  buffer_store_dwordx4 v[100:103], v5, s[68:71], s37 offen sc1
  s_add_u32 s37, s36, 25179136
  buffer_store_dwordx4 v[104:107], v5, s[68:71], s37 offen sc1
  s_add_u32 s37, s36, 25176064
  buffer_store_dwordx4 v[108:111], v5, s[68:71], s37 offen sc1
  s_add_u32 s37, s36, 25180160
  buffer_store_dwordx4 v[112:115], v5, s[68:71], s37 offen sc1
  s_add_u32 s37, s36, 25177088
  buffer_store_dwordx4 v[116:119], v5, s[68:71], s37 offen sc1
  s_add_u32 s37, s36, 25181184
  buffer_store_dwordx4 v[120:123], v5, s[68:71], s37 offen sc1
  s_add_u32 s40, s88, 0
  s_addc_u32 s41, s89, 0
  s_and_b32 s41, s41, 0xffff
  s_mov_b32 s42, 12582912
  s_mov_b32 s43, 0x20000
  s_add_u32 s44, s86, 0
  s_addc_u32 s45, s87, 0
  s_and_b32 s45, s45, 0xffff
  s_mov_b32 s46, 2048
  s_mov_b32 s47, 0x20000
  s_waitcnt vmcnt(26)
  s_barrier
  ds_read_b64_tr_b16 v[144:145], v6 offset:0
  ds_read_b64_tr_b16 v[146:147], v6 offset:2048
  ds_read_b64_tr_b16 v[148:149], v7 offset:0
  ds_read_b64_tr_b16 v[150:151], v7 offset:2048
  ds_read_b64_tr_b16 v[152:153], v6 offset:1024
  ds_read_b64_tr_b16 v[154:155], v6 offset:3072
  ds_read_b64_tr_b16 v[156:157], v7 offset:1024
  ds_read_b64_tr_b16 v[158:159], v7 offset:3072
  ds_read_b64_tr_b16 v[160:161], v6 offset:4096
  ds_read_b64_tr_b16 v[162:163], v6 offset:6144
  ds_read_b64_tr_b16 v[164:165], v7 offset:4096
  ds_read_b64_tr_b16 v[166:167], v7 offset:6144
  ds_read_b64_tr_b16 v[168:169], v6 offset:5120
  ds_read_b64_tr_b16 v[170:171], v6 offset:7168
  ds_read_b64_tr_b16 v[172:173], v7 offset:5120
  ds_read_b64_tr_b16 v[174:175], v7 offset:7168
  s_waitcnt lgkmcnt(0)
  v_mfma_f32_32x32x16_bf16 v[16:31], v[144:147], a[128:131], 0
  ds_read_b64_tr_b16 v[176:177], v6 offset:8192
  ds_read_b64_tr_b16 v[178:179], v6 offset:10240
  buffer_load_dwordx4 a[240:243], v12, s[68:71], s32 offen offset:2048 sc1
  s_add_u32 s37, s36, 8396800
  buffer_store_dwordx4 v[208:211], v5, s[68:71], s37 offen sc1
  v_mfma_f32_32x32x16_bf16 v[80:95], v[144:147], a[132:135], 0
  ds_read_b64_tr_b16 v[180:181], v7 offset:8192
  buffer_load_dwordx4 a[244:247], v13, s[68:71], s32 offen offset:2048 sc1
  v_mfma_f32_32x32x16_bf16 v[32:47], v[148:151], a[128:131], 0
  ds_read_b64_tr_b16 v[182:183], v7 offset:10240
  v_mfma_f32_32x32x16_bf16 v[96:111], v[148:151], a[132:135], 0
  ds_read_b64_tr_b16 v[184:185], v6 offset:9216
  ds_read_b64_tr_b16 v[186:187], v6 offset:11264
  buffer_load_dwordx4 a[248:251], v12, s[68:71], s32 offen offset:3072 sc1
  v_mfma_f32_32x32x16_bf16 v[48:63], v[152:155], a[128:131], 0
  ds_read_b64_tr_b16 v[188:189], v7 offset:9216
  v_mfma_f32_32x32x16_bf16 v[112:127], v[152:155], a[132:135], 0
  ds_read_b64_tr_b16 v[190:191], v7 offset:11264
  buffer_load_dwordx4 a[252:255], v13, s[68:71], s32 offen offset:3072 sc1
  s_add_u32 s32, s32, 4096
  v_mfma_f32_32x32x16_bf16 v[64:79], v[156:159], a[128:131], 0
  ds_read_b64_tr_b16 v[192:193], v6 offset:12288
  ds_read_b64_tr_b16 v[194:195], v6 offset:14336
  v_mfma_f32_32x32x16_bf16 v[128:143], v[156:159], a[132:135], 0
  ds_read_b64_tr_b16 v[196:197], v7 offset:12288
  v_mfma_f32_32x32x16_bf16 v[16:31], v[160:163], a[136:139], v[16:31]
  ds_read_b64_tr_b16 v[198:199], v7 offset:14336
  v_mfma_f32_32x32x16_bf16 v[80:95], v[160:163], a[140:143], v[80:95]
  ds_read_b64_tr_b16 v[200:201], v6 offset:13312
  ds_read_b64_tr_b16 v[202:203], v6 offset:15360
  v_mfma_f32_32x32x16_bf16 v[32:47], v[164:167], a[136:139], v[32:47]
  ds_read_b64_tr_b16 v[204:205], v7 offset:13312
  v_mfma_f32_32x32x16_bf16 v[96:111], v[164:167], a[140:143], v[96:111]
  ds_read_b64_tr_b16 v[206:207], v7 offset:15360
  v_mfma_f32_32x32x16_bf16 v[48:63], v[168:171], a[136:139], v[48:63]
  v_mfma_f32_32x32x16_bf16 v[112:127], v[168:171], a[140:143], v[112:127]
  v_mfma_f32_32x32x16_bf16 v[64:79], v[172:175], a[136:139], v[64:79]
  v_mfma_f32_32x32x16_bf16 v[128:143], v[172:175], a[140:143], v[128:143]
  s_waitcnt vmcnt(23) lgkmcnt(0)
  s_barrier
  v_mfma_f32_32x32x16_bf16 v[16:31], v[176:179], a[144:147], v[16:31]
  ds_read_b64_tr_b16 v[144:145], v6 offset:16384
  ds_read_b64_tr_b16 v[146:147], v6 offset:18432
  s_add_u32 m0, s31, 0
  s_nop 0
  buffer_load_dwordx4 v8, s[72:75], s30 offen offset:0 lds
  s_add_u32 s37, s36, 8397824
  buffer_store_dwordx4 v[212:215], v5, s[68:71], s37 offen sc1
  v_mfma_f32_32x32x16_bf16 v[80:95], v[176:179], a[148:151], v[80:95]
  ds_read_b64_tr_b16 v[148:149], v7 offset:16384
  buffer_load_dwordx4 v9, s[72:75], s30 offen offset:1024 lds
  v_mfma_f32_32x32x16_bf16 v[32:47], v[180:183], a[144:147], v[32:47]
  ds_read_b64_tr_b16 v[150:151], v7 offset:18432
  v_mfma_f32_32x32x16_bf16 v[96:111], v[180:183], a[148:151], v[96:111]
  ds_read_b64_tr_b16 v[152:153], v6 offset:17408
  ds_read_b64_tr_b16 v[154:155], v6 offset:19456
  buffer_load_dwordx4 v10, s[72:75], s30 offen offset:2048 lds
  v_mfma_f32_32x32x16_bf16 v[48:63], v[184:187], a[144:147], v[48:63]
  ds_read_b64_tr_b16 v[156:157], v7 offset:17408
  v_mfma_f32_32x32x16_bf16 v[112:127], v[184:187], a[148:151], v[112:127]
  ds_read_b64_tr_b16 v[158:159], v7 offset:19456
  buffer_load_dwordx4 v11, s[72:75], s30 offen offset:3072 lds
  v_mfma_f32_32x32x16_bf16 v[64:79], v[188:191], a[144:147], v[64:79]
  ds_read_b64_tr_b16 v[160:161], v6 offset:20480
  ds_read_b64_tr_b16 v[162:163], v6 offset:22528
  v_mfma_f32_32x32x16_bf16 v[128:143], v[188:191], a[148:151], v[128:143]
  ds_read_b64_tr_b16 v[164:165], v7 offset:20480
  s_add_u32 s30, s30, 524288
  v_mfma_f32_32x32x16_bf16 v[16:31], v[192:195], a[152:155], v[16:31]
  ds_read_b64_tr_b16 v[166:167], v7 offset:22528
  buffer_load_dwordx4 a[128:131], v12, s[68:71], s32 offen offset:0 sc1
  v_mfma_f32_32x32x16_bf16 v[80:95], v[192:195], a[156:159], v[80:95]
  ds_read_b64_tr_b16 v[168:169], v6 offset:21504
  ds_read_b64_tr_b16 v[170:171], v6 offset:23552
  v_mfma_f32_32x32x16_bf16 v[32:47], v[196:199], a[152:155], v[32:47]
  ds_read_b64_tr_b16 v[172:173], v7 offset:21504
  buffer_load_dwordx4 a[132:135], v13, s[68:71], s32 offen offset:0 sc1
  v_mfma_f32_32x32x16_bf16 v[96:111], v[196:199], a[156:159], v[96:111]
  ds_read_b64_tr_b16 v[174:175], v7 offset:23552
  v_mfma_f32_32x32x16_bf16 v[48:63], v[200:203], a[152:155], v[48:63]
  buffer_load_dwordx4 a[136:139], v12, s[68:71], s32 offen offset:1024 sc1
  v_mfma_f32_32x32x16_bf16 v[112:127], v[200:203], a[156:159], v[112:127]
  v_mfma_f32_32x32x16_bf16 v[64:79], v[204:207], a[152:155], v[64:79]
  buffer_load_dwordx4 a[140:143], v13, s[68:71], s32 offen offset:1024 sc1
  v_mfma_f32_32x32x16_bf16 v[128:143], v[204:207], a[156:159], v[128:143]
  s_waitcnt lgkmcnt(0)
  v_mfma_f32_32x32x16_bf16 v[16:31], v[144:147], a[160:163], v[16:31]
  ds_read_b64_tr_b16 v[176:177], v6 offset:24576
  ds_read_b64_tr_b16 v[178:179], v6 offset:26624
  buffer_load_dwordx4 a[144:147], v12, s[68:71], s32 offen offset:2048 sc1
  s_add_u32 s37, s36, 8398848
  buffer_store_dwordx4 v[216:219], v5, s[68:71], s37 offen sc1
  v_mfma_f32_32x32x16_bf16 v[80:95], v[144:147], a[164:167], v[80:95]
  ds_read_b64_tr_b16 v[180:181], v7 offset:24576
  buffer_load_dwordx4 a[148:151], v13, s[68:71], s32 offen offset:2048 sc1
  v_mfma_f32_32x32x16_bf16 v[32:47], v[148:151], a[160:163], v[32:47]
  ds_read_b64_tr_b16 v[182:183], v7 offset:26624
  v_mfma_f32_32x32x16_bf16 v[96:111], v[148:151], a[164:167], v[96:111]
  ds_read_b64_tr_b16 v[184:185], v6 offset:25600
  ds_read_b64_tr_b16 v[186:187], v6 offset:27648
  buffer_load_dwordx4 a[152:155], v12, s[68:71], s32 offen offset:3072 sc1
  v_mfma_f32_32x32x16_bf16 v[48:63], v[152:155], a[160:163], v[48:63]
  ds_read_b64_tr_b16 v[188:189], v7 offset:25600
  v_mfma_f32_32x32x16_bf16 v[112:127], v[152:155], a[164:167], v[112:127]
  ds_read_b64_tr_b16 v[190:191], v7 offset:27648
  buffer_load_dwordx4 a[156:159], v13, s[68:71], s32 offen offset:3072 sc1
  s_add_u32 s32, s32, 4096
  v_mfma_f32_32x32x16_bf16 v[64:79], v[156:159], a[160:163], v[64:79]
  ds_read_b64_tr_b16 v[192:193], v6 offset:28672
  ds_read_b64_tr_b16 v[194:195], v6 offset:30720
  v_mfma_f32_32x32x16_bf16 v[128:143], v[156:159], a[164:167], v[128:143]
  ds_read_b64_tr_b16 v[196:197], v7 offset:28672
  v_mfma_f32_32x32x16_bf16 v[16:31], v[160:163], a[168:171], v[16:31]
  ds_read_b64_tr_b16 v[198:199], v7 offset:30720
  v_mfma_f32_32x32x16_bf16 v[80:95], v[160:163], a[172:175], v[80:95]
  ds_read_b64_tr_b16 v[200:201], v6 offset:29696
  ds_read_b64_tr_b16 v[202:203], v6 offset:31744
  v_mfma_f32_32x32x16_bf16 v[32:47], v[164:167], a[168:171], v[32:47]
  ds_read_b64_tr_b16 v[204:205], v7 offset:29696
  v_mfma_f32_32x32x16_bf16 v[96:111], v[164:167], a[172:175], v[96:111]
  ds_read_b64_tr_b16 v[206:207], v7 offset:31744
  v_mfma_f32_32x32x16_bf16 v[48:63], v[168:171], a[168:171], v[48:63]
  v_mfma_f32_32x32x16_bf16 v[112:127], v[168:171], a[172:175], v[112:127]
  v_mfma_f32_32x32x16_bf16 v[64:79], v[172:175], a[168:171], v[64:79]
  v_mfma_f32_32x32x16_bf16 v[128:143], v[172:175], a[172:175], v[128:143]
  s_waitcnt vmcnt(29) lgkmcnt(0)
  s_barrier
  v_mfma_f32_32x32x16_bf16 v[16:31], v[176:179], a[176:179], v[16:31]
  ds_read_b64_tr_b16 v[144:145], v6 offset:32768
  ds_read_b64_tr_b16 v[146:147], v6 offset:34816
  s_add_u32 m0, s31, 16384
  s_nop 0
  buffer_load_dwordx4 v8, s[72:75], s30 offen offset:0 lds
  s_add_u32 s37, s36, 8399872
  buffer_store_dwordx4 v[220:223], v5, s[68:71], s37 offen sc1
  v_mfma_f32_32x32x16_bf16 v[80:95], v[176:179], a[180:183], v[80:95]
  ds_read_b64_tr_b16 v[148:149], v7 offset:32768
  buffer_load_dwordx4 v9, s[72:75], s30 offen offset:1024 lds
  v_mfma_f32_32x32x16_bf16 v[32:47], v[180:183], a[176:179], v[32:47]
  ds_read_b64_tr_b16 v[150:151], v7 offset:34816
  v_mfma_f32_32x32x16_bf16 v[96:111], v[180:183], a[180:183], v[96:111]
  ds_read_b64_tr_b16 v[152:153], v6 offset:33792
  ds_read_b64_tr_b16 v[154:155], v6 offset:35840
  buffer_load_dwordx4 v10, s[72:75], s30 offen offset:2048 lds
  v_mfma_f32_32x32x16_bf16 v[48:63], v[184:187], a[176:179], v[48:63]
  ds_read_b64_tr_b16 v[156:157], v7 offset:33792
  v_mfma_f32_32x32x16_bf16 v[112:127], v[184:187], a[180:183], v[112:127]
  ds_read_b64_tr_b16 v[158:159], v7 offset:35840
  buffer_load_dwordx4 v11, s[72:75], s30 offen offset:3072 lds
  v_mfma_f32_32x32x16_bf16 v[64:79], v[188:191], a[176:179], v[64:79]
  ds_read_b64_tr_b16 v[160:161], v6 offset:36864
  ds_read_b64_tr_b16 v[162:163], v6 offset:38912
  v_mfma_f32_32x32x16_bf16 v[128:143], v[188:191], a[180:183], v[128:143]
  ds_read_b64_tr_b16 v[164:165], v7 offset:36864
  s_add_u32 s30, s30, 524288
  v_mfma_f32_32x32x16_bf16 v[16:31], v[192:195], a[184:187], v[16:31]
  ds_read_b64_tr_b16 v[166:167], v7 offset:38912
  buffer_load_dwordx4 a[160:163], v12, s[68:71], s32 offen offset:0 sc1
  s_add_u32 s37, s36, 8400896
  buffer_store_dwordx4 v[224:227], v5, s[68:71], s37 offen sc1
  v_mfma_f32_32x32x16_bf16 v[80:95], v[192:195], a[188:191], v[80:95]
  ds_read_b64_tr_b16 v[168:169], v6 offset:37888
  ds_read_b64_tr_b16 v[170:171], v6 offset:39936
  v_mfma_f32_32x32x16_bf16 v[32:47], v[196:199], a[184:187], v[32:47]
  ds_read_b64_tr_b16 v[172:173], v7 offset:37888
  buffer_load_dwordx4 a[164:167], v13, s[68:71], s32 offen offset:0 sc1
  v_mfma_f32_32x32x16_bf16 v[96:111], v[196:199], a[188:191], v[96:111]
  ds_read_b64_tr_b16 v[174:175], v7 offset:39936
  v_mfma_f32_32x32x16_bf16 v[48:63], v[200:203], a[184:187], v[48:63]
  buffer_load_dwordx4 a[168:171], v12, s[68:71], s32 offen offset:1024 sc1
  v_mfma_f32_32x32x16_bf16 v[112:127], v[200:203], a[188:191], v[112:127]
  v_mfma_f32_32x32x16_bf16 v[64:79], v[204:207], a[184:187], v[64:79]
  buffer_load_dwordx4 a[172:175], v13, s[68:71], s32 offen offset:1024 sc1
  v_mfma_f32_32x32x16_bf16 v[128:143], v[204:207], a[188:191], v[128:143]
  s_waitcnt lgkmcnt(0)
  v_mfma_f32_32x32x16_bf16 v[16:31], v[144:147], a[192:195], v[16:31]
  ds_read_b64_tr_b16 v[176:177], v6 offset:40960
  ds_read_b64_tr_b16 v[178:179], v6 offset:43008
  buffer_load_dwordx4 a[176:179], v12, s[68:71], s32 offen offset:2048 sc1
  s_add_u32 s37, s36, 8401920
  buffer_store_dwordx4 v[228:231], v5, s[68:71], s37 offen sc1
  v_mfma_f32_32x32x16_bf16 v[80:95], v[144:147], a[196:199], v[80:95]
  ds_read_b64_tr_b16 v[180:181], v7 offset:40960
  buffer_load_dwordx4 a[180:183], v13, s[68:71], s32 offen offset:2048 sc1
  v_mfma_f32_32x32x16_bf16 v[32:47], v[148:151], a[192:195], v[32:47]
  ds_read_b64_tr_b16 v[182:183], v7 offset:43008
  v_mfma_f32_32x32x16_bf16 v[96:111], v[148:151], a[196:199], v[96:111]
  ds_read_b64_tr_b16 v[184:185], v6 offset:41984
  ds_read_b64_tr_b16 v[186:187], v6 offset:44032
  buffer_load_dwordx4 a[184:187], v12, s[68:71], s32 offen offset:3072 sc1
  v_mfma_f32_32x32x16_bf16 v[48:63], v[152:155], a[192:195], v[48:63]
  ds_read_b64_tr_b16 v[188:189], v7 offset:41984
  v_mfma_f32_32x32x16_bf16 v[112:127], v[152:155], a[196:199], v[112:127]
  ds_read_b64_tr_b16 v[190:191], v7 offset:44032
  buffer_load_dwordx4 a[188:191], v13, s[68:71], s32 offen offset:3072 sc1
  s_add_u32 s32, s32, 4096
  v_mfma_f32_32x32x16_bf16 v[64:79], v[156:159], a[192:195], v[64:79]
  ds_read_b64_tr_b16 v[192:193], v6 offset:45056
  ds_read_b64_tr_b16 v[194:195], v6 offset:47104
  v_mfma_f32_32x32x16_bf16 v[128:143], v[156:159], a[196:199], v[128:143]
  ds_read_b64_tr_b16 v[196:197], v7 offset:45056
  v_mfma_f32_32x32x16_bf16 v[16:31], v[160:163], a[200:203], v[16:31]
  ds_read_b64_tr_b16 v[198:199], v7 offset:47104
  v_mfma_f32_32x32x16_bf16 v[80:95], v[160:163], a[204:207], v[80:95]
  ds_read_b64_tr_b16 v[200:201], v6 offset:46080
  ds_read_b64_tr_b16 v[202:203], v6 offset:48128
  v_mfma_f32_32x32x16_bf16 v[32:47], v[164:167], a[200:203], v[32:47]
  ds_read_b64_tr_b16 v[204:205], v7 offset:46080
  v_mfma_f32_32x32x16_bf16 v[96:111], v[164:167], a[204:207], v[96:111]
  ds_read_b64_tr_b16 v[206:207], v7 offset:48128
  v_mfma_f32_32x32x16_bf16 v[48:63], v[168:171], a[200:203], v[48:63]
  v_mfma_f32_32x32x16_bf16 v[112:127], v[168:171], a[204:207], v[112:127]
  v_mfma_f32_32x32x16_bf16 v[64:79], v[172:175], a[200:203], v[64:79]
  v_mfma_f32_32x32x16_bf16 v[128:143], v[172:175], a[204:207], v[128:143]
  s_waitcnt vmcnt(29) lgkmcnt(0)
  s_barrier
  v_mfma_f32_32x32x16_bf16 v[16:31], v[176:179], a[208:211], v[16:31]
  ds_read_b64_tr_b16 v[144:145], v6 offset:49152
  ds_read_b64_tr_b16 v[146:147], v6 offset:51200
  s_add_u32 m0, s31, 32768
  s_nop 0
  buffer_load_dwordx4 v8, s[72:75], s30 offen offset:0 lds
  s_add_u32 s37, s36, 8402944
  buffer_store_dwordx4 v[232:235], v5, s[68:71], s37 offen sc1
  v_mfma_f32_32x32x16_bf16 v[80:95], v[176:179], a[212:215], v[80:95]
  ds_read_b64_tr_b16 v[148:149], v7 offset:49152
  buffer_load_dwordx4 v9, s[72:75], s30 offen offset:1024 lds
  v_mfma_f32_32x32x16_bf16 v[32:47], v[180:183], a[208:211], v[32:47]
  ds_read_b64_tr_b16 v[150:151], v7 offset:51200
  v_mfma_f32_32x32x16_bf16 v[96:111], v[180:183], a[212:215], v[96:111]
  ds_read_b64_tr_b16 v[152:153], v6 offset:50176
  ds_read_b64_tr_b16 v[154:155], v6 offset:52224
  buffer_load_dwordx4 v10, s[72:75], s30 offen offset:2048 lds
  v_mfma_f32_32x32x16_bf16 v[48:63], v[184:187], a[208:211], v[48:63]
  ds_read_b64_tr_b16 v[156:157], v7 offset:50176
  v_mfma_f32_32x32x16_bf16 v[112:127], v[184:187], a[212:215], v[112:127]
  ds_read_b64_tr_b16 v[158:159], v7 offset:52224
  buffer_load_dwordx4 v11, s[72:75], s30 offen offset:3072 lds
  v_mfma_f32_32x32x16_bf16 v[64:79], v[188:191], a[208:211], v[64:79]
  ds_read_b64_tr_b16 v[160:161], v6 offset:53248
  ds_read_b64_tr_b16 v[162:163], v6 offset:55296
  v_mfma_f32_32x32x16_bf16 v[128:143], v[188:191], a[212:215], v[128:143]
  ds_read_b64_tr_b16 v[164:165], v7 offset:53248
  s_add_u32 s30, s30, 524288
  v_mfma_f32_32x32x16_bf16 v[16:31], v[192:195], a[216:219], v[16:31]
  ds_read_b64_tr_b16 v[166:167], v7 offset:55296
  buffer_load_dwordx4 a[192:195], v12, s[68:71], s32 offen offset:0 sc1
  v_mfma_f32_32x32x16_bf16 v[80:95], v[192:195], a[220:223], v[80:95]
  ds_read_b64_tr_b16 v[168:169], v6 offset:54272
  ds_read_b64_tr_b16 v[170:171], v6 offset:56320
  v_mfma_f32_32x32x16_bf16 v[32:47], v[196:199], a[216:219], v[32:47]
  ds_read_b64_tr_b16 v[172:173], v7 offset:54272
  buffer_load_dwordx4 a[196:199], v13, s[68:71], s32 offen offset:0 sc1
  v_mfma_f32_32x32x16_bf16 v[96:111], v[196:199], a[220:223], v[96:111]
  ds_read_b64_tr_b16 v[174:175], v7 offset:56320
  v_mfma_f32_32x32x16_bf16 v[48:63], v[200:203], a[216:219], v[48:63]
  buffer_load_dwordx4 a[200:203], v12, s[68:71], s32 offen offset:1024 sc1
  v_mfma_f32_32x32x16_bf16 v[112:127], v[200:203], a[220:223], v[112:127]
  v_mfma_f32_32x32x16_bf16 v[64:79], v[204:207], a[216:219], v[64:79]
  buffer_load_dwordx4 a[204:207], v13, s[68:71], s32 offen offset:1024 sc1
  v_mfma_f32_32x32x16_bf16 v[128:143], v[204:207], a[220:223], v[128:143]
  s_waitcnt lgkmcnt(0)
  v_mfma_f32_32x32x16_bf16 v[16:31], v[144:147], a[224:227], v[16:31]
  ds_read_b64_tr_b16 v[176:177], v6 offset:57344
  ds_read_b64_tr_b16 v[178:179], v6 offset:59392
  buffer_load_dwordx4 a[208:211], v12, s[68:71], s32 offen offset:2048 sc1
  s_add_u32 s37, s36, 8403968
  buffer_store_dwordx4 v[236:239], v5, s[68:71], s37 offen sc1
  v_mfma_f32_32x32x16_bf16 v[80:95], v[144:147], a[228:231], v[80:95]
  ds_read_b64_tr_b16 v[180:181], v7 offset:57344
  buffer_load_dwordx4 a[212:215], v13, s[68:71], s32 offen offset:2048 sc1
  v_mfma_f32_32x32x16_bf16 v[32:47], v[148:151], a[224:227], v[32:47]
  ds_read_b64_tr_b16 v[182:183], v7 offset:59392
  v_mfma_f32_32x32x16_bf16 v[96:111], v[148:151], a[228:231], v[96:111]
  ds_read_b64_tr_b16 v[184:185], v6 offset:58368
  ds_read_b64_tr_b16 v[186:187], v6 offset:60416
  buffer_load_dwordx4 a[216:219], v12, s[68:71], s32 offen offset:3072 sc1
  v_mfma_f32_32x32x16_bf16 v[48:63], v[152:155], a[224:227], v[48:63]
  ds_read_b64_tr_b16 v[188:189], v7 offset:58368
  v_mfma_f32_32x32x16_bf16 v[112:127], v[152:155], a[228:231], v[112:127]
  ds_read_b64_tr_b16 v[190:191], v7 offset:60416
  buffer_load_dwordx4 a[220:223], v13, s[68:71], s32 offen offset:3072 sc1
  s_add_u32 s32, s32, 4096
  v_mfma_f32_32x32x16_bf16 v[64:79], v[156:159], a[224:227], v[64:79]
  ds_read_b64_tr_b16 v[192:193], v6 offset:61440
  ds_read_b64_tr_b16 v[194:195], v6 offset:63488
  v_mfma_f32_32x32x16_bf16 v[128:143], v[156:159], a[228:231], v[128:143]
  ds_read_b64_tr_b16 v[196:197], v7 offset:61440
  v_mfma_f32_32x32x16_bf16 v[16:31], v[160:163], a[232:235], v[16:31]
  ds_read_b64_tr_b16 v[198:199], v7 offset:63488
  v_mfma_f32_32x32x16_bf16 v[80:95], v[160:163], a[236:239], v[80:95]
  ds_read_b64_tr_b16 v[200:201], v6 offset:62464
  ds_read_b64_tr_b16 v[202:203], v6 offset:64512
  v_mfma_f32_32x32x16_bf16 v[32:47], v[164:167], a[232:235], v[32:47]
  ds_read_b64_tr_b16 v[204:205], v7 offset:62464
  v_mfma_f32_32x32x16_bf16 v[96:111], v[164:167], a[236:239], v[96:111]
  ds_read_b64_tr_b16 v[206:207], v7 offset:64512
  v_mfma_f32_32x32x16_bf16 v[48:63], v[168:171], a[232:235], v[48:63]
  v_mfma_f32_32x32x16_bf16 v[112:127], v[168:171], a[236:239], v[112:127]
  v_mfma_f32_32x32x16_bf16 v[64:79], v[172:175], a[232:235], v[64:79]
  v_mfma_f32_32x32x16_bf16 v[128:143], v[172:175], a[236:239], v[128:143]
  s_waitcnt vmcnt(29) lgkmcnt(0)
  s_barrier
  v_mfma_f32_32x32x16_bf16 v[16:31], v[176:179], a[240:243], v[16:31]
  ds_read_b64_tr_b16 v[144:145], v6 offset:0
  ds_read_b64_tr_b16 v[146:147], v6 offset:2048
  s_add_u32 m0, s31, 49152
  s_nop 0
  buffer_load_dwordx4 v8, s[72:75], s30 offen offset:0 lds
  s_add_u32 s37, s36, 25174016
  buffer_store_dwordx4 v[240:243], v5, s[68:71], s37 offen sc1
  v_mfma_f32_32x32x16_bf16 v[80:95], v[176:179], a[244:247], v[80:95]
  ds_read_b64_tr_b16 v[148:149], v7 offset:0
  buffer_load_dwordx4 v9, s[72:75], s30 offen offset:1024 lds
  v_mfma_f32_32x32x16_bf16 v[32:47], v[180:183], a[240:243], v[32:47]
  ds_read_b64_tr_b16 v[150:151], v7 offset:2048
  v_mfma_f32_32x32x16_bf16 v[96:111], v[180:183], a[244:247], v[96:111]
  ds_read_b64_tr_b16 v[152:153], v6 offset:1024
  ds_read_b64_tr_b16 v[154:155], v6 offset:3072
  buffer_load_dwordx4 v10, s[72:75], s30 offen offset:2048 lds
  v_mfma_f32_32x32x16_bf16 v[48:63], v[184:187], a[240:243], v[48:63]
  ds_read_b64_tr_b16 v[156:157], v7 offset:1024
  v_mfma_f32_32x32x16_bf16 v[112:127], v[184:187], a[244:247], v[112:127]
  ds_read_b64_tr_b16 v[158:159], v7 offset:3072
  buffer_load_dwordx4 v11, s[72:75], s30 offen offset:3072 lds
  v_mfma_f32_32x32x16_bf16 v[64:79], v[188:191], a[240:243], v[64:79]
  ds_read_b64_tr_b16 v[160:161], v6 offset:4096
  ds_read_b64_tr_b16 v[162:163], v6 offset:6144
  v_mfma_f32_32x32x16_bf16 v[128:143], v[188:191], a[244:247], v[128:143]
  ds_read_b64_tr_b16 v[164:165], v7 offset:4096
  s_add_u32 s30, s30, 524288
  v_mfma_f32_32x32x16_bf16 v[16:31], v[192:195], a[248:251], v[16:31]
  ds_read_b64_tr_b16 v[166:167], v7 offset:6144
  buffer_load_dwordx4 a[224:227], v12, s[68:71], s32 offen offset:0 sc1
  s_add_u32 s37, s36, 25178112
  buffer_store_dwordx4 v[244:247], v5, s[68:71], s37 offen sc1
  v_mfma_f32_32x32x16_bf16 v[80:95], v[192:195], a[252:255], v[80:95]
  ds_read_b64_tr_b16 v[168:169], v6 offset:5120
  ds_read_b64_tr_b16 v[170:171], v6 offset:7168
  v_mfma_f32_32x32x16_bf16 v[32:47], v[196:199], a[248:251], v[32:47]
  ds_read_b64_tr_b16 v[172:173], v7 offset:5120
  buffer_load_dwordx4 a[228:231], v13, s[68:71], s32 offen offset:0 sc1
  v_mfma_f32_32x32x16_bf16 v[96:111], v[196:199], a[252:255], v[96:111]
  ds_read_b64_tr_b16 v[174:175], v7 offset:7168
  v_mfma_f32_32x32x16_bf16 v[48:63], v[200:203], a[248:251], v[48:63]
  buffer_load_dwordx4 a[232:235], v12, s[68:71], s32 offen offset:1024 sc1
  v_mfma_f32_32x32x16_bf16 v[112:127], v[200:203], a[252:255], v[112:127]
  v_mfma_f32_32x32x16_bf16 v[64:79], v[204:207], a[248:251], v[64:79]
  buffer_load_dwordx4 a[236:239], v13, s[68:71], s32 offen offset:1024 sc1
  v_mfma_f32_32x32x16_bf16 v[128:143], v[204:207], a[252:255], v[128:143]
  s_waitcnt lgkmcnt(0)
  v_mfma_f32_32x32x16_bf16 v[16:31], v[144:147], a[128:131], v[16:31]
  ds_read_b64_tr_b16 v[176:177], v6 offset:8192
  ds_read_b64_tr_b16 v[178:179], v6 offset:10240
  buffer_load_dwordx4 a[240:243], v12, s[68:71], s32 offen offset:2048 sc1
  v_accvgpr_read_b32 v208, a0
  v_accvgpr_read_b32 v209, a1
  v_mfma_f32_32x32x16_bf16 v[80:95], v[144:147], a[132:135], v[80:95]
  ds_read_b64_tr_b16 v[180:181], v7 offset:8192
  buffer_load_dwordx4 a[244:247], v13, s[68:71], s32 offen offset:2048 sc1
  v_accvgpr_read_b32 v210, a2
  v_mfma_f32_32x32x16_bf16 v[32:47], v[148:151], a[128:131], v[32:47]
  ds_read_b64_tr_b16 v[182:183], v7 offset:10240
  v_accvgpr_read_b32 v211, a3
  v_mfma_f32_32x32x16_bf16 v[96:111], v[148:151], a[132:135], v[96:111]
  ds_read_b64_tr_b16 v[184:185], v6 offset:9216
  ds_read_b64_tr_b16 v[186:187], v6 offset:11264
  buffer_load_dwordx4 a[248:251], v12, s[68:71], s32 offen offset:3072 sc1
  v_accvgpr_read_b32 v212, a4
  v_mfma_f32_32x32x16_bf16 v[48:63], v[152:155], a[128:131], v[48:63]
  ds_read_b64_tr_b16 v[188:189], v7 offset:9216
  v_accvgpr_read_b32 v213, a5
  v_mfma_f32_32x32x16_bf16 v[112:127], v[152:155], a[132:135], v[112:127]
  ds_read_b64_tr_b16 v[190:191], v7 offset:11264
  buffer_load_dwordx4 a[252:255], v13, s[68:71], s32 offen offset:3072 sc1
  s_add_u32 s32, s32, 4096
  v_accvgpr_read_b32 v214, a6
  v_mfma_f32_32x32x16_bf16 v[64:79], v[156:159], a[128:131], v[64:79]
  ds_read_b64_tr_b16 v[192:193], v6 offset:12288
  ds_read_b64_tr_b16 v[194:195], v6 offset:14336
  v_accvgpr_read_b32 v215, a7
  v_mfma_f32_32x32x16_bf16 v[128:143], v[156:159], a[132:135], v[128:143]
  ds_read_b64_tr_b16 v[196:197], v7 offset:12288
  v_cvt_pk_bf16_f32 v216, v208, v209
  v_mfma_f32_32x32x16_bf16 v[16:31], v[160:163], a[136:139], v[16:31]
  ds_read_b64_tr_b16 v[198:199], v7 offset:14336
  v_cvt_pk_bf16_f32 v217, v210, v211
  v_mfma_f32_32x32x16_bf16 v[80:95], v[160:163], a[140:143], v[80:95]
  ds_read_b64_tr_b16 v[200:201], v6 offset:13312
  ds_read_b64_tr_b16 v[202:203], v6 offset:15360
  v_cvt_pk_bf16_f32 v218, v212, v213
  v_mfma_f32_32x32x16_bf16 v[32:47], v[164:167], a[136:139], v[32:47]
  ds_read_b64_tr_b16 v[204:205], v7 offset:13312
  v_cvt_pk_bf16_f32 v219, v214, v215
  v_mfma_f32_32x32x16_bf16 v[96:111], v[164:167], a[140:143], v[96:111]
  ds_read_b64_tr_b16 v[206:207], v7 offset:15360
  s_add_u32 s37, s36, 8388608
  buffer_store_dwordx4 v[216:219], v5, s[68:71], s37 offen sc1
  v_mfma_f32_32x32x16_bf16 v[48:63], v[168:171], a[136:139], v[48:63]
  v_accvgpr_read_b32 v220, a8
  v_mfma_f32_32x32x16_bf16 v[112:127], v[168:171], a[140:143], v[112:127]
  v_accvgpr_read_b32 v221, a9
  v_mfma_f32_32x32x16_bf16 v[64:79], v[172:175], a[136:139], v[64:79]
  v_accvgpr_read_b32 v222, a10
  v_mfma_f32_32x32x16_bf16 v[128:143], v[172:175], a[140:143], v[128:143]
  v_accvgpr_read_b32 v223, a11
  s_waitcnt vmcnt(29) lgkmcnt(0)
  s_barrier
  v_mfma_f32_32x32x16_bf16 v[16:31], v[176:179], a[144:147], v[16:31]
  ds_read_b64_tr_b16 v[144:145], v6 offset:16384
  ds_read_b64_tr_b16 v[146:147], v6 offset:18432
  s_add_u32 m0, s31, 0
  s_nop 0
  buffer_load_dwordx4 v8, s[72:75], s30 offen offset:0 lds
  v_accvgpr_read_b32 v224, a12
  v_accvgpr_read_b32 v225, a13
  v_mfma_f32_32x32x16_bf16 v[80:95], v[176:179], a[148:151], v[80:95]
  ds_read_b64_tr_b16 v[148:149], v7 offset:16384
  buffer_load_dwordx4 v9, s[72:75], s30 offen offset:1024 lds
  v_accvgpr_read_b32 v226, a14
  v_mfma_f32_32x32x16_bf16 v[32:47], v[180:183], a[144:147], v[32:47]
  ds_read_b64_tr_b16 v[150:151], v7 offset:18432
  v_accvgpr_read_b32 v227, a15
  v_mfma_f32_32x32x16_bf16 v[96:111], v[180:183], a[148:151], v[96:111]
  ds_read_b64_tr_b16 v[152:153], v6 offset:17408
  ds_read_b64_tr_b16 v[154:155], v6 offset:19456
  buffer_load_dwordx4 v10, s[72:75], s30 offen offset:2048 lds
  v_cvt_pk_bf16_f32 v228, v220, v221
  v_mfma_f32_32x32x16_bf16 v[48:63], v[184:187], a[144:147], v[48:63]
  ds_read_b64_tr_b16 v[156:157], v7 offset:17408
  v_cvt_pk_bf16_f32 v229, v222, v223
  v_mfma_f32_32x32x16_bf16 v[112:127], v[184:187], a[148:151], v[112:127]
  ds_read_b64_tr_b16 v[158:159], v7 offset:19456
  buffer_load_dwordx4 v11, s[72:75], s30 offen offset:3072 lds
  v_cvt_pk_bf16_f32 v230, v224, v225
  v_mfma_f32_32x32x16_bf16 v[64:79], v[188:191], a[144:147], v[64:79]
  ds_read_b64_tr_b16 v[160:161], v6 offset:20480
  ds_read_b64_tr_b16 v[162:163], v6 offset:22528
  v_cvt_pk_bf16_f32 v231, v226, v227
  v_mfma_f32_32x32x16_bf16 v[128:143], v[188:191], a[148:151], v[128:143]
  ds_read_b64_tr_b16 v[164:165], v7 offset:20480
  s_add_u32 s30, s30, 524288
  s_add_u32 s37, s36, 8389632
  buffer_store_dwordx4 v[228:231], v5, s[68:71], s37 offen sc1
  v_mfma_f32_32x32x16_bf16 v[16:31], v[192:195], a[152:155], v[16:31]
  ds_read_b64_tr_b16 v[166:167], v7 offset:22528
  buffer_load_dwordx4 a[128:131], v12, s[68:71], s32 offen offset:0 sc1
  v_accvgpr_read_b32 v232, a16
  v_mfma_f32_32x32x16_bf16 v[80:95], v[192:195], a[156:159], v[80:95]
  ds_read_b64_tr_b16 v[168:169], v6 offset:21504
  ds_read_b64_tr_b16 v[170:171], v6 offset:23552
  v_accvgpr_read_b32 v233, a17
  v_mfma_f32_32x32x16_bf16 v[32:47], v[196:199], a[152:155], v[32:47]
  ds_read_b64_tr_b16 v[172:173], v7 offset:21504
  buffer_load_dwordx4 a[132:135], v13, s[68:71], s32 offen offset:0 sc1
  v_accvgpr_read_b32 v234, a18
  v_mfma_f32_32x32x16_bf16 v[96:111], v[196:199], a[156:159], v[96:111]
  ds_read_b64_tr_b16 v[174:175], v7 offset:23552
  v_accvgpr_read_b32 v235, a19
  v_mfma_f32_32x32x16_bf16 v[48:63], v[200:203], a[152:155], v[48:63]
  buffer_load_dwordx4 a[136:139], v12, s[68:71], s32 offen offset:1024 sc1
  v_accvgpr_read_b32 v236, a20
  v_mfma_f32_32x32x16_bf16 v[112:127], v[200:203], a[156:159], v[112:127]
  v_accvgpr_read_b32 v237, a21
  v_mfma_f32_32x32x16_bf16 v[64:79], v[204:207], a[152:155], v[64:79]
  buffer_load_dwordx4 a[140:143], v13, s[68:71], s32 offen offset:1024 sc1
  v_accvgpr_read_b32 v238, a22
  v_mfma_f32_32x32x16_bf16 v[128:143], v[204:207], a[156:159], v[128:143]
  v_accvgpr_read_b32 v239, a23
  s_waitcnt lgkmcnt(0)
  v_mfma_f32_32x32x16_bf16 v[16:31], v[144:147], a[160:163], v[16:31]
  ds_read_b64_tr_b16 v[176:177], v6 offset:24576
  ds_read_b64_tr_b16 v[178:179], v6 offset:26624
  buffer_load_dwordx4 a[144:147], v12, s[68:71], s32 offen offset:2048 sc1
  v_cvt_pk_bf16_f32 v240, v232, v233
  v_cvt_pk_bf16_f32 v241, v234, v235
  v_mfma_f32_32x32x16_bf16 v[80:95], v[144:147], a[164:167], v[80:95]
  ds_read_b64_tr_b16 v[180:181], v7 offset:24576
  buffer_load_dwordx4 a[148:151], v13, s[68:71], s32 offen offset:2048 sc1
  v_cvt_pk_bf16_f32 v242, v236, v237
  v_mfma_f32_32x32x16_bf16 v[32:47], v[148:151], a[160:163], v[32:47]
  ds_read_b64_tr_b16 v[182:183], v7 offset:26624
  v_cvt_pk_bf16_f32 v243, v238, v239
  v_mfma_f32_32x32x16_bf16 v[96:111], v[148:151], a[164:167], v[96:111]
  ds_read_b64_tr_b16 v[184:185], v6 offset:25600
  ds_read_b64_tr_b16 v[186:187], v6 offset:27648
  buffer_load_dwordx4 a[152:155], v12, s[68:71], s32 offen offset:3072 sc1
  s_add_u32 s37, s36, 8390656
  buffer_store_dwordx4 v[240:243], v5, s[68:71], s37 offen sc1
  v_mfma_f32_32x32x16_bf16 v[48:63], v[152:155], a[160:163], v[48:63]
  ds_read_b64_tr_b16 v[188:189], v7 offset:25600
  v_accvgpr_read_b32 v208, a24
  v_mfma_f32_32x32x16_bf16 v[112:127], v[152:155], a[164:167], v[112:127]
  ds_read_b64_tr_b16 v[190:191], v7 offset:27648
  buffer_load_dwordx4 a[156:159], v13, s[68:71], s32 offen offset:3072 sc1
  s_add_u32 s32, s32, 4096
  v_accvgpr_read_b32 v209, a25
  v_mfma_f32_32x32x16_bf16 v[64:79], v[156:159], a[160:163], v[64:79]
  ds_read_b64_tr_b16 v[192:193], v6 offset:28672
  ds_read_b64_tr_b16 v[194:195], v6 offset:30720
  v_accvgpr_read_b32 v210, a26
  v_mfma_f32_32x32x16_bf16 v[128:143], v[156:159], a[164:167], v[128:143]
  ds_read_b64_tr_b16 v[196:197], v7 offset:28672
  v_accvgpr_read_b32 v211, a27
  v_mfma_f32_32x32x16_bf16 v[16:31], v[160:163], a[168:171], v[16:31]
  ds_read_b64_tr_b16 v[198:199], v7 offset:30720
  v_accvgpr_read_b32 v212, a28
  v_accvgpr_read_b32 v213, a29
  v_mfma_f32_32x32x16_bf16 v[80:95], v[160:163], a[172:175], v[80:95]
  ds_read_b64_tr_b16 v[200:201], v6 offset:29696
  ds_read_b64_tr_b16 v[202:203], v6 offset:31744
  v_accvgpr_read_b32 v214, a30
  v_mfma_f32_32x32x16_bf16 v[32:47], v[164:167], a[168:171], v[32:47]
  ds_read_b64_tr_b16 v[204:205], v7 offset:29696
  v_accvgpr_read_b32 v215, a31
  v_mfma_f32_32x32x16_bf16 v[96:111], v[164:167], a[172:175], v[96:111]
  ds_read_b64_tr_b16 v[206:207], v7 offset:31744
  v_cvt_pk_bf16_f32 v216, v208, v209
  v_mfma_f32_32x32x16_bf16 v[48:63], v[168:171], a[168:171], v[48:63]
  v_cvt_pk_bf16_f32 v217, v210, v211
  v_mfma_f32_32x32x16_bf16 v[112:127], v[168:171], a[172:175], v[112:127]
  v_cvt_pk_bf16_f32 v218, v212, v213
  v_mfma_f32_32x32x16_bf16 v[64:79], v[172:175], a[168:171], v[64:79]
  v_cvt_pk_bf16_f32 v219, v214, v215
  v_mfma_f32_32x32x16_bf16 v[128:143], v[172:175], a[172:175], v[128:143]
  s_add_u32 s37, s36, 8391680
  buffer_store_dwordx4 v[216:219], v5, s[68:71], s37 offen sc1
  s_waitcnt vmcnt(30) lgkmcnt(0)
  s_barrier
  v_mfma_f32_32x32x16_bf16 v[16:31], v[176:179], a[176:179], v[16:31]
  ds_read_b64_tr_b16 v[144:145], v6 offset:32768
  ds_read_b64_tr_b16 v[146:147], v6 offset:34816
  s_add_u32 m0, s31, 16384
  s_nop 0
  buffer_load_dwordx4 v8, s[72:75], s30 offen offset:0 lds
  v_accvgpr_read_b32 v220, a32
  v_accvgpr_read_b32 v221, a33
  v_mfma_f32_32x32x16_bf16 v[80:95], v[176:179], a[180:183], v[80:95]
  ds_read_b64_tr_b16 v[148:149], v7 offset:32768
  buffer_load_dwordx4 v9, s[72:75], s30 offen offset:1024 lds
  v_accvgpr_read_b32 v222, a34
  v_mfma_f32_32x32x16_bf16 v[32:47], v[180:183], a[176:179], v[32:47]
  ds_read_b64_tr_b16 v[150:151], v7 offset:34816
  v_accvgpr_read_b32 v223, a35
  v_mfma_f32_32x32x16_bf16 v[96:111], v[180:183], a[180:183], v[96:111]
  ds_read_b64_tr_b16 v[152:153], v6 offset:33792
  ds_read_b64_tr_b16 v[154:155], v6 offset:35840
  buffer_load_dwordx4 v10, s[72:75], s30 offen offset:2048 lds
  v_accvgpr_read_b32 v224, a36
  v_mfma_f32_32x32x16_bf16 v[48:63], v[184:187], a[176:179], v[48:63]
  ds_read_b64_tr_b16 v[156:157], v7 offset:33792
  v_accvgpr_read_b32 v225, a37
  v_mfma_f32_32x32x16_bf16 v[112:127], v[184:187], a[180:183], v[112:127]
  ds_read_b64_tr_b16 v[158:159], v7 offset:35840
  buffer_load_dwordx4 v11, s[72:75], s30 offen offset:3072 lds
  v_accvgpr_read_b32 v226, a38
  v_mfma_f32_32x32x16_bf16 v[64:79], v[188:191], a[176:179], v[64:79]
  ds_read_b64_tr_b16 v[160:161], v6 offset:36864
  ds_read_b64_tr_b16 v[162:163], v6 offset:38912
  v_accvgpr_read_b32 v227, a39
  v_mfma_f32_32x32x16_bf16 v[128:143], v[188:191], a[180:183], v[128:143]
  ds_read_b64_tr_b16 v[164:165], v7 offset:36864
  s_add_u32 s30, s30, 524288
  v_cvt_pk_bf16_f32 v228, v220, v221
  v_mfma_f32_32x32x16_bf16 v[16:31], v[192:195], a[184:187], v[16:31]
  ds_read_b64_tr_b16 v[166:167], v7 offset:38912
  buffer_load_dwordx4 a[160:163], v12, s[68:71], s32 offen offset:0 sc1
  v_cvt_pk_bf16_f32 v229, v222, v223
  v_mfma_f32_32x32x16_bf16 v[80:95], v[192:195], a[188:191], v[80:95]
  ds_read_b64_tr_b16 v[168:169], v6 offset:37888
  ds_read_b64_tr_b16 v[170:171], v6 offset:39936
  v_cvt_pk_bf16_f32 v230, v224, v225
  v_mfma_f32_32x32x16_bf16 v[32:47], v[196:199], a[184:187], v[32:47]
  ds_read_b64_tr_b16 v[172:173], v7 offset:37888
  buffer_load_dwordx4 a[164:167], v13, s[68:71], s32 offen offset:0 sc1
  v_cvt_pk_bf16_f32 v231, v226, v227
  v_mfma_f32_32x32x16_bf16 v[96:111], v[196:199], a[188:191], v[96:111]
  ds_read_b64_tr_b16 v[174:175], v7 offset:39936
  s_add_u32 s37, s36, 8392704
  buffer_store_dwordx4 v[228:231], v5, s[68:71], s37 offen sc1
  v_mfma_f32_32x32x16_bf16 v[48:63], v[200:203], a[184:187], v[48:63]
  buffer_load_dwordx4 a[168:171], v12, s[68:71], s32 offen offset:1024 sc1
  v_accvgpr_read_b32 v232, a40
  v_mfma_f32_32x32x16_bf16 v[112:127], v[200:203], a[188:191], v[112:127]
  v_accvgpr_read_b32 v233, a41
  v_mfma_f32_32x32x16_bf16 v[64:79], v[204:207], a[184:187], v[64:79]
  buffer_load_dwordx4 a[172:175], v13, s[68:71], s32 offen offset:1024 sc1
  v_accvgpr_read_b32 v234, a42
  v_mfma_f32_32x32x16_bf16 v[128:143], v[204:207], a[188:191], v[128:143]
  v_accvgpr_read_b32 v235, a43
  s_waitcnt lgkmcnt(0)
  v_mfma_f32_32x32x16_bf16 v[16:31], v[144:147], a[192:195], v[16:31]
  ds_read_b64_tr_b16 v[176:177], v6 offset:40960
  ds_read_b64_tr_b16 v[178:179], v6 offset:43008
  buffer_load_dwordx4 a[176:179], v12, s[68:71], s32 offen offset:2048 sc1
  v_accvgpr_read_b32 v236, a44
  v_accvgpr_read_b32 v237, a45
  v_mfma_f32_32x32x16_bf16 v[80:95], v[144:147], a[196:199], v[80:95]
  ds_read_b64_tr_b16 v[180:181], v7 offset:40960
  buffer_load_dwordx4 a[180:183], v13, s[68:71], s32 offen offset:2048 sc1
  v_accvgpr_read_b32 v238, a46
  v_mfma_f32_32x32x16_bf16 v[32:47], v[148:151], a[192:195], v[32:47]
  ds_read_b64_tr_b16 v[182:183], v7 offset:43008
  v_accvgpr_read_b32 v239, a47
  v_mfma_f32_32x32x16_bf16 v[96:111], v[148:151], a[196:199], v[96:111]
  ds_read_b64_tr_b16 v[184:185], v6 offset:41984
  ds_read_b64_tr_b16 v[186:187], v6 offset:44032
  buffer_load_dwordx4 a[184:187], v12, s[68:71], s32 offen offset:3072 sc1
  v_cvt_pk_bf16_f32 v240, v232, v233
  v_mfma_f32_32x32x16_bf16 v[48:63], v[152:155], a[192:195], v[48:63]
  ds_read_b64_tr_b16 v[188:189], v7 offset:41984
  v_cvt_pk_bf16_f32 v241, v234, v235
  v_mfma_f32_32x32x16_bf16 v[112:127], v[152:155], a[196:199], v[112:127]
  ds_read_b64_tr_b16 v[190:191], v7 offset:44032
  buffer_load_dwordx4 a[188:191], v13, s[68:71], s32 offen offset:3072 sc1
  s_add_u32 s32, s32, 4096
  v_cvt_pk_bf16_f32 v242, v236, v237
  v_mfma_f32_32x32x16_bf16 v[64:79], v[156:159], a[192:195], v[64:79]
  ds_read_b64_tr_b16 v[192:193], v6 offset:45056
  ds_read_b64_tr_b16 v[194:195], v6 offset:47104
  v_cvt_pk_bf16_f32 v243, v238, v239
  v_mfma_f32_32x32x16_bf16 v[128:143], v[156:159], a[196:199], v[128:143]
  ds_read_b64_tr_b16 v[196:197], v7 offset:45056
  s_add_u32 s37, s36, 8393728
  buffer_store_dwordx4 v[240:243], v5, s[68:71], s37 offen sc1
  v_mfma_f32_32x32x16_bf16 v[16:31], v[160:163], a[200:203], v[16:31]
  ds_read_b64_tr_b16 v[198:199], v7 offset:47104
  v_accvgpr_read_b32 v208, a48
  v_accvgpr_read_b32 v209, a49
  v_mfma_f32_32x32x16_bf16 v[80:95], v[160:163], a[204:207], v[80:95]
  ds_read_b64_tr_b16 v[200:201], v6 offset:46080
  ds_read_b64_tr_b16 v[202:203], v6 offset:48128
  v_accvgpr_read_b32 v210, a50
  v_mfma_f32_32x32x16_bf16 v[32:47], v[164:167], a[200:203], v[32:47]
  ds_read_b64_tr_b16 v[204:205], v7 offset:46080
  v_accvgpr_read_b32 v211, a51
  v_mfma_f32_32x32x16_bf16 v[96:111], v[164:167], a[204:207], v[96:111]
  ds_read_b64_tr_b16 v[206:207], v7 offset:48128
  v_accvgpr_read_b32 v212, a52
  v_mfma_f32_32x32x16_bf16 v[48:63], v[168:171], a[200:203], v[48:63]
  v_accvgpr_read_b32 v213, a53
  v_mfma_f32_32x32x16_bf16 v[112:127], v[168:171], a[204:207], v[112:127]
  v_accvgpr_read_b32 v214, a54
  v_mfma_f32_32x32x16_bf16 v[64:79], v[172:175], a[200:203], v[64:79]
  v_accvgpr_read_b32 v215, a55
  v_mfma_f32_32x32x16_bf16 v[128:143], v[172:175], a[204:207], v[128:143]
  v_cvt_pk_bf16_f32 v216, v208, v209
  s_waitcnt vmcnt(30) lgkmcnt(0)
  s_barrier
  v_mfma_f32_32x32x16_bf16 v[16:31], v[176:179], a[208:211], v[16:31]
  ds_read_b64_tr_b16 v[144:145], v6 offset:49152
  ds_read_b64_tr_b16 v[146:147], v6 offset:51200
  s_add_u32 m0, s31, 32768
  s_nop 0
  buffer_load_dwordx4 v8, s[72:75], s30 offen offset:0 lds
  v_cvt_pk_bf16_f32 v217, v210, v211
  v_cvt_pk_bf16_f32 v218, v212, v213
  v_mfma_f32_32x32x16_bf16 v[80:95], v[176:179], a[212:215], v[80:95]
  ds_read_b64_tr_b16 v[148:149], v7 offset:49152
  buffer_load_dwordx4 v9, s[72:75], s30 offen offset:1024 lds
  v_cvt_pk_bf16_f32 v219, v214, v215
  v_mfma_f32_32x32x16_bf16 v[32:47], v[180:183], a[208:211], v[32:47]
  ds_read_b64_tr_b16 v[150:151], v7 offset:51200
  s_add_u32 s37, s36, 8394752
  buffer_store_dwordx4 v[216:219], v5, s[68:71], s37 offen sc1
  v_mfma_f32_32x32x16_bf16 v[96:111], v[180:183], a[212:215], v[96:111]
  ds_read_b64_tr_b16 v[152:153], v6 offset:50176
  ds_read_b64_tr_b16 v[154:155], v6 offset:52224
  buffer_load_dwordx4 v10, s[72:75], s30 offen offset:2048 lds
  v_accvgpr_read_b32 v220, a56
  v_mfma_f32_32x32x16_bf16 v[48:63], v[184:187], a[208:211], v[48:63]
  ds_read_b64_tr_b16 v[156:157], v7 offset:50176
  v_accvgpr_read_b32 v221, a57
  v_mfma_f32_32x32x16_bf16 v[112:127], v[184:187], a[212:215], v[112:127]
  ds_read_b64_tr_b16 v[158:159], v7 offset:52224
  buffer_load_dwordx4 v11, s[72:75], s30 offen offset:3072 lds
  v_accvgpr_read_b32 v222, a58
  v_mfma_f32_32x32x16_bf16 v[64:79], v[188:191], a[208:211], v[64:79]
  ds_read_b64_tr_b16 v[160:161], v6 offset:53248
  ds_read_b64_tr_b16 v[162:163], v6 offset:55296
  v_accvgpr_read_b32 v223, a59
  v_mfma_f32_32x32x16_bf16 v[128:143], v[188:191], a[212:215], v[128:143]
  ds_read_b64_tr_b16 v[164:165], v7 offset:53248
  s_add_u32 s30, s30, 524288
  v_accvgpr_read_b32 v224, a60
  v_mfma_f32_32x32x16_bf16 v[16:31], v[192:195], a[216:219], v[16:31]
  ds_read_b64_tr_b16 v[166:167], v7 offset:55296
  buffer_load_dwordx4 a[192:195], v12, s[68:71], s32 offen offset:0 sc1
  v_accvgpr_read_b32 v225, a61
  v_mfma_f32_32x32x16_bf16 v[80:95], v[192:195], a[220:223], v[80:95]
  ds_read_b64_tr_b16 v[168:169], v6 offset:54272
  ds_read_b64_tr_b16 v[170:171], v6 offset:56320
  v_accvgpr_read_b32 v226, a62
  v_mfma_f32_32x32x16_bf16 v[32:47], v[196:199], a[216:219], v[32:47]
  ds_read_b64_tr_b16 v[172:173], v7 offset:54272
  buffer_load_dwordx4 a[196:199], v13, s[68:71], s32 offen offset:0 sc1
  v_accvgpr_read_b32 v227, a63
  v_mfma_f32_32x32x16_bf16 v[96:111], v[196:199], a[220:223], v[96:111]
  ds_read_b64_tr_b16 v[174:175], v7 offset:56320
  v_cvt_pk_bf16_f32 v228, v220, v221
  v_mfma_f32_32x32x16_bf16 v[48:63], v[200:203], a[216:219], v[48:63]
  buffer_load_dwordx4 a[200:203], v12, s[68:71], s32 offen offset:1024 sc1
  v_cvt_pk_bf16_f32 v229, v222, v223
  v_mfma_f32_32x32x16_bf16 v[112:127], v[200:203], a[220:223], v[112:127]
  v_cvt_pk_bf16_f32 v230, v224, v225
  v_mfma_f32_32x32x16_bf16 v[64:79], v[204:207], a[216:219], v[64:79]
  buffer_load_dwordx4 a[204:207], v13, s[68:71], s32 offen offset:1024 sc1
  v_cvt_pk_bf16_f32 v231, v226, v227
  v_mfma_f32_32x32x16_bf16 v[128:143], v[204:207], a[220:223], v[128:143]
  s_add_u32 s37, s36, 8395776
  buffer_store_dwordx4 v[228:231], v5, s[68:71], s37 offen sc1
  s_waitcnt lgkmcnt(0)
  v_mfma_f32_32x32x16_bf16 v[16:31], v[144:147], a[224:227], v[16:31]
  ds_read_b64_tr_b16 v[176:177], v6 offset:57344
  ds_read_b64_tr_b16 v[178:179], v6 offset:59392
  buffer_load_dwordx4 a[208:211], v12, s[68:71], s32 offen offset:2048 sc1
  v_accvgpr_read_b32 v232, a64
  v_accvgpr_read_b32 v233, a65
  v_mfma_f32_32x32x16_bf16 v[80:95], v[144:147], a[228:231], v[80:95]
  ds_read_b64_tr_b16 v[180:181], v7 offset:57344
  buffer_load_dwordx4 a[212:215], v13, s[68:71], s32 offen offset:2048 sc1
  v_accvgpr_read_b32 v234, a66
  v_mfma_f32_32x32x16_bf16 v[32:47], v[148:151], a[224:227], v[32:47]
  ds_read_b64_tr_b16 v[182:183], v7 offset:59392
  v_accvgpr_read_b32 v235, a67
  v_mfma_f32_32x32x16_bf16 v[96:111], v[148:151], a[228:231], v[96:111]
  ds_read_b64_tr_b16 v[184:185], v6 offset:58368
  ds_read_b64_tr_b16 v[186:187], v6 offset:60416
  buffer_load_dwordx4 a[216:219], v12, s[68:71], s32 offen offset:3072 sc1
  v_accvgpr_read_b32 v236, a68
  v_mfma_f32_32x32x16_bf16 v[48:63], v[152:155], a[224:227], v[48:63]
  ds_read_b64_tr_b16 v[188:189], v7 offset:58368
  v_accvgpr_read_b32 v237, a69
  v_mfma_f32_32x32x16_bf16 v[112:127], v[152:155], a[228:231], v[112:127]
  ds_read_b64_tr_b16 v[190:191], v7 offset:60416
  buffer_load_dwordx4 a[220:223], v13, s[68:71], s32 offen offset:3072 sc1
  s_add_u32 s32, s32, 4096
  v_accvgpr_read_b32 v238, a70
  v_mfma_f32_32x32x16_bf16 v[64:79], v[156:159], a[224:227], v[64:79]
  ds_read_b64_tr_b16 v[192:193], v6 offset:61440
  ds_read_b64_tr_b16 v[194:195], v6 offset:63488
  v_accvgpr_read_b32 v239, a71
  v_mfma_f32_32x32x16_bf16 v[128:143], v[156:159], a[228:231], v[128:143]
  ds_read_b64_tr_b16 v[196:197], v7 offset:61440
  v_cvt_pk_bf16_f32 v240, v232, v233
  v_mfma_f32_32x32x16_bf16 v[16:31], v[160:163], a[232:235], v[16:31]
  ds_read_b64_tr_b16 v[198:199], v7 offset:63488
  v_cvt_pk_bf16_f32 v241, v234, v235
  v_mfma_f32_32x32x16_bf16 v[80:95], v[160:163], a[236:239], v[80:95]
  ds_read_b64_tr_b16 v[200:201], v6 offset:62464
  ds_read_b64_tr_b16 v[202:203], v6 offset:64512
  v_cvt_pk_bf16_f32 v242, v236, v237
  v_mfma_f32_32x32x16_bf16 v[32:47], v[164:167], a[232:235], v[32:47]
  ds_read_b64_tr_b16 v[204:205], v7 offset:62464
  v_cvt_pk_bf16_f32 v243, v238, v239
  v_mfma_f32_32x32x16_bf16 v[96:111], v[164:167], a[236:239], v[96:111]
  ds_read_b64_tr_b16 v[206:207], v7 offset:64512
  s_add_u32 s37, s36, 25165824
  buffer_store_dwordx4 v[240:243], v5, s[68:71], s37 offen sc1
  v_mfma_f32_32x32x16_bf16 v[48:63], v[168:171], a[232:235], v[48:63]
  v_accvgpr_read_b32 v208, a72
  v_mfma_f32_32x32x16_bf16 v[112:127], v[168:171], a[236:239], v[112:127]
  v_accvgpr_read_b32 v209, a73
  v_mfma_f32_32x32x16_bf16 v[64:79], v[172:175], a[232:235], v[64:79]
  v_accvgpr_read_b32 v210, a74
  v_mfma_f32_32x32x16_bf16 v[128:143], v[172:175], a[236:239], v[128:143]
  v_accvgpr_read_b32 v211, a75
  s_waitcnt vmcnt(30) lgkmcnt(0)
  s_barrier
  v_mfma_f32_32x32x16_bf16 v[16:31], v[176:179], a[240:243], v[16:31]
  ds_read_b64_tr_b16 v[144:145], v6 offset:0
  ds_read_b64_tr_b16 v[146:147], v6 offset:2048
  s_add_u32 m0, s31, 49152
  s_nop 0
  buffer_load_dwordx4 v8, s[72:75], s30 offen offset:0 lds
  v_accvgpr_read_b32 v212, a76
  v_accvgpr_read_b32 v213, a77
  v_mfma_f32_32x32x16_bf16 v[80:95], v[176:179], a[244:247], v[80:95]
  ds_read_b64_tr_b16 v[148:149], v7 offset:0
  buffer_load_dwordx4 v9, s[72:75], s30 offen offset:1024 lds
  v_accvgpr_read_b32 v214, a78
  v_mfma_f32_32x32x16_bf16 v[32:47], v[180:183], a[240:243], v[32:47]
  ds_read_b64_tr_b16 v[150:151], v7 offset:2048
  v_accvgpr_read_b32 v215, a79
  v_mfma_f32_32x32x16_bf16 v[96:111], v[180:183], a[244:247], v[96:111]
  ds_read_b64_tr_b16 v[152:153], v6 offset:1024
  ds_read_b64_tr_b16 v[154:155], v6 offset:3072
  buffer_load_dwordx4 v10, s[72:75], s30 offen offset:2048 lds
  v_cvt_pk_bf16_f32 v216, v208, v209
  v_mfma_f32_32x32x16_bf16 v[48:63], v[184:187], a[240:243], v[48:63]
  ds_read_b64_tr_b16 v[156:157], v7 offset:1024
  v_cvt_pk_bf16_f32 v217, v210, v211
  v_mfma_f32_32x32x16_bf16 v[112:127], v[184:187], a[244:247], v[112:127]
  ds_read_b64_tr_b16 v[158:159], v7 offset:3072
  buffer_load_dwordx4 v11, s[72:75], s30 offen offset:3072 lds
  v_cvt_pk_bf16_f32 v218, v212, v213
  v_mfma_f32_32x32x16_bf16 v[64:79], v[188:191], a[240:243], v[64:79]
  ds_read_b64_tr_b16 v[160:161], v6 offset:4096
  ds_read_b64_tr_b16 v[162:163], v6 offset:6144
  v_cvt_pk_bf16_f32 v219, v214, v215
  v_mfma_f32_32x32x16_bf16 v[128:143], v[188:191], a[244:247], v[128:143]
  ds_read_b64_tr_b16 v[164:165], v7 offset:4096
  s_add_u32 s30, s30, 524288
  s_add_u32 s37, s36, 25169920
  buffer_store_dwordx4 v[216:219], v5, s[68:71], s37 offen sc1
  v_mfma_f32_32x32x16_bf16 v[16:31], v[192:195], a[248:251], v[16:31]
  ds_read_b64_tr_b16 v[166:167], v7 offset:6144
  buffer_load_dwordx4 a[224:227], v12, s[68:71], s32 offen offset:0 sc1
  v_accvgpr_read_b32 v220, a80
  v_accvgpr_read_b32 v221, a81
  v_mfma_f32_32x32x16_bf16 v[80:95], v[192:195], a[252:255], v[80:95]
  ds_read_b64_tr_b16 v[168:169], v6 offset:5120
  ds_read_b64_tr_b16 v[170:171], v6 offset:7168
  v_accvgpr_read_b32 v222, a82
  v_mfma_f32_32x32x16_bf16 v[32:47], v[196:199], a[248:251], v[32:47]
  ds_read_b64_tr_b16 v[172:173], v7 offset:5120
  buffer_load_dwordx4 a[228:231], v13, s[68:71], s32 offen offset:0 sc1
  v_accvgpr_read_b32 v223, a83
  v_mfma_f32_32x32x16_bf16 v[96:111], v[196:199], a[252:255], v[96:111]
  ds_read_b64_tr_b16 v[174:175], v7 offset:7168
  v_accvgpr_read_b32 v224, a84
  v_mfma_f32_32x32x16_bf16 v[48:63], v[200:203], a[248:251], v[48:63]
  buffer_load_dwordx4 a[232:235], v12, s[68:71], s32 offen offset:1024 sc1
  v_accvgpr_read_b32 v225, a85
  v_mfma_f32_32x32x16_bf16 v[112:127], v[200:203], a[252:255], v[112:127]
  v_accvgpr_read_b32 v226, a86
  v_mfma_f32_32x32x16_bf16 v[64:79], v[204:207], a[248:251], v[64:79]
  buffer_load_dwordx4 a[236:239], v13, s[68:71], s32 offen offset:1024 sc1
  v_accvgpr_read_b32 v227, a87
  v_mfma_f32_32x32x16_bf16 v[128:143], v[204:207], a[252:255], v[128:143]
  v_cvt_pk_bf16_f32 v228, v220, v221
  s_waitcnt lgkmcnt(0)
  v_mfma_f32_32x32x16_bf16 v[16:31], v[144:147], a[128:131], v[16:31]
  ds_read_b64_tr_b16 v[176:177], v6 offset:8192
  ds_read_b64_tr_b16 v[178:179], v6 offset:10240
  buffer_load_dwordx4 a[240:243], v12, s[68:71], s32 offen offset:2048 sc1
  v_cvt_pk_bf16_f32 v229, v222, v223
  v_cvt_pk_bf16_f32 v230, v224, v225
  v_mfma_f32_32x32x16_bf16 v[80:95], v[144:147], a[132:135], v[80:95]
  ds_read_b64_tr_b16 v[180:181], v7 offset:8192
  buffer_load_dwordx4 a[244:247], v13, s[68:71], s32 offen offset:2048 sc1
  v_cvt_pk_bf16_f32 v231, v226, v227
  v_mfma_f32_32x32x16_bf16 v[32:47], v[148:151], a[128:131], v[32:47]
  ds_read_b64_tr_b16 v[182:183], v7 offset:10240
  s_add_u32 s37, s36, 25166848
  buffer_store_dwordx4 v[228:231], v5, s[68:71], s37 offen sc1
  v_mfma_f32_32x32x16_bf16 v[96:111], v[148:151], a[132:135], v[96:111]
  ds_read_b64_tr_b16 v[184:185], v6 offset:9216
  ds_read_b64_tr_b16 v[186:187], v6 offset:11264
  buffer_load_dwordx4 a[248:251], v12, s[68:71], s32 offen offset:3072 sc1
  v_accvgpr_read_b32 v232, a88
  v_mfma_f32_32x32x16_bf16 v[48:63], v[152:155], a[128:131], v[48:63]
  ds_read_b64_tr_b16 v[188:189], v7 offset:9216
  v_accvgpr_read_b32 v233, a89
  v_mfma_f32_32x32x16_bf16 v[112:127], v[152:155], a[132:135], v[112:127]
  ds_read_b64_tr_b16 v[190:191], v7 offset:11264
  buffer_load_dwordx4 a[252:255], v13, s[68:71], s32 offen offset:3072 sc1
  s_add_u32 s32, s32, 4096
  v_accvgpr_read_b32 v234, a90
  v_mfma_f32_32x32x16_bf16 v[64:79], v[156:159], a[128:131], v[64:79]
  ds_read_b64_tr_b16 v[192:193], v6 offset:12288
  ds_read_b64_tr_b16 v[194:195], v6 offset:14336
  v_accvgpr_read_b32 v235, a91
  v_mfma_f32_32x32x16_bf16 v[128:143], v[156:159], a[132:135], v[128:143]
  ds_read_b64_tr_b16 v[196:197], v7 offset:12288
  v_accvgpr_read_b32 v236, a92
  v_mfma_f32_32x32x16_bf16 v[16:31], v[160:163], a[136:139], v[16:31]
  ds_read_b64_tr_b16 v[198:199], v7 offset:14336
  v_accvgpr_read_b32 v237, a93
  v_mfma_f32_32x32x16_bf16 v[80:95], v[160:163], a[140:143], v[80:95]
  ds_read_b64_tr_b16 v[200:201], v6 offset:13312
  ds_read_b64_tr_b16 v[202:203], v6 offset:15360
  v_accvgpr_read_b32 v238, a94
  v_mfma_f32_32x32x16_bf16 v[32:47], v[164:167], a[136:139], v[32:47]
  ds_read_b64_tr_b16 v[204:205], v7 offset:13312
  v_accvgpr_read_b32 v239, a95
  v_mfma_f32_32x32x16_bf16 v[96:111], v[164:167], a[140:143], v[96:111]
  ds_read_b64_tr_b16 v[206:207], v7 offset:15360
  v_cvt_pk_bf16_f32 v240, v232, v233
  v_mfma_f32_32x32x16_bf16 v[48:63], v[168:171], a[136:139], v[48:63]
  v_cvt_pk_bf16_f32 v241, v234, v235
  v_mfma_f32_32x32x16_bf16 v[112:127], v[168:171], a[140:143], v[112:127]
  v_cvt_pk_bf16_f32 v242, v236, v237
  v_mfma_f32_32x32x16_bf16 v[64:79], v[172:175], a[136:139], v[64:79]
  v_cvt_pk_bf16_f32 v243, v238, v239
  v_mfma_f32_32x32x16_bf16 v[128:143], v[172:175], a[140:143], v[128:143]
  s_add_u32 s37, s36, 25170944
  buffer_store_dwordx4 v[240:243], v5, s[68:71], s37 offen sc1
  s_waitcnt vmcnt(31) lgkmcnt(0)
  s_barrier
  v_mfma_f32_32x32x16_bf16 v[16:31], v[176:179], a[144:147], v[16:31]
  ds_read_b64_tr_b16 v[144:145], v6 offset:16384
  ds_read_b64_tr_b16 v[146:147], v6 offset:18432
  s_add_u32 m0, s31, 0
  s_nop 0
  buffer_load_dwordx4 v8, s[72:75], s30 offen offset:0 lds
  v_accvgpr_read_b32 v208, a96
  v_accvgpr_read_b32 v209, a97
  v_mfma_f32_32x32x16_bf16 v[80:95], v[176:179], a[148:151], v[80:95]
  ds_read_b64_tr_b16 v[148:149], v7 offset:16384
  buffer_load_dwordx4 v9, s[72:75], s30 offen offset:1024 lds
  v_accvgpr_read_b32 v210, a98
  v_mfma_f32_32x32x16_bf16 v[32:47], v[180:183], a[144:147], v[32:47]
  ds_read_b64_tr_b16 v[150:151], v7 offset:18432
  v_accvgpr_read_b32 v211, a99
  v_mfma_f32_32x32x16_bf16 v[96:111], v[180:183], a[148:151], v[96:111]
  ds_read_b64_tr_b16 v[152:153], v6 offset:17408
  ds_read_b64_tr_b16 v[154:155], v6 offset:19456
  buffer_load_dwordx4 v10, s[72:75], s30 offen offset:2048 lds
  v_accvgpr_read_b32 v212, a100
  v_mfma_f32_32x32x16_bf16 v[48:63], v[184:187], a[144:147], v[48:63]
  ds_read_b64_tr_b16 v[156:157], v7 offset:17408
  v_accvgpr_read_b32 v213, a101
  v_mfma_f32_32x32x16_bf16 v[112:127], v[184:187], a[148:151], v[112:127]
  ds_read_b64_tr_b16 v[158:159], v7 offset:19456
  buffer_load_dwordx4 v11, s[72:75], s30 offen offset:3072 lds
  v_accvgpr_read_b32 v214, a102
  v_mfma_f32_32x32x16_bf16 v[64:79], v[188:191], a[144:147], v[64:79]
  ds_read_b64_tr_b16 v[160:161], v6 offset:20480
  ds_read_b64_tr_b16 v[162:163], v6 offset:22528
  v_accvgpr_read_b32 v215, a103
  v_mfma_f32_32x32x16_bf16 v[128:143], v[188:191], a[148:151], v[128:143]
  ds_read_b64_tr_b16 v[164:165], v7 offset:20480
  s_add_u32 s30, s30, 524288
  v_cvt_pk_bf16_f32 v216, v208, v209
  v_mfma_f32_32x32x16_bf16 v[16:31], v[192:195], a[152:155], v[16:31]
  ds_read_b64_tr_b16 v[166:167], v7 offset:22528
  buffer_load_dwordx4 a[128:131], v12, s[68:71], s32 offen offset:0 sc1
  v_cvt_pk_bf16_f32 v217, v210, v211
  v_cvt_pk_bf16_f32 v218, v212, v213
  v_mfma_f32_32x32x16_bf16 v[80:95], v[192:195], a[156:159], v[80:95]
  ds_read_b64_tr_b16 v[168:169], v6 offset:21504
  ds_read_b64_tr_b16 v[170:171], v6 offset:23552
  v_cvt_pk_bf16_f32 v219, v214, v215
  v_mfma_f32_32x32x16_bf16 v[32:47], v[196:199], a[152:155], v[32:47]
  ds_read_b64_tr_b16 v[172:173], v7 offset:21504
  buffer_load_dwordx4 a[132:135], v13, s[68:71], s32 offen offset:0 sc1
  s_add_u32 s37, s36, 25167872
  buffer_store_dwordx4 v[216:219], v5, s[68:71], s37 offen sc1
  v_mfma_f32_32x32x16_bf16 v[96:111], v[196:199], a[156:159], v[96:111]
  ds_read_b64_tr_b16 v[174:175], v7 offset:23552
  v_accvgpr_read_b32 v220, a104
  v_mfma_f32_32x32x16_bf16 v[48:63], v[200:203], a[152:155], v[48:63]
  buffer_load_dwordx4 a[136:139], v12, s[68:71], s32 offen offset:1024 sc1
  v_accvgpr_read_b32 v221, a105
  v_mfma_f32_32x32x16_bf16 v[112:127], v[200:203], a[156:159], v[112:127]
  v_accvgpr_read_b32 v222, a106
  v_mfma_f32_32x32x16_bf16 v[64:79], v[204:207], a[152:155], v[64:79]
  buffer_load_dwordx4 a[140:143], v13, s[68:71], s32 offen offset:1024 sc1
  v_accvgpr_read_b32 v223, a107
  v_mfma_f32_32x32x16_bf16 v[128:143], v[204:207], a[156:159], v[128:143]
  v_accvgpr_read_b32 v224, a108
  s_waitcnt lgkmcnt(0)
  v_mfma_f32_32x32x16_bf16 v[16:31], v[144:147], a[160:163], v[16:31]
  ds_read_b64_tr_b16 v[176:177], v6 offset:24576
  ds_read_b64_tr_b16 v[178:179], v6 offset:26624
  buffer_load_dwordx4 a[144:147], v12, s[68:71], s32 offen offset:2048 sc1
  v_accvgpr_read_b32 v225, a109
  v_accvgpr_read_b32 v226, a110
  v_mfma_f32_32x32x16_bf16 v[80:95], v[144:147], a[164:167], v[80:95]
  ds_read_b64_tr_b16 v[180:181], v7 offset:24576
  buffer_load_dwordx4 a[148:151], v13, s[68:71], s32 offen offset:2048 sc1
  v_accvgpr_read_b32 v227, a111
  v_mfma_f32_32x32x16_bf16 v[32:47], v[148:151], a[160:163], v[32:47]
  ds_read_b64_tr_b16 v[182:183], v7 offset:26624
  v_cvt_pk_bf16_f32 v228, v220, v221
  v_mfma_f32_32x32x16_bf16 v[96:111], v[148:151], a[164:167], v[96:111]
  ds_read_b64_tr_b16 v[184:185], v6 offset:25600
  ds_read_b64_tr_b16 v[186:187], v6 offset:27648
  buffer_load_dwordx4 a[152:155], v12, s[68:71], s32 offen offset:3072 sc1
  v_cvt_pk_bf16_f32 v229, v222, v223
  v_mfma_f32_32x32x16_bf16 v[48:63], v[152:155], a[160:163], v[48:63]
  ds_read_b64_tr_b16 v[188:189], v7 offset:25600
  v_cvt_pk_bf16_f32 v230, v224, v225
  v_mfma_f32_32x32x16_bf16 v[112:127], v[152:155], a[164:167], v[112:127]
  ds_read_b64_tr_b16 v[190:191], v7 offset:27648
  buffer_load_dwordx4 a[156:159], v13, s[68:71], s32 offen offset:3072 sc1
  s_add_u32 s32, s32, 4096
  v_cvt_pk_bf16_f32 v231, v226, v227
  v_mfma_f32_32x32x16_bf16 v[64:79], v[156:159], a[160:163], v[64:79]
  ds_read_b64_tr_b16 v[192:193], v6 offset:28672
  ds_read_b64_tr_b16 v[194:195], v6 offset:30720
  s_add_u32 s37, s36, 25171968
  buffer_store_dwordx4 v[228:231], v5, s[68:71], s37 offen sc1
  v_mfma_f32_32x32x16_bf16 v[128:143], v[156:159], a[164:167], v[128:143]
  ds_read_b64_tr_b16 v[196:197], v7 offset:28672
  v_accvgpr_read_b32 v232, a112
  v_mfma_f32_32x32x16_bf16 v[16:31], v[160:163], a[168:171], v[16:31]
  ds_read_b64_tr_b16 v[198:199], v7 offset:30720
  v_accvgpr_read_b32 v233, a113
  v_mfma_f32_32x32x16_bf16 v[80:95], v[160:163], a[172:175], v[80:95]
  ds_read_b64_tr_b16 v[200:201], v6 offset:29696
  ds_read_b64_tr_b16 v[202:203], v6 offset:31744
  v_accvgpr_read_b32 v234, a114
  v_mfma_f32_32x32x16_bf16 v[32:47], v[164:167], a[168:171], v[32:47]
  ds_read_b64_tr_b16 v[204:205], v7 offset:29696
  v_accvgpr_read_b32 v235, a115
  v_mfma_f32_32x32x16_bf16 v[96:111], v[164:167], a[172:175], v[96:111]
  ds_read_b64_tr_b16 v[206:207], v7 offset:31744
  v_accvgpr_read_b32 v236, a116
  v_mfma_f32_32x32x16_bf16 v[48:63], v[168:171], a[168:171], v[48:63]
  v_accvgpr_read_b32 v237, a117
  v_mfma_f32_32x32x16_bf16 v[112:127], v[168:171], a[172:175], v[112:127]
  v_accvgpr_read_b32 v238, a118
  v_mfma_f32_32x32x16_bf16 v[64:79], v[172:175], a[168:171], v[64:79]
  v_accvgpr_read_b32 v239, a119
  v_mfma_f32_32x32x16_bf16 v[128:143], v[172:175], a[172:175], v[128:143]
  v_cvt_pk_bf16_f32 v240, v232, v233
  s_waitcnt vmcnt(30) lgkmcnt(0)
  s_barrier
  v_mfma_f32_32x32x16_bf16 v[16:31], v[176:179], a[176:179], v[16:31]
  ds_read_b64_tr_b16 v[144:145], v6 offset:32768
  ds_read_b64_tr_b16 v[146:147], v6 offset:34816
  s_add_u32 m0, s31, 16384
  s_nop 0
  buffer_load_dwordx4 v8, s[72:75], s30 offen offset:0 lds
  v_cvt_pk_bf16_f32 v241, v234, v235
  v_cvt_pk_bf16_f32 v242, v236, v237
  v_mfma_f32_32x32x16_bf16 v[80:95], v[176:179], a[180:183], v[80:95]
  ds_read_b64_tr_b16 v[148:149], v7 offset:32768
  buffer_load_dwordx4 v9, s[72:75], s30 offen offset:1024 lds
  v_cvt_pk_bf16_f32 v243, v238, v239
  v_mfma_f32_32x32x16_bf16 v[32:47], v[180:183], a[176:179], v[32:47]
  ds_read_b64_tr_b16 v[150:151], v7 offset:34816
  s_add_u32 s37, s36, 25168896
  buffer_store_dwordx4 v[240:243], v5, s[68:71], s37 offen sc1
  v_mfma_f32_32x32x16_bf16 v[96:111], v[180:183], a[180:183], v[96:111]
  ds_read_b64_tr_b16 v[152:153], v6 offset:33792
  ds_read_b64_tr_b16 v[154:155], v6 offset:35840
  buffer_load_dwordx4 v10, s[72:75], s30 offen offset:2048 lds
  v_accvgpr_read_b32 v208, a120
  v_mfma_f32_32x32x16_bf16 v[48:63], v[184:187], a[176:179], v[48:63]
  ds_read_b64_tr_b16 v[156:157], v7 offset:33792
  v_accvgpr_read_b32 v209, a121
  v_mfma_f32_32x32x16_bf16 v[112:127], v[184:187], a[180:183], v[112:127]
  ds_read_b64_tr_b16 v[158:159], v7 offset:35840
  buffer_load_dwordx4 v11, s[72:75], s30 offen offset:3072 lds
  v_accvgpr_read_b32 v210, a122
  v_mfma_f32_32x32x16_bf16 v[64:79], v[188:191], a[176:179], v[64:79]
  ds_read_b64_tr_b16 v[160:161], v6 offset:36864
  ds_read_b64_tr_b16 v[162:163], v6 offset:38912
  v_accvgpr_read_b32 v211, a123
  v_mfma_f32_32x32x16_bf16 v[128:143], v[188:191], a[180:183], v[128:143]
  ds_read_b64_tr_b16 v[164:165], v7 offset:36864
  s_add_u32 s30, s30, 524288
  v_accvgpr_read_b32 v212, a124
  v_mfma_f32_32x32x16_bf16 v[16:31], v[192:195], a[184:187], v[16:31]
  ds_read_b64_tr_b16 v[166:167], v7 offset:38912
  buffer_load_dwordx4 a[160:163], v12, s[68:71], s32 offen offset:0 sc1
  v_accvgpr_read_b32 v213, a125
  v_accvgpr_read_b32 v214, a126
  v_mfma_f32_32x32x16_bf16 v[80:95], v[192:195], a[188:191], v[80:95]
  ds_read_b64_tr_b16 v[168:169], v6 offset:37888
  ds_read_b64_tr_b16 v[170:171], v6 offset:39936
  v_accvgpr_read_b32 v215, a127
  v_mfma_f32_32x32x16_bf16 v[32:47], v[196:199], a[184:187], v[32:47]
  ds_read_b64_tr_b16 v[172:173], v7 offset:37888
  buffer_load_dwordx4 a[164:167], v13, s[68:71], s32 offen offset:0 sc1
  v_cvt_pk_bf16_f32 v216, v208, v209
  v_mfma_f32_32x32x16_bf16 v[96:111], v[196:199], a[188:191], v[96:111]
  ds_read_b64_tr_b16 v[174:175], v7 offset:39936
  v_cvt_pk_bf16_f32 v217, v210, v211
  v_mfma_f32_32x32x16_bf16 v[48:63], v[200:203], a[184:187], v[48:63]
  buffer_load_dwordx4 a[168:171], v12, s[68:71], s32 offen offset:1024 sc1
  v_cvt_pk_bf16_f32 v218, v212, v213
  v_mfma_f32_32x32x16_bf16 v[112:127], v[200:203], a[188:191], v[112:127]
  v_cvt_pk_bf16_f32 v219, v214, v215
  v_mfma_f32_32x32x16_bf16 v[64:79], v[204:207], a[184:187], v[64:79]
  buffer_load_dwordx4 a[172:175], v13, s[68:71], s32 offen offset:1024 sc1
  s_add_u32 s37, s36, 25172992
  buffer_store_dwordx4 v[216:219], v5, s[68:71], s37 offen sc1
  v_mfma_f32_32x32x16_bf16 v[128:143], v[204:207], a[188:191], v[128:143]
  s_waitcnt lgkmcnt(0)
  v_mfma_f32_32x32x16_bf16 v[16:31], v[144:147], a[192:195], v[16:31]
  ds_read_b64_tr_b16 v[176:177], v6 offset:40960
  ds_read_b64_tr_b16 v[178:179], v6 offset:43008
  buffer_load_dwordx4 a[176:179], v12, s[68:71], s32 offen offset:2048 sc1
  s_lshl_b32 s34, s26, 19
  s_lshl_b32 s33, s3, 12
  s_add_u32 s34, s34, s33
  s_add_u32 s34, s34, 8388608
  s_mov_b32 s38, s33
  s_add_u32 s39, s33, 16384
  v_mfma_f32_32x32x16_bf16 v[80:95], v[144:147], a[196:199], v[80:95]
  ds_read_b64_tr_b16 v[180:181], v7 offset:40960
  buffer_load_dwordx4 a[180:183], v13, s[68:71], s32 offen offset:2048 sc1
  v_mfma_f32_32x32x16_bf16 v[32:47], v[148:151], a[192:195], v[32:47]
  ds_read_b64_tr_b16 v[182:183], v7 offset:43008
  v_mfma_f32_32x32x16_bf16 v[96:111], v[148:151], a[196:199], v[96:111]
  ds_read_b64_tr_b16 v[184:185], v6 offset:41984
  ds_read_b64_tr_b16 v[186:187], v6 offset:44032
  buffer_load_dwordx4 a[184:187], v12, s[68:71], s32 offen offset:3072 sc1
  v_mfma_f32_32x32x16_bf16 v[48:63], v[152:155], a[192:195], v[48:63]
  ds_read_b64_tr_b16 v[188:189], v7 offset:41984
  v_mfma_f32_32x32x16_bf16 v[112:127], v[152:155], a[196:199], v[112:127]
  ds_read_b64_tr_b16 v[190:191], v7 offset:44032
  buffer_load_dwordx4 a[188:191], v13, s[68:71], s32 offen offset:3072 sc1
  s_add_u32 s32, s32, 4096
  v_mfma_f32_32x32x16_bf16 v[64:79], v[156:159], a[192:195], v[64:79]
  ds_read_b64_tr_b16 v[192:193], v6 offset:45056
  ds_read_b64_tr_b16 v[194:195], v6 offset:47104
  v_mfma_f32_32x32x16_bf16 v[128:143], v[156:159], a[196:199], v[128:143]
  ds_read_b64_tr_b16 v[196:197], v7 offset:45056
  v_mfma_f32_32x32x16_bf16 v[16:31], v[160:163], a[200:203], v[16:31]
  ds_read_b64_tr_b16 v[198:199], v7 offset:47104
  s_add_u32 s35, s34, 16777216
  s_lshl_b32 s33, s27, 15
  s_sub_u32 s33, 524288, s33
  s_add_u32 s36, s34, s33
  s_add_u32 s37, s35, s33
  v_mfma_f32_32x32x16_bf16 v[80:95], v[160:163], a[204:207], v[80:95]
  ds_read_b64_tr_b16 v[200:201], v6 offset:46080
  ds_read_b64_tr_b16 v[202:203], v6 offset:48128
  v_mfma_f32_32x32x16_bf16 v[32:47], v[164:167], a[200:203], v[32:47]
  ds_read_b64_tr_b16 v[204:205], v7 offset:46080
  v_mfma_f32_32x32x16_bf16 v[96:111], v[164:167], a[204:207], v[96:111]
  ds_read_b64_tr_b16 v[206:207], v7 offset:48128
  v_mfma_f32_32x32x16_bf16 v[48:63], v[168:171], a[200:203], v[48:63]
  v_mfma_f32_32x32x16_bf16 v[112:127], v[168:171], a[204:207], v[112:127]
  v_mfma_f32_32x32x16_bf16 v[64:79], v[172:175], a[200:203], v[64:79]
  v_mfma_f32_32x32x16_bf16 v[128:143], v[172:175], a[204:207], v[128:143]
  s_waitcnt vmcnt(29) lgkmcnt(0)
  s_barrier
  v_mfma_f32_32x32x16_bf16 v[16:31], v[176:179], a[208:211], v[16:31]
  ds_read_b64_tr_b16 v[144:145], v6 offset:49152
  ds_read_b64_tr_b16 v[146:147], v6 offset:51200
  s_add_u32 m0, s31, 32768
  s_nop 0
  buffer_load_dwordx4 v8, s[72:75], s30 offen offset:0 lds
  v_mfma_f32_32x32x16_bf16 v[80:95], v[176:179], a[212:215], v[80:95]
  ds_read_b64_tr_b16 v[148:149], v7 offset:49152
  buffer_load_dwordx4 v9, s[72:75], s30 offen offset:1024 lds
  v_mfma_f32_32x32x16_bf16 v[32:47], v[180:183], a[208:211], v[32:47]
  ds_read_b64_tr_b16 v[150:151], v7 offset:51200
  v_mfma_f32_32x32x16_bf16 v[96:111], v[180:183], a[212:215], v[96:111]
  ds_read_b64_tr_b16 v[152:153], v6 offset:50176
  ds_read_b64_tr_b16 v[154:155], v6 offset:52224
  buffer_load_dwordx4 v10, s[72:75], s30 offen offset:2048 lds
  v_mfma_f32_32x32x16_bf16 v[48:63], v[184:187], a[208:211], v[48:63]
  ds_read_b64_tr_b16 v[156:157], v7 offset:50176
  v_mfma_f32_32x32x16_bf16 v[112:127], v[184:187], a[212:215], v[112:127]
  ds_read_b64_tr_b16 v[158:159], v7 offset:52224
  buffer_load_dwordx4 v11, s[72:75], s30 offen offset:3072 lds
  v_mfma_f32_32x32x16_bf16 v[64:79], v[188:191], a[208:211], v[64:79]
  ds_read_b64_tr_b16 v[160:161], v6 offset:53248
  ds_read_b64_tr_b16 v[162:163], v6 offset:55296
  v_mfma_f32_32x32x16_bf16 v[128:143], v[188:191], a[212:215], v[128:143]
  ds_read_b64_tr_b16 v[164:165], v7 offset:53248
  s_add_u32 s30, s30, 524288
  v_mfma_f32_32x32x16_bf16 v[16:31], v[192:195], a[216:219], v[16:31]
  ds_read_b64_tr_b16 v[166:167], v7 offset:55296
  buffer_load_dwordx4 a[192:195], v12, s[68:71], s32 offen offset:0 sc1
  v_mfma_f32_32x32x16_bf16 v[80:95], v[192:195], a[220:223], v[80:95]
  ds_read_b64_tr_b16 v[168:169], v6 offset:54272
  ds_read_b64_tr_b16 v[170:171], v6 offset:56320
  v_mfma_f32_32x32x16_bf16 v[32:47], v[196:199], a[216:219], v[32:47]
  ds_read_b64_tr_b16 v[172:173], v7 offset:54272
  buffer_load_dwordx4 a[196:199], v13, s[68:71], s32 offen offset:0 sc1
  v_mfma_f32_32x32x16_bf16 v[96:111], v[196:199], a[220:223], v[96:111]
  ds_read_b64_tr_b16 v[174:175], v7 offset:56320
  v_mfma_f32_32x32x16_bf16 v[48:63], v[200:203], a[216:219], v[48:63]
  buffer_load_dwordx4 a[200:203], v12, s[68:71], s32 offen offset:1024 sc1
  v_mfma_f32_32x32x16_bf16 v[112:127], v[200:203], a[220:223], v[112:127]
  v_mfma_f32_32x32x16_bf16 v[64:79], v[204:207], a[216:219], v[64:79]
  buffer_load_dwordx4 a[204:207], v13, s[68:71], s32 offen offset:1024 sc1
  v_mfma_f32_32x32x16_bf16 v[128:143], v[204:207], a[220:223], v[128:143]
  s_waitcnt lgkmcnt(0)
  v_mfma_f32_32x32x16_bf16 v[16:31], v[144:147], a[224:227], v[16:31]
  ds_read_b64_tr_b16 v[176:177], v6 offset:57344
  ds_read_b64_tr_b16 v[178:179], v6 offset:59392
  buffer_load_dwordx4 a[208:211], v12, s[68:71], s32 offen offset:2048 sc1
  v_mfma_f32_32x32x16_bf16 v[80:95], v[144:147], a[228:231], v[80:95]
  ds_read_b64_tr_b16 v[180:181], v7 offset:57344
  buffer_load_dwordx4 a[212:215], v13, s[68:71], s32 offen offset:2048 sc1
  v_mfma_f32_32x32x16_bf16 v[32:47], v[148:151], a[224:227], v[32:47]
  ds_read_b64_tr_b16 v[182:183], v7 offset:59392
  v_mfma_f32_32x32x16_bf16 v[96:111], v[148:151], a[228:231], v[96:111]
  ds_read_b64_tr_b16 v[184:185], v6 offset:58368
  ds_read_b64_tr_b16 v[186:187], v6 offset:60416
  buffer_load_dwordx4 a[216:219], v12, s[68:71], s32 offen offset:3072 sc1
  v_mfma_f32_32x32x16_bf16 v[48:63], v[152:155], a[224:227], v[48:63]
  ds_read_b64_tr_b16 v[188:189], v7 offset:58368
  v_mfma_f32_32x32x16_bf16 v[112:127], v[152:155], a[228:231], v[112:127]
  ds_read_b64_tr_b16 v[190:191], v7 offset:60416
  buffer_load_dwordx4 a[220:223], v13, s[68:71], s32 offen offset:3072 sc1
  s_add_u32 s32, s32, 4096
  v_mfma_f32_32x32x16_bf16 v[64:79], v[156:159], a[224:227], v[64:79]
  ds_read_b64_tr_b16 v[192:193], v6 offset:61440
  ds_read_b64_tr_b16 v[194:195], v6 offset:63488
  v_mfma_f32_32x32x16_bf16 v[128:143], v[156:159], a[228:231], v[128:143]
  ds_read_b64_tr_b16 v[196:197], v7 offset:61440
  v_mfma_f32_32x32x16_bf16 v[16:31], v[160:163], a[232:235], v[16:31]
  ds_read_b64_tr_b16 v[198:199], v7 offset:63488
  v_mfma_f32_32x32x16_bf16 v[80:95], v[160:163], a[236:239], v[80:95]
  ds_read_b64_tr_b16 v[200:201], v6 offset:62464
  ds_read_b64_tr_b16 v[202:203], v6 offset:64512
  v_mfma_f32_32x32x16_bf16 v[32:47], v[164:167], a[232:235], v[32:47]
  ds_read_b64_tr_b16 v[204:205], v7 offset:62464
  v_mfma_f32_32x32x16_bf16 v[96:111], v[164:167], a[236:239], v[96:111]
  ds_read_b64_tr_b16 v[206:207], v7 offset:64512
  v_mfma_f32_32x32x16_bf16 v[48:63], v[168:171], a[232:235], v[48:63]
  v_mfma_f32_32x32x16_bf16 v[112:127], v[168:171], a[236:239], v[112:127]
  v_mfma_f32_32x32x16_bf16 v[64:79], v[172:175], a[232:235], v[64:79]
  v_mfma_f32_32x32x16_bf16 v[128:143], v[172:175], a[236:239], v[128:143]
  s_waitcnt vmcnt(16) lgkmcnt(0)
  s_barrier
  v_mfma_f32_32x32x16_bf16 v[16:31], v[176:179], a[240:243], v[16:31]
  ds_read_b64_tr_b16 v[144:145], v6 offset:0
  ds_read_b64_tr_b16 v[146:147], v6 offset:2048
  s_add_u32 m0, s31, 49152
  s_nop 0
  buffer_load_dwordx4 v8, s[72:75], s30 offen offset:0 lds
  s_lshl_b32 s33, s26, 10
  s_lshl_b32 s21, s27, 7
  s_add_u32 s33, s33, s21
  s_add_u32 s33, s33, 557056
  v_cmp_eq_u32 vcc, 0, v0
  v_mov_b32 v2, 2130706432
  v_mov_b32 v3, 1
  v_cndmask_b32 v2, v2, v0, vcc
  buffer_store_dword v3, v2, s[68:71], s33 offen sc0 sc1
  v_mfma_f32_32x32x16_bf16 v[80:95], v[176:179], a[244:247], v[80:95]
  ds_read_b64_tr_b16 v[148:149], v7 offset:0
  buffer_load_dwordx4 v9, s[72:75], s30 offen offset:1024 lds
  v_mfma_f32_32x32x16_bf16 v[32:47], v[180:183], a[240:243], v[32:47]
  ds_read_b64_tr_b16 v[150:151], v7 offset:2048
  v_mfma_f32_32x32x16_bf16 v[96:111], v[180:183], a[244:247], v[96:111]
  ds_read_b64_tr_b16 v[152:153], v6 offset:1024
  ds_read_b64_tr_b16 v[154:155], v6 offset:3072
  buffer_load_dwordx4 v10, s[72:75], s30 offen offset:2048 lds
  v_mfma_f32_32x32x16_bf16 v[48:63], v[184:187], a[240:243], v[48:63]
  ds_read_b64_tr_b16 v[156:157], v7 offset:1024
  v_mfma_f32_32x32x16_bf16 v[112:127], v[184:187], a[244:247], v[112:127]
  ds_read_b64_tr_b16 v[158:159], v7 offset:3072
  buffer_load_dwordx4 v11, s[72:75], s30 offen offset:3072 lds
  v_mfma_f32_32x32x16_bf16 v[64:79], v[188:191], a[240:243], v[64:79]
  ds_read_b64_tr_b16 v[160:161], v6 offset:4096
  ds_read_b64_tr_b16 v[162:163], v6 offset:6144
  v_mfma_f32_32x32x16_bf16 v[128:143], v[188:191], a[244:247], v[128:143]
  ds_read_b64_tr_b16 v[164:165], v7 offset:4096
  s_add_u32 s30, s30, 524288
  v_mfma_f32_32x32x16_bf16 v[16:31], v[192:195], a[248:251], v[16:31]
  ds_read_b64_tr_b16 v[166:167], v7 offset:6144
  buffer_load_dwordx4 a[224:227], v12, s[68:71], s32 offen offset:0 sc1
  v_mfma_f32_32x32x16_bf16 v[80:95], v[192:195], a[252:255], v[80:95]
  ds_read_b64_tr_b16 v[168:169], v6 offset:5120
  ds_read_b64_tr_b16 v[170:171], v6 offset:7168
  v_mfma_f32_32x32x16_bf16 v[32:47], v[196:199], a[248:251], v[32:47]
  ds_read_b64_tr_b16 v[172:173], v7 offset:5120
  buffer_load_dwordx4 a[228:231], v13, s[68:71], s32 offen offset:0 sc1
  v_mfma_f32_32x32x16_bf16 v[96:111], v[196:199], a[252:255], v[96:111]
  ds_read_b64_tr_b16 v[174:175], v7 offset:7168
  v_mfma_f32_32x32x16_bf16 v[48:63], v[200:203], a[248:251], v[48:63]
  buffer_load_dwordx4 a[232:235], v12, s[68:71], s32 offen offset:1024 sc1
  v_mfma_f32_32x32x16_bf16 v[112:127], v[200:203], a[252:255], v[112:127]
  v_mfma_f32_32x32x16_bf16 v[64:79], v[204:207], a[248:251], v[64:79]
  buffer_load_dwordx4 a[236:239], v13, s[68:71], s32 offen offset:1024 sc1
  v_mfma_f32_32x32x16_bf16 v[128:143], v[204:207], a[252:255], v[128:143]
  s_waitcnt lgkmcnt(0)
  v_mfma_f32_32x32x16_bf16 v[16:31], v[144:147], a[128:131], v[16:31]
  ds_read_b64_tr_b16 v[176:177], v6 offset:8192
  ds_read_b64_tr_b16 v[178:179], v6 offset:10240
  buffer_load_dwordx4 a[240:243], v12, s[68:71], s32 offen offset:2048 sc1
  v_and_b32 v2, 3, v0
  v_lshlrev_b32 v2, 7, v2
  s_mul_i32 s21, s25, 512
  s_add_u32 s21, s21, kn_at-kn_cb
  v_add_u32 v2, s21, v2
  v_min_u32 v2, kn_ce-kn_cb-4, v2
  global_load_dword v239, v2, s[0:1]
  v_accvgpr_write_b32 a0, 0
  v_accvgpr_write_b32 a1, 0
  v_mfma_f32_32x32x16_bf16 v[80:95], v[144:147], a[132:135], v[80:95]
  ds_read_b64_tr_b16 v[180:181], v7 offset:8192
  buffer_load_dwordx4 a[244:247], v13, s[68:71], s32 offen offset:2048 sc1
  v_accvgpr_write_b32 a2, 0
  v_accvgpr_write_b32 a3, 0
  v_mfma_f32_32x32x16_bf16 v[32:47], v[148:151], a[128:131], v[32:47]
  ds_read_b64_tr_b16 v[182:183], v7 offset:10240
  v_accvgpr_write_b32 a4, 0
  v_accvgpr_write_b32 a5, 0
  v_mfma_f32_32x32x16_bf16 v[96:111], v[148:151], a[132:135], v[96:111]
  ds_read_b64_tr_b16 v[184:185], v6 offset:9216
  ds_read_b64_tr_b16 v[186:187], v6 offset:11264
  buffer_load_dwordx4 a[248:251], v12, s[68:71], s32 offen offset:3072 sc1
  v_accvgpr_write_b32 a6, 0
  v_accvgpr_write_b32 a7, 0
  v_mfma_f32_32x32x16_bf16 v[48:63], v[152:155], a[128:131], v[48:63]
  ds_read_b64_tr_b16 v[188:189], v7 offset:9216
  v_accvgpr_write_b32 a8, 0
  v_accvgpr_write_b32 a9, 0
  v_mfma_f32_32x32x16_bf16 v[112:127], v[152:155], a[132:135], v[112:127]
  ds_read_b64_tr_b16 v[190:191], v7 offset:11264
  buffer_load_dwordx4 a[252:255], v13, s[68:71], s32 offen offset:3072 sc1
  s_add_u32 s32, s32, 4096
  v_accvgpr_write_b32 a10, 0
  v_accvgpr_write_b32 a11, 0
  v_mfma_f32_32x32x16_bf16 v[64:79], v[156:159], a[128:131], v[64:79]
  ds_read_b64_tr_b16 v[192:193], v6 offset:12288
  ds_read_b64_tr_b16 v[194:195], v6 offset:14336
  v_accvgpr_write_b32 a12, 0
  v_accvgpr_write_b32 a13, 0
  v_mfma_f32_32x32x16_bf16 v[128:143], v[156:159], a[132:135], v[128:143]
  ds_read_b64_tr_b16 v[196:197], v7 offset:12288
  v_accvgpr_write_b32 a14, 0
  v_accvgpr_write_b32 a15, 0
  v_mfma_f32_32x32x16_bf16 v[16:31], v[160:163], a[136:139], v[16:31]
  ds_read_b64_tr_b16 v[198:199], v7 offset:14336
  v_accvgpr_write_b32 a16, 0
  v_accvgpr_write_b32 a17, 0
  v_mfma_f32_32x32x16_bf16 v[80:95], v[160:163], a[140:143], v[80:95]
  ds_read_b64_tr_b16 v[200:201], v6 offset:13312
  ds_read_b64_tr_b16 v[202:203], v6 offset:15360
  v_accvgpr_write_b32 a18, 0
  v_accvgpr_write_b32 a19, 0
  v_mfma_f32_32x32x16_bf16 v[32:47], v[164:167], a[136:139], v[32:47]
  ds_read_b64_tr_b16 v[204:205], v7 offset:13312
  v_accvgpr_write_b32 a20, 0
  v_accvgpr_write_b32 a21, 0
  v_mfma_f32_32x32x16_bf16 v[96:111], v[164:167], a[140:143], v[96:111]
  ds_read_b64_tr_b16 v[206:207], v7 offset:15360
  v_accvgpr_write_b32 a22, 0
  v_accvgpr_write_b32 a23, 0
  v_mfma_f32_32x32x16_bf16 v[48:63], v[168:171], a[136:139], v[48:63]
  v_accvgpr_write_b32 a24, 0
  v_accvgpr_write_b32 a25, 0
  v_mfma_f32_32x32x16_bf16 v[112:127], v[168:171], a[140:143], v[112:127]
  v_accvgpr_write_b32 a26, 0
  v_accvgpr_write_b32 a27, 0
  v_mfma_f32_32x32x16_bf16 v[64:79], v[172:175], a[136:139], v[64:79]
  v_accvgpr_write_b32 a28, 0
  v_accvgpr_write_b32 a29, 0
  v_mfma_f32_32x32x16_bf16 v[128:143], v[172:175], a[140:143], v[128:143]
  v_accvgpr_write_b32 a30, 0
  v_accvgpr_write_b32 a31, 0
  s_waitcnt vmcnt(26) lgkmcnt(0)
  s_barrier
  v_mfma_f32_32x32x16_bf16 v[16:31], v[176:179], a[144:147], v[16:31]
  ds_read_b64_tr_b16 v[144:145], v6 offset:16384
  ds_read_b64_tr_b16 v[146:147], v6 offset:18432
  v_and_b32 v2, 3, v0
  v_lshlrev_b32 v2, 7, v2
  s_mul_i32 s21, s25, 512
  s_add_u32 s21, s21, kn_st-kn_cb
  v_add_u32 v2, s21, v2
  v_min_u32 v2, kn_ce-kn_cb-4, v2
  global_load_dword v239, v2, s[0:1]
  v_accvgpr_write_b32 a32, 0
  v_accvgpr_write_b32 a33, 0
  v_mfma_f32_32x32x16_bf16 v[80:95], v[176:179], a[148:151], v[80:95]
  ds_read_b64_tr_b16 v[148:149], v7 offset:16384
  v_accvgpr_write_b32 a34, 0
  v_accvgpr_write_b32 a35, 0
  v_mfma_f32_32x32x16_bf16 v[32:47], v[180:183], a[144:147], v[32:47]
  ds_read_b64_tr_b16 v[150:151], v7 offset:18432
  v_accvgpr_write_b32 a36, 0
  v_accvgpr_write_b32 a37, 0
  v_mfma_f32_32x32x16_bf16 v[96:111], v[180:183], a[148:151], v[96:111]
  ds_read_b64_tr_b16 v[152:153], v6 offset:17408
  ds_read_b64_tr_b16 v[154:155], v6 offset:19456
  v_accvgpr_write_b32 a38, 0
  v_accvgpr_write_b32 a39, 0
  v_mfma_f32_32x32x16_bf16 v[48:63], v[184:187], a[144:147], v[48:63]
  ds_read_b64_tr_b16 v[156:157], v7 offset:17408
  v_accvgpr_write_b32 a40, 0
  v_accvgpr_write_b32 a41, 0
  v_mfma_f32_32x32x16_bf16 v[112:127], v[184:187], a[148:151], v[112:127]
  ds_read_b64_tr_b16 v[158:159], v7 offset:19456
  v_accvgpr_write_b32 a42, 0
  v_accvgpr_write_b32 a43, 0
  v_mfma_f32_32x32x16_bf16 v[64:79], v[188:191], a[144:147], v[64:79]
  ds_read_b64_tr_b16 v[160:161], v6 offset:20480
  ds_read_b64_tr_b16 v[162:163], v6 offset:22528
  v_accvgpr_write_b32 a44, 0
  v_accvgpr_write_b32 a45, 0
  v_mfma_f32_32x32x16_bf16 v[128:143], v[188:191], a[148:151], v[128:143]
  ds_read_b64_tr_b16 v[164:165], v7 offset:20480
  v_accvgpr_write_b32 a46, 0
  v_accvgpr_write_b32 a47, 0
  v_mfma_f32_32x32x16_bf16 v[16:31], v[192:195], a[152:155], v[16:31]
  ds_read_b64_tr_b16 v[166:167], v7 offset:22528
  v_accvgpr_write_b32 a48, 0
  v_accvgpr_write_b32 a49, 0
  v_mfma_f32_32x32x16_bf16 v[80:95], v[192:195], a[156:159], v[80:95]
  ds_read_b64_tr_b16 v[168:169], v6 offset:21504
  ds_read_b64_tr_b16 v[170:171], v6 offset:23552
  v_accvgpr_write_b32 a50, 0
  v_accvgpr_write_b32 a51, 0
  v_mfma_f32_32x32x16_bf16 v[32:47], v[196:199], a[152:155], v[32:47]
  ds_read_b64_tr_b16 v[172:173], v7 offset:21504
  v_accvgpr_write_b32 a52, 0
  v_accvgpr_write_b32 a53, 0
  v_mfma_f32_32x32x16_bf16 v[96:111], v[196:199], a[156:159], v[96:111]
  ds_read_b64_tr_b16 v[174:175], v7 offset:23552
  v_accvgpr_write_b32 a54, 0
  v_accvgpr_write_b32 a55, 0
  v_mfma_f32_32x32x16_bf16 v[48:63], v[200:203], a[152:155], v[48:63]
  v_accvgpr_write_b32 a56, 0
  v_accvgpr_write_b32 a57, 0
  v_mfma_f32_32x32x16_bf16 v[112:127], v[200:203], a[156:159], v[112:127]
  v_accvgpr_write_b32 a58, 0
  v_accvgpr_write_b32 a59, 0
  v_mfma_f32_32x32x16_bf16 v[64:79], v[204:207], a[152:155], v[64:79]
  v_accvgpr_write_b32 a60, 0
  v_accvgpr_write_b32 a61, 0
  v_mfma_f32_32x32x16_bf16 v[128:143], v[204:207], a[156:159], v[128:143]
  v_accvgpr_write_b32 a62, 0
  v_accvgpr_write_b32 a63, 0
  s_waitcnt lgkmcnt(0)
  v_mfma_f32_32x32x16_bf16 v[16:31], v[144:147], a[160:163], v[16:31]
  ds_read_b64_tr_b16 v[176:177], v6 offset:24576
  ds_read_b64_tr_b16 v[178:179], v6 offset:26624
  v_and_b32 v2, 7, v1
  v_lshlrev_b32 v2, 7, v2
  s_lshl_b32 s33, s26, 10
  s_add_u32 s33, s33, 557056
  v_add_u32 v251, s33, v2
  buffer_load_dword v250, v251, s[68:71], 0 offen sc1
  v_accvgpr_write_b32 a64, 0
  v_accvgpr_write_b32 a65, 0
  v_mfma_f32_32x32x16_bf16 v[80:95], v[144:147], a[164:167], v[80:95]
  ds_read_b64_tr_b16 v[180:181], v7 offset:24576
  v_accvgpr_write_b32 a66, 0
  v_accvgpr_write_b32 a67, 0
  v_mfma_f32_32x32x16_bf16 v[32:47], v[148:151], a[160:163], v[32:47]
  ds_read_b64_tr_b16 v[182:183], v7 offset:26624
  v_accvgpr_write_b32 a68, 0
  v_accvgpr_write_b32 a69, 0
  v_mfma_f32_32x32x16_bf16 v[96:111], v[148:151], a[164:167], v[96:111]
  ds_read_b64_tr_b16 v[184:185], v6 offset:25600
  ds_read_b64_tr_b16 v[186:187], v6 offset:27648
  v_accvgpr_write_b32 a70, 0
  v_accvgpr_write_b32 a71, 0
  v_mfma_f32_32x32x16_bf16 v[48:63], v[152:155], a[160:163], v[48:63]
  ds_read_b64_tr_b16 v[188:189], v7 offset:25600
  v_accvgpr_write_b32 a72, 0
  v_accvgpr_write_b32 a73, 0
  v_mfma_f32_32x32x16_bf16 v[112:127], v[152:155], a[164:167], v[112:127]
  ds_read_b64_tr_b16 v[190:191], v7 offset:27648
  v_accvgpr_write_b32 a74, 0
  v_accvgpr_write_b32 a75, 0
  v_mfma_f32_32x32x16_bf16 v[64:79], v[156:159], a[160:163], v[64:79]
  ds_read_b64_tr_b16 v[192:193], v6 offset:28672
  ds_read_b64_tr_b16 v[194:195], v6 offset:30720
  v_accvgpr_write_b32 a76, 0
  v_accvgpr_write_b32 a77, 0
  v_mfma_f32_32x32x16_bf16 v[128:143], v[156:159], a[164:167], v[128:143]
  ds_read_b64_tr_b16 v[196:197], v7 offset:28672
  v_accvgpr_write_b32 a78, 0
  v_accvgpr_write_b32 a79, 0
  v_mfma_f32_32x32x16_bf16 v[16:31], v[160:163], a[168:171], v[16:31]
  ds_read_b64_tr_b16 v[198:199], v7 offset:30720
  v_accvgpr_write_b32 a80, 0
  v_accvgpr_write_b32 a81, 0
  v_mfma_f32_32x32x16_bf16 v[80:95], v[160:163], a[172:175], v[80:95]
  ds_read_b64_tr_b16 v[200:201], v6 offset:29696
  ds_read_b64_tr_b16 v[202:203], v6 offset:31744
  v_accvgpr_write_b32 a82, 0
  v_accvgpr_write_b32 a83, 0
  v_mfma_f32_32x32x16_bf16 v[32:47], v[164:167], a[168:171], v[32:47]
  ds_read_b64_tr_b16 v[204:205], v7 offset:29696
  v_accvgpr_write_b32 a84, 0
  v_accvgpr_write_b32 a85, 0
  v_mfma_f32_32x32x16_bf16 v[96:111], v[164:167], a[172:175], v[96:111]
  ds_read_b64_tr_b16 v[206:207], v7 offset:31744
  v_accvgpr_write_b32 a86, 0
  v_accvgpr_write_b32 a87, 0
  v_mfma_f32_32x32x16_bf16 v[48:63], v[168:171], a[168:171], v[48:63]
  v_accvgpr_write_b32 a88, 0
  v_accvgpr_write_b32 a89, 0
  v_mfma_f32_32x32x16_bf16 v[112:127], v[168:171], a[172:175], v[112:127]
  v_accvgpr_write_b32 a90, 0
  v_accvgpr_write_b32 a91, 0
  v_mfma_f32_32x32x16_bf16 v[64:79], v[172:175], a[168:171], v[64:79]
  v_accvgpr_write_b32 a92, 0
  v_accvgpr_write_b32 a93, 0
  v_mfma_f32_32x32x16_bf16 v[128:143], v[172:175], a[172:175], v[128:143]
  v_accvgpr_write_b32 a94, 0
  v_accvgpr_write_b32 a95, 0
  s_waitcnt vmcnt(16) lgkmcnt(0)
  s_barrier
  v_mfma_f32_32x32x16_bf16 v[16:31], v[176:179], a[176:179], v[16:31]
  ds_read_b64_tr_b16 v[144:145], v6 offset:32768
  ds_read_b64_tr_b16 v[146:147], v6 offset:34816
  v_accvgpr_write_b32 a96, 0
  v_accvgpr_write_b32 a97, 0
  v_mfma_f32_32x32x16_bf16 v[80:95], v[176:179], a[180:183], v[80:95]
  ds_read_b64_tr_b16 v[148:149], v7 offset:32768
  v_accvgpr_write_b32 a98, 0
  v_accvgpr_write_b32 a99, 0
  v_mfma_f32_32x32x16_bf16 v[32:47], v[180:183], a[176:179], v[32:47]
  ds_read_b64_tr_b16 v[150:151], v7 offset:34816
  v_accvgpr_write_b32 a100, 0
  v_accvgpr_write_b32 a101, 0
  v_mfma_f32_32x32x16_bf16 v[96:111], v[180:183], a[180:183], v[96:111]
  ds_read_b64_tr_b16 v[152:153], v6 offset:33792
  ds_read_b64_tr_b16 v[154:155], v6 offset:35840
  v_accvgpr_write_b32 a102, 0
  v_accvgpr_write_b32 a103, 0
  v_mfma_f32_32x32x16_bf16 v[48:63], v[184:187], a[176:179], v[48:63]
  ds_read_b64_tr_b16 v[156:157], v7 offset:33792
  v_accvgpr_write_b32 a104, 0
  v_accvgpr_write_b32 a105, 0
  v_mfma_f32_32x32x16_bf16 v[112:127], v[184:187], a[180:183], v[112:127]
  ds_read_b64_tr_b16 v[158:159], v7 offset:35840
  v_accvgpr_write_b32 a106, 0
  v_accvgpr_write_b32 a107, 0
  v_mfma_f32_32x32x16_bf16 v[64:79], v[188:191], a[176:179], v[64:79]
  ds_read_b64_tr_b16 v[160:161], v6 offset:36864
  ds_read_b64_tr_b16 v[162:163], v6 offset:38912
  v_accvgpr_write_b32 a108, 0
  v_accvgpr_write_b32 a109, 0
  v_mfma_f32_32x32x16_bf16 v[128:143], v[188:191], a[180:183], v[128:143]
  ds_read_b64_tr_b16 v[164:165], v7 offset:36864
  v_accvgpr_write_b32 a110, 0
  v_accvgpr_write_b32 a111, 0
  v_mfma_f32_32x32x16_bf16 v[16:31], v[192:195], a[184:187], v[16:31]
  ds_read_b64_tr_b16 v[166:167], v7 offset:38912
  v_accvgpr_write_b32 a112, 0
  v_accvgpr_write_b32 a113, 0
  v_mfma_f32_32x32x16_bf16 v[80:95], v[192:195], a[188:191], v[80:95]
  ds_read_b64_tr_b16 v[168:169], v6 offset:37888
  ds_read_b64_tr_b16 v[170:171], v6 offset:39936
  v_accvgpr_write_b32 a114, 0
  v_accvgpr_write_b32 a115, 0
  v_mfma_f32_32x32x16_bf16 v[32:47], v[196:199], a[184:187], v[32:47]
  ds_read_b64_tr_b16 v[172:173], v7 offset:37888
  v_accvgpr_write_b32 a116, 0
  v_accvgpr_write_b32 a117, 0
  v_mfma_f32_32x32x16_bf16 v[96:111], v[196:199], a[188:191], v[96:111]
  ds_read_b64_tr_b16 v[174:175], v7 offset:39936
  v_accvgpr_write_b32 a118, 0
  v_accvgpr_write_b32 a119, 0
  v_mfma_f32_32x32x16_bf16 v[48:63], v[200:203], a[184:187], v[48:63]
  v_accvgpr_write_b32 a120, 0
  v_accvgpr_write_b32 a121, 0
  v_mfma_f32_32x32x16_bf16 v[112:127], v[200:203], a[188:191], v[112:127]
  v_accvgpr_write_b32 a122, 0
  v_accvgpr_write_b32 a123, 0
  v_mfma_f32_32x32x16_bf16 v[64:79], v[204:207], a[184:187], v[64:79]
  v_accvgpr_write_b32 a124, 0
  v_accvgpr_write_b32 a125, 0
  v_mfma_f32_32x32x16_bf16 v[128:143], v[204:207], a[188:191], v[128:143]
  v_accvgpr_write_b32 a126, 0
  v_accvgpr_write_b32 a127, 0
  s_waitcnt lgkmcnt(0)
  v_mfma_f32_32x32x16_bf16 v[16:31], v[144:147], a[192:195], v[16:31]
  ds_read_b64_tr_b16 v[176:177], v6 offset:40960
  ds_read_b64_tr_b16 v[178:179], v6 offset:43008
  v_mov_b32 v208, 0
  v_mov_b32 v209, 0
  v_mov_b32 v210, 0
  v_mfma_f32_32x32x16_bf16 v[80:95], v[144:147], a[196:199], v[80:95]
  ds_read_b64_tr_b16 v[180:181], v7 offset:40960
  v_mov_b32 v211, 0
  v_mov_b32 v212, 0
  v_mfma_f32_32x32x16_bf16 v[32:47], v[148:151], a[192:195], v[32:47]
  ds_read_b64_tr_b16 v[182:183], v7 offset:43008
  v_mov_b32 v213, 0
  v_mov_b32 v214, 0
  v_mov_b32 v215, 0
  v_mfma_f32_32x32x16_bf16 v[96:111], v[148:151], a[196:199], v[96:111]
  ds_read_b64_tr_b16 v[184:185], v6 offset:41984
  ds_read_b64_tr_b16 v[186:187], v6 offset:44032
  v_mov_b32 v216, 0
  v_mov_b32 v217, 0
  v_mfma_f32_32x32x16_bf16 v[48:63], v[152:155], a[192:195], v[48:63]
  ds_read_b64_tr_b16 v[188:189], v7 offset:41984
  v_mov_b32 v218, 0
  v_mov_b32 v219, 0
  v_mov_b32 v220, 0
  v_mfma_f32_32x32x16_bf16 v[112:127], v[152:155], a[196:199], v[112:127]
  ds_read_b64_tr_b16 v[190:191], v7 offset:44032
  v_mov_b32 v221, 0
  v_mov_b32 v222, 0
  v_mfma_f32_32x32x16_bf16 v[64:79], v[156:159], a[192:195], v[64:79]
  ds_read_b64_tr_b16 v[192:193], v6 offset:45056
  ds_read_b64_tr_b16 v[194:195], v6 offset:47104
  v_mov_b32 v223, 0
  v_mov_b32 v232, 0
  v_mov_b32 v233, 0
  v_mfma_f32_32x32x16_bf16 v[128:143], v[156:159], a[196:199], v[128:143]
  ds_read_b64_tr_b16 v[196:197], v7 offset:45056
  v_mov_b32 v236, v14
  v_add_u32 v235, 32768, v14
  v_mfma_f32_32x32x16_bf16 v[16:31], v[160:163], a[200:203], v[16:31]
  ds_read_b64_tr_b16 v[198:199], v7 offset:47104
  v_and_b32 v2, 31, v1
  s_lshl_b32 s33, s3, 5
  v_mfma_f32_32x32x16_bf16 v[80:95], v[160:163], a[204:207], v[80:95]
  ds_read_b64_tr_b16 v[200:201], v6 offset:46080
  ds_read_b64_tr_b16 v[202:203], v6 offset:48128
  v_add_u32 v2, s33, v2
  v_lshrrev_b32 v3, 5, v1
  v_lshlrev_b32 v3, 2, v3
  v_mfma_f32_32x32x16_bf16 v[32:47], v[164:167], a[200:203], v[32:47]
  ds_read_b64_tr_b16 v[204:205], v7 offset:46080
  v_sub_u32 v2, v2, v3
  v_cvt_f32_i32 v2, v2
  v_mfma_f32_32x32x16_bf16 v[96:111], v[164:167], a[204:207], v[96:111]
  ds_read_b64_tr_b16 v[206:207], v7 offset:48128
  v_add_f32 v2, 0.5, v2
  v_mul_f32 v237, 0x71800000, v2
  s_mov_b32 s76, -1.0
  v_mfma_f32_32x32x16_bf16 v[48:63], v[168:171], a[200:203], v[48:63]
  s_mov_b32 s77, -1.0
  s_mov_b32 s78, 0xff800000
  v_mfma_f32_32x32x16_bf16 v[112:127], v[168:171], a[204:207], v[112:127]
  s_mov_b32 s79, 0xff800000
  v_lshrrev_b32 v244, 1, v0
  v_lshlrev_b32 v243, 1, v244
  v_mul_u32_u24 v244, 12288, v244
  v_and_b32 v245, 1, v0
  v_lshl_add_u32 v244, v245, 4, v244
  s_lshl_b32 s82, s24, 5
  s_add_u32 s82, s82, s25
  s_lshl_b32 s82, s82, 5
  s_add_u32 s82, s82, 4096
  s_lshl_b32 s83, s3, 10
  s_add_u32 s83, s83, 131072
  v_mfma_f32_32x32x16_bf16 v[64:79], v[172:175], a[200:203], v[64:79]
  s_lshl_b32 s33, s26, 2
  s_and_b32 s21, s27, 3
  s_add_u32 s33, s33, s21
  s_lshl_b32 s96, s33, 16
  s_min_u32 s96, s96, 8321024
  s_add_u32 s96, s96, 4096
  s_mul_i32 s66, s33, 57344
  s_min_u32 s66, s66, 7272448
  s_add_u32 s66, s66, 4096
  s_cmp_ge_u32 s27, 4
  s_cselect_b32 s96, s96, 2130706432
  s_cselect_b32 s67, 0, 9
  v_mfma_f32_32x32x16_bf16 v[128:143], v[172:175], a[204:207], v[128:143]
  s_mov_b32 s72, s48
  s_mov_b32 s73, s49
  s_mov_b32 s74, s50
  s_mov_b32 s75, s51
  v_min_u32 v245, 175, v0
  v_lshlrev_b32 v245, 7, v245
  s_waitcnt vmcnt(0) lgkmcnt(0)
  s_barrier
  v_cmp_ne_u32 vcc, 1, v250
  s_cbranch_vccnz at_k_sp
at_k_ok:
  v_mfma_f32_32x32x16_bf16 v[16:31], v[176:179], a[208:211], v[16:31]
  ds_read_b64_tr_b16 v[144:145], v6 offset:49152
  ds_read_b64_tr_b16 v[146:147], v6 offset:51200
  s_cmp_lt_u32 s34, s36
  s_cselect_b32 s33, s34, 0x7f000000
  s_mov_b32 m0, s38
  s_add_u32 s34, s34, 16384
  buffer_load_dwordx4 v14, s[68:71], s33 offen sc1 lds
  v_mfma_f32_32x32x16_bf16 v[80:95], v[176:179], a[212:215], v[80:95]
  ds_read_b64_tr_b16 v[148:149], v7 offset:49152
  buffer_load_dwordx4 v14, s[68:71], s33 offen offset:1024 sc1 lds
  v_mfma_f32_32x32x16_bf16 v[32:47], v[180:183], a[208:211], v[32:47]
  ds_read_b64_tr_b16 v[150:151], v7 offset:51200
  buffer_load_dwordx4 v14, s[68:71], s33 offen offset:2048 sc1 lds
  s_add_u32 s38, s38, 32768
  v_mfma_f32_32x32x16_bf16 v[96:111], v[180:183], a[212:215], v[96:111]
  ds_read_b64_tr_b16 v[152:153], v6 offset:50176
  ds_read_b64_tr_b16 v[154:155], v6 offset:52224
  buffer_load_dwordx4 v14, s[68:71], s33 offen offset:3072 sc1 lds
  s_and_b32 s38, s38, 0x1ffff
  v_mfma_f32_32x32x16_bf16 v[48:63], v[184:187], a[208:211], v[48:63]
  ds_read_b64_tr_b16 v[156:157], v7 offset:50176
  s_cmp_lt_u32 s34, s36
  s_cselect_b32 s33, s34, 0x7f000000
  s_mov_b32 m0, s38
  s_add_u32 s34, s34, 16384
  buffer_load_dwordx4 v14, s[68:71], s33 offen sc1 lds
  v_mfma_f32_32x32x16_bf16 v[112:127], v[184:187], a[212:215], v[112:127]
  ds_read_b64_tr_b16 v[158:159], v7 offset:52224
  v_mfma_f32_32x32x16_bf16 v[64:79], v[188:191], a[208:211], v[64:79]
  ds_read_b64_tr_b16 v[160:161], v6 offset:53248
  ds_read_b64_tr_b16 v[162:163], v6 offset:55296
  buffer_load_dwordx4 v14, s[68:71], s33 offen offset:1024 sc1 lds
  v_mfma_f32_32x32x16_bf16 v[128:143], v[188:191], a[212:215], v[128:143]
  ds_read_b64_tr_b16 v[164:165], v7 offset:53248
  buffer_load_dwordx4 v14, s[68:71], s33 offen offset:2048 sc1 lds
  s_add_u32 s38, s38, 32768
  v_mfma_f32_32x32x16_bf16 v[16:31], v[192:195], a[216:219], v[16:31]
  ds_read_b64_tr_b16 v[166:167], v7 offset:55296
  buffer_load_dwordx4 v14, s[68:71], s33 offen offset:3072 sc1 lds
  s_and_b32 s38, s38, 0x1ffff
  v_mfma_f32_32x32x16_bf16 v[80:95], v[192:195], a[220:223], v[80:95]
  ds_read_b64_tr_b16 v[168:169], v6 offset:54272
  ds_read_b64_tr_b16 v[170:171], v6 offset:56320
  s_cmp_lt_u32 s35, s37
  s_cselect_b32 s33, s35, 0x7f000000
  s_mov_b32 m0, s39
  s_add_u32 s35, s35, 16384
  buffer_load_dwordx4 v14, s[68:71], s33 offen sc1 lds
  v_mfma_f32_32x32x16_bf16 v[32:47], v[196:199], a[216:219], v[32:47]
  ds_read_b64_tr_b16 v[172:173], v7 offset:54272
  v_mfma_f32_32x32x16_bf16 v[96:111], v[196:199], a[220:223], v[96:111]
  ds_read_b64_tr_b16 v[174:175], v7 offset:56320
  buffer_load_dwordx4 v14, s[68:71], s33 offen offset:1024 sc1 lds
  v_mfma_f32_32x32x16_bf16 v[48:63], v[200:203], a[216:219], v[48:63]
  buffer_load_dwordx4 v14, s[68:71], s33 offen offset:2048 sc1 lds
  s_add_u32 s39, s39, 32768
  v_mfma_f32_32x32x16_bf16 v[112:127], v[200:203], a[220:223], v[112:127]
  buffer_load_dwordx4 v14, s[68:71], s33 offen offset:3072 sc1 lds
  s_and_b32 s39, s39, 0x1ffff
  v_mfma_f32_32x32x16_bf16 v[64:79], v[204:207], a[216:219], v[64:79]
  v_mfma_f32_32x32x16_bf16 v[128:143], v[204:207], a[220:223], v[128:143]
  s_waitcnt lgkmcnt(0)
  v_mfma_f32_32x32x16_bf16 v[16:31], v[144:147], a[224:227], v[16:31]
  ds_read_b64_tr_b16 v[176:177], v6 offset:57344
  ds_read_b64_tr_b16 v[178:179], v6 offset:59392
  s_cmp_lt_u32 s34, s36
  s_cselect_b32 s33, s34, 0x7f000000
  s_mov_b32 m0, s38
  s_add_u32 s34, s34, 16384
  buffer_load_dwordx4 v14, s[68:71], s33 offen sc1 lds
  v_mfma_f32_32x32x16_bf16 v[80:95], v[144:147], a[228:231], v[80:95]
  ds_read_b64_tr_b16 v[180:181], v7 offset:57344
  v_mfma_f32_32x32x16_bf16 v[32:47], v[148:151], a[224:227], v[32:47]
  ds_read_b64_tr_b16 v[182:183], v7 offset:59392
  buffer_load_dwordx4 v14, s[68:71], s33 offen offset:1024 sc1 lds
  v_mfma_f32_32x32x16_bf16 v[96:111], v[148:151], a[228:231], v[96:111]
  ds_read_b64_tr_b16 v[184:185], v6 offset:58368
  ds_read_b64_tr_b16 v[186:187], v6 offset:60416
  v_mfma_f32_32x32x16_bf16 v[48:63], v[152:155], a[224:227], v[48:63]
  ds_read_b64_tr_b16 v[188:189], v7 offset:58368
  buffer_load_dwordx4 v14, s[68:71], s33 offen offset:2048 sc1 lds
  s_add_u32 s38, s38, 32768
  v_mfma_f32_32x32x16_bf16 v[112:127], v[152:155], a[228:231], v[112:127]
  ds_read_b64_tr_b16 v[190:191], v7 offset:60416
  v_mfma_f32_32x32x16_bf16 v[64:79], v[156:159], a[224:227], v[64:79]
  ds_read_b64_tr_b16 v[192:193], v6 offset:61440
  ds_read_b64_tr_b16 v[194:195], v6 offset:63488
  buffer_load_dwordx4 v14, s[68:71], s33 offen offset:3072 sc1 lds
  s_and_b32 s38, s38, 0x1ffff
  v_mfma_f32_32x32x16_bf16 v[128:143], v[156:159], a[228:231], v[128:143]
  ds_read_b64_tr_b16 v[196:197], v7 offset:61440
  v_mfma_f32_32x32x16_bf16 v[16:31], v[160:163], a[232:235], v[16:31]
  ds_read_b64_tr_b16 v[198:199], v7 offset:63488
  s_cmp_lt_u32 s35, s37
  s_cselect_b32 s33, s35, 0x7f000000
  s_mov_b32 m0, s39
  s_add_u32 s35, s35, 16384
  buffer_load_dwordx4 v14, s[68:71], s33 offen sc1 lds
  v_mfma_f32_32x32x16_bf16 v[80:95], v[160:163], a[236:239], v[80:95]
  ds_read_b64_tr_b16 v[200:201], v6 offset:62464
  ds_read_b64_tr_b16 v[202:203], v6 offset:64512
  v_mfma_f32_32x32x16_bf16 v[32:47], v[164:167], a[232:235], v[32:47]
  ds_read_b64_tr_b16 v[204:205], v7 offset:62464
  buffer_load_dwordx4 v14, s[68:71], s33 offen offset:1024 sc1 lds
  v_mfma_f32_32x32x16_bf16 v[96:111], v[164:167], a[236:239], v[96:111]
  ds_read_b64_tr_b16 v[206:207], v7 offset:64512
  v_mfma_f32_32x32x16_bf16 v[48:63], v[168:171], a[232:235], v[48:63]
  buffer_load_dwordx4 v14, s[68:71], s33 offen offset:2048 sc1 lds
  s_add_u32 s39, s39, 32768
  v_mfma_f32_32x32x16_bf16 v[112:127], v[168:171], a[236:239], v[112:127]
  v_mfma_f32_32x32x16_bf16 v[64:79], v[172:175], a[232:235], v[64:79]
  buffer_load_dwordx4 v14, s[68:71], s33 offen offset:3072 sc1 lds
  s_and_b32 s39, s39, 0x1ffff
  v_mfma_f32_32x32x16_bf16 v[128:143], v[172:175], a[236:239], v[128:143]
  s_waitcnt lgkmcnt(0)
  v_mfma_f32_32x32x16_bf16 v[16:31], v[176:179], a[240:243], v[16:31]
  v_and_b32 v2, 3, v0
  v_lshlrev_b32 v2, 7, v2
  s_mul_i32 s21, s25, 512
  s_add_u32 s21, s21, kn_op-kn_cb
  v_add_u32 v2, s21, v2
  v_min_u32 v2, kn_ce-kn_cb-4, v2
  global_load_dword v239, v2, s[0:1]
  v_mfma_f32_32x32x16_bf16 v[80:95], v[176:179], a[244:247], v[80:95]
  v_mfma_f32_32x32x16_bf16 v[32:47], v[180:183], a[240:243], v[32:47]
  v_mfma_f32_32x32x16_bf16 v[96:111], v[180:183], a[244:247], v[96:111]
  v_mfma_f32_32x32x16_bf16 v[48:63], v[184:187], a[240:243], v[48:63]
  v_mfma_f32_32x32x16_bf16 v[112:127], v[184:187], a[244:247], v[112:127]
  v_mfma_f32_32x32x16_bf16 v[64:79], v[188:191], a[240:243], v[64:79]
  v_mfma_f32_32x32x16_bf16 v[128:143], v[188:191], a[244:247], v[128:143]
  v_mfma_f32_32x32x16_bf16 v[16:31], v[192:195], a[248:251], v[16:31]
  v_and_b32 v2, 3, v0
  v_lshlrev_b32 v2, 7, v2
  s_mul_i32 s21, s25, 512
  s_add_u32 s21, s21, kn_f1-kn_cb
  v_add_u32 v2, s21, v2
  v_min_u32 v2, kn_ce-kn_cb-4, v2
  global_load_dword v239, v2, s[0:1]
  v_mfma_f32_32x32x16_bf16 v[80:95], v[192:195], a[252:255], v[80:95]
  v_mfma_f32_32x32x16_bf16 v[32:47], v[196:199], a[248:251], v[32:47]
  v_mfma_f32_32x32x16_bf16 v[96:111], v[196:199], a[252:255], v[96:111]
  v_mfma_f32_32x32x16_bf16 v[48:63], v[200:203], a[248:251], v[48:63]
  v_mfma_f32_32x32x16_bf16 v[112:127], v[200:203], a[252:255], v[112:127]
  v_mfma_f32_32x32x16_bf16 v[64:79], v[204:207], a[248:251], v[64:79]
  v_mfma_f32_32x32x16_bf16 v[128:143], v[204:207], a[252:255], v[128:143]
  s_waitcnt vmcnt(10)
  s_barrier
kn_at:
  ds_read_b128 v[144:147], v236 offset:0
  ds_read_b128 v[148:151], v236 offset:1024
  ds_read_b128 v[152:155], v236 offset:2048
  ds_read_b128 v[156:159], v236 offset:3072
  ds_read_b128 v[160:163], v236 offset:4096
  ds_read_b128 v[164:167], v236 offset:5120
  ds_read_b128 v[168:171], v236 offset:6144
  ds_read_b128 v[172:175], v236 offset:7168
  s_nop 7
  v_cvt_pk_bf16_f32 v16, v16, v17
  v_cvt_pk_bf16_f32 v17, v18, v19
  v_cvt_pk_bf16_f32 v18, v20, v21
  v_cvt_pk_bf16_f32 v19, v22, v23
  v_cvt_pk_bf16_f32 v20, v24, v25
  v_cvt_pk_bf16_f32 v21, v26, v27
  v_cvt_pk_bf16_f32 v22, v28, v29
  v_cvt_pk_bf16_f32 v23, v30, v31
  v_cvt_pk_bf16_f32 v24, v32, v33
  v_cvt_pk_bf16_f32 v25, v34, v35
  v_cvt_pk_bf16_f32 v26, v36, v37
  v_cvt_pk_bf16_f32 v27, v38, v39
  v_cvt_pk_bf16_f32 v28, v40, v41
  v_cvt_pk_bf16_f32 v29, v42, v43
  v_cvt_pk_bf16_f32 v30, v44, v45
  v_cvt_pk_bf16_f32 v31, v46, v47
  v_cvt_pk_bf16_f32 v32, v48, v49
  v_cvt_pk_bf16_f32 v33, v50, v51
  v_cvt_pk_bf16_f32 v34, v52, v53
  v_cvt_pk_bf16_f32 v35, v54, v55
  v_cvt_pk_bf16_f32 v36, v56, v57
  v_cvt_pk_bf16_f32 v37, v58, v59
  v_cvt_pk_bf16_f32 v38, v60, v61
  v_cvt_pk_bf16_f32 v39, v62, v63
  v_cvt_pk_bf16_f32 v40, v64, v65
  v_cvt_pk_bf16_f32 v41, v66, v67
  v_cvt_pk_bf16_f32 v42, v68, v69
  v_cvt_pk_bf16_f32 v43, v70, v71
  v_cvt_pk_bf16_f32 v44, v72, v73
  v_cvt_pk_bf16_f32 v45, v74, v75
  v_cvt_pk_bf16_f32 v46, v76, v77
  v_cvt_pk_bf16_f32 v47, v78, v79
  v_cvt_pk_bf16_f32 v48, v80, v81
  v_cvt_pk_bf16_f32 v49, v82, v83
  v_cvt_pk_bf16_f32 v50, v84, v85
  v_cvt_pk_bf16_f32 v51, v86, v87
  v_cvt_pk_bf16_f32 v52, v88, v89
  v_cvt_pk_bf16_f32 v53, v90, v91
  v_cvt_pk_bf16_f32 v54, v92, v93
  v_cvt_pk_bf16_f32 v55, v94, v95
  v_cvt_pk_bf16_f32 v56, v96, v97
  v_cvt_pk_bf16_f32 v57, v98, v99
  v_cvt_pk_bf16_f32 v58, v100, v101
  v_cvt_pk_bf16_f32 v59, v102, v103
  v_cvt_pk_bf16_f32 v60, v104, v105
  v_cvt_pk_bf16_f32 v61, v106, v107
  v_cvt_pk_bf16_f32 v62, v108, v109
  v_cvt_pk_bf16_f32 v63, v110, v111
  v_cvt_pk_bf16_f32 v64, v112, v113
  v_cvt_pk_bf16_f32 v65, v114, v115
  v_cvt_pk_bf16_f32 v66, v116, v117
  v_cvt_pk_bf16_f32 v67, v118, v119
  v_cvt_pk_bf16_f32 v68, v120, v121
  v_cvt_pk_bf16_f32 v69, v122, v123
  v_cvt_pk_bf16_f32 v70, v124, v125
  v_cvt_pk_bf16_f32 v71, v126, v127
  v_cvt_pk_bf16_f32 v72, v128, v129
  v_cvt_pk_bf16_f32 v73, v130, v131
  v_cvt_pk_bf16_f32 v74, v132, v133
  v_cvt_pk_bf16_f32 v75, v134, v135
  v_cvt_pk_bf16_f32 v76, v136, v137
  v_cvt_pk_bf16_f32 v77, v138, v139
  v_cvt_pk_bf16_f32 v78, v140, v141
  v_cvt_pk_bf16_f32 v79, v142, v143
  v_mov_b32 v112, 0
  v_mov_b32 v113, 0
  v_mov_b32 v114, 0
  v_mov_b32 v115, 0
  v_mov_b32 v116, 0
  v_mov_b32 v117, 0
  v_mov_b32 v118, 0
  v_mov_b32 v119, 0
  v_mov_b32 v120, 0
  v_mov_b32 v121, 0
  v_mov_b32 v122, 0
  v_mov_b32 v123, 0
  v_mov_b32 v124, 0
  v_mov_b32 v125, 0
  v_mov_b32 v126, 0
  v_mov_b32 v127, 0
  v_mov_b32 v128, 0
  v_mov_b32 v129, 0
  v_mov_b32 v130, 0
  v_mov_b32 v131, 0
  v_mov_b32 v132, 0
  v_mov_b32 v133, 0
  v_mov_b32 v134, 0
  v_mov_b32 v135, 0
  v_mov_b32 v136, 0
  v_mov_b32 v137, 0
  v_mov_b32 v138, 0
  v_mov_b32 v139, 0
  v_mov_b32 v140, 0
  v_mov_b32 v141, 0
  v_mov_b32 v142, 0
  v_mov_b32 v143, 0
  s_waitcnt lgkmcnt(0)
  v_mfma_f32_32x32x16_bf16 v[80:95], v[144:147], v[16:19], v[112:127]
  v_mfma_f32_32x32x16_bf16 v[80:95], v[148:151], v[20:23], v[80:95]
  v_mfma_f32_32x32x16_bf16 v[80:95], v[152:155], v[24:27], v[80:95]
  v_mfma_f32_32x32x16_bf16 v[80:95], v[156:159], v[28:31], v[80:95]
  v_mfma_f32_32x32x16_bf16 v[80:95], v[160:163], v[32:35], v[80:95]
  v_mfma_f32_32x32x16_bf16 v[80:95], v[164:167], v[36:39], v[80:95]
  v_mfma_f32_32x32x16_bf16 v[80:95], v[168:171], v[40:43], v[80:95]
  v_mfma_f32_32x32x16_bf16 v[80:95], v[172:175], v[44:47], v[80:95]
  s_nop 15
  s_lshl_b32 s20, s27, 1
  s_cmp_eq_u32 s20, 0
  s_cbranch_scc1 at_p1e
.p2align 3
at_p1:
  s_waitcnt vmcnt(12)
  s_barrier
  v_mfma_f32_32x32x16_bf16 v[96:111], v[144:147], v[48:51], v[128:143]
  ds_read_b128 v[144:147], v236 offset:8192
  s_cmp_lt_u32 s34, s36
  s_cselect_b32 s33, s34, 0x7f000000
  s_mov_b32 m0, s38
  s_add_u32 s34, s34, 16384
  buffer_load_dwordx4 v14, s[68:71], s33 offen sc1 lds
  v_exp_f32 v224, v80
  v_exp_f32 v225, v81
  v_exp_f32 v226, v82
  v_mfma_f32_32x32x16_bf16 v[96:111], v[148:151], v[52:55], v[96:111]
  ds_read_b128 v[148:151], v236 offset:9216
  buffer_load_dwordx4 v14, s[68:71], s33 offen offset:1024 sc1 lds
  v_add_f32 v234, v224, v225
  v_cvt_pk_bf16_f32 v208, v224, v225
  v_mfma_f32_32x32x16_bf16 v[96:111], v[152:155], v[56:59], v[96:111]
  ds_read_b128 v[152:155], v236 offset:10240
  buffer_load_dwordx4 v14, s[68:71], s33 offen offset:2048 sc1 lds
  s_add_u32 s38, s38, 32768
  v_exp_f32 v227, v83
  v_add_f32 v234, v234, v226
  v_exp_f32 v224, v84
  v_mfma_f32_32x32x16_bf16 v[96:111], v[156:159], v[60:63], v[96:111]
  ds_read_b128 v[156:159], v236 offset:11264
  v_add_f32 v234, v234, v227
  v_cvt_pk_bf16_f32 v209, v226, v227
  v_mfma_f32_32x32x16_bf16 v[96:111], v[160:163], v[64:67], v[96:111]
  ds_read_b128 v[160:163], v236 offset:12288
  buffer_load_dwordx4 v14, s[68:71], s33 offen offset:3072 sc1 lds
  s_and_b32 s38, s38, 0x1ffff
  v_exp_f32 v225, v85
  v_add_f32 v234, v234, v224
  v_exp_f32 v226, v86
  v_mfma_f32_32x32x16_bf16 v[96:111], v[164:167], v[68:71], v[96:111]
  ds_read_b128 v[164:167], v236 offset:13312
  s_cmp_lt_u32 s35, s37
  s_cselect_b32 s33, s35, 0x7f000000
  s_mov_b32 m0, s39
  s_add_u32 s35, s35, 16384
  buffer_load_dwordx4 v14, s[68:71], s33 offen sc1 lds
  v_add_f32 v234, v234, v225
  v_cvt_pk_bf16_f32 v210, v224, v225
  v_mfma_f32_32x32x16_bf16 v[96:111], v[168:171], v[72:75], v[96:111]
  ds_read_b128 v[168:171], v236 offset:14336
  v_exp_f32 v227, v87
  v_add_f32 v234, v234, v226
  v_exp_f32 v224, v88
  v_mfma_f32_32x32x16_bf16 v[96:111], v[172:175], v[76:79], v[96:111]
  ds_read_b128 v[172:175], v236 offset:15360
  buffer_load_dwordx4 v14, s[68:71], s33 offen offset:1024 sc1 lds
  v_add_f32 v234, v234, v227
  v_cvt_pk_bf16_f32 v211, v226, v227
  v_mfma_f32_32x32x16_bf16 a[64:79], v[176:179], v[216:219], a[64:79]
  ds_read_b128 v[176:179], v236 offset:16384
  buffer_load_dwordx4 v14, s[68:71], s33 offen offset:2048 sc1 lds
  s_add_u32 s39, s39, 32768
  v_exp_f32 v225, v89
  v_add_f32 v234, v234, v224
  v_exp_f32 v226, v90
  v_mfma_f32_32x32x16_bf16 a[80:95], v[180:183], v[216:219], a[80:95]
  ds_read_b128 v[180:183], v236 offset:17408
  v_add_f32 v234, v234, v225
  v_cvt_pk_bf16_f32 v212, v224, v225
  v_mfma_f32_32x32x16_bf16 a[96:111], v[184:187], v[216:219], a[96:111]
  ds_read_b128 v[184:187], v236 offset:18432
  buffer_load_dwordx4 v14, s[68:71], s33 offen offset:3072 sc1 lds
  s_and_b32 s39, s39, 0x1ffff
  v_exp_f32 v227, v91
  v_add_f32 v234, v234, v226
  v_exp_f32 v224, v92
  v_mfma_f32_32x32x16_bf16 a[112:127], v[188:191], v[216:219], a[112:127]
  ds_read_b128 v[188:191], v236 offset:19456
  s_mov_b32 m0, s83
  s_add_u32 s83, s83, 4096
  buffer_load_dwordx4 v244, s[40:43], s82 offen lds
  s_add_u32 s82, s82, 1572864
  v_add_f32 v234, v234, v227
  v_cvt_pk_bf16_f32 v213, v226, v227
  v_mfma_f32_32x32x16_bf16 a[64:79], v[192:195], v[220:223], a[64:79]
  ds_read_b128 v[192:195], v236 offset:20480
  v_exp_f32 v225, v93
  v_add_f32 v234, v234, v224
  v_exp_f32 v226, v94
  v_mfma_f32_32x32x16_bf16 a[80:95], v[196:199], v[220:223], a[80:95]
  ds_read_b128 v[196:199], v236 offset:21504
  buffer_load_dword v239, v245, s[72:75], s96 offen
  s_add_u32 s96, s96, 22528
  s_add_u32 s67, s67, 1
  s_cmp_eq_u32 s67, 3
  s_cselect_b32 s72, s52, s72
  s_cselect_b32 s73, s53, s73
  s_cselect_b32 s96, s66, s96
  v_add_f32 v234, v234, v225
  v_cvt_pk_bf16_f32 v214, v224, v225
  v_mfma_f32_32x32x16_bf16 a[96:111], v[200:203], v[220:223], a[96:111]
  ds_read_b128 v[200:203], v236 offset:22528
  s_cmp_eq_u32 s67, 6
  s_cselect_b32 s72, s56, s72
  s_cselect_b32 s73, s57, s73
  s_cselect_b32 s96, s66, s96
  s_cmp_ge_u32 s67, 9
  s_cselect_b32 s96, 2130706432, s96
  v_exp_f32 v227, v95
  v_add_f32 v234, v234, v226
  v_add_f32 v234, v234, v227
  v_mfma_f32_32x32x16_bf16 a[112:127], v[204:207], v[220:223], a[112:127]
  ds_read_b128 v[204:207], v236 offset:23552
  v_cvt_pk_bf16_f32 v215, v226, v227
  v_cmp_nge_f32 vcc, s76, v234
  s_cbranch_vccnz at_s0
at_s0r:
  v_add_f32 v232, v232, v234
  s_waitcnt lgkmcnt(8)
  v_mfma_f32_32x32x16_bf16 v[80:95], v[144:147], v[16:19], v[112:127]
  v_exp_f32 v224, v96
  v_exp_f32 v225, v97
  v_exp_f32 v226, v98
  v_mfma_f32_32x32x16_bf16 v[80:95], v[148:151], v[20:23], v[80:95]
  v_add_f32 v234, v224, v225
  v_cvt_pk_bf16_f32 v216, v224, v225
  v_mfma_f32_32x32x16_bf16 v[80:95], v[152:155], v[24:27], v[80:95]
  v_exp_f32 v227, v99
  v_add_f32 v234, v234, v226
  v_exp_f32 v224, v100
  v_mfma_f32_32x32x16_bf16 v[80:95], v[156:159], v[28:31], v[80:95]
  v_add_f32 v234, v234, v227
  v_cvt_pk_bf16_f32 v217, v226, v227
  v_mfma_f32_32x32x16_bf16 v[80:95], v[160:163], v[32:35], v[80:95]
  v_exp_f32 v225, v101
  v_add_f32 v234, v234, v224
  v_exp_f32 v226, v102
  v_mfma_f32_32x32x16_bf16 v[80:95], v[164:167], v[36:39], v[80:95]
  v_add_f32 v234, v234, v225
  v_cvt_pk_bf16_f32 v218, v224, v225
  v_mfma_f32_32x32x16_bf16 v[80:95], v[168:171], v[40:43], v[80:95]
  v_exp_f32 v227, v103
  v_add_f32 v234, v234, v226
  v_exp_f32 v224, v104
  v_mfma_f32_32x32x16_bf16 v[80:95], v[172:175], v[44:47], v[80:95]
  v_add_f32 v234, v234, v227
  v_cvt_pk_bf16_f32 v219, v226, v227
  s_waitcnt lgkmcnt(0)
  v_mfma_f32_32x32x16_bf16 a[0:15], v[176:179], v[208:211], a[0:15]
  v_exp_f32 v225, v105
  v_add_f32 v234, v234, v224
  v_exp_f32 v226, v106
  v_mfma_f32_32x32x16_bf16 a[16:31], v[180:183], v[208:211], a[16:31]
  v_add_f32 v234, v234, v225
  v_cvt_pk_bf16_f32 v220, v224, v225
  v_mfma_f32_32x32x16_bf16 a[32:47], v[184:187], v[208:211], a[32:47]
  v_exp_f32 v227, v107
  v_add_f32 v234, v234, v226
  v_exp_f32 v224, v108
  v_mfma_f32_32x32x16_bf16 a[48:63], v[188:191], v[208:211], a[48:63]
  v_add_f32 v234, v234, v227
  v_cvt_pk_bf16_f32 v221, v226, v227
  v_mfma_f32_32x32x16_bf16 a[0:15], v[192:195], v[212:215], a[0:15]
  v_exp_f32 v225, v109
  v_add_f32 v234, v234, v224
  v_exp_f32 v226, v110
  v_mfma_f32_32x32x16_bf16 a[16:31], v[196:199], v[212:215], a[16:31]
  v_add_f32 v234, v234, v225
  v_cvt_pk_bf16_f32 v222, v224, v225
  v_mfma_f32_32x32x16_bf16 a[32:47], v[200:203], v[212:215], a[32:47]
  v_exp_f32 v227, v111
  v_add_f32 v234, v234, v226
  v_add_f32 v234, v234, v227
  v_mfma_f32_32x32x16_bf16 a[48:63], v[204:207], v[212:215], a[48:63]
  v_cvt_pk_bf16_f32 v223, v226, v227
  v_cmp_nge_f32 vcc, s77, v234
  s_cbranch_vccnz at_s1
at_s1r:
  v_add_f32 v233, v233, v234
  v_mfma_f32_32x32x16_bf16 v[96:111], v[144:147], v[48:51], v[128:143]
  ds_read_b128 v[144:147], v235 offset:0
  v_exp_f32 v224, v80
  v_exp_f32 v225, v81
  v_exp_f32 v226, v82
  v_mfma_f32_32x32x16_bf16 v[96:111], v[148:151], v[52:55], v[96:111]
  ds_read_b128 v[148:151], v235 offset:1024
  v_add_f32 v234, v224, v225
  v_cvt_pk_bf16_f32 v208, v224, v225
  v_mfma_f32_32x32x16_bf16 v[96:111], v[152:155], v[56:59], v[96:111]
  ds_read_b128 v[152:155], v235 offset:2048
  v_exp_f32 v227, v83
  v_add_f32 v234, v234, v226
  v_exp_f32 v224, v84
  v_mfma_f32_32x32x16_bf16 v[96:111], v[156:159], v[60:63], v[96:111]
  ds_read_b128 v[156:159], v235 offset:3072
  v_add_f32 v234, v234, v227
  v_cvt_pk_bf16_f32 v209, v226, v227
  v_mfma_f32_32x32x16_bf16 v[96:111], v[160:163], v[64:67], v[96:111]
  ds_read_b128 v[160:163], v235 offset:4096
  v_exp_f32 v225, v85
  v_add_f32 v234, v234, v224
  v_exp_f32 v226, v86
  v_mfma_f32_32x32x16_bf16 v[96:111], v[164:167], v[68:71], v[96:111]
  ds_read_b128 v[164:167], v235 offset:5120
  v_add_f32 v234, v234, v225
  v_cvt_pk_bf16_f32 v210, v224, v225
  v_mfma_f32_32x32x16_bf16 v[96:111], v[168:171], v[72:75], v[96:111]
  ds_read_b128 v[168:171], v235 offset:6144
  v_exp_f32 v227, v87
  v_add_f32 v234, v234, v226
  v_exp_f32 v224, v88
  v_mfma_f32_32x32x16_bf16 v[96:111], v[172:175], v[76:79], v[96:111]
  ds_read_b128 v[172:175], v235 offset:7168
  v_add_f32 v234, v234, v227
  v_cvt_pk_bf16_f32 v211, v226, v227
  v_mfma_f32_32x32x16_bf16 a[64:79], v[176:179], v[216:219], a[64:79]
  ds_read_b128 v[176:179], v236 offset:24576
  v_exp_f32 v225, v89
  v_add_f32 v234, v234, v224
  v_exp_f32 v226, v90
  v_mfma_f32_32x32x16_bf16 a[80:95], v[180:183], v[216:219], a[80:95]
  ds_read_b128 v[180:183], v236 offset:25600
  v_add_f32 v234, v234, v225
  v_cvt_pk_bf16_f32 v212, v224, v225
  v_mfma_f32_32x32x16_bf16 a[96:111], v[184:187], v[216:219], a[96:111]
  ds_read_b128 v[184:187], v236 offset:26624
  v_exp_f32 v227, v91
  v_add_f32 v234, v234, v226
  v_exp_f32 v224, v92
  v_mfma_f32_32x32x16_bf16 a[112:127], v[188:191], v[216:219], a[112:127]
  ds_read_b128 v[188:191], v236 offset:27648
  v_add_f32 v234, v234, v227
  v_cvt_pk_bf16_f32 v213, v226, v227
  v_mfma_f32_32x32x16_bf16 a[64:79], v[192:195], v[220:223], a[64:79]
  ds_read_b128 v[192:195], v236 offset:28672
  v_exp_f32 v225, v93
  v_add_f32 v234, v234, v224
  v_exp_f32 v226, v94
  v_mfma_f32_32x32x16_bf16 a[80:95], v[196:199], v[220:223], a[80:95]
  ds_read_b128 v[196:199], v236 offset:29696
  v_add_f32 v234, v234, v225
  v_cvt_pk_bf16_f32 v214, v224, v225
  v_mfma_f32_32x32x16_bf16 a[96:111], v[200:203], v[220:223], a[96:111]
  ds_read_b128 v[200:203], v236 offset:30720
  v_exp_f32 v227, v95
  v_add_f32 v234, v234, v226
  v_add_f32 v234, v234, v227
  v_mfma_f32_32x32x16_bf16 a[112:127], v[204:207], v[220:223], a[112:127]
  ds_read_b128 v[204:207], v236 offset:31744
  v_cvt_pk_bf16_f32 v215, v226, v227
  v_cmp_nge_f32 vcc, s76, v234
  s_cbranch_vccnz at_s2
at_s2r:
  v_add_f32 v232, v232, v234
  s_waitcnt lgkmcnt(8)
  v_mfma_f32_32x32x16_bf16 v[80:95], v[144:147], v[16:19], v[112:127]
  v_exp_f32 v224, v96
  v_exp_f32 v225, v97
  v_exp_f32 v226, v98
  v_mfma_f32_32x32x16_bf16 v[80:95], v[148:151], v[20:23], v[80:95]
  v_add_f32 v234, v224, v225
  v_cvt_pk_bf16_f32 v216, v224, v225
  v_mfma_f32_32x32x16_bf16 v[80:95], v[152:155], v[24:27], v[80:95]
  v_exp_f32 v227, v99
  v_add_f32 v234, v234, v226
  v_exp_f32 v224, v100
  v_mfma_f32_32x32x16_bf16 v[80:95], v[156:159], v[28:31], v[80:95]
  v_add_f32 v234, v234, v227
  v_cvt_pk_bf16_f32 v217, v226, v227
  v_mfma_f32_32x32x16_bf16 v[80:95], v[160:163], v[32:35], v[80:95]
  v_exp_f32 v225, v101
  v_add_f32 v234, v234, v224
  v_exp_f32 v226, v102
  v_mfma_f32_32x32x16_bf16 v[80:95], v[164:167], v[36:39], v[80:95]
  v_add_f32 v234, v234, v225
  v_cvt_pk_bf16_f32 v218, v224, v225
  v_mfma_f32_32x32x16_bf16 v[80:95], v[168:171], v[40:43], v[80:95]
  v_exp_f32 v227, v103
  v_add_f32 v234, v234, v226
  v_exp_f32 v224, v104
  v_mfma_f32_32x32x16_bf16 v[80:95], v[172:175], v[44:47], v[80:95]
  v_add_f32 v234, v234, v227
  v_cvt_pk_bf16_f32 v219, v226, v227
  s_waitcnt lgkmcnt(0)
  v_mfma_f32_32x32x16_bf16 a[0:15], v[176:179], v[208:211], a[0:15]
  v_exp_f32 v225, v105
  v_add_f32 v234, v234, v224
  v_exp_f32 v226, v106
  v_mfma_f32_32x32x16_bf16 a[16:31], v[180:183], v[208:211], a[16:31]
  v_add_f32 v234, v234, v225
  v_cvt_pk_bf16_f32 v220, v224, v225
  v_mfma_f32_32x32x16_bf16 a[32:47], v[184:187], v[208:211], a[32:47]
  v_exp_f32 v227, v107
  v_add_f32 v234, v234, v226
  v_exp_f32 v224, v108
  v_mfma_f32_32x32x16_bf16 a[48:63], v[188:191], v[208:211], a[48:63]
  v_add_f32 v234, v234, v227
  v_cvt_pk_bf16_f32 v221, v226, v227
  v_mfma_f32_32x32x16_bf16 a[0:15], v[192:195], v[212:215], a[0:15]
  v_exp_f32 v225, v109
  v_add_f32 v234, v234, v224
  v_exp_f32 v226, v110
  v_mfma_f32_32x32x16_bf16 a[16:31], v[196:199], v[212:215], a[16:31]
  v_add_f32 v234, v234, v225
  v_cvt_pk_bf16_f32 v222, v224, v225
  v_mfma_f32_32x32x16_bf16 a[32:47], v[200:203], v[212:215], a[32:47]
  v_exp_f32 v227, v111
  v_add_f32 v234, v234, v226
  v_add_f32 v234, v234, v227
  v_mfma_f32_32x32x16_bf16 a[48:63], v[204:207], v[212:215], a[48:63]
  v_cvt_pk_bf16_f32 v223, v226, v227
  v_cmp_nge_f32 vcc, s77, v234
  s_cbranch_vccnz at_s3
at_s3r:
  v_add_f32 v233, v233, v234
  v_mov_b32 v236, v235
  v_add_u32 v235, 32768, v235
  v_and_b32 v235, 0x1ffff, v235
  s_sub_u32 s20, s20, 1
  s_cmp_lg_u32 s20, 0
  s_cbranch_scc1 at_p1
at_p1e:
  s_waitcnt vmcnt(12)
  s_barrier
  v_mfma_f32_32x32x16_bf16 v[96:111], v[144:147], v[48:51], v[128:143]
  ds_read_b128 v[144:147], v236 offset:8192
  s_cmp_lt_u32 s34, s36
  s_cselect_b32 s33, s34, 0x7f000000
  s_mov_b32 m0, s38
  s_add_u32 s34, s34, 16384
  buffer_load_dwordx4 v14, s[68:71], s33 offen sc1 lds
  v_exp_f32 v224, v80
  v_exp_f32 v225, v81
  v_exp_f32 v226, v82
  v_mfma_f32_32x32x16_bf16 v[96:111], v[148:151], v[52:55], v[96:111]
  ds_read_b128 v[148:151], v236 offset:9216
  buffer_load_dwordx4 v14, s[68:71], s33 offen offset:1024 sc1 lds
  v_add_f32 v234, v224, v225
  v_cvt_pk_bf16_f32 v208, v224, v225
  v_mfma_f32_32x32x16_bf16 v[96:111], v[152:155], v[56:59], v[96:111]
  ds_read_b128 v[152:155], v236 offset:10240
  buffer_load_dwordx4 v14, s[68:71], s33 offen offset:2048 sc1 lds
  s_add_u32 s38, s38, 32768
  v_exp_f32 v227, v83
  v_add_f32 v234, v234, v226
  v_exp_f32 v224, v84
  v_mfma_f32_32x32x16_bf16 v[96:111], v[156:159], v[60:63], v[96:111]
  ds_read_b128 v[156:159], v236 offset:11264
  v_add_f32 v234, v234, v227
  v_cvt_pk_bf16_f32 v209, v226, v227
  v_mfma_f32_32x32x16_bf16 v[96:111], v[160:163], v[64:67], v[96:111]
  ds_read_b128 v[160:163], v236 offset:12288
  buffer_load_dwordx4 v14, s[68:71], s33 offen offset:3072 sc1 lds
  s_and_b32 s38, s38, 0x1ffff
  v_exp_f32 v225, v85
  v_add_f32 v234, v234, v224
  v_exp_f32 v226, v86
  v_mfma_f32_32x32x16_bf16 v[96:111], v[164:167], v[68:71], v[96:111]
  ds_read_b128 v[164:167], v236 offset:13312
  s_cmp_lt_u32 s35, s37
  s_cselect_b32 s33, s35, 0x7f000000
  s_mov_b32 m0, s39
  s_add_u32 s35, s35, 16384
  buffer_load_dwordx4 v14, s[68:71], s33 offen sc1 lds
  v_add_f32 v234, v234, v225
  v_cvt_pk_bf16_f32 v210, v224, v225
  v_mfma_f32_32x32x16_bf16 v[96:111], v[168:171], v[72:75], v[96:111]
  ds_read_b128 v[168:171], v236 offset:14336
  v_exp_f32 v227, v87
  v_add_f32 v234, v234, v226
  v_exp_f32 v224, v88
  v_mfma_f32_32x32x16_bf16 v[96:111], v[172:175], v[76:79], v[96:111]
  ds_read_b128 v[172:175], v236 offset:15360
  buffer_load_dwordx4 v14, s[68:71], s33 offen offset:1024 sc1 lds
  v_add_f32 v234, v234, v227
  v_cvt_pk_bf16_f32 v211, v226, v227
  v_mfma_f32_32x32x16_bf16 a[64:79], v[176:179], v[216:219], a[64:79]
  ds_read_b128 v[176:179], v236 offset:16384
  buffer_load_dwordx4 v14, s[68:71], s33 offen offset:2048 sc1 lds
  s_add_u32 s39, s39, 32768
  v_exp_f32 v225, v89
  v_add_f32 v234, v234, v224
  v_exp_f32 v226, v90
  v_mfma_f32_32x32x16_bf16 a[80:95], v[180:183], v[216:219], a[80:95]
  ds_read_b128 v[180:183], v236 offset:17408
  v_add_f32 v234, v234, v225
  v_cvt_pk_bf16_f32 v212, v224, v225
  v_mfma_f32_32x32x16_bf16 a[96:111], v[184:187], v[216:219], a[96:111]
  ds_read_b128 v[184:187], v236 offset:18432
  buffer_load_dwordx4 v14, s[68:71], s33 offen offset:3072 sc1 lds
  s_and_b32 s39, s39, 0x1ffff
  v_exp_f32 v227, v91
  v_add_f32 v234, v234, v226
  v_exp_f32 v224, v92
  v_mfma_f32_32x32x16_bf16 a[112:127], v[188:191], v[216:219], a[112:127]
  ds_read_b128 v[188:191], v236 offset:19456
  s_mov_b32 m0, s83
  s_add_u32 s83, s83, 4096
  buffer_load_dwordx4 v244, s[40:43], s82 offen lds
  s_add_u32 s82, s82, 1572864
  v_add_f32 v234, v234, v227
  v_cvt_pk_bf16_f32 v213, v226, v227
  v_mfma_f32_32x32x16_bf16 a[64:79], v[192:195], v[220:223], a[64:79]
  ds_read_b128 v[192:195], v236 offset:20480
  v_exp_f32 v225, v93
  v_add_f32 v234, v234, v224
  v_exp_f32 v226, v94
  v_mfma_f32_32x32x16_bf16 a[80:95], v[196:199], v[220:223], a[80:95]
  ds_read_b128 v[196:199], v236 offset:21504
  buffer_load_dword v239, v245, s[72:75], s96 offen
  s_add_u32 s96, s96, 22528
  s_add_u32 s67, s67, 1
  s_cmp_eq_u32 s67, 3
  s_cselect_b32 s72, s52, s72
  s_cselect_b32 s73, s53, s73
  s_cselect_b32 s96, s66, s96
  v_add_f32 v234, v234, v225
  v_cvt_pk_bf16_f32 v214, v224, v225
  v_mfma_f32_32x32x16_bf16 a[96:111], v[200:203], v[220:223], a[96:111]
  ds_read_b128 v[200:203], v236 offset:22528
  s_cmp_eq_u32 s67, 6
  s_cselect_b32 s72, s56, s72
  s_cselect_b32 s73, s57, s73
  s_cselect_b32 s96, s66, s96
  s_cmp_ge_u32 s67, 9
  s_cselect_b32 s96, 2130706432, s96
  v_exp_f32 v227, v95
  v_add_f32 v234, v234, v226
  v_add_f32 v234, v234, v227
  v_mfma_f32_32x32x16_bf16 a[112:127], v[204:207], v[220:223], a[112:127]
  ds_read_b128 v[204:207], v236 offset:23552
  v_cvt_pk_bf16_f32 v215, v226, v227
  v_cmp_nge_f32 vcc, s76, v234
  s_cbranch_vccnz at_s4
at_s4r:
  v_add_f32 v232, v232, v234
  s_waitcnt lgkmcnt(8)
  v_mfma_f32_32x32x16_bf16 v[80:95], v[144:147], v[16:19], v[112:127]
  v_add_f32 v238, 0x00000000, v237
  v_min_f32 v96, v96, v238
  v_exp_f32 v224, v96
  v_add_f32 v238, 0xf1800000, v237
  v_min_f32 v97, v97, v238
  v_mfma_f32_32x32x16_bf16 v[80:95], v[148:151], v[20:23], v[80:95]
  v_exp_f32 v225, v97
  v_add_f32 v238, 0xf2000000, v237
  v_min_f32 v98, v98, v238
  v_exp_f32 v226, v98
  v_mfma_f32_32x32x16_bf16 v[80:95], v[152:155], v[24:27], v[80:95]
  v_add_f32 v234, v224, v225
  v_cvt_pk_bf16_f32 v216, v224, v225
  v_add_f32 v238, 0xf2400000, v237
  v_min_f32 v99, v99, v238
  v_exp_f32 v227, v99
  v_mfma_f32_32x32x16_bf16 v[80:95], v[156:159], v[28:31], v[80:95]
  v_add_f32 v234, v234, v226
  v_add_f32 v238, 0xf3000000, v237
  v_min_f32 v100, v100, v238
  v_exp_f32 v224, v100
  v_mfma_f32_32x32x16_bf16 v[80:95], v[160:163], v[32:35], v[80:95]
  v_add_f32 v234, v234, v227
  v_cvt_pk_bf16_f32 v217, v226, v227
  v_add_f32 v238, 0xf3100000, v237
  v_min_f32 v101, v101, v238
  v_exp_f32 v225, v101
  v_mfma_f32_32x32x16_bf16 v[80:95], v[164:167], v[36:39], v[80:95]
  v_add_f32 v234, v234, v224
  v_add_f32 v238, 0xf3200000, v237
  v_min_f32 v102, v102, v238
  v_exp_f32 v226, v102
  v_mfma_f32_32x32x16_bf16 v[80:95], v[168:171], v[40:43], v[80:95]
  v_add_f32 v234, v234, v225
  v_cvt_pk_bf16_f32 v218, v224, v225
  v_add_f32 v238, 0xf3300000, v237
  v_min_f32 v103, v103, v238
  v_exp_f32 v227, v103
  v_mfma_f32_32x32x16_bf16 v[80:95], v[172:175], v[44:47], v[80:95]
  v_add_f32 v234, v234, v226
  v_add_f32 v238, 0xf3800000, v237
  v_min_f32 v104, v104, v238
  v_exp_f32 v224, v104
  s_waitcnt lgkmcnt(0)
  v_mfma_f32_32x32x16_bf16 a[0:15], v[176:179], v[208:211], a[0:15]
  v_add_f32 v234, v234, v227
  v_cvt_pk_bf16_f32 v219, v226, v227
  v_add_f32 v238, 0xf3880000, v237
  v_min_f32 v105, v105, v238
  v_exp_f32 v225, v105
  buffer_load_ushort a160, v243, s[44:47], 0 offen offset:0
  v_mfma_f32_32x32x16_bf16 a[16:31], v[180:183], v[208:211], a[16:31]
  v_add_f32 v234, v234, v224
  v_add_f32 v238, 0xf3900000, v237
  v_min_f32 v106, v106, v238
  v_exp_f32 v226, v106
  buffer_load_ushort a161, v243, s[44:47], 0 offen offset:256
  v_mfma_f32_32x32x16_bf16 a[32:47], v[184:187], v[208:211], a[32:47]
  v_add_f32 v234, v234, v225
  v_cvt_pk_bf16_f32 v220, v224, v225
  v_add_f32 v238, 0xf3980000, v237
  v_min_f32 v107, v107, v238
  v_exp_f32 v227, v107
  buffer_load_ushort a162, v243, s[44:47], 0 offen offset:512
  v_mfma_f32_32x32x16_bf16 a[48:63], v[188:191], v[208:211], a[48:63]
  v_add_f32 v234, v234, v226
  v_add_f32 v238, 0xf3c00000, v237
  v_min_f32 v108, v108, v238
  v_exp_f32 v224, v108
  buffer_load_ushort a163, v243, s[44:47], 0 offen offset:768
  v_mfma_f32_32x32x16_bf16 a[0:15], v[192:195], v[212:215], a[0:15]
  v_add_f32 v234, v234, v227
  v_cvt_pk_bf16_f32 v221, v226, v227
  v_add_f32 v238, 0xf3c80000, v237
  v_min_f32 v109, v109, v238
  v_exp_f32 v225, v109
  buffer_load_ushort a164, v243, s[44:47], 0 offen offset:1024
  v_mfma_f32_32x32x16_bf16 a[16:31], v[196:199], v[212:215], a[16:31]
  v_add_f32 v234, v234, v224
  v_add_f32 v238, 0xf3d00000, v237
  v_min_f32 v110, v110, v238
  v_exp_f32 v226, v110
  buffer_load_ushort a165, v243, s[44:47], 0 offen offset:1280
  v_mfma_f32_32x32x16_bf16 a[32:47], v[200:203], v[212:215], a[32:47]
  v_add_f32 v234, v234, v225
  v_cvt_pk_bf16_f32 v222, v224, v225
  v_add_f32 v238, 0xf3d80000, v237
  v_min_f32 v111, v111, v238
  v_exp_f32 v227, v111
  buffer_load_ushort a166, v243, s[44:47], 0 offen offset:1536
  v_mfma_f32_32x32x16_bf16 a[48:63], v[204:207], v[212:215], a[48:63]
  v_add_f32 v234, v234, v226
  v_add_f32 v234, v234, v227
  v_cvt_pk_bf16_f32 v223, v226, v227
  v_cmp_nge_f32 vcc, s77, v234
  s_cbranch_vccnz at_s5
at_s5r:
  v_add_f32 v233, v233, v234
  buffer_load_ushort a167, v243, s[44:47], 0 offen offset:1792
  v_mfma_f32_32x32x16_bf16 v[96:111], v[144:147], v[48:51], v[128:143]
  ds_read_b128 v[144:147], v235 offset:0
  v_exp_f32 v224, v80
  v_exp_f32 v225, v81
  v_exp_f32 v226, v82
  v_mfma_f32_32x32x16_bf16 v[96:111], v[148:151], v[52:55], v[96:111]
  ds_read_b128 v[148:151], v235 offset:1024
  v_add_f32 v234, v224, v225
  v_cvt_pk_bf16_f32 v208, v224, v225
  v_mfma_f32_32x32x16_bf16 v[96:111], v[152:155], v[56:59], v[96:111]
  ds_read_b128 v[152:155], v235 offset:2048
  v_exp_f32 v227, v83
  v_add_f32 v234, v234, v226
  v_exp_f32 v224, v84
  v_mfma_f32_32x32x16_bf16 v[96:111], v[156:159], v[60:63], v[96:111]
  ds_read_b128 v[156:159], v235 offset:3072
  v_add_f32 v234, v234, v227
  v_cvt_pk_bf16_f32 v209, v226, v227
  v_mfma_f32_32x32x16_bf16 v[96:111], v[160:163], v[64:67], v[96:111]
  ds_read_b128 v[160:163], v235 offset:4096
  v_exp_f32 v225, v85
  v_add_f32 v234, v234, v224
  v_exp_f32 v226, v86
  v_mfma_f32_32x32x16_bf16 v[96:111], v[164:167], v[68:71], v[96:111]
  ds_read_b128 v[164:167], v235 offset:5120
  v_add_f32 v234, v234, v225
  v_cvt_pk_bf16_f32 v210, v224, v225
  v_mfma_f32_32x32x16_bf16 v[96:111], v[168:171], v[72:75], v[96:111]
  ds_read_b128 v[168:171], v235 offset:6144
  v_exp_f32 v227, v87
  v_add_f32 v234, v234, v226
  v_exp_f32 v224, v88
  v_mfma_f32_32x32x16_bf16 v[96:111], v[172:175], v[76:79], v[96:111]
  ds_read_b128 v[172:175], v235 offset:7168
  v_add_f32 v234, v234, v227
  v_cvt_pk_bf16_f32 v211, v226, v227
  v_mfma_f32_32x32x16_bf16 a[64:79], v[176:179], v[216:219], a[64:79]
  ds_read_b128 v[176:179], v236 offset:24576
  v_exp_f32 v225, v89
  v_add_f32 v234, v234, v224
  v_exp_f32 v226, v90
  v_mfma_f32_32x32x16_bf16 a[80:95], v[180:183], v[216:219], a[80:95]
  ds_read_b128 v[180:183], v236 offset:25600
  v_add_f32 v234, v234, v225
  v_cvt_pk_bf16_f32 v212, v224, v225
  v_mfma_f32_32x32x16_bf16 a[96:111], v[184:187], v[216:219], a[96:111]
  ds_read_b128 v[184:187], v236 offset:26624
  v_exp_f32 v227, v91
  v_add_f32 v234, v234, v226
  v_exp_f32 v224, v92
  v_mfma_f32_32x32x16_bf16 a[112:127], v[188:191], v[216:219], a[112:127]
  ds_read_b128 v[188:191], v236 offset:27648
  v_add_f32 v234, v234, v227
  v_cvt_pk_bf16_f32 v213, v226, v227
  v_mfma_f32_32x32x16_bf16 a[64:79], v[192:195], v[220:223], a[64:79]
  ds_read_b128 v[192:195], v236 offset:28672
  v_exp_f32 v225, v93
  v_add_f32 v234, v234, v224
  v_exp_f32 v226, v94
  v_mfma_f32_32x32x16_bf16 a[80:95], v[196:199], v[220:223], a[80:95]
  ds_read_b128 v[196:199], v236 offset:29696
  v_add_f32 v234, v234, v225
  v_cvt_pk_bf16_f32 v214, v224, v225
  v_mfma_f32_32x32x16_bf16 a[96:111], v[200:203], v[220:223], a[96:111]
  ds_read_b128 v[200:203], v236 offset:30720
  v_exp_f32 v227, v95
  v_add_f32 v234, v234, v226
  v_add_f32 v234, v234, v227
  v_mfma_f32_32x32x16_bf16 a[112:127], v[204:207], v[220:223], a[112:127]
  ds_read_b128 v[204:207], v236 offset:31744
  v_cvt_pk_bf16_f32 v215, v226, v227
  v_cmp_nge_f32 vcc, s76, v234
  s_cbranch_vccnz at_s6
at_s6r:
  v_add_f32 v232, v232, v234
  s_waitcnt lgkmcnt(8)
  v_mfma_f32_32x32x16_bf16 v[80:95], v[144:147], v[16:19], v[112:127]
  v_add_f32 v238, 0xf4000000, v237
  v_min_f32 v96, v96, v238
  v_exp_f32 v224, v96
  v_add_f32 v238, 0xf4040000, v237
  v_min_f32 v97, v97, v238
  v_mfma_f32_32x32x16_bf16 v[80:95], v[148:151], v[20:23], v[80:95]
  v_exp_f32 v225, v97
  v_add_f32 v238, 0xf4080000, v237
  v_min_f32 v98, v98, v238
  v_exp_f32 v226, v98
  v_mfma_f32_32x32x16_bf16 v[80:95], v[152:155], v[24:27], v[80:95]
  v_add_f32 v234, v224, v225
  v_cvt_pk_bf16_f32 v216, v224, v225
  v_add_f32 v238, 0xf40c0000, v237
  v_min_f32 v99, v99, v238
  v_exp_f32 v227, v99
  v_mfma_f32_32x32x16_bf16 v[80:95], v[156:159], v[28:31], v[80:95]
  v_add_f32 v234, v234, v226
  v_add_f32 v238, 0xf4200000, v237
  v_min_f32 v100, v100, v238
  v_exp_f32 v224, v100
  v_mfma_f32_32x32x16_bf16 v[80:95], v[160:163], v[32:35], v[80:95]
  v_add_f32 v234, v234, v227
  v_cvt_pk_bf16_f32 v217, v226, v227
  v_add_f32 v238, 0xf4240000, v237
  v_min_f32 v101, v101, v238
  v_exp_f32 v225, v101
  v_mfma_f32_32x32x16_bf16 v[80:95], v[164:167], v[36:39], v[80:95]
  v_add_f32 v234, v234, v224
  v_add_f32 v238, 0xf4280000, v237
  v_min_f32 v102, v102, v238
  v_exp_f32 v226, v102
  v_mfma_f32_32x32x16_bf16 v[80:95], v[168:171], v[40:43], v[80:95]
  v_add_f32 v234, v234, v225
  v_cvt_pk_bf16_f32 v218, v224, v225
  v_add_f32 v238, 0xf42c0000, v237
  v_min_f32 v103, v103, v238
  v_exp_f32 v227, v103
  v_mfma_f32_32x32x16_bf16 v[80:95], v[172:175], v[44:47], v[80:95]
  v_add_f32 v234, v234, v226
  v_add_f32 v238, 0xf4400000, v237
  v_min_f32 v104, v104, v238
  v_exp_f32 v224, v104
  s_waitcnt lgkmcnt(0)
  v_mfma_f32_32x32x16_bf16 a[0:15], v[176:179], v[208:211], a[0:15]
  v_add_f32 v234, v234, v227
  v_cvt_pk_bf16_f32 v219, v226, v227
  v_add_f32 v238, 0xf4440000, v237
  v_min_f32 v105, v105, v238
  v_exp_f32 v225, v105
  v_mfma_f32_32x32x16_bf16 a[16:31], v[180:183], v[208:211], a[16:31]
  v_add_f32 v234, v234, v224
  v_add_f32 v238, 0xf4480000, v237
  v_min_f32 v106, v106, v238
  v_exp_f32 v226, v106
  v_mfma_f32_32x32x16_bf16 a[32:47], v[184:187], v[208:211], a[32:47]
  v_add_f32 v234, v234, v225
  v_cvt_pk_bf16_f32 v220, v224, v225
  v_add_f32 v238, 0xf44c0000, v237
  v_min_f32 v107, v107, v238
  v_exp_f32 v227, v107
  v_mfma_f32_32x32x16_bf16 a[48:63], v[188:191], v[208:211], a[48:63]
  v_add_f32 v234, v234, v226
  v_add_f32 v238, 0xf4600000, v237
  v_min_f32 v108, v108, v238
  v_exp_f32 v224, v108
  v_mfma_f32_32x32x16_bf16 a[0:15], v[192:195], v[212:215], a[0:15]
  v_add_f32 v234, v234, v227
  v_cvt_pk_bf16_f32 v221, v226, v227
  v_add_f32 v238, 0xf4640000, v237
  v_min_f32 v109, v109, v238
  v_exp_f32 v225, v109
  v_mfma_f32_32x32x16_bf16 a[16:31], v[196:199], v[212:215], a[16:31]
  v_add_f32 v234, v234, v224
  v_add_f32 v238, 0xf4680000, v237
  v_min_f32 v110, v110, v238
  v_exp_f32 v226, v110
  v_mfma_f32_32x32x16_bf16 a[32:47], v[200:203], v[212:215], a[32:47]
  v_add_f32 v234, v234, v225
  v_cvt_pk_bf16_f32 v222, v224, v225
  v_add_f32 v238, 0xf46c0000, v237
  v_min_f32 v111, v111, v238
  v_exp_f32 v227, v111
  v_mfma_f32_32x32x16_bf16 a[48:63], v[204:207], v[212:215], a[48:63]
  v_add_f32 v234, v234, v226
  v_add_f32 v234, v234, v227
  v_cvt_pk_bf16_f32 v223, v226, v227
  v_cmp_nge_f32 vcc, s77, v234
  s_cbranch_vccnz at_s7
at_s7r:
  v_add_f32 v233, v233, v234
  v_mov_b32 v236, v235
  v_add_u32 v235, 32768, v235
  v_and_b32 v235, 0x1ffff, v235
  s_waitcnt vmcnt(20)
  s_barrier
  v_mfma_f32_32x32x16_bf16 v[96:111], v[144:147], v[48:51], v[128:143]
  ds_read_b128 v[144:147], v236 offset:8192
  s_cmp_lt_u32 s34, s36
  s_cselect_b32 s33, s34, 0x7f000000
  s_mov_b32 m0, s38
  s_add_u32 s34, s34, 16384
  buffer_load_dwordx4 v14, s[68:71], s33 offen sc1 lds
  v_exp_f32 v224, v80
  v_exp_f32 v225, v81
  v_exp_f32 v226, v82
  v_mfma_f32_32x32x16_bf16 v[96:111], v[148:151], v[52:55], v[96:111]
  ds_read_b128 v[148:151], v236 offset:9216
  buffer_load_dwordx4 v14, s[68:71], s33 offen offset:1024 sc1 lds
  v_add_f32 v234, v224, v225
  v_cvt_pk_bf16_f32 v208, v224, v225
  v_mfma_f32_32x32x16_bf16 v[96:111], v[152:155], v[56:59], v[96:111]
  ds_read_b128 v[152:155], v236 offset:10240
  buffer_load_dwordx4 v14, s[68:71], s33 offen offset:2048 sc1 lds
  s_add_u32 s38, s38, 32768
  v_exp_f32 v227, v83
  v_add_f32 v234, v234, v226
  v_exp_f32 v224, v84
  v_mfma_f32_32x32x16_bf16 v[96:111], v[156:159], v[60:63], v[96:111]
  ds_read_b128 v[156:159], v236 offset:11264
  v_add_f32 v234, v234, v227
  v_cvt_pk_bf16_f32 v209, v226, v227
  v_mfma_f32_32x32x16_bf16 v[96:111], v[160:163], v[64:67], v[96:111]
  ds_read_b128 v[160:163], v236 offset:12288
  buffer_load_dwordx4 v14, s[68:71], s33 offen offset:3072 sc1 lds
  s_and_b32 s38, s38, 0x1ffff
  v_exp_f32 v225, v85
  v_add_f32 v234, v234, v224
  v_exp_f32 v226, v86
  v_mfma_f32_32x32x16_bf16 v[96:111], v[164:167], v[68:71], v[96:111]
  ds_read_b128 v[164:167], v236 offset:13312
  s_cmp_lt_u32 s35, s37
  s_cselect_b32 s33, s35, 0x7f000000
  s_mov_b32 m0, s39
  s_add_u32 s35, s35, 16384
  buffer_load_dwordx4 v14, s[68:71], s33 offen sc1 lds
  v_add_f32 v234, v234, v225
  v_cvt_pk_bf16_f32 v210, v224, v225
  v_mfma_f32_32x32x16_bf16 v[96:111], v[168:171], v[72:75], v[96:111]
  ds_read_b128 v[168:171], v236 offset:14336
  v_exp_f32 v227, v87
  v_add_f32 v234, v234, v226
  v_exp_f32 v224, v88
  v_mfma_f32_32x32x16_bf16 v[96:111], v[172:175], v[76:79], v[96:111]
  ds_read_b128 v[172:175], v236 offset:15360
  buffer_load_dwordx4 v14, s[68:71], s33 offen offset:1024 sc1 lds
  v_add_f32 v234, v234, v227
  v_cvt_pk_bf16_f32 v211, v226, v227
  v_mfma_f32_32x32x16_bf16 a[64:79], v[176:179], v[216:219], a[64:79]
  ds_read_b128 v[176:179], v236 offset:16384
  buffer_load_dwordx4 v14, s[68:71], s33 offen offset:2048 sc1 lds
  s_add_u32 s39, s39, 32768
  v_exp_f32 v225, v89
  v_add_f32 v234, v234, v224
  v_exp_f32 v226, v90
  v_mfma_f32_32x32x16_bf16 a[80:95], v[180:183], v[216:219], a[80:95]
  ds_read_b128 v[180:183], v236 offset:17408
  v_add_f32 v234, v234, v225
  v_cvt_pk_bf16_f32 v212, v224, v225
  v_mfma_f32_32x32x16_bf16 a[96:111], v[184:187], v[216:219], a[96:111]
  ds_read_b128 v[184:187], v236 offset:18432
  buffer_load_dwordx4 v14, s[68:71], s33 offen offset:3072 sc1 lds
  s_and_b32 s39, s39, 0x1ffff
  v_exp_f32 v227, v91
  v_add_f32 v234, v234, v226
  v_exp_f32 v224, v92
  v_mfma_f32_32x32x16_bf16 a[112:127], v[188:191], v[216:219], a[112:127]
  ds_read_b128 v[188:191], v236 offset:19456
  s_mov_b32 m0, s83
  s_add_u32 s83, s83, 4096
  buffer_load_dwordx4 v244, s[40:43], s82 offen lds
  s_add_u32 s82, s82, 1572864
  v_add_f32 v234, v234, v227
  v_cvt_pk_bf16_f32 v213, v226, v227
  v_mfma_f32_32x32x16_bf16 a[64:79], v[192:195], v[220:223], a[64:79]
  ds_read_b128 v[192:195], v236 offset:20480
  v_exp_f32 v225, v93
  v_add_f32 v234, v234, v224
  v_exp_f32 v226, v94
  v_mfma_f32_32x32x16_bf16 a[80:95], v[196:199], v[220:223], a[80:95]
  ds_read_b128 v[196:199], v236 offset:21504
  buffer_load_dword v239, v245, s[72:75], s96 offen
  s_add_u32 s96, s96, 22528
  s_add_u32 s67, s67, 1
  s_cmp_eq_u32 s67, 3
  s_cselect_b32 s72, s52, s72
  s_cselect_b32 s73, s53, s73
  s_cselect_b32 s96, s66, s96
  v_add_f32 v234, v234, v225
  v_cvt_pk_bf16_f32 v214, v224, v225
  v_mfma_f32_32x32x16_bf16 a[96:111], v[200:203], v[220:223], a[96:111]
  ds_read_b128 v[200:203], v236 offset:22528
  s_cmp_eq_u32 s67, 6
  s_cselect_b32 s72, s56, s72
  s_cselect_b32 s73, s57, s73
  s_cselect_b32 s96, s66, s96
  s_cmp_ge_u32 s67, 9
  s_cselect_b32 s96, 2130706432, s96
  v_exp_f32 v227, v95
  v_add_f32 v234, v234, v226
  v_add_f32 v234, v234, v227
  v_mfma_f32_32x32x16_bf16 a[112:127], v[204:207], v[220:223], a[112:127]
  ds_read_b128 v[204:207], v236 offset:23552
  v_cvt_pk_bf16_f32 v215, v226, v227
  v_cmp_nge_f32 vcc, s76, v234
  s_cbranch_vccnz at_s8
at_s8r:
  v_add_f32 v232, v232, v234
  s_waitcnt lgkmcnt(8)
  v_mfma_f32_32x32x16_bf16 v[80:95], v[144:147], v[16:19], v[112:127]
  v_add_f32 v238, 0xf4800000, v237
  v_min_f32 v96, v96, v238
  v_exp_f32 v224, v96
  v_add_f32 v238, 0xf4820000, v237
  v_min_f32 v97, v97, v238
  v_mfma_f32_32x32x16_bf16 v[80:95], v[148:151], v[20:23], v[80:95]
  v_exp_f32 v225, v97
  v_add_f32 v238, 0xf4840000, v237
  v_min_f32 v98, v98, v238
  v_exp_f32 v226, v98
  v_mfma_f32_32x32x16_bf16 v[80:95], v[152:155], v[24:27], v[80:95]
  v_add_f32 v234, v224, v225
  v_cvt_pk_bf16_f32 v216, v224, v225
  v_add_f32 v238, 0xf4860000, v237
  v_min_f32 v99, v99, v238
  v_exp_f32 v227, v99
  v_mfma_f32_32x32x16_bf16 v[80:95], v[156:159], v[28:31], v[80:95]
  v_add_f32 v234, v234, v226
  v_add_f32 v238, 0xf4900000, v237
  v_min_f32 v100, v100, v238
  v_exp_f32 v224, v100
  v_mfma_f32_32x32x16_bf16 v[80:95], v[160:163], v[32:35], v[80:95]
  v_add_f32 v234, v234, v227
  v_cvt_pk_bf16_f32 v217, v226, v227
  v_add_f32 v238, 0xf4920000, v237
  v_min_f32 v101, v101, v238
  v_exp_f32 v225, v101
  v_mfma_f32_32x32x16_bf16 v[80:95], v[164:167], v[36:39], v[80:95]
  v_add_f32 v234, v234, v224
  v_add_f32 v238, 0xf4940000, v237
  v_min_f32 v102, v102, v238
  v_exp_f32 v226, v102
  v_mfma_f32_32x32x16_bf16 v[80:95], v[168:171], v[40:43], v[80:95]
  v_add_f32 v234, v234, v225
  v_cvt_pk_bf16_f32 v218, v224, v225
  v_add_f32 v238, 0xf4960000, v237
  v_min_f32 v103, v103, v238
  v_exp_f32 v227, v103
  v_mfma_f32_32x32x16_bf16 v[80:95], v[172:175], v[44:47], v[80:95]
  v_add_f32 v234, v234, v226
  v_add_f32 v238, 0xf4a00000, v237
  v_min_f32 v104, v104, v238
  v_exp_f32 v224, v104
  s_waitcnt lgkmcnt(0)
  v_mfma_f32_32x32x16_bf16 a[0:15], v[176:179], v[208:211], a[0:15]
  v_add_f32 v234, v234, v227
  v_cvt_pk_bf16_f32 v219, v226, v227
  v_add_f32 v238, 0xf4a20000, v237
  v_min_f32 v105, v105, v238
  v_exp_f32 v225, v105
  v_mfma_f32_32x32x16_bf16 a[16:31], v[180:183], v[208:211], a[16:31]
  v_add_f32 v234, v234, v224
  v_add_f32 v238, 0xf4a40000, v237
  v_min_f32 v106, v106, v238
  v_exp_f32 v226, v106
  v_mfma_f32_32x32x16_bf16 a[32:47], v[184:187], v[208:211], a[32:47]
  v_add_f32 v234, v234, v225
  v_cvt_pk_bf16_f32 v220, v224, v225
  v_add_f32 v238, 0xf4a60000, v237
  v_min_f32 v107, v107, v238
  v_exp_f32 v227, v107
  v_mfma_f32_32x32x16_bf16 a[48:63], v[188:191], v[208:211], a[48:63]
  v_add_f32 v234, v234, v226
  v_add_f32 v238, 0xf4b00000, v237
  v_min_f32 v108, v108, v238
  v_exp_f32 v224, v108
  v_mfma_f32_32x32x16_bf16 a[0:15], v[192:195], v[212:215], a[0:15]
  v_add_f32 v234, v234, v227
  v_cvt_pk_bf16_f32 v221, v226, v227
  v_add_f32 v238, 0xf4b20000, v237
  v_min_f32 v109, v109, v238
  v_exp_f32 v225, v109
  v_mfma_f32_32x32x16_bf16 a[16:31], v[196:199], v[212:215], a[16:31]
  v_add_f32 v234, v234, v224
  v_add_f32 v238, 0xf4b40000, v237
  v_min_f32 v110, v110, v238
  v_exp_f32 v226, v110
  v_mfma_f32_32x32x16_bf16 a[32:47], v[200:203], v[212:215], a[32:47]
  v_add_f32 v234, v234, v225
  v_cvt_pk_bf16_f32 v222, v224, v225
  v_add_f32 v238, 0xf4b60000, v237
  v_min_f32 v111, v111, v238
  v_exp_f32 v227, v111
  v_mfma_f32_32x32x16_bf16 a[48:63], v[204:207], v[212:215], a[48:63]
  v_add_f32 v234, v234, v226
  v_add_f32 v234, v234, v227
  v_cvt_pk_bf16_f32 v223, v226, v227
  v_cmp_nge_f32 vcc, s77, v234
  s_cbranch_vccnz at_s9
at_s9r:
  v_add_f32 v233, v233, v234
  v_mfma_f32_32x32x16_bf16 v[96:111], v[144:147], v[48:51], v[128:143]
  ds_read_b128 v[144:147], v235 offset:0
  v_exp_f32 v224, v80
  v_exp_f32 v225, v81
  v_exp_f32 v226, v82
  v_mfma_f32_32x32x16_bf16 v[96:111], v[148:151], v[52:55], v[96:111]
  ds_read_b128 v[148:151], v235 offset:1024
  v_add_f32 v234, v224, v225
  v_cvt_pk_bf16_f32 v208, v224, v225
  v_mfma_f32_32x32x16_bf16 v[96:111], v[152:155], v[56:59], v[96:111]
  ds_read_b128 v[152:155], v235 offset:2048
  v_exp_f32 v227, v83
  v_add_f32 v234, v234, v226
  v_exp_f32 v224, v84
  v_mfma_f32_32x32x16_bf16 v[96:111], v[156:159], v[60:63], v[96:111]
  ds_read_b128 v[156:159], v235 offset:3072
  v_add_f32 v234, v234, v227
  v_cvt_pk_bf16_f32 v209, v226, v227
  v_mfma_f32_32x32x16_bf16 v[96:111], v[160:163], v[64:67], v[96:111]
  ds_read_b128 v[160:163], v235 offset:4096
  v_exp_f32 v225, v85
  v_add_f32 v234, v234, v224
  v_exp_f32 v226, v86
  v_mfma_f32_32x32x16_bf16 v[96:111], v[164:167], v[68:71], v[96:111]
  ds_read_b128 v[164:167], v235 offset:5120
  v_add_f32 v234, v234, v225
  v_cvt_pk_bf16_f32 v210, v224, v225
  v_mfma_f32_32x32x16_bf16 v[96:111], v[168:171], v[72:75], v[96:111]
  ds_read_b128 v[168:171], v235 offset:6144
  v_exp_f32 v227, v87
  v_add_f32 v234, v234, v226
  v_exp_f32 v224, v88
  v_mfma_f32_32x32x16_bf16 v[96:111], v[172:175], v[76:79], v[96:111]
  ds_read_b128 v[172:175], v235 offset:7168
  v_add_f32 v234, v234, v227
  v_cvt_pk_bf16_f32 v211, v226, v227
  v_mfma_f32_32x32x16_bf16 a[64:79], v[176:179], v[216:219], a[64:79]
  ds_read_b128 v[176:179], v236 offset:24576
  v_exp_f32 v225, v89
  v_add_f32 v234, v234, v224
  v_exp_f32 v226, v90
  v_mfma_f32_32x32x16_bf16 a[80:95], v[180:183], v[216:219], a[80:95]
  ds_read_b128 v[180:183], v236 offset:25600
  v_add_f32 v234, v234, v225
  v_cvt_pk_bf16_f32 v212, v224, v225
  v_mfma_f32_32x32x16_bf16 a[96:111], v[184:187], v[216:219], a[96:111]
  ds_read_b128 v[184:187], v236 offset:26624
  v_exp_f32 v227, v91
  v_add_f32 v234, v234, v226
  v_exp_f32 v224, v92
  v_mfma_f32_32x32x16_bf16 a[112:127], v[188:191], v[216:219], a[112:127]
  ds_read_b128 v[188:191], v236 offset:27648
  v_add_f32 v234, v234, v227
  v_cvt_pk_bf16_f32 v213, v226, v227
  v_mfma_f32_32x32x16_bf16 a[64:79], v[192:195], v[220:223], a[64:79]
  ds_read_b128 v[192:195], v236 offset:28672
  v_exp_f32 v225, v93
  v_add_f32 v234, v234, v224
  v_exp_f32 v226, v94
  v_mfma_f32_32x32x16_bf16 a[80:95], v[196:199], v[220:223], a[80:95]
  ds_read_b128 v[196:199], v236 offset:29696
  v_add_f32 v234, v234, v225
  v_cvt_pk_bf16_f32 v214, v224, v225
  v_mfma_f32_32x32x16_bf16 a[96:111], v[200:203], v[220:223], a[96:111]
  ds_read_b128 v[200:203], v236 offset:30720
  v_exp_f32 v227, v95
  v_add_f32 v234, v234, v226
  v_add_f32 v234, v234, v227
  v_mfma_f32_32x32x16_bf16 a[112:127], v[204:207], v[220:223], a[112:127]
  ds_read_b128 v[204:207], v236 offset:31744
  v_cvt_pk_bf16_f32 v215, v226, v227
  v_cmp_nge_f32 vcc, s76, v234
  s_cbranch_vccnz at_s10
at_s10r:
  v_add_f32 v232, v232, v234
  s_waitcnt lgkmcnt(8)
  v_mfma_f32_32x32x16_bf16 v[80:95], v[144:147], v[16:19], v[112:127]
  ds_read_b128 v[144:147], v235 offset:8192
  v_add_f32 v238, 0xf4c00000, v237
  v_min_f32 v96, v96, v238
  v_exp_f32 v224, v96
  v_add_f32 v238, 0xf4c20000, v237
  v_min_f32 v97, v97, v238
  v_mfma_f32_32x32x16_bf16 v[80:95], v[148:151], v[20:23], v[80:95]
  ds_read_b128 v[148:151], v235 offset:9216
  v_exp_f32 v225, v97
  v_add_f32 v238, 0xf4c40000, v237
  v_min_f32 v98, v98, v238
  v_exp_f32 v226, v98
  v_mfma_f32_32x32x16_bf16 v[80:95], v[152:155], v[24:27], v[80:95]
  ds_read_b128 v[152:155], v235 offset:10240
  v_add_f32 v234, v224, v225
  v_cvt_pk_bf16_f32 v216, v224, v225
  v_add_f32 v238, 0xf4c60000, v237
  v_min_f32 v99, v99, v238
  v_exp_f32 v227, v99
  v_mfma_f32_32x32x16_bf16 v[80:95], v[156:159], v[28:31], v[80:95]
  ds_read_b128 v[156:159], v235 offset:11264
  v_add_f32 v234, v234, v226
  v_add_f32 v238, 0xf4d00000, v237
  v_min_f32 v100, v100, v238
  v_exp_f32 v224, v100
  v_mfma_f32_32x32x16_bf16 v[80:95], v[160:163], v[32:35], v[80:95]
  ds_read_b128 v[160:163], v235 offset:12288
  v_add_f32 v234, v234, v227
  v_cvt_pk_bf16_f32 v217, v226, v227
  v_add_f32 v238, 0xf4d20000, v237
  v_min_f32 v101, v101, v238
  v_exp_f32 v225, v101
  v_mfma_f32_32x32x16_bf16 v[80:95], v[164:167], v[36:39], v[80:95]
  ds_read_b128 v[164:167], v235 offset:13312
  v_add_f32 v234, v234, v224
  v_add_f32 v238, 0xf4d40000, v237
  v_min_f32 v102, v102, v238
  v_exp_f32 v226, v102
  v_mfma_f32_32x32x16_bf16 v[80:95], v[168:171], v[40:43], v[80:95]
  ds_read_b128 v[168:171], v235 offset:14336
  v_add_f32 v234, v234, v225
  v_cvt_pk_bf16_f32 v218, v224, v225
  v_add_f32 v238, 0xf4d60000, v237
  v_min_f32 v103, v103, v238
  v_exp_f32 v227, v103
  v_mfma_f32_32x32x16_bf16 v[80:95], v[172:175], v[44:47], v[80:95]
  ds_read_b128 v[172:175], v235 offset:15360
  v_add_f32 v234, v234, v226
  v_add_f32 v238, 0xf4e00000, v237
  v_min_f32 v104, v104, v238
  v_exp_f32 v224, v104
  s_waitcnt lgkmcnt(8)
  v_mfma_f32_32x32x16_bf16 a[0:15], v[176:179], v[208:211], a[0:15]
  v_add_f32 v234, v234, v227
  v_cvt_pk_bf16_f32 v219, v226, v227
  v_add_f32 v238, 0xf4e20000, v237
  v_min_f32 v105, v105, v238
  v_exp_f32 v225, v105
  v_mfma_f32_32x32x16_bf16 a[16:31], v[180:183], v[208:211], a[16:31]
  v_add_f32 v234, v234, v224
  v_add_f32 v238, 0xf4e40000, v237
  v_min_f32 v106, v106, v238
  v_exp_f32 v226, v106
  v_mfma_f32_32x32x16_bf16 a[32:47], v[184:187], v[208:211], a[32:47]
  v_add_f32 v234, v234, v225
  v_cvt_pk_bf16_f32 v220, v224, v225
  v_add_f32 v238, 0xf4e60000, v237
  v_min_f32 v107, v107, v238
  v_exp_f32 v227, v107
  v_mfma_f32_32x32x16_bf16 a[48:63], v[188:191], v[208:211], a[48:63]
  v_add_f32 v234, v234, v226
  v_add_f32 v238, 0xf4f00000, v237
  v_min_f32 v108, v108, v238
  v_exp_f32 v224, v108
  v_mfma_f32_32x32x16_bf16 a[0:15], v[192:195], v[212:215], a[0:15]
  v_add_f32 v234, v234, v227
  v_cvt_pk_bf16_f32 v221, v226, v227
  v_add_f32 v238, 0xf4f20000, v237
  v_min_f32 v109, v109, v238
  v_exp_f32 v225, v109
  v_mfma_f32_32x32x16_bf16 a[16:31], v[196:199], v[212:215], a[16:31]
  v_add_f32 v234, v234, v224
  v_add_f32 v238, 0xf4f40000, v237
  v_min_f32 v110, v110, v238
  v_exp_f32 v226, v110
  v_mfma_f32_32x32x16_bf16 a[32:47], v[200:203], v[212:215], a[32:47]
  v_add_f32 v234, v234, v225
  v_cvt_pk_bf16_f32 v222, v224, v225
  v_add_f32 v238, 0xf4f60000, v237
  v_min_f32 v111, v111, v238
  v_exp_f32 v227, v111
  v_mfma_f32_32x32x16_bf16 a[48:63], v[204:207], v[212:215], a[48:63]
  v_add_f32 v234, v234, v226
  v_add_f32 v234, v234, v227
  v_cvt_pk_bf16_f32 v223, v226, v227
  v_cmp_nge_f32 vcc, s77, v234
  s_cbranch_vccnz at_s11
at_s11r:
  v_add_f32 v233, v233, v234
  v_mov_b32 v236, v235
  v_add_u32 v235, 32768, v235
  v_and_b32 v235, 0x1ffff, v235
  s_nop 1
  v_mfma_f32_32x32x16_bf16 a[64:79], v[176:179], v[216:219], a[64:79]
  v_mfma_f32_32x32x16_bf16 a[80:95], v[180:183], v[216:219], a[80:95]
  v_mfma_f32_32x32x16_bf16 a[96:111], v[184:187], v[216:219], a[96:111]
  v_mfma_f32_32x32x16_bf16 a[112:127], v[188:191], v[216:219], a[112:127]
  v_mfma_f32_32x32x16_bf16 a[64:79], v[192:195], v[220:223], a[64:79]
  v_mfma_f32_32x32x16_bf16 a[80:95], v[196:199], v[220:223], a[80:95]
  v_mfma_f32_32x32x16_bf16 a[96:111], v[200:203], v[220:223], a[96:111]
  v_mfma_f32_32x32x16_bf16 a[112:127], v[204:207], v[220:223], a[112:127]
  s_nop 15
  v_mov_b32 v2, v233
  s_nop 1
  v_permlane32_swap_b32 v233, v2
  s_nop 1
  v_add_f32 v2, v233, v2
  v_rcp_f32 v2, v2
  s_lshl_b32 s33, s29, 18
  s_lshl_b32 s21, s26, 13
  s_add_u32 s33, s33, s21
  s_add_u32 s33, s33, 41943040
  v_accvgpr_read_b32 v48, a64
  v_accvgpr_read_b32 v49, a65
  v_accvgpr_read_b32 v50, a66
  v_accvgpr_read_b32 v51, a67
  v_accvgpr_read_b32 v52, a68
  v_accvgpr_read_b32 v53, a69
  v_accvgpr_read_b32 v54, a70
  v_accvgpr_read_b32 v55, a71
  v_mul_f32 v48, v48, v2
  v_mul_f32 v49, v49, v2
  v_mul_f32 v50, v50, v2
  v_mul_f32 v51, v51, v2
  v_mul_f32 v52, v52, v2
  v_mul_f32 v53, v53, v2
  v_mul_f32 v54, v54, v2
  v_mul_f32 v55, v55, v2
  v_cvt_pk_bf16_f32 v56, v48, v49
  v_cvt_pk_bf16_f32 v57, v50, v51
  v_cvt_pk_bf16_f32 v58, v52, v53
  v_cvt_pk_bf16_f32 v59, v54, v55
  buffer_store_dwordx4 v[56:59], v14, s[68:71], s33 offen offset:0 sc1
  v_accvgpr_read_b32 v60, a72
  v_accvgpr_read_b32 v61, a73
  v_accvgpr_read_b32 v62, a74
  v_accvgpr_read_b32 v63, a75
  v_accvgpr_read_b32 v64, a76
  v_accvgpr_read_b32 v65, a77
  v_accvgpr_read_b32 v66, a78
  v_accvgpr_read_b32 v67, a79
  v_mul_f32 v60, v60, v2
  v_mul_f32 v61, v61, v2
  v_mul_f32 v62, v62, v2
  v_mul_f32 v63, v63, v2
  v_mul_f32 v64, v64, v2
  v_mul_f32 v65, v65, v2
  v_mul_f32 v66, v66, v2
  v_mul_f32 v67, v67, v2
  v_cvt_pk_bf16_f32 v68, v60, v61
  v_cvt_pk_bf16_f32 v69, v62, v63
  v_cvt_pk_bf16_f32 v70, v64, v65
  v_cvt_pk_bf16_f32 v71, v66, v67
  buffer_store_dwordx4 v[68:71], v14, s[68:71], s33 offen offset:1024 sc1
  v_accvgpr_read_b32 v48, a80
  v_accvgpr_read_b32 v49, a81
  v_accvgpr_read_b32 v50, a82
  v_accvgpr_read_b32 v51, a83
  v_accvgpr_read_b32 v52, a84
  v_accvgpr_read_b32 v53, a85
  v_accvgpr_read_b32 v54, a86
  v_accvgpr_read_b32 v55, a87
  v_mul_f32 v48, v48, v2
  v_mul_f32 v49, v49, v2
  v_mul_f32 v50, v50, v2
  v_mul_f32 v51, v51, v2
  v_mul_f32 v52, v52, v2
  v_mul_f32 v53, v53, v2
  v_mul_f32 v54, v54, v2
  v_mul_f32 v55, v55, v2
  v_cvt_pk_bf16_f32 v56, v48, v49
  v_cvt_pk_bf16_f32 v57, v50, v51
  v_cvt_pk_bf16_f32 v58, v52, v53
  v_cvt_pk_bf16_f32 v59, v54, v55
  buffer_store_dwordx4 v[56:59], v14, s[68:71], s33 offen offset:2048 sc1
  v_accvgpr_read_b32 v60, a88
  v_accvgpr_read_b32 v61, a89
  v_accvgpr_read_b32 v62, a90
  v_accvgpr_read_b32 v63, a91
  v_accvgpr_read_b32 v64, a92
  v_accvgpr_read_b32 v65, a93
  v_accvgpr_read_b32 v66, a94
  v_accvgpr_read_b32 v67, a95
  v_mul_f32 v60, v60, v2
  v_mul_f32 v61, v61, v2
  v_mul_f32 v62, v62, v2
  v_mul_f32 v63, v63, v2
  v_mul_f32 v64, v64, v2
  v_mul_f32 v65, v65, v2
  v_mul_f32 v66, v66, v2
  v_mul_f32 v67, v67, v2
  v_cvt_pk_bf16_f32 v68, v60, v61
  v_cvt_pk_bf16_f32 v69, v62, v63
  v_cvt_pk_bf16_f32 v70, v64, v65
  v_cvt_pk_bf16_f32 v71, v66, v67
  buffer_store_dwordx4 v[68:71], v14, s[68:71], s33 offen offset:3072 sc1
  v_accvgpr_read_b32 v48, a96
  v_accvgpr_read_b32 v49, a97
  v_accvgpr_read_b32 v50, a98
  v_accvgpr_read_b32 v51, a99
  v_accvgpr_read_b32 v52, a100
  v_accvgpr_read_b32 v53, a101
  v_accvgpr_read_b32 v54, a102
  v_accvgpr_read_b32 v55, a103
  v_mul_f32 v48, v48, v2
  v_mul_f32 v49, v49, v2
  v_mul_f32 v50, v50, v2
  v_mul_f32 v51, v51, v2
  v_mul_f32 v52, v52, v2
  v_mul_f32 v53, v53, v2
  v_mul_f32 v54, v54, v2
  v_mul_f32 v55, v55, v2
  v_cvt_pk_bf16_f32 v56, v48, v49
  v_cvt_pk_bf16_f32 v57, v50, v51
  v_cvt_pk_bf16_f32 v58, v52, v53
  v_cvt_pk_bf16_f32 v59, v54, v55
  s_add_u32 s33, s33, 4096
  buffer_store_dwordx4 v[56:59], v14, s[68:71], s33 offen offset:0 sc1
  v_accvgpr_read_b32 v60, a104
  v_accvgpr_read_b32 v61, a105
  v_accvgpr_read_b32 v62, a106
  v_accvgpr_read_b32 v63, a107
  v_accvgpr_read_b32 v64, a108
  v_accvgpr_read_b32 v65, a109
  v_accvgpr_read_b32 v66, a110
  v_accvgpr_read_b32 v67, a111
  v_mul_f32 v60, v60, v2
  v_mul_f32 v61, v61, v2
  v_mul_f32 v62, v62, v2
  v_mul_f32 v63, v63, v2
  v_mul_f32 v64, v64, v2
  v_mul_f32 v65, v65, v2
  v_mul_f32 v66, v66, v2
  v_mul_f32 v67, v67, v2
  v_cvt_pk_bf16_f32 v68, v60, v61
  v_cvt_pk_bf16_f32 v69, v62, v63
  v_cvt_pk_bf16_f32 v70, v64, v65
  v_cvt_pk_bf16_f32 v71, v66, v67
  buffer_store_dwordx4 v[68:71], v14, s[68:71], s33 offen offset:1024 sc1
  v_accvgpr_read_b32 v48, a112
  v_accvgpr_read_b32 v49, a113
  v_accvgpr_read_b32 v50, a114
  v_accvgpr_read_b32 v51, a115
  v_accvgpr_read_b32 v52, a116
  v_accvgpr_read_b32 v53, a117
  v_accvgpr_read_b32 v54, a118
  v_accvgpr_read_b32 v55, a119
  v_mul_f32 v48, v48, v2
  v_mul_f32 v49, v49, v2
  v_mul_f32 v50, v50, v2
  v_mul_f32 v51, v51, v2
  v_mul_f32 v52, v52, v2
  v_mul_f32 v53, v53, v2
  v_mul_f32 v54, v54, v2
  v_mul_f32 v55, v55, v2
  v_cvt_pk_bf16_f32 v56, v48, v49
  v_cvt_pk_bf16_f32 v57, v50, v51
  v_cvt_pk_bf16_f32 v58, v52, v53
  v_cvt_pk_bf16_f32 v59, v54, v55
  buffer_store_dwordx4 v[56:59], v14, s[68:71], s33 offen offset:2048 sc1
  v_accvgpr_read_b32 v60, a120
  v_accvgpr_read_b32 v61, a121
  v_accvgpr_read_b32 v62, a122
  v_accvgpr_read_b32 v63, a123
  v_accvgpr_read_b32 v64, a124
  v_accvgpr_read_b32 v65, a125
  v_accvgpr_read_b32 v66, a126
  v_accvgpr_read_b32 v67, a127
  v_mul_f32 v60, v60, v2
  v_mul_f32 v61, v61, v2
  v_mul_f32 v62, v62, v2
  v_mul_f32 v63, v63, v2
  v_mul_f32 v64, v64, v2
  v_mul_f32 v65, v65, v2
  v_mul_f32 v66, v66, v2
  v_mul_f32 v67, v67, v2
  v_cvt_pk_bf16_f32 v68, v60, v61
  v_cvt_pk_bf16_f32 v69, v62, v63
  v_cvt_pk_bf16_f32 v70, v64, v65
  v_cvt_pk_bf16_f32 v71, v66, v67
  buffer_store_dwordx4 v[68:71], v14, s[68:71], s33 offen offset:3072 sc1
  v_mov_b32 v216, 0
  v_mov_b32 v217, 0
  v_mov_b32 v218, 0
  v_mov_b32 v219, 0
  v_mov_b32 v220, 0
  v_mov_b32 v221, 0
  v_mov_b32 v222, 0
  v_mov_b32 v223, 0
  s_waitcnt lgkmcnt(0)
  s_sub_u32 s20, 7, s27
  s_lshl_b32 s20, s20, 1
  s_cmp_eq_u32 s20, 0
  s_cbranch_scc1 at_p2e
.p2align 3
at_p2:
  s_waitcnt vmcnt(10) lgkmcnt(8)
  s_barrier
  v_mfma_f32_32x32x16_bf16 v[96:111], v[144:147], v[16:19], v[112:127]
  ds_read_b128 v[144:147], v235 offset:0
  s_cmp_lt_u32 s34, s36
  s_cselect_b32 s33, s34, 0x7f000000
  s_mov_b32 m0, s38
  s_add_u32 s34, s34, 16384
  buffer_load_dwordx4 v14, s[68:71], s33 offen sc1 lds
  v_exp_f32 v224, v80
  v_exp_f32 v225, v81
  v_exp_f32 v226, v82
  v_mfma_f32_32x32x16_bf16 v[96:111], v[148:151], v[20:23], v[96:111]
  ds_read_b128 v[148:151], v235 offset:1024
  buffer_load_dwordx4 v14, s[68:71], s33 offen offset:1024 sc1 lds
  v_add_f32 v234, v224, v225
  v_cvt_pk_bf16_f32 v208, v224, v225
  v_mfma_f32_32x32x16_bf16 v[96:111], v[152:155], v[24:27], v[96:111]
  ds_read_b128 v[152:155], v235 offset:2048
  v_exp_f32 v227, v83
  v_add_f32 v234, v234, v226
  v_exp_f32 v224, v84
  v_mfma_f32_32x32x16_bf16 v[96:111], v[156:159], v[28:31], v[96:111]
  ds_read_b128 v[156:159], v235 offset:3072
  buffer_load_dwordx4 v14, s[68:71], s33 offen offset:2048 sc1 lds
  s_add_u32 s38, s38, 32768
  v_add_f32 v234, v234, v227
  v_cvt_pk_bf16_f32 v209, v226, v227
  v_mfma_f32_32x32x16_bf16 v[96:111], v[160:163], v[32:35], v[96:111]
  ds_read_b128 v[160:163], v235 offset:4096
  v_exp_f32 v225, v85
  v_add_f32 v234, v234, v224
  v_exp_f32 v226, v86
  v_mfma_f32_32x32x16_bf16 v[96:111], v[164:167], v[36:39], v[96:111]
  ds_read_b128 v[164:167], v235 offset:5120
  buffer_load_dwordx4 v14, s[68:71], s33 offen offset:3072 sc1 lds
  s_and_b32 s38, s38, 0x1ffff
  v_add_f32 v234, v234, v225
  v_cvt_pk_bf16_f32 v210, v224, v225
  v_mfma_f32_32x32x16_bf16 v[96:111], v[168:171], v[40:43], v[96:111]
  ds_read_b128 v[168:171], v235 offset:6144
  v_exp_f32 v227, v87
  v_add_f32 v234, v234, v226
  v_exp_f32 v224, v88
  v_mfma_f32_32x32x16_bf16 v[96:111], v[172:175], v[44:47], v[96:111]
  ds_read_b128 v[172:175], v235 offset:7168
  s_cmp_lt_u32 s35, s37
  s_cselect_b32 s33, s35, 0x7f000000
  s_mov_b32 m0, s39
  s_add_u32 s35, s35, 16384
  buffer_load_dwordx4 v14, s[68:71], s33 offen sc1 lds
  v_add_f32 v234, v234, v227
  v_cvt_pk_bf16_f32 v211, v226, v227
  s_waitcnt lgkmcnt(8)
  v_mfma_f32_32x32x16_bf16 a[0:15], v[176:179], v[216:219], a[0:15]
  ds_read_b128 v[176:179], v236 offset:16384
  buffer_load_dwordx4 v14, s[68:71], s33 offen offset:1024 sc1 lds
  v_exp_f32 v225, v89
  v_add_f32 v234, v234, v224
  v_exp_f32 v226, v90
  v_mfma_f32_32x32x16_bf16 a[16:31], v[180:183], v[216:219], a[16:31]
  ds_read_b128 v[180:183], v236 offset:17408
  v_add_f32 v234, v234, v225
  v_cvt_pk_bf16_f32 v212, v224, v225
  v_mfma_f32_32x32x16_bf16 a[32:47], v[184:187], v[216:219], a[32:47]
  ds_read_b128 v[184:187], v236 offset:18432
  buffer_load_dwordx4 v14, s[68:71], s33 offen offset:2048 sc1 lds
  s_add_u32 s39, s39, 32768
  v_exp_f32 v227, v91
  v_add_f32 v234, v234, v226
  v_exp_f32 v224, v92
  v_mfma_f32_32x32x16_bf16 a[48:63], v[188:191], v[216:219], a[48:63]
  ds_read_b128 v[188:191], v236 offset:19456
  v_add_f32 v234, v234, v227
  v_cvt_pk_bf16_f32 v213, v226, v227
  v_mfma_f32_32x32x16_bf16 a[0:15], v[192:195], v[220:223], a[0:15]
  ds_read_b128 v[192:195], v236 offset:20480
  buffer_load_dwordx4 v14, s[68:71], s33 offen offset:3072 sc1 lds
  s_and_b32 s39, s39, 0x1ffff
  v_exp_f32 v225, v93
  v_add_f32 v234, v234, v224
  v_exp_f32 v226, v94
  v_mfma_f32_32x32x16_bf16 a[16:31], v[196:199], v[220:223], a[16:31]
  ds_read_b128 v[196:199], v236 offset:21504
  v_add_f32 v234, v234, v225
  v_cvt_pk_bf16_f32 v214, v224, v225
  v_mfma_f32_32x32x16_bf16 a[32:47], v[200:203], v[220:223], a[32:47]
  ds_read_b128 v[200:203], v236 offset:22528
  s_mov_b32 m0, s83
  s_add_u32 s83, s83, 4096
  buffer_load_dwordx4 v244, s[40:43], s82 offen lds
  s_add_u32 s82, s82, 1572864
  v_exp_f32 v227, v95
  v_add_f32 v234, v234, v226
  v_add_f32 v234, v234, v227
  v_mfma_f32_32x32x16_bf16 a[48:63], v[204:207], v[220:223], a[48:63]
  ds_read_b128 v[204:207], v236 offset:23552
  v_cvt_pk_bf16_f32 v215, v226, v227
  v_cmp_nge_f32 vcc, s76, v234
  s_cbranch_vccnz at_s12
at_s12r:
  v_add_f32 v232, v232, v234
  s_waitcnt lgkmcnt(8)
  v_mfma_f32_32x32x16_bf16 v[80:95], v[144:147], v[16:19], v[112:127]
  ds_read_b128 v[144:147], v235 offset:8192
  v_exp_f32 v224, v96
  v_exp_f32 v225, v97
  v_exp_f32 v226, v98
  v_mfma_f32_32x32x16_bf16 v[80:95], v[148:151], v[20:23], v[80:95]
  ds_read_b128 v[148:151], v235 offset:9216
  v_add_f32 v234, v224, v225
  v_cvt_pk_bf16_f32 v216, v224, v225
  v_mfma_f32_32x32x16_bf16 v[80:95], v[152:155], v[24:27], v[80:95]
  ds_read_b128 v[152:155], v235 offset:10240
  v_exp_f32 v227, v99
  v_add_f32 v234, v234, v226
  v_exp_f32 v224, v100
  v_mfma_f32_32x32x16_bf16 v[80:95], v[156:159], v[28:31], v[80:95]
  ds_read_b128 v[156:159], v235 offset:11264
  v_add_f32 v234, v234, v227
  v_cvt_pk_bf16_f32 v217, v226, v227
  v_mfma_f32_32x32x16_bf16 v[80:95], v[160:163], v[32:35], v[80:95]
  ds_read_b128 v[160:163], v235 offset:12288
  v_exp_f32 v225, v101
  v_add_f32 v234, v234, v224
  v_exp_f32 v226, v102
  v_mfma_f32_32x32x16_bf16 v[80:95], v[164:167], v[36:39], v[80:95]
  ds_read_b128 v[164:167], v235 offset:13312
  v_add_f32 v234, v234, v225
  v_cvt_pk_bf16_f32 v218, v224, v225
  v_mfma_f32_32x32x16_bf16 v[80:95], v[168:171], v[40:43], v[80:95]
  ds_read_b128 v[168:171], v235 offset:14336
  v_exp_f32 v227, v103
  v_add_f32 v234, v234, v226
  v_exp_f32 v224, v104
  v_mfma_f32_32x32x16_bf16 v[80:95], v[172:175], v[44:47], v[80:95]
  ds_read_b128 v[172:175], v235 offset:15360
  v_add_f32 v234, v234, v227
  v_cvt_pk_bf16_f32 v219, v226, v227
  s_waitcnt lgkmcnt(8)
  v_mfma_f32_32x32x16_bf16 a[0:15], v[176:179], v[208:211], a[0:15]
  ds_read_b128 v[176:179], v236 offset:24576
  v_exp_f32 v225, v105
  v_add_f32 v234, v234, v224
  v_exp_f32 v226, v106
  v_mfma_f32_32x32x16_bf16 a[16:31], v[180:183], v[208:211], a[16:31]
  ds_read_b128 v[180:183], v236 offset:25600
  v_add_f32 v234, v234, v225
  v_cvt_pk_bf16_f32 v220, v224, v225
  v_mfma_f32_32x32x16_bf16 a[32:47], v[184:187], v[208:211], a[32:47]
  ds_read_b128 v[184:187], v236 offset:26624
  v_exp_f32 v227, v107
  v_add_f32 v234, v234, v226
  v_exp_f32 v224, v108
  v_mfma_f32_32x32x16_bf16 a[48:63], v[188:191], v[208:211], a[48:63]
  ds_read_b128 v[188:191], v236 offset:27648
  v_add_f32 v234, v234, v227
  v_cvt_pk_bf16_f32 v221, v226, v227
  v_mfma_f32_32x32x16_bf16 a[0:15], v[192:195], v[212:215], a[0:15]
  ds_read_b128 v[192:195], v236 offset:28672
  v_exp_f32 v225, v109
  v_add_f32 v234, v234, v224
  v_exp_f32 v226, v110
  v_mfma_f32_32x32x16_bf16 a[16:31], v[196:199], v[212:215], a[16:31]
  ds_read_b128 v[196:199], v236 offset:29696
  v_add_f32 v234, v234, v225
  v_cvt_pk_bf16_f32 v222, v224, v225
  v_mfma_f32_32x32x16_bf16 a[32:47], v[200:203], v[212:215], a[32:47]
  ds_read_b128 v[200:203], v236 offset:30720
  v_exp_f32 v227, v111
  v_add_f32 v234, v234, v226
  v_add_f32 v234, v234, v227
  v_mfma_f32_32x32x16_bf16 a[48:63], v[204:207], v[212:215], a[48:63]
  ds_read_b128 v[204:207], v236 offset:31744
  v_cvt_pk_bf16_f32 v223, v226, v227
  v_cmp_nge_f32 vcc, s76, v234
  s_cbranch_vccnz at_s13
at_s13r:
  v_add_f32 v232, v232, v234
  v_mov_b32 v236, v235
  v_add_u32 v235, 32768, v235
  v_and_b32 v235, 0x1ffff, v235
  s_waitcnt vmcnt(10) lgkmcnt(8)
  s_barrier
  v_mfma_f32_32x32x16_bf16 v[96:111], v[144:147], v[16:19], v[112:127]
  ds_read_b128 v[144:147], v235 offset:0
  s_cmp_lt_u32 s34, s36
  s_cselect_b32 s33, s34, 0x7f000000
  s_mov_b32 m0, s38
  s_add_u32 s34, s34, 16384
  buffer_load_dwordx4 v14, s[68:71], s33 offen sc1 lds
  v_exp_f32 v224, v80
  v_exp_f32 v225, v81
  v_exp_f32 v226, v82
  v_mfma_f32_32x32x16_bf16 v[96:111], v[148:151], v[20:23], v[96:111]
  ds_read_b128 v[148:151], v235 offset:1024
  buffer_load_dwordx4 v14, s[68:71], s33 offen offset:1024 sc1 lds
  v_add_f32 v234, v224, v225
  v_cvt_pk_bf16_f32 v208, v224, v225
  v_mfma_f32_32x32x16_bf16 v[96:111], v[152:155], v[24:27], v[96:111]
  ds_read_b128 v[152:155], v235 offset:2048
  v_exp_f32 v227, v83
  v_add_f32 v234, v234, v226
  v_exp_f32 v224, v84
  v_mfma_f32_32x32x16_bf16 v[96:111], v[156:159], v[28:31], v[96:111]
  ds_read_b128 v[156:159], v235 offset:3072
  buffer_load_dwordx4 v14, s[68:71], s33 offen offset:2048 sc1 lds
  s_add_u32 s38, s38, 32768
  v_add_f32 v234, v234, v227
  v_cvt_pk_bf16_f32 v209, v226, v227
  v_mfma_f32_32x32x16_bf16 v[96:111], v[160:163], v[32:35], v[96:111]
  ds_read_b128 v[160:163], v235 offset:4096
  v_exp_f32 v225, v85
  v_add_f32 v234, v234, v224
  v_exp_f32 v226, v86
  v_mfma_f32_32x32x16_bf16 v[96:111], v[164:167], v[36:39], v[96:111]
  ds_read_b128 v[164:167], v235 offset:5120
  buffer_load_dwordx4 v14, s[68:71], s33 offen offset:3072 sc1 lds
  s_and_b32 s38, s38, 0x1ffff
  v_add_f32 v234, v234, v225
  v_cvt_pk_bf16_f32 v210, v224, v225
  v_mfma_f32_32x32x16_bf16 v[96:111], v[168:171], v[40:43], v[96:111]
  ds_read_b128 v[168:171], v235 offset:6144
  v_exp_f32 v227, v87
  v_add_f32 v234, v234, v226
  v_exp_f32 v224, v88
  v_mfma_f32_32x32x16_bf16 v[96:111], v[172:175], v[44:47], v[96:111]
  ds_read_b128 v[172:175], v235 offset:7168
  s_cmp_lt_u32 s35, s37
  s_cselect_b32 s33, s35, 0x7f000000
  s_mov_b32 m0, s39
  s_add_u32 s35, s35, 16384
  buffer_load_dwordx4 v14, s[68:71], s33 offen sc1 lds
  v_add_f32 v234, v234, v227
  v_cvt_pk_bf16_f32 v211, v226, v227
  s_waitcnt lgkmcnt(8)
  v_mfma_f32_32x32x16_bf16 a[0:15], v[176:179], v[216:219], a[0:15]
  ds_read_b128 v[176:179], v236 offset:16384
  buffer_load_dwordx4 v14, s[68:71], s33 offen offset:1024 sc1 lds
  v_exp_f32 v225, v89
  v_add_f32 v234, v234, v224
  v_exp_f32 v226, v90
  v_mfma_f32_32x32x16_bf16 a[16:31], v[180:183], v[216:219], a[16:31]
  ds_read_b128 v[180:183], v236 offset:17408
  v_add_f32 v234, v234, v225
  v_cvt_pk_bf16_f32 v212, v224, v225
  v_mfma_f32_32x32x16_bf16 a[32:47], v[184:187], v[216:219], a[32:47]
  ds_read_b128 v[184:187], v236 offset:18432
  buffer_load_dwordx4 v14, s[68:71], s33 offen offset:2048 sc1 lds
  s_add_u32 s39, s39, 32768
  v_exp_f32 v227, v91
  v_add_f32 v234, v234, v226
  v_exp_f32 v224, v92
  v_mfma_f32_32x32x16_bf16 a[48:63], v[188:191], v[216:219], a[48:63]
  ds_read_b128 v[188:191], v236 offset:19456
  v_add_f32 v234, v234, v227
  v_cvt_pk_bf16_f32 v213, v226, v227
  v_mfma_f32_32x32x16_bf16 a[0:15], v[192:195], v[220:223], a[0:15]
  ds_read_b128 v[192:195], v236 offset:20480
  buffer_load_dwordx4 v14, s[68:71], s33 offen offset:3072 sc1 lds
  s_and_b32 s39, s39, 0x1ffff
  v_exp_f32 v225, v93
  v_add_f32 v234, v234, v224
  v_exp_f32 v226, v94
  v_mfma_f32_32x32x16_bf16 a[16:31], v[196:199], v[220:223], a[16:31]
  ds_read_b128 v[196:199], v236 offset:21504
  v_add_f32 v234, v234, v225
  v_cvt_pk_bf16_f32 v214, v224, v225
  v_mfma_f32_32x32x16_bf16 a[32:47], v[200:203], v[220:223], a[32:47]
  ds_read_b128 v[200:203], v236 offset:22528
  s_mov_b32 m0, s83
  s_add_u32 s83, s83, 4096
  buffer_load_dwordx4 v244, s[40:43], s82 offen lds
  s_add_u32 s82, s82, 1572864
  v_exp_f32 v227, v95
  v_add_f32 v234, v234, v226
  v_add_f32 v234, v234, v227
  v_mfma_f32_32x32x16_bf16 a[48:63], v[204:207], v[220:223], a[48:63]
  ds_read_b128 v[204:207], v236 offset:23552
  v_cvt_pk_bf16_f32 v215, v226, v227
  v_cmp_nge_f32 vcc, s76, v234
  s_cbranch_vccnz at_s14
at_s14r:
  v_add_f32 v232, v232, v234
  s_waitcnt lgkmcnt(8)
  v_mfma_f32_32x32x16_bf16 v[80:95], v[144:147], v[16:19], v[112:127]
  ds_read_b128 v[144:147], v235 offset:8192
  v_exp_f32 v224, v96
  v_exp_f32 v225, v97
  v_exp_f32 v226, v98
  v_mfma_f32_32x32x16_bf16 v[80:95], v[148:151], v[20:23], v[80:95]
  ds_read_b128 v[148:151], v235 offset:9216
  v_add_f32 v234, v224, v225
  v_cvt_pk_bf16_f32 v216, v224, v225
  v_mfma_f32_32x32x16_bf16 v[80:95], v[152:155], v[24:27], v[80:95]
  ds_read_b128 v[152:155], v235 offset:10240
  v_exp_f32 v227, v99
  v_add_f32 v234, v234, v226
  v_exp_f32 v224, v100
  v_mfma_f32_32x32x16_bf16 v[80:95], v[156:159], v[28:31], v[80:95]
  ds_read_b128 v[156:159], v235 offset:11264
  v_add_f32 v234, v234, v227
  v_cvt_pk_bf16_f32 v217, v226, v227
  v_mfma_f32_32x32x16_bf16 v[80:95], v[160:163], v[32:35], v[80:95]
  ds_read_b128 v[160:163], v235 offset:12288
  v_exp_f32 v225, v101
  v_add_f32 v234, v234, v224
  v_exp_f32 v226, v102
  v_mfma_f32_32x32x16_bf16 v[80:95], v[164:167], v[36:39], v[80:95]
  ds_read_b128 v[164:167], v235 offset:13312
  v_add_f32 v234, v234, v225
  v_cvt_pk_bf16_f32 v218, v224, v225
  v_mfma_f32_32x32x16_bf16 v[80:95], v[168:171], v[40:43], v[80:95]
  ds_read_b128 v[168:171], v235 offset:14336
  v_exp_f32 v227, v103
  v_add_f32 v234, v234, v226
  v_exp_f32 v224, v104
  v_mfma_f32_32x32x16_bf16 v[80:95], v[172:175], v[44:47], v[80:95]
  ds_read_b128 v[172:175], v235 offset:15360
  v_add_f32 v234, v234, v227
  v_cvt_pk_bf16_f32 v219, v226, v227
  s_waitcnt lgkmcnt(8)
  v_mfma_f32_32x32x16_bf16 a[0:15], v[176:179], v[208:211], a[0:15]
  ds_read_b128 v[176:179], v236 offset:24576
  v_exp_f32 v225, v105
  v_add_f32 v234, v234, v224
  v_exp_f32 v226, v106
  v_mfma_f32_32x32x16_bf16 a[16:31], v[180:183], v[208:211], a[16:31]
  ds_read_b128 v[180:183], v236 offset:25600
  v_add_f32 v234, v234, v225
  v_cvt_pk_bf16_f32 v220, v224, v225
  v_mfma_f32_32x32x16_bf16 a[32:47], v[184:187], v[208:211], a[32:47]
  ds_read_b128 v[184:187], v236 offset:26624
  v_exp_f32 v227, v107
  v_add_f32 v234, v234, v226
  v_exp_f32 v224, v108
  v_mfma_f32_32x32x16_bf16 a[48:63], v[188:191], v[208:211], a[48:63]
  ds_read_b128 v[188:191], v236 offset:27648
  v_add_f32 v234, v234, v227
  v_cvt_pk_bf16_f32 v221, v226, v227
  v_mfma_f32_32x32x16_bf16 a[0:15], v[192:195], v[212:215], a[0:15]
  ds_read_b128 v[192:195], v236 offset:28672
  v_exp_f32 v225, v109
  v_add_f32 v234, v234, v224
  v_exp_f32 v226, v110
  v_mfma_f32_32x32x16_bf16 a[16:31], v[196:199], v[212:215], a[16:31]
  ds_read_b128 v[196:199], v236 offset:29696
  v_add_f32 v234, v234, v225
  v_cvt_pk_bf16_f32 v222, v224, v225
  v_mfma_f32_32x32x16_bf16 a[32:47], v[200:203], v[212:215], a[32:47]
  ds_read_b128 v[200:203], v236 offset:30720
  v_exp_f32 v227, v111
  v_add_f32 v234, v234, v226
  v_add_f32 v234, v234, v227
  v_mfma_f32_32x32x16_bf16 a[48:63], v[204:207], v[212:215], a[48:63]
  ds_read_b128 v[204:207], v236 offset:31744
  v_cvt_pk_bf16_f32 v223, v226, v227
  v_cmp_nge_f32 vcc, s76, v234
  s_cbranch_vccnz at_s15
at_s15r:
  v_add_f32 v232, v232, v234
  v_mov_b32 v236, v235
  v_add_u32 v235, 32768, v235
  v_and_b32 v235, 0x1ffff, v235
  s_sub_u32 s20, s20, 1
  s_cmp_lg_u32 s20, 0
  s_cbranch_scc1 at_p2
at_p2e:
  s_waitcnt vmcnt(10) lgkmcnt(8)
  s_barrier
  v_mfma_f32_32x32x16_bf16 v[96:111], v[144:147], v[16:19], v[112:127]
  ds_read_b128 v[144:147], v235 offset:0
  s_cmp_lt_u32 s34, s36
  s_cselect_b32 s33, s34, 0x7f000000
  s_mov_b32 m0, s38
  s_add_u32 s34, s34, 16384
  buffer_load_dwordx4 v14, s[68:71], s33 offen sc1 lds
  v_add_f32 v238, 0x00000000, v237
  v_min_f32 v80, v80, v238
  v_exp_f32 v224, v80
  v_add_f32 v238, 0xf1800000, v237
  v_min_f32 v81, v81, v238
  v_mfma_f32_32x32x16_bf16 v[96:111], v[148:151], v[20:23], v[96:111]
  ds_read_b128 v[148:151], v235 offset:1024
  buffer_load_dwordx4 v14, s[68:71], s33 offen offset:1024 sc1 lds
  v_exp_f32 v225, v81
  v_add_f32 v238, 0xf2000000, v237
  v_min_f32 v82, v82, v238
  v_exp_f32 v226, v82
  v_mfma_f32_32x32x16_bf16 v[96:111], v[152:155], v[24:27], v[96:111]
  ds_read_b128 v[152:155], v235 offset:2048
  v_add_f32 v234, v224, v225
  v_cvt_pk_bf16_f32 v208, v224, v225
  v_add_f32 v238, 0xf2400000, v237
  v_min_f32 v83, v83, v238
  v_exp_f32 v227, v83
  v_mfma_f32_32x32x16_bf16 v[96:111], v[156:159], v[28:31], v[96:111]
  ds_read_b128 v[156:159], v235 offset:3072
  buffer_load_dwordx4 v14, s[68:71], s33 offen offset:2048 sc1 lds
  s_add_u32 s38, s38, 32768
  v_add_f32 v234, v234, v226
  v_add_f32 v238, 0xf3000000, v237
  v_min_f32 v84, v84, v238
  v_exp_f32 v224, v84
  v_mfma_f32_32x32x16_bf16 v[96:111], v[160:163], v[32:35], v[96:111]
  ds_read_b128 v[160:163], v235 offset:4096
  v_add_f32 v234, v234, v227
  v_cvt_pk_bf16_f32 v209, v226, v227
  v_add_f32 v238, 0xf3100000, v237
  v_min_f32 v85, v85, v238
  v_exp_f32 v225, v85
  v_mfma_f32_32x32x16_bf16 v[96:111], v[164:167], v[36:39], v[96:111]
  ds_read_b128 v[164:167], v235 offset:5120
  buffer_load_dwordx4 v14, s[68:71], s33 offen offset:3072 sc1 lds
  s_and_b32 s38, s38, 0x1ffff
  v_add_f32 v234, v234, v224
  v_add_f32 v238, 0xf3200000, v237
  v_min_f32 v86, v86, v238
  v_exp_f32 v226, v86
  v_mfma_f32_32x32x16_bf16 v[96:111], v[168:171], v[40:43], v[96:111]
  ds_read_b128 v[168:171], v235 offset:6144
  v_add_f32 v234, v234, v225
  v_cvt_pk_bf16_f32 v210, v224, v225
  v_add_f32 v238, 0xf3300000, v237
  v_min_f32 v87, v87, v238
  v_exp_f32 v227, v87
  v_mfma_f32_32x32x16_bf16 v[96:111], v[172:175], v[44:47], v[96:111]
  ds_read_b128 v[172:175], v235 offset:7168
  s_cmp_lt_u32 s35, s37
  s_cselect_b32 s33, s35, 0x7f000000
  s_mov_b32 m0, s39
  s_add_u32 s35, s35, 16384
  buffer_load_dwordx4 v14, s[68:71], s33 offen sc1 lds
  v_add_f32 v234, v234, v226
  v_add_f32 v238, 0xf3800000, v237
  v_min_f32 v88, v88, v238
  v_exp_f32 v224, v88
  s_waitcnt lgkmcnt(8)
  v_mfma_f32_32x32x16_bf16 a[0:15], v[176:179], v[216:219], a[0:15]
  ds_read_b128 v[176:179], v236 offset:16384
  buffer_load_dwordx4 v14, s[68:71], s33 offen offset:1024 sc1 lds
  v_add_f32 v234, v234, v227
  v_cvt_pk_bf16_f32 v211, v226, v227
  v_add_f32 v238, 0xf3880000, v237
  v_min_f32 v89, v89, v238
  v_exp_f32 v225, v89
  v_and_b32 v2, 3, v0
  v_lshlrev_b32 v2, 7, v2
  s_mul_i32 s65, s25, 512
  s_add_u32 s65, s65, kn_op-kn_cb
  v_add_u32 v2, s65, v2
  v_min_u32 v2, kn_ce-kn_cb-4, v2
  global_load_dword v239, v2, s[0:1]
  v_mfma_f32_32x32x16_bf16 a[16:31], v[180:183], v[216:219], a[16:31]
  ds_read_b128 v[180:183], v236 offset:17408
  v_add_f32 v234, v234, v224
  v_add_f32 v238, 0xf3900000, v237
  v_min_f32 v90, v90, v238
  v_exp_f32 v226, v90
  v_mfma_f32_32x32x16_bf16 a[32:47], v[184:187], v[216:219], a[32:47]
  ds_read_b128 v[184:187], v236 offset:18432
  buffer_load_dwordx4 v14, s[68:71], s33 offen offset:2048 sc1 lds
  s_add_u32 s39, s39, 32768
  v_add_f32 v234, v234, v225
  v_cvt_pk_bf16_f32 v212, v224, v225
  v_add_f32 v238, 0xf3980000, v237
  v_min_f32 v91, v91, v238
  v_exp_f32 v227, v91
  v_mfma_f32_32x32x16_bf16 a[48:63], v[188:191], v[216:219], a[48:63]
  ds_read_b128 v[188:191], v236 offset:19456
  v_add_f32 v234, v234, v226
  v_add_f32 v238, 0xf3c00000, v237
  v_min_f32 v92, v92, v238
  v_exp_f32 v224, v92
  v_mfma_f32_32x32x16_bf16 a[0:15], v[192:195], v[220:223], a[0:15]
  ds_read_b128 v[192:195], v236 offset:20480
  buffer_load_dwordx4 v14, s[68:71], s33 offen offset:3072 sc1 lds
  s_and_b32 s39, s39, 0x1ffff
  v_add_f32 v234, v234, v227
  v_cvt_pk_bf16_f32 v213, v226, v227
  v_add_f32 v238, 0xf3c80000, v237
  v_min_f32 v93, v93, v238
  v_exp_f32 v225, v93
  v_mfma_f32_32x32x16_bf16 a[16:31], v[196:199], v[220:223], a[16:31]
  ds_read_b128 v[196:199], v236 offset:21504
  v_add_f32 v234, v234, v224
  v_add_f32 v238, 0xf3d00000, v237
  v_min_f32 v94, v94, v238
  v_exp_f32 v226, v94
  v_mfma_f32_32x32x16_bf16 a[32:47], v[200:203], v[220:223], a[32:47]
  ds_read_b128 v[200:203], v236 offset:22528
  s_mov_b32 m0, s83
  s_add_u32 s83, s83, 4096
  buffer_load_dwordx4 v244, s[40:43], s82 offen lds
  s_add_u32 s82, s82, 1572864
  v_add_f32 v234, v234, v225
  v_cvt_pk_bf16_f32 v214, v224, v225
  v_add_f32 v238, 0xf3d80000, v237
  v_min_f32 v95, v95, v238
  v_exp_f32 v227, v95
  v_mfma_f32_32x32x16_bf16 a[48:63], v[204:207], v[220:223], a[48:63]
  ds_read_b128 v[204:207], v236 offset:23552
  v_add_f32 v234, v234, v226
  v_add_f32 v234, v234, v227
  v_cvt_pk_bf16_f32 v215, v226, v227
  v_cmp_nge_f32 vcc, s76, v234
  s_cbranch_vccnz at_s16
at_s16r:
  v_add_f32 v232, v232, v234
  s_waitcnt lgkmcnt(8)
  v_mfma_f32_32x32x16_bf16 v[80:95], v[144:147], v[16:19], v[112:127]
  ds_read_b128 v[144:147], v235 offset:8192
  v_add_f32 v238, 0xf4000000, v237
  v_min_f32 v96, v96, v238
  v_exp_f32 v224, v96
  v_add_f32 v238, 0xf4040000, v237
  v_min_f32 v97, v97, v238
  v_mfma_f32_32x32x16_bf16 v[80:95], v[148:151], v[20:23], v[80:95]
  ds_read_b128 v[148:151], v235 offset:9216
  v_exp_f32 v225, v97
  v_add_f32 v238, 0xf4080000, v237
  v_min_f32 v98, v98, v238
  v_exp_f32 v226, v98
  v_mfma_f32_32x32x16_bf16 v[80:95], v[152:155], v[24:27], v[80:95]
  ds_read_b128 v[152:155], v235 offset:10240
  v_add_f32 v234, v224, v225
  v_cvt_pk_bf16_f32 v216, v224, v225
  v_add_f32 v238, 0xf40c0000, v237
  v_min_f32 v99, v99, v238
  v_exp_f32 v227, v99
  v_mfma_f32_32x32x16_bf16 v[80:95], v[156:159], v[28:31], v[80:95]
  ds_read_b128 v[156:159], v235 offset:11264
  v_add_f32 v234, v234, v226
  v_add_f32 v238, 0xf4200000, v237
  v_min_f32 v100, v100, v238
  v_exp_f32 v224, v100
  v_mfma_f32_32x32x16_bf16 v[80:95], v[160:163], v[32:35], v[80:95]
  ds_read_b128 v[160:163], v235 offset:12288
  v_add_f32 v234, v234, v227
  v_cvt_pk_bf16_f32 v217, v226, v227
  v_add_f32 v238, 0xf4240000, v237
  v_min_f32 v101, v101, v238
  v_exp_f32 v225, v101
  v_mfma_f32_32x32x16_bf16 v[80:95], v[164:167], v[36:39], v[80:95]
  ds_read_b128 v[164:167], v235 offset:13312
  v_add_f32 v234, v234, v224
  v_add_f32 v238, 0xf4280000, v237
  v_min_f32 v102, v102, v238
  v_exp_f32 v226, v102
  v_mfma_f32_32x32x16_bf16 v[80:95], v[168:171], v[40:43], v[80:95]
  ds_read_b128 v[168:171], v235 offset:14336
  v_add_f32 v234, v234, v225
  v_cvt_pk_bf16_f32 v218, v224, v225
  v_add_f32 v238, 0xf42c0000, v237
  v_min_f32 v103, v103, v238
  v_exp_f32 v227, v103
  v_mfma_f32_32x32x16_bf16 v[80:95], v[172:175], v[44:47], v[80:95]
  ds_read_b128 v[172:175], v235 offset:15360
  v_add_f32 v234, v234, v226
  v_add_f32 v238, 0xf4400000, v237
  v_min_f32 v104, v104, v238
  v_exp_f32 v224, v104
  s_waitcnt lgkmcnt(8)
  v_mfma_f32_32x32x16_bf16 a[0:15], v[176:179], v[208:211], a[0:15]
  ds_read_b128 v[176:179], v236 offset:24576
  v_add_f32 v234, v234, v227
  v_cvt_pk_bf16_f32 v219, v226, v227
  v_add_f32 v238, 0xf4440000, v237
  v_min_f32 v105, v105, v238
  v_exp_f32 v225, v105
  v_mfma_f32_32x32x16_bf16 a[16:31], v[180:183], v[208:211], a[16:31]
  ds_read_b128 v[180:183], v236 offset:25600
  v_add_f32 v234, v234, v224
  v_add_f32 v238, 0xf4480000, v237
  v_min_f32 v106, v106, v238
  v_exp_f32 v226, v106
  v_mfma_f32_32x32x16_bf16 a[32:47], v[184:187], v[208:211], a[32:47]
  ds_read_b128 v[184:187], v236 offset:26624
  v_add_f32 v234, v234, v225
  v_cvt_pk_bf16_f32 v220, v224, v225
  v_add_f32 v238, 0xf44c0000, v237
  v_min_f32 v107, v107, v238
  v_exp_f32 v227, v107
  v_mfma_f32_32x32x16_bf16 a[48:63], v[188:191], v[208:211], a[48:63]
  ds_read_b128 v[188:191], v236 offset:27648
  v_add_f32 v234, v234, v226
  v_add_f32 v238, 0xf4600000, v237
  v_min_f32 v108, v108, v238
  v_exp_f32 v224, v108
  v_mfma_f32_32x32x16_bf16 a[0:15], v[192:195], v[212:215], a[0:15]
  ds_read_b128 v[192:195], v236 offset:28672
  v_add_f32 v234, v234, v227
  v_cvt_pk_bf16_f32 v221, v226, v227
  v_add_f32 v238, 0xf4640000, v237
  v_min_f32 v109, v109, v238
  v_exp_f32 v225, v109
  v_mfma_f32_32x32x16_bf16 a[16:31], v[196:199], v[212:215], a[16:31]
  ds_read_b128 v[196:199], v236 offset:29696
  v_add_f32 v234, v234, v224
  v_add_f32 v238, 0xf4680000, v237
  v_min_f32 v110, v110, v238
  v_exp_f32 v226, v110
  v_mfma_f32_32x32x16_bf16 a[32:47], v[200:203], v[212:215], a[32:47]
  ds_read_b128 v[200:203], v236 offset:30720
  v_add_f32 v234, v234, v225
  v_cvt_pk_bf16_f32 v222, v224, v225
  v_add_f32 v238, 0xf46c0000, v237
  v_min_f32 v111, v111, v238
  v_exp_f32 v227, v111
  v_mfma_f32_32x32x16_bf16 a[48:63], v[204:207], v[212:215], a[48:63]
  ds_read_b128 v[204:207], v236 offset:31744
  v_add_f32 v234, v234, v226
  v_add_f32 v234, v234, v227
  v_cvt_pk_bf16_f32 v223, v226, v227
  v_cmp_nge_f32 vcc, s76, v234
  s_cbranch_vccnz at_s17
at_s17r:
  v_add_f32 v232, v232, v234
  v_mov_b32 v236, v235
  v_add_u32 v235, 32768, v235
  v_and_b32 v235, 0x1ffff, v235
  s_waitcnt vmcnt(10) lgkmcnt(8)
  s_barrier
  v_mfma_f32_32x32x16_bf16 v[96:111], v[144:147], v[16:19], v[112:127]
  s_cmp_lt_u32 s34, s36
  s_cselect_b32 s33, s34, 0x7f000000
  s_mov_b32 m0, s38
  s_add_u32 s34, s34, 16384
  buffer_load_dwordx4 v14, s[68:71], s33 offen sc1 lds
  v_add_f32 v238, 0xf4800000, v237
  v_min_f32 v80, v80, v238
  v_exp_f32 v224, v80
  v_add_f32 v238, 0xf4820000, v237
  v_min_f32 v81, v81, v238
  v_mfma_f32_32x32x16_bf16 v[96:111], v[148:151], v[20:23], v[96:111]
  buffer_load_dwordx4 v14, s[68:71], s33 offen offset:1024 sc1 lds
  v_exp_f32 v225, v81
  v_add_f32 v238, 0xf4840000, v237
  v_min_f32 v82, v82, v238
  v_exp_f32 v226, v82
  v_mfma_f32_32x32x16_bf16 v[96:111], v[152:155], v[24:27], v[96:111]
  v_add_f32 v234, v224, v225
  v_cvt_pk_bf16_f32 v208, v224, v225
  v_add_f32 v238, 0xf4860000, v237
  v_min_f32 v83, v83, v238
  v_exp_f32 v227, v83
  v_mfma_f32_32x32x16_bf16 v[96:111], v[156:159], v[28:31], v[96:111]
  buffer_load_dwordx4 v14, s[68:71], s33 offen offset:2048 sc1 lds
  s_add_u32 s38, s38, 32768
  v_add_f32 v234, v234, v226
  v_add_f32 v238, 0xf4900000, v237
  v_min_f32 v84, v84, v238
  v_exp_f32 v224, v84
  v_mfma_f32_32x32x16_bf16 v[96:111], v[160:163], v[32:35], v[96:111]
  v_add_f32 v234, v234, v227
  v_cvt_pk_bf16_f32 v209, v226, v227
  v_add_f32 v238, 0xf4920000, v237
  v_min_f32 v85, v85, v238
  v_exp_f32 v225, v85
  v_mfma_f32_32x32x16_bf16 v[96:111], v[164:167], v[36:39], v[96:111]
  buffer_load_dwordx4 v14, s[68:71], s33 offen offset:3072 sc1 lds
  s_and_b32 s38, s38, 0x1ffff
  v_add_f32 v234, v234, v224
  v_add_f32 v238, 0xf4940000, v237
  v_min_f32 v86, v86, v238
  v_exp_f32 v226, v86
  v_mfma_f32_32x32x16_bf16 v[96:111], v[168:171], v[40:43], v[96:111]
  v_add_f32 v234, v234, v225
  v_cvt_pk_bf16_f32 v210, v224, v225
  v_add_f32 v238, 0xf4960000, v237
  v_min_f32 v87, v87, v238
  v_exp_f32 v227, v87
  v_mfma_f32_32x32x16_bf16 v[96:111], v[172:175], v[44:47], v[96:111]
  s_cmp_lt_u32 s35, s37
  s_cselect_b32 s33, s35, 0x7f000000
  s_mov_b32 m0, s39
  s_add_u32 s35, s35, 16384
  buffer_load_dwordx4 v14, s[68:71], s33 offen sc1 lds
  v_add_f32 v234, v234, v226
  v_add_f32 v238, 0xf4a00000, v237
  v_min_f32 v88, v88, v238
  v_exp_f32 v224, v88
  s_waitcnt lgkmcnt(0)
  v_mfma_f32_32x32x16_bf16 a[0:15], v[176:179], v[216:219], a[0:15]
  ds_read_b128 v[176:179], v236 offset:16384
  buffer_load_dwordx4 v14, s[68:71], s33 offen offset:1024 sc1 lds
  v_add_f32 v234, v234, v227
  v_cvt_pk_bf16_f32 v211, v226, v227
  v_add_f32 v238, 0xf4a20000, v237
  v_min_f32 v89, v89, v238
  v_exp_f32 v225, v89
  v_mfma_f32_32x32x16_bf16 a[16:31], v[180:183], v[216:219], a[16:31]
  ds_read_b128 v[180:183], v236 offset:17408
  v_add_f32 v234, v234, v224
  v_add_f32 v238, 0xf4a40000, v237
  v_min_f32 v90, v90, v238
  v_exp_f32 v226, v90
  v_mfma_f32_32x32x16_bf16 a[32:47], v[184:187], v[216:219], a[32:47]
  ds_read_b128 v[184:187], v236 offset:18432
  buffer_load_dwordx4 v14, s[68:71], s33 offen offset:2048 sc1 lds
  s_add_u32 s39, s39, 32768
  v_add_f32 v234, v234, v225
  v_cvt_pk_bf16_f32 v212, v224, v225
  v_add_f32 v238, 0xf4a60000, v237
  v_min_f32 v91, v91, v238
  v_exp_f32 v227, v91
  v_mfma_f32_32x32x16_bf16 a[48:63], v[188:191], v[216:219], a[48:63]
  ds_read_b128 v[188:191], v236 offset:19456
  v_add_f32 v234, v234, v226
  v_add_f32 v238, 0xf4b00000, v237
  v_min_f32 v92, v92, v238
  v_exp_f32 v224, v92
  v_mfma_f32_32x32x16_bf16 a[0:15], v[192:195], v[220:223], a[0:15]
  ds_read_b128 v[192:195], v236 offset:20480
  buffer_load_dwordx4 v14, s[68:71], s33 offen offset:3072 sc1 lds
  s_and_b32 s39, s39, 0x1ffff
  v_add_f32 v234, v234, v227
  v_cvt_pk_bf16_f32 v213, v226, v227
  v_add_f32 v238, 0xf4b20000, v237
  v_min_f32 v93, v93, v238
  v_exp_f32 v225, v93
  v_mfma_f32_32x32x16_bf16 a[16:31], v[196:199], v[220:223], a[16:31]
  ds_read_b128 v[196:199], v236 offset:21504
  v_add_f32 v234, v234, v224
  v_add_f32 v238, 0xf4b40000, v237
  v_min_f32 v94, v94, v238
  v_exp_f32 v226, v94
  v_mfma_f32_32x32x16_bf16 a[32:47], v[200:203], v[220:223], a[32:47]
  ds_read_b128 v[200:203], v236 offset:22528
  s_mov_b32 m0, s83
  s_add_u32 s83, s83, 4096
  buffer_load_dwordx4 v244, s[40:43], s82 offen lds
  s_add_u32 s82, s82, 1572864
  v_add_f32 v234, v234, v225
  v_cvt_pk_bf16_f32 v214, v224, v225
  v_add_f32 v238, 0xf4b60000, v237
  v_min_f32 v95, v95, v238
  v_exp_f32 v227, v95
  v_mfma_f32_32x32x16_bf16 a[48:63], v[204:207], v[220:223], a[48:63]
  ds_read_b128 v[204:207], v236 offset:23552
  v_add_f32 v234, v234, v226
  v_add_f32 v234, v234, v227
  v_cvt_pk_bf16_f32 v215, v226, v227
  v_cmp_nge_f32 vcc, s76, v234
  s_cbranch_vccnz at_s18
at_s18r:
  v_add_f32 v232, v232, v234
  s_waitcnt lgkmcnt(0)
  v_mfma_f32_32x32x16_bf16 a[0:15], v[176:179], v[208:211], a[0:15]
  ds_read_b128 v[176:179], v236 offset:24576
  v_add_f32 v238, 0xf4c00000, v237
  v_min_f32 v96, v96, v238
  v_exp_f32 v224, v96
  v_add_f32 v238, 0xf4c20000, v237
  v_min_f32 v97, v97, v238
  v_exp_f32 v225, v97
  v_add_f32 v238, 0xf4c40000, v237
  v_min_f32 v98, v98, v238
  v_exp_f32 v226, v98
  v_mfma_f32_32x32x16_bf16 a[16:31], v[180:183], v[208:211], a[16:31]
  ds_read_b128 v[180:183], v236 offset:25600
  v_add_f32 v234, v224, v225
  v_cvt_pk_bf16_f32 v216, v224, v225
  v_add_f32 v238, 0xf4c60000, v237
  v_min_f32 v99, v99, v238
  v_exp_f32 v227, v99
  v_add_f32 v234, v234, v226
  v_add_f32 v238, 0xf4d00000, v237
  v_min_f32 v100, v100, v238
  v_exp_f32 v224, v100
  v_mfma_f32_32x32x16_bf16 a[32:47], v[184:187], v[208:211], a[32:47]
  ds_read_b128 v[184:187], v236 offset:26624
  v_add_f32 v234, v234, v227
  v_cvt_pk_bf16_f32 v217, v226, v227
  v_add_f32 v238, 0xf4d20000, v237
  v_min_f32 v101, v101, v238
  v_exp_f32 v225, v101
  v_add_f32 v234, v234, v224
  v_add_f32 v238, 0xf4d40000, v237
  v_min_f32 v102, v102, v238
  v_exp_f32 v226, v102
  v_mfma_f32_32x32x16_bf16 a[48:63], v[188:191], v[208:211], a[48:63]
  ds_read_b128 v[188:191], v236 offset:27648
  v_add_f32 v234, v234, v225
  v_cvt_pk_bf16_f32 v218, v224, v225
  v_add_f32 v238, 0xf4d60000, v237
  v_min_f32 v103, v103, v238
  v_exp_f32 v227, v103
  v_add_f32 v234, v234, v226
  v_add_f32 v238, 0xf4e00000, v237
  v_min_f32 v104, v104, v238
  v_exp_f32 v224, v104
  v_mfma_f32_32x32x16_bf16 a[0:15], v[192:195], v[212:215], a[0:15]
  ds_read_b128 v[192:195], v236 offset:28672
  v_add_f32 v234, v234, v227
  v_cvt_pk_bf16_f32 v219, v226, v227
  v_add_f32 v238, 0xf4e20000, v237
  v_min_f32 v105, v105, v238
  v_exp_f32 v225, v105
  v_add_f32 v234, v234, v224
  v_add_f32 v238, 0xf4e40000, v237
  v_min_f32 v106, v106, v238
  v_exp_f32 v226, v106
  v_mfma_f32_32x32x16_bf16 a[16:31], v[196:199], v[212:215], a[16:31]
  ds_read_b128 v[196:199], v236 offset:29696
  v_add_f32 v234, v234, v225
  v_cvt_pk_bf16_f32 v220, v224, v225
  v_add_f32 v238, 0xf4e60000, v237
  v_min_f32 v107, v107, v238
  v_exp_f32 v227, v107
  v_add_f32 v234, v234, v226
  v_add_f32 v238, 0xf4f00000, v237
  v_min_f32 v108, v108, v238
  v_exp_f32 v224, v108
  v_mfma_f32_32x32x16_bf16 a[32:47], v[200:203], v[212:215], a[32:47]
  ds_read_b128 v[200:203], v236 offset:30720
  v_add_f32 v234, v234, v227
  v_cvt_pk_bf16_f32 v221, v226, v227
  v_add_f32 v238, 0xf4f20000, v237
  v_min_f32 v109, v109, v238
  v_exp_f32 v225, v109
  v_add_f32 v234, v234, v224
  v_add_f32 v238, 0xf4f40000, v237
  v_min_f32 v110, v110, v238
  v_exp_f32 v226, v110
  v_mfma_f32_32x32x16_bf16 a[48:63], v[204:207], v[212:215], a[48:63]
  ds_read_b128 v[204:207], v236 offset:31744
  v_add_f32 v234, v234, v225
  v_cvt_pk_bf16_f32 v222, v224, v225
  v_add_f32 v238, 0xf4f60000, v237
  v_min_f32 v111, v111, v238
  v_exp_f32 v227, v111
  v_add_f32 v234, v234, v226
  v_add_f32 v234, v234, v227
  v_cvt_pk_bf16_f32 v223, v226, v227
  v_cmp_nge_f32 vcc, s76, v234
  s_cbranch_vccnz at_s19
at_s19r:
  v_add_f32 v232, v232, v234
  v_mov_b32 v236, v235
  v_add_u32 v235, 32768, v235
  v_and_b32 v235, 0x1ffff, v235
  s_waitcnt lgkmcnt(0)
  v_mfma_f32_32x32x16_bf16 a[0:15], v[176:179], v[216:219], a[0:15]
  v_mfma_f32_32x32x16_bf16 a[16:31], v[180:183], v[216:219], a[16:31]
  v_mfma_f32_32x32x16_bf16 a[32:47], v[184:187], v[216:219], a[32:47]
  v_mfma_f32_32x32x16_bf16 a[48:63], v[188:191], v[216:219], a[48:63]
  v_mfma_f32_32x32x16_bf16 a[0:15], v[192:195], v[220:223], a[0:15]
  v_mfma_f32_32x32x16_bf16 a[16:31], v[196:199], v[220:223], a[16:31]
  v_mfma_f32_32x32x16_bf16 a[32:47], v[200:203], v[220:223], a[32:47]
  v_mfma_f32_32x32x16_bf16 a[48:63], v[204:207], v[220:223], a[48:63]
  v_mov_b32 v2, v232
  s_nop 1
  v_permlane32_swap_b32 v232, v2
  s_nop 1
  v_add_f32 v2, v232, v2
  v_rcp_f32 v2, v2
  s_lshl_b32 s33, s28, 18
  s_lshl_b32 s21, s26, 13
  s_add_u32 s33, s33, s21
  s_add_u32 s33, s33, 41943040
  v_accvgpr_read_b32 v80, a0
  v_accvgpr_read_b32 v81, a1
  v_accvgpr_read_b32 v82, a2
  v_accvgpr_read_b32 v83, a3
  v_accvgpr_read_b32 v84, a4
  v_accvgpr_read_b32 v85, a5
  v_accvgpr_read_b32 v86, a6
  v_accvgpr_read_b32 v87, a7
  v_mul_f32 v80, v80, v2
  v_mul_f32 v81, v81, v2
  v_mul_f32 v82, v82, v2
  v_mul_f32 v83, v83, v2
  v_mul_f32 v84, v84, v2
  v_mul_f32 v85, v85, v2
  v_mul_f32 v86, v86, v2
  v_mul_f32 v87, v87, v2
  v_cvt_pk_bf16_f32 v88, v80, v81
  v_cvt_pk_bf16_f32 v89, v82, v83
  v_cvt_pk_bf16_f32 v90, v84, v85
  v_cvt_pk_bf16_f32 v91, v86, v87
  buffer_store_dwordx4 v[88:91], v14, s[68:71], s33 offen offset:0 sc1
  v_accvgpr_read_b32 v92, a8
  v_accvgpr_read_b32 v93, a9
  v_accvgpr_read_b32 v94, a10
  v_accvgpr_read_b32 v95, a11
  v_accvgpr_read_b32 v96, a12
  v_accvgpr_read_b32 v97, a13
  v_accvgpr_read_b32 v98, a14
  v_accvgpr_read_b32 v99, a15
  v_mul_f32 v92, v92, v2
  v_mul_f32 v93, v93, v2
  v_mul_f32 v94, v94, v2
  v_mul_f32 v95, v95, v2
  v_mul_f32 v96, v96, v2
  v_mul_f32 v97, v97, v2
  v_mul_f32 v98, v98, v2
  v_mul_f32 v99, v99, v2
  v_cvt_pk_bf16_f32 v100, v92, v93
  v_cvt_pk_bf16_f32 v101, v94, v95
  v_cvt_pk_bf16_f32 v102, v96, v97
  v_cvt_pk_bf16_f32 v103, v98, v99
  buffer_store_dwordx4 v[100:103], v14, s[68:71], s33 offen offset:1024 sc1
  v_accvgpr_read_b32 v80, a16
  v_accvgpr_read_b32 v81, a17
  v_accvgpr_read_b32 v82, a18
  v_accvgpr_read_b32 v83, a19
  v_accvgpr_read_b32 v84, a20
  v_accvgpr_read_b32 v85, a21
  v_accvgpr_read_b32 v86, a22
  v_accvgpr_read_b32 v87, a23
  v_mul_f32 v80, v80, v2
  v_mul_f32 v81, v81, v2
  v_mul_f32 v82, v82, v2
  v_mul_f32 v83, v83, v2
  v_mul_f32 v84, v84, v2
  v_mul_f32 v85, v85, v2
  v_mul_f32 v86, v86, v2
  v_mul_f32 v87, v87, v2
  v_cvt_pk_bf16_f32 v88, v80, v81
  v_cvt_pk_bf16_f32 v89, v82, v83
  v_cvt_pk_bf16_f32 v90, v84, v85
  v_cvt_pk_bf16_f32 v91, v86, v87
  buffer_store_dwordx4 v[88:91], v14, s[68:71], s33 offen offset:2048 sc1
  v_accvgpr_read_b32 v92, a24
  v_accvgpr_read_b32 v93, a25
  v_accvgpr_read_b32 v94, a26
  v_accvgpr_read_b32 v95, a27
  v_accvgpr_read_b32 v96, a28
  v_accvgpr_read_b32 v97, a29
  v_accvgpr_read_b32 v98, a30
  v_accvgpr_read_b32 v99, a31
  v_mul_f32 v92, v92, v2
  v_mul_f32 v93, v93, v2
  v_mul_f32 v94, v94, v2
  v_mul_f32 v95, v95, v2
  v_mul_f32 v96, v96, v2
  v_mul_f32 v97, v97, v2
  v_mul_f32 v98, v98, v2
  v_mul_f32 v99, v99, v2
  v_cvt_pk_bf16_f32 v100, v92, v93
  v_cvt_pk_bf16_f32 v101, v94, v95
  v_cvt_pk_bf16_f32 v102, v96, v97
  v_cvt_pk_bf16_f32 v103, v98, v99
  buffer_store_dwordx4 v[100:103], v14, s[68:71], s33 offen offset:3072 sc1
  v_accvgpr_read_b32 v80, a32
  v_accvgpr_read_b32 v81, a33
  v_accvgpr_read_b32 v82, a34
  v_accvgpr_read_b32 v83, a35
  v_accvgpr_read_b32 v84, a36
  v_accvgpr_read_b32 v85, a37
  v_accvgpr_read_b32 v86, a38
  v_accvgpr_read_b32 v87, a39
  v_mul_f32 v80, v80, v2
  v_mul_f32 v81, v81, v2
  v_mul_f32 v82, v82, v2
  v_mul_f32 v83, v83, v2
  v_mul_f32 v84, v84, v2
  v_mul_f32 v85, v85, v2
  v_mul_f32 v86, v86, v2
  v_mul_f32 v87, v87, v2
  v_cvt_pk_bf16_f32 v88, v80, v81
  v_cvt_pk_bf16_f32 v89, v82, v83
  v_cvt_pk_bf16_f32 v90, v84, v85
  v_cvt_pk_bf16_f32 v91, v86, v87
  s_add_u32 s33, s33, 4096
  buffer_store_dwordx4 v[88:91], v14, s[68:71], s33 offen offset:0 sc1
  v_accvgpr_read_b32 v92, a40
  v_accvgpr_read_b32 v93, a41
  v_accvgpr_read_b32 v94, a42
  v_accvgpr_read_b32 v95, a43
  v_accvgpr_read_b32 v96, a44
  v_accvgpr_read_b32 v97, a45
  v_accvgpr_read_b32 v98, a46
  v_accvgpr_read_b32 v99, a47
  v_mul_f32 v92, v92, v2
  v_mul_f32 v93, v93, v2
  v_mul_f32 v94, v94, v2
  v_mul_f32 v95, v95, v2
  v_mul_f32 v96, v96, v2
  v_mul_f32 v97, v97, v2
  v_mul_f32 v98, v98, v2
  v_mul_f32 v99, v99, v2
  v_cvt_pk_bf16_f32 v100, v92, v93
  v_cvt_pk_bf16_f32 v101, v94, v95
  v_cvt_pk_bf16_f32 v102, v96, v97
  v_cvt_pk_bf16_f32 v103, v98, v99
  buffer_store_dwordx4 v[100:103], v14, s[68:71], s33 offen offset:1024 sc1
  v_accvgpr_read_b32 v80, a48
  v_accvgpr_read_b32 v81, a49
  v_accvgpr_read_b32 v82, a50
  v_accvgpr_read_b32 v83, a51
  v_accvgpr_read_b32 v84, a52
  v_accvgpr_read_b32 v85, a53
  v_accvgpr_read_b32 v86, a54
  v_accvgpr_read_b32 v87, a55
  v_mul_f32 v80, v80, v2
  v_mul_f32 v81, v81, v2
  v_mul_f32 v82, v82, v2
  v_mul_f32 v83, v83, v2
  v_mul_f32 v84, v84, v2
  v_mul_f32 v85, v85, v2
  v_mul_f32 v86, v86, v2
  v_mul_f32 v87, v87, v2
  v_cvt_pk_bf16_f32 v88, v80, v81
  v_cvt_pk_bf16_f32 v89, v82, v83
  v_cvt_pk_bf16_f32 v90, v84, v85
  v_cvt_pk_bf16_f32 v91, v86, v87
  buffer_store_dwordx4 v[88:91], v14, s[68:71], s33 offen offset:2048 sc1
  v_accvgpr_read_b32 v92, a56
  v_accvgpr_read_b32 v93, a57
  v_accvgpr_read_b32 v94, a58
  v_accvgpr_read_b32 v95, a59
  v_accvgpr_read_b32 v96, a60
  v_accvgpr_read_b32 v97, a61
  v_accvgpr_read_b32 v98, a62
  v_accvgpr_read_b32 v99, a63
  v_mul_f32 v92, v92, v2
  v_mul_f32 v93, v93, v2
  v_mul_f32 v94, v94, v2
  v_mul_f32 v95, v95, v2
  v_mul_f32 v96, v96, v2
  v_mul_f32 v97, v97, v2
  v_mul_f32 v98, v98, v2
  v_mul_f32 v99, v99, v2
  v_cvt_pk_bf16_f32 v100, v92, v93
  v_cvt_pk_bf16_f32 v101, v94, v95
  v_cvt_pk_bf16_f32 v102, v96, v97
  v_cvt_pk_bf16_f32 v103, v98, v99
  buffer_store_dwordx4 v[100:103], v14, s[68:71], s33 offen offset:3072 sc1
kn_op:
  s_lshl_b32 s38, s26, 7
  s_add_u32 s38, s38, 589824
  s_lshl_b32 s39, s27, 12
  s_add_u32 s21, s38, 61440
  s_sub_u32 s21, s21, s39
  s_add_u32 s38, s38, s39
  s_mov_b32 s39, s21
  s_and_b32 s26, s24, 3
  s_lshl_b32 s26, s26, 2
  s_and_b32 s27, s25, 3
  s_add_u32 s26, s26, s27
  s_lshr_b32 s27, s24, 2
  s_lshl_b32 s27, s27, 3
  s_lshr_b32 s28, s25, 2
  s_add_u32 s27, s27, s28
  s_lshl_b32 s28, s26, 2
  s_add_u32 s28, s28, s3
  v_bfe_u32 v2, v1, 2, 2
  v_lshlrev_b32 v6, 7, v2
  v_bfe_u32 v2, v1, 3, 1
  v_lshl_add_u32 v6, v2, 6, v6
  v_bfe_u32 v2, v1, 4, 1
  v_lshl_add_u32 v6, v2, 5, v6
  v_and_b32 v2, 3, v1
  v_lshl_add_u32 v6, v2, 3, v6
  v_lshrrev_b32 v2, 5, v1
  v_mul_u32_u24 v2, 512, v2
  v_add_u32 v6, v6, v2
  v_xor_b32 v7, 64, v6
  v_lshrrev_b32 v2, 3, v1
  v_mul_u32_u24 v2, 2048, v2
  v_bfe_u32 v3, v1, 4, 1
  v_lshlrev_b32 v3, 2, v3
  v_and_b32 v4, 7, v1
  v_xor_b32 v3, v3, v4
  v_lshl_add_u32 v2, v3, 4, v2
  s_mul_i32 s31, s3, 65536
  v_add_u32 v2, s31, v2
  v_add_u32 v8, 4096, v2
  v_add_u32 v9, 19456, v2
  v_add_u32 v10, 34816, v2
  v_add_u32 v11, 50176, v2
  s_mul_i32 s31, s3, 4096
  s_add_u32 s31, s31, 0
  s_lshl_b32 s30, s27, 7
  s_mul_i32 s32, s28, 262144
  s_add_u32 s32, s32, 41943040
  v_lshlrev_b32 v12, 4, v1
  s_waitcnt vmcnt(8)
  s_barrier
  s_add_u32 m0, s31, 0
  s_nop 0
  buffer_load_dwordx4 v8, s[48:51], s30 offen offset:0 lds
  buffer_load_dwordx4 v9, s[48:51], s30 offen offset:1024 lds
  buffer_load_dwordx4 v10, s[48:51], s30 offen offset:2048 lds
  buffer_load_dwordx4 v11, s[48:51], s30 offen offset:3072 lds
  s_add_u32 s30, s30, 262144
  s_add_u32 m0, s31, 16384
  s_nop 0
  buffer_load_dwordx4 v8, s[48:51], s30 offen offset:0 lds
  buffer_load_dwordx4 v9, s[48:51], s30 offen offset:1024 lds
  buffer_load_dwordx4 v10, s[48:51], s30 offen offset:2048 lds
  buffer_load_dwordx4 v11, s[48:51], s30 offen offset:3072 lds
  s_add_u32 s30, s30, 262144
  s_add_u32 m0, s31, 32768
  s_nop 0
  buffer_load_dwordx4 v8, s[48:51], s30 offen offset:0 lds
  buffer_load_dwordx4 v9, s[48:51], s30 offen offset:1024 lds
  buffer_load_dwordx4 v10, s[48:51], s30 offen offset:2048 lds
  buffer_load_dwordx4 v11, s[48:51], s30 offen offset:3072 lds
  s_add_u32 s30, s30, 262144
  s_add_u32 m0, s31, 49152
  s_nop 0
  buffer_load_dwordx4 v8, s[48:51], s30 offen offset:0 lds
  buffer_load_dwordx4 v9, s[48:51], s30 offen offset:1024 lds
  buffer_load_dwordx4 v10, s[48:51], s30 offen offset:2048 lds
  buffer_load_dwordx4 v11, s[48:51], s30 offen offset:3072 lds
  s_add_u32 s30, s30, 262144
  v_lshrrev_b32 v13, 5, v1
  v_and_b32 v14, 31, v1
  v_lshlrev_b32 v15, 4, v13
  s_lshl_b32 s33, s27, 8
  s_lshl_b32 s36, s28, 16
  s_lshl_b32 s37, s27, 7
  s_add_u32 s36, s36, s37
  v_lshlrev_b32 v3, 11, v14
  v_lshl_add_u32 v3, v13, 3, v3
  buffer_load_dwordx2 v[112:113], v3, s[60:63], s36 offen offset:0
  buffer_load_dwordx2 v[114:115], v3, s[60:63], s36 offen offset:16
  buffer_load_dwordx2 v[116:117], v3, s[60:63], s36 offen offset:32
  buffer_load_dwordx2 v[118:119], v3, s[60:63], s36 offen offset:48
  buffer_load_dwordx2 v[120:121], v3, s[60:63], s36 offen offset:64
  buffer_load_dwordx2 v[122:123], v3, s[60:63], s36 offen offset:80
  buffer_load_dwordx2 v[124:125], v3, s[60:63], s36 offen offset:96
  buffer_load_dwordx2 v[126:127], v3, s[60:63], s36 offen offset:112
  v_lshlrev_b32 v2, 4, v0
  v_add_u32 v2, 131072, v2
  ds_read_b128 v[16:19], v2 offset:0
  ds_read_b128 v[20:23], v2 offset:4096
  ds_read_b128 v[24:27], v2 offset:8192
  ds_read_b128 v[28:31], v2 offset:12288
  ds_read_b128 v[32:35], v2 offset:16384
  ds_read_b128 v[36:39], v2 offset:20480
  ds_read_b128 v[40:43], v2 offset:24576
  ds_read_b128 v[44:47], v2 offset:28672
  v_accvgpr_read_b32 v48, a160
  v_accvgpr_read_b32 v49, a161
  v_accvgpr_read_b32 v50, a162
  v_accvgpr_read_b32 v51, a163
  v_accvgpr_read_b32 v52, a164
  v_accvgpr_read_b32 v53, a165
  v_accvgpr_read_b32 v54, a166
  v_accvgpr_read_b32 v55, a167
  s_waitcnt lgkmcnt(0)
  v_lshlrev_b32 v48, 16, v48
  v_mul_f32 v2, 0xbfb8aa3b, v48
  v_exp_f32 v2, v2
  s_nop 0
  v_add_f32 v2, 1.0, v2
  v_rcp_f32 v2, v2
  s_nop 0
  v_mul_f32 v48, v48, v2
  v_cvt_pk_bf16_f32 v48, v48, v48
  v_and_b32 v48, 0xffff0000, v48
  v_lshlrev_b32 v2, 16, v16
  v_and_b32 v3, 0xffff0000, v16
  v_mul_f32 v56, v2, v48
  v_mul_f32 v57, v3, v48
  v_lshlrev_b32 v2, 16, v17
  v_and_b32 v3, 0xffff0000, v17
  v_mul_f32 v58, v2, v48
  v_mul_f32 v59, v3, v48
  v_lshlrev_b32 v2, 16, v18
  v_and_b32 v3, 0xffff0000, v18
  v_mul_f32 v60, v2, v48
  v_mul_f32 v61, v3, v48
  v_lshlrev_b32 v2, 16, v19
  v_and_b32 v3, 0xffff0000, v19
  v_mul_f32 v62, v2, v48
  v_mul_f32 v63, v3, v48
  v_lshlrev_b32 v49, 16, v49
  v_mul_f32 v2, 0xbfb8aa3b, v49
  v_exp_f32 v2, v2
  s_nop 0
  v_add_f32 v2, 1.0, v2
  v_rcp_f32 v2, v2
  s_nop 0
  v_mul_f32 v49, v49, v2
  v_cvt_pk_bf16_f32 v49, v49, v49
  v_and_b32 v49, 0xffff0000, v49
  v_lshlrev_b32 v2, 16, v20
  v_and_b32 v3, 0xffff0000, v20
  v_fmac_f32 v56, v2, v49
  v_fmac_f32 v57, v3, v49
  v_lshlrev_b32 v2, 16, v21
  v_and_b32 v3, 0xffff0000, v21
  v_fmac_f32 v58, v2, v49
  v_fmac_f32 v59, v3, v49
  v_lshlrev_b32 v2, 16, v22
  v_and_b32 v3, 0xffff0000, v22
  v_fmac_f32 v60, v2, v49
  v_fmac_f32 v61, v3, v49
  v_lshlrev_b32 v2, 16, v23
  v_and_b32 v3, 0xffff0000, v23
  v_fmac_f32 v62, v2, v49
  v_fmac_f32 v63, v3, v49
  v_lshlrev_b32 v50, 16, v50
  v_mul_f32 v2, 0xbfb8aa3b, v50
  v_exp_f32 v2, v2
  s_nop 0
  v_add_f32 v2, 1.0, v2
  v_rcp_f32 v2, v2
  s_nop 0
  v_mul_f32 v50, v50, v2
  v_cvt_pk_bf16_f32 v50, v50, v50
  v_and_b32 v50, 0xffff0000, v50
  v_lshlrev_b32 v2, 16, v24
  v_and_b32 v3, 0xffff0000, v24
  v_fmac_f32 v56, v2, v50
  v_fmac_f32 v57, v3, v50
  v_lshlrev_b32 v2, 16, v25
  v_and_b32 v3, 0xffff0000, v25
  v_fmac_f32 v58, v2, v50
  v_fmac_f32 v59, v3, v50
  v_lshlrev_b32 v2, 16, v26
  v_and_b32 v3, 0xffff0000, v26
  v_fmac_f32 v60, v2, v50
  v_fmac_f32 v61, v3, v50
  v_lshlrev_b32 v2, 16, v27
  v_and_b32 v3, 0xffff0000, v27
  v_fmac_f32 v62, v2, v50
  v_fmac_f32 v63, v3, v50
  v_lshlrev_b32 v51, 16, v51
  v_mul_f32 v2, 0xbfb8aa3b, v51
  v_exp_f32 v2, v2
  s_nop 0
  v_add_f32 v2, 1.0, v2
  v_rcp_f32 v2, v2
  s_nop 0
  v_mul_f32 v51, v51, v2
  v_cvt_pk_bf16_f32 v51, v51, v51
  v_and_b32 v51, 0xffff0000, v51
  v_lshlrev_b32 v2, 16, v28
  v_and_b32 v3, 0xffff0000, v28
  v_fmac_f32 v56, v2, v51
  v_fmac_f32 v57, v3, v51
  v_lshlrev_b32 v2, 16, v29
  v_and_b32 v3, 0xffff0000, v29
  v_fmac_f32 v58, v2, v51
  v_fmac_f32 v59, v3, v51
  v_lshlrev_b32 v2, 16, v30
  v_and_b32 v3, 0xffff0000, v30
  v_fmac_f32 v60, v2, v51
  v_fmac_f32 v61, v3, v51
  v_lshlrev_b32 v2, 16, v31
  v_and_b32 v3, 0xffff0000, v31
  v_fmac_f32 v62, v2, v51
  v_fmac_f32 v63, v3, v51
  v_lshlrev_b32 v52, 16, v52
  v_mul_f32 v2, 0xbfb8aa3b, v52
  v_exp_f32 v2, v2
  s_nop 0
  v_add_f32 v2, 1.0, v2
  v_rcp_f32 v2, v2
  s_nop 0
  v_mul_f32 v52, v52, v2
  v_cvt_pk_bf16_f32 v52, v52, v52
  v_and_b32 v52, 0xffff0000, v52
  v_lshlrev_b32 v2, 16, v32
  v_and_b32 v3, 0xffff0000, v32
  v_fmac_f32 v56, v2, v52
  v_fmac_f32 v57, v3, v52
  v_lshlrev_b32 v2, 16, v33
  v_and_b32 v3, 0xffff0000, v33
  v_fmac_f32 v58, v2, v52
  v_fmac_f32 v59, v3, v52
  v_lshlrev_b32 v2, 16, v34
  v_and_b32 v3, 0xffff0000, v34
  v_fmac_f32 v60, v2, v52
  v_fmac_f32 v61, v3, v52
  v_lshlrev_b32 v2, 16, v35
  v_and_b32 v3, 0xffff0000, v35
  v_fmac_f32 v62, v2, v52
  v_fmac_f32 v63, v3, v52
  v_lshlrev_b32 v53, 16, v53
  v_mul_f32 v2, 0xbfb8aa3b, v53
  v_exp_f32 v2, v2
  s_nop 0
  v_add_f32 v2, 1.0, v2
  v_rcp_f32 v2, v2
  s_nop 0
  v_mul_f32 v53, v53, v2
  v_cvt_pk_bf16_f32 v53, v53, v53
  v_and_b32 v53, 0xffff0000, v53
  v_lshlrev_b32 v2, 16, v36
  v_and_b32 v3, 0xffff0000, v36
  v_fmac_f32 v56, v2, v53
  v_fmac_f32 v57, v3, v53
  v_lshlrev_b32 v2, 16, v37
  v_and_b32 v3, 0xffff0000, v37
  v_fmac_f32 v58, v2, v53
  v_fmac_f32 v59, v3, v53
  v_lshlrev_b32 v2, 16, v38
  v_and_b32 v3, 0xffff0000, v38
  v_fmac_f32 v60, v2, v53
  v_fmac_f32 v61, v3, v53
  v_lshlrev_b32 v2, 16, v39
  v_and_b32 v3, 0xffff0000, v39
  v_fmac_f32 v62, v2, v53
  v_fmac_f32 v63, v3, v53
  v_lshlrev_b32 v54, 16, v54
  v_mul_f32 v2, 0xbfb8aa3b, v54
  v_exp_f32 v2, v2
  s_nop 0
  v_add_f32 v2, 1.0, v2
  v_rcp_f32 v2, v2
  s_nop 0
  v_mul_f32 v54, v54, v2
  v_cvt_pk_bf16_f32 v54, v54, v54
  v_and_b32 v54, 0xffff0000, v54
  v_lshlrev_b32 v2, 16, v40
  v_and_b32 v3, 0xffff0000, v40
  v_fmac_f32 v56, v2, v54
  v_fmac_f32 v57, v3, v54
  v_lshlrev_b32 v2, 16, v41
  v_and_b32 v3, 0xffff0000, v41
  v_fmac_f32 v58, v2, v54
  v_fmac_f32 v59, v3, v54
  v_lshlrev_b32 v2, 16, v42
  v_and_b32 v3, 0xffff0000, v42
  v_fmac_f32 v60, v2, v54
  v_fmac_f32 v61, v3, v54
  v_lshlrev_b32 v2, 16, v43
  v_and_b32 v3, 0xffff0000, v43
  v_fmac_f32 v62, v2, v54
  v_fmac_f32 v63, v3, v54
  v_lshlrev_b32 v55, 16, v55
  v_mul_f32 v2, 0xbfb8aa3b, v55
  v_exp_f32 v2, v2
  s_nop 0
  v_add_f32 v2, 1.0, v2
  v_rcp_f32 v2, v2
  s_nop 0
  v_mul_f32 v55, v55, v2
  v_cvt_pk_bf16_f32 v55, v55, v55
  v_and_b32 v55, 0xffff0000, v55
  v_lshlrev_b32 v2, 16, v44
  v_and_b32 v3, 0xffff0000, v44
  v_fmac_f32 v56, v2, v55
  v_fmac_f32 v57, v3, v55
  v_lshlrev_b32 v2, 16, v45
  v_and_b32 v3, 0xffff0000, v45
  v_fmac_f32 v58, v2, v55
  v_fmac_f32 v59, v3, v55
  v_lshlrev_b32 v2, 16, v46
  v_and_b32 v3, 0xffff0000, v46
  v_fmac_f32 v60, v2, v55
  v_fmac_f32 v61, v3, v55
  v_lshlrev_b32 v2, 16, v47
  v_and_b32 v3, 0xffff0000, v47
  v_fmac_f32 v62, v2, v55
  v_fmac_f32 v63, v3, v55
  v_add_f32_dpp v56, v56, v56 row_ror:2 row_mask:0xf bank_mask:0xf
  v_add_f32_dpp v57, v57, v57 row_ror:2 row_mask:0xf bank_mask:0xf
  v_add_f32_dpp v58, v58, v58 row_ror:2 row_mask:0xf bank_mask:0xf
  v_add_f32_dpp v59, v59, v59 row_ror:2 row_mask:0xf bank_mask:0xf
  v_add_f32_dpp v60, v60, v60 row_ror:2 row_mask:0xf bank_mask:0xf
  v_add_f32_dpp v61, v61, v61 row_ror:2 row_mask:0xf bank_mask:0xf
  v_add_f32_dpp v62, v62, v62 row_ror:2 row_mask:0xf bank_mask:0xf
  v_add_f32_dpp v63, v63, v63 row_ror:2 row_mask:0xf bank_mask:0xf
  v_add_f32_dpp v56, v56, v56 row_ror:4 row_mask:0xf bank_mask:0xf
  v_add_f32_dpp v57, v57, v57 row_ror:4 row_mask:0xf bank_mask:0xf
  v_add_f32_dpp v58, v58, v58 row_ror:4 row_mask:0xf bank_mask:0xf
  v_add_f32_dpp v59, v59, v59 row_ror:4 row_mask:0xf bank_mask:0xf
  v_add_f32_dpp v60, v60, v60 row_ror:4 row_mask:0xf bank_mask:0xf
  v_add_f32_dpp v61, v61, v61 row_ror:4 row_mask:0xf bank_mask:0xf
  v_add_f32_dpp v62, v62, v62 row_ror:4 row_mask:0xf bank_mask:0xf
  v_add_f32_dpp v63, v63, v63 row_ror:4 row_mask:0xf bank_mask:0xf
  v_add_f32_dpp v56, v56, v56 row_ror:8 row_mask:0xf bank_mask:0xf
  v_add_f32_dpp v57, v57, v57 row_ror:8 row_mask:0xf bank_mask:0xf
  v_add_f32_dpp v58, v58, v58 row_ror:8 row_mask:0xf bank_mask:0xf
  v_add_f32_dpp v59, v59, v59 row_ror:8 row_mask:0xf bank_mask:0xf
  v_add_f32_dpp v60, v60, v60 row_ror:8 row_mask:0xf bank_mask:0xf
  v_add_f32_dpp v61, v61, v61 row_ror:8 row_mask:0xf bank_mask:0xf
  v_add_f32_dpp v62, v62, v62 row_ror:8 row_mask:0xf bank_mask:0xf
  v_add_f32_dpp v63, v63, v63 row_ror:8 row_mask:0xf bank_mask:0xf
  v_lshrrev_b32 v2, 4, v0
  v_and_b32 v3, 1, v0
  v_mul_u32_u24 v2, 64, v2
  v_lshl_add_u32 v2, v3, 5, v2
  v_add_u32 v2, 65536, v2
  ds_write_b128 v2, v[56:59]
  ds_write_b128 v2, v[60:63] offset:16
  s_lshl_b32 s35, s24, 5
  s_add_u32 s35, s35, s25
  s_lshl_b32 s35, s35, 6
  s_add_u32 s35, s35, 8192
  s_waitcnt vmcnt(24) lgkmcnt(0)
  s_barrier
  v_cmp_eq_u32 vcc, 0, v0
  v_mov_b32 v2, 2130706432
  v_mov_b32 v3, 1
  v_cndmask_b32 v2, v2, v0, vcc
  buffer_store_dword v3, v2, s[68:71], s38 offen sc0 sc1
  buffer_store_dword v3, v2, s[68:71], s39 offen sc0 sc1
  v_lshlrev_b32 v2, 2, v1
  v_add_u32 v2, 65536, v2
  ds_read_b32 v16, v2 offset:0
  ds_read_b32 v17, v2 offset:64
  ds_read_b32 v18, v2 offset:128
  ds_read_b32 v19, v2 offset:192
  ds_read_b32 v20, v2 offset:256
  ds_read_b32 v21, v2 offset:320
  ds_read_b32 v22, v2 offset:384
  ds_read_b32 v23, v2 offset:448
  ds_read_b32 v24, v2 offset:512
  ds_read_b32 v25, v2 offset:576
  ds_read_b32 v26, v2 offset:640
  ds_read_b32 v27, v2 offset:704
  ds_read_b32 v28, v2 offset:768
  ds_read_b32 v29, v2 offset:832
  ds_read_b32 v30, v2 offset:896
  ds_read_b32 v31, v2 offset:960
  s_waitcnt lgkmcnt(0)
  v_add_f32 v16, v16, v18
  v_add_f32 v17, v17, v19
  v_add_f32 v16, v16, v20
  v_add_f32 v17, v17, v21
  v_add_f32 v16, v16, v22
  v_add_f32 v17, v17, v23
  v_add_f32 v16, v16, v24
  v_add_f32 v17, v17, v25
  v_add_f32 v16, v16, v26
  v_add_f32 v17, v17, v27
  v_add_f32 v16, v16, v28
  v_add_f32 v17, v17, v29
  v_add_f32 v16, v16, v30
  v_add_f32 v17, v17, v31
  v_add_f32 v16, v16, v17
  v_cvt_pk_bf16_f32 v16, v16, v16
  v_and_b32 v16, 0xffff0000, v16
  v_lshlrev_b32 v2, 2, v0
  v_cmp_gt_u32 vcc, 16, v0
  v_mov_b32 v3, 2130706432
  s_nop 0
  v_cndmask_b32 v2, v3, v2, vcc
  buffer_store_dword v16, v2, s[68:71], s35 offen sc0 sc1
  s_lshl_b32 s34, s26, 12
  s_add_u32 s34, s34, 589824
  v_and_b32 v2, 7, v1
  v_lshl_add_u32 v2, s3, 3, v2
  v_min_u32 v2, 31, v2
  v_lshlrev_b32 v2, 7, v2
  v_add_u32 v251, s34, v2
  buffer_load_dword v250, v251, s[68:71], 0 offen sc1
  s_waitcnt vmcnt(0)
  v_cmp_ne_u32 vcc, 1, v250
  s_cbranch_vccnz op_w_sp
op_w_ok:
  s_barrier
  s_lshr_b32 s35, s2, 2
  s_lshl_b32 s35, s35, 7
  s_and_b32 s34, s2, 3
  s_add_u32 s35, s35, s34
  s_add_u32 s35, s35, 720896
  v_cmp_eq_u32 vcc, 0, v0
  v_mov_b32 v2, 2130706432
  v_mov_b32 v3, 1
  v_cndmask_b32 v2, v2, v0, vcc
  buffer_store_byte v3, v2, s[68:71], s35 offen sc0 sc1
  buffer_load_dwordx4 a[0:3], v12, s[68:71], s32 offen offset:0 sc1
  buffer_load_dwordx4 a[4:7], v12, s[68:71], s32 offen offset:1024 sc1
  buffer_load_dwordx4 a[8:11], v12, s[68:71], s32 offen offset:2048 sc1
  buffer_load_dwordx4 a[12:15], v12, s[68:71], s32 offen offset:3072 sc1
  s_add_u32 s32, s32, 4096
  buffer_load_dwordx4 a[16:19], v12, s[68:71], s32 offen offset:0 sc1
  buffer_load_dwordx4 a[20:23], v12, s[68:71], s32 offen offset:1024 sc1
  buffer_load_dwordx4 a[24:27], v12, s[68:71], s32 offen offset:2048 sc1
  buffer_load_dwordx4 a[28:31], v12, s[68:71], s32 offen offset:3072 sc1
  s_add_u32 s32, s32, 4096
  buffer_load_dwordx4 a[32:35], v12, s[68:71], s32 offen offset:0 sc1
  buffer_load_dwordx4 a[36:39], v12, s[68:71], s32 offen offset:1024 sc1
  buffer_load_dwordx4 a[40:43], v12, s[68:71], s32 offen offset:2048 sc1
  buffer_load_dwordx4 a[44:47], v12, s[68:71], s32 offen offset:3072 sc1
  s_add_u32 s32, s32, 4096
  buffer_load_dwordx4 a[48:51], v12, s[68:71], s32 offen offset:0 sc1
  buffer_load_dwordx4 a[52:55], v12, s[68:71], s32 offen offset:1024 sc1
  buffer_load_dwordx4 a[56:59], v12, s[68:71], s32 offen offset:2048 sc1
  buffer_load_dwordx4 a[60:63], v12, s[68:71], s32 offen offset:3072 sc1
  s_add_u32 s32, s32, 4096
  buffer_load_dwordx4 a[64:67], v12, s[68:71], s32 offen offset:0 sc1
  buffer_load_dwordx4 a[68:71], v12, s[68:71], s32 offen offset:1024 sc1
  buffer_load_dwordx4 a[72:75], v12, s[68:71], s32 offen offset:2048 sc1
  buffer_load_dwordx4 a[76:79], v12, s[68:71], s32 offen offset:3072 sc1
  s_add_u32 s32, s32, 4096
  buffer_load_dwordx4 a[80:83], v12, s[68:71], s32 offen offset:0 sc1
  buffer_load_dwordx4 a[84:87], v12, s[68:71], s32 offen offset:1024 sc1
  buffer_load_dwordx4 a[88:91], v12, s[68:71], s32 offen offset:2048 sc1
  buffer_load_dwordx4 a[92:95], v12, s[68:71], s32 offen offset:3072 sc1
  s_add_u32 s32, s32, 4096
  buffer_load_dwordx4 a[96:99], v12, s[68:71], s32 offen offset:0 sc1
  buffer_load_dwordx4 a[100:103], v12, s[68:71], s32 offen offset:1024 sc1
  buffer_load_dwordx4 a[104:107], v12, s[68:71], s32 offen offset:2048 sc1
  buffer_load_dwordx4 a[108:111], v12, s[68:71], s32 offen offset:3072 sc1
  s_waitcnt vmcnt(20) lgkmcnt(0)
  s_barrier
  ds_read_b64_tr_b16 v[48:49], v6 offset:0
  ds_read_b64_tr_b16 v[50:51], v6 offset:1024
  ds_read_b64_tr_b16 v[52:53], v7 offset:0
  ds_read_b64_tr_b16 v[54:55], v7 offset:1024
  ds_read_b64_tr_b16 v[56:57], v6 offset:2048
  ds_read_b64_tr_b16 v[58:59], v6 offset:3072
  ds_read_b64_tr_b16 v[60:61], v7 offset:2048
  ds_read_b64_tr_b16 v[62:63], v7 offset:3072
  ds_read_b64_tr_b16 v[64:65], v6 offset:4096
  ds_read_b64_tr_b16 v[66:67], v6 offset:5120
  ds_read_b64_tr_b16 v[68:69], v7 offset:4096
  ds_read_b64_tr_b16 v[70:71], v7 offset:5120
  ds_read_b64_tr_b16 v[72:73], v6 offset:6144
  ds_read_b64_tr_b16 v[74:75], v6 offset:7168
  ds_read_b64_tr_b16 v[76:77], v7 offset:6144
  ds_read_b64_tr_b16 v[78:79], v7 offset:7168
  s_waitcnt lgkmcnt(0)
  v_mfma_f32_32x32x16_bf16 v[16:31], v[48:51], a[0:3], 0
  ds_read_b64_tr_b16 v[80:81], v6 offset:8192
  ds_read_b64_tr_b16 v[82:83], v6 offset:9216
  ds_read_b64_tr_b16 v[84:85], v7 offset:8192
  s_add_u32 s32, s32, 4096
  buffer_load_dwordx4 a[112:115], v12, s[68:71], s32 offen offset:0 sc1
  v_mfma_f32_32x32x16_bf16 v[32:47], v[52:55], a[0:3], 0
  ds_read_b64_tr_b16 v[86:87], v7 offset:9216
  ds_read_b64_tr_b16 v[88:89], v6 offset:10240
  ds_read_b64_tr_b16 v[90:91], v6 offset:11264
  buffer_load_dwordx4 a[116:119], v12, s[68:71], s32 offen offset:1024 sc1
  v_mfma_f32_32x32x16_bf16 v[16:31], v[56:59], a[4:7], v[16:31]
  ds_read_b64_tr_b16 v[92:93], v7 offset:10240
  ds_read_b64_tr_b16 v[94:95], v7 offset:11264
  buffer_load_dwordx4 a[120:123], v12, s[68:71], s32 offen offset:2048 sc1
  v_mfma_f32_32x32x16_bf16 v[32:47], v[60:63], a[4:7], v[32:47]
  ds_read_b64_tr_b16 v[96:97], v6 offset:12288
  ds_read_b64_tr_b16 v[98:99], v6 offset:13312
  ds_read_b64_tr_b16 v[100:101], v7 offset:12288
  buffer_load_dwordx4 a[124:127], v12, s[68:71], s32 offen offset:3072 sc1
  s_add_u32 s32, s32, 4096
  v_mfma_f32_32x32x16_bf16 v[16:31], v[64:67], a[8:11], v[16:31]
  ds_read_b64_tr_b16 v[102:103], v7 offset:13312
  ds_read_b64_tr_b16 v[104:105], v6 offset:14336
  ds_read_b64_tr_b16 v[106:107], v6 offset:15360
  v_mfma_f32_32x32x16_bf16 v[32:47], v[68:71], a[8:11], v[32:47]
  ds_read_b64_tr_b16 v[108:109], v7 offset:14336
  ds_read_b64_tr_b16 v[110:111], v7 offset:15360
  v_mfma_f32_32x32x16_bf16 v[16:31], v[72:75], a[12:15], v[16:31]
  v_mfma_f32_32x32x16_bf16 v[32:47], v[76:79], a[12:15], v[32:47]
  s_waitcnt vmcnt(16) lgkmcnt(0)
  s_barrier
  v_mfma_f32_32x32x16_bf16 v[16:31], v[80:83], a[16:19], v[16:31]
  ds_read_b64_tr_b16 v[48:49], v6 offset:16384
  ds_read_b64_tr_b16 v[50:51], v6 offset:17408
  ds_read_b64_tr_b16 v[52:53], v7 offset:16384
  s_add_u32 m0, s31, 0
  s_nop 0
  buffer_load_dwordx4 v8, s[48:51], s30 offen offset:0 lds
  buffer_load_dwordx4 v9, s[48:51], s30 offen offset:1024 lds
  v_mfma_f32_32x32x16_bf16 v[32:47], v[84:87], a[16:19], v[32:47]
  ds_read_b64_tr_b16 v[54:55], v7 offset:17408
  ds_read_b64_tr_b16 v[56:57], v6 offset:18432
  ds_read_b64_tr_b16 v[58:59], v6 offset:19456
  buffer_load_dwordx4 v10, s[48:51], s30 offen offset:2048 lds
  v_mfma_f32_32x32x16_bf16 v[16:31], v[88:91], a[20:23], v[16:31]
  ds_read_b64_tr_b16 v[60:61], v7 offset:18432
  ds_read_b64_tr_b16 v[62:63], v7 offset:19456
  buffer_load_dwordx4 v11, s[48:51], s30 offen offset:3072 lds
  v_mfma_f32_32x32x16_bf16 v[32:47], v[92:95], a[20:23], v[32:47]
  ds_read_b64_tr_b16 v[64:65], v6 offset:20480
  ds_read_b64_tr_b16 v[66:67], v6 offset:21504
  ds_read_b64_tr_b16 v[68:69], v7 offset:20480
  s_add_u32 s30, s30, 262144
  v_mfma_f32_32x32x16_bf16 v[16:31], v[96:99], a[24:27], v[16:31]
  ds_read_b64_tr_b16 v[70:71], v7 offset:21504
  ds_read_b64_tr_b16 v[72:73], v6 offset:22528
  ds_read_b64_tr_b16 v[74:75], v6 offset:23552
  buffer_load_dwordx4 a[0:3], v12, s[68:71], s32 offen offset:0 sc1
  v_mfma_f32_32x32x16_bf16 v[32:47], v[100:103], a[24:27], v[32:47]
  ds_read_b64_tr_b16 v[76:77], v7 offset:22528
  ds_read_b64_tr_b16 v[78:79], v7 offset:23552
  buffer_load_dwordx4 a[4:7], v12, s[68:71], s32 offen offset:1024 sc1
  v_mfma_f32_32x32x16_bf16 v[16:31], v[104:107], a[28:31], v[16:31]
  buffer_load_dwordx4 a[8:11], v12, s[68:71], s32 offen offset:2048 sc1
  v_mfma_f32_32x32x16_bf16 v[32:47], v[108:111], a[28:31], v[32:47]
  buffer_load_dwordx4 a[12:15], v12, s[68:71], s32 offen offset:3072 sc1
  s_waitcnt lgkmcnt(0)
  v_mfma_f32_32x32x16_bf16 v[16:31], v[48:51], a[32:35], v[16:31]
  ds_read_b64_tr_b16 v[80:81], v6 offset:24576
  ds_read_b64_tr_b16 v[82:83], v6 offset:25600
  ds_read_b64_tr_b16 v[84:85], v7 offset:24576
  s_add_u32 s32, s32, 4096
  buffer_load_dwordx4 a[16:19], v12, s[68:71], s32 offen offset:0 sc1
  v_mfma_f32_32x32x16_bf16 v[32:47], v[52:55], a[32:35], v[32:47]
  ds_read_b64_tr_b16 v[86:87], v7 offset:25600
  ds_read_b64_tr_b16 v[88:89], v6 offset:26624
  ds_read_b64_tr_b16 v[90:91], v6 offset:27648
  buffer_load_dwordx4 a[20:23], v12, s[68:71], s32 offen offset:1024 sc1
  v_mfma_f32_32x32x16_bf16 v[16:31], v[56:59], a[36:39], v[16:31]
  ds_read_b64_tr_b16 v[92:93], v7 offset:26624
  ds_read_b64_tr_b16 v[94:95], v7 offset:27648
  buffer_load_dwordx4 a[24:27], v12, s[68:71], s32 offen offset:2048 sc1
  v_mfma_f32_32x32x16_bf16 v[32:47], v[60:63], a[36:39], v[32:47]
  ds_read_b64_tr_b16 v[96:97], v6 offset:28672
  ds_read_b64_tr_b16 v[98:99], v6 offset:29696
  ds_read_b64_tr_b16 v[100:101], v7 offset:28672
  buffer_load_dwordx4 a[28:31], v12, s[68:71], s32 offen offset:3072 sc1
  s_add_u32 s32, s32, 4096
  v_mfma_f32_32x32x16_bf16 v[16:31], v[64:67], a[40:43], v[16:31]
  ds_read_b64_tr_b16 v[102:103], v7 offset:29696
  ds_read_b64_tr_b16 v[104:105], v6 offset:30720
  ds_read_b64_tr_b16 v[106:107], v6 offset:31744
  v_mfma_f32_32x32x16_bf16 v[32:47], v[68:71], a[40:43], v[32:47]
  ds_read_b64_tr_b16 v[108:109], v7 offset:30720
  ds_read_b64_tr_b16 v[110:111], v7 offset:31744
  v_mfma_f32_32x32x16_bf16 v[16:31], v[72:75], a[44:47], v[16:31]
  v_mfma_f32_32x32x16_bf16 v[32:47], v[76:79], a[44:47], v[32:47]
  s_waitcnt vmcnt(20) lgkmcnt(0)
  s_barrier
  v_mfma_f32_32x32x16_bf16 v[16:31], v[80:83], a[48:51], v[16:31]
  ds_read_b64_tr_b16 v[48:49], v6 offset:32768
  ds_read_b64_tr_b16 v[50:51], v6 offset:33792
  ds_read_b64_tr_b16 v[52:53], v7 offset:32768
  s_add_u32 m0, s31, 16384
  s_nop 0
  buffer_load_dwordx4 v8, s[48:51], s30 offen offset:0 lds
  buffer_load_dwordx4 v9, s[48:51], s30 offen offset:1024 lds
  v_mfma_f32_32x32x16_bf16 v[32:47], v[84:87], a[48:51], v[32:47]
  ds_read_b64_tr_b16 v[54:55], v7 offset:33792
  ds_read_b64_tr_b16 v[56:57], v6 offset:34816
  ds_read_b64_tr_b16 v[58:59], v6 offset:35840
  buffer_load_dwordx4 v10, s[48:51], s30 offen offset:2048 lds
  v_mfma_f32_32x32x16_bf16 v[16:31], v[88:91], a[52:55], v[16:31]
  ds_read_b64_tr_b16 v[60:61], v7 offset:34816
  ds_read_b64_tr_b16 v[62:63], v7 offset:35840
  buffer_load_dwordx4 v11, s[48:51], s30 offen offset:3072 lds
  v_mfma_f32_32x32x16_bf16 v[32:47], v[92:95], a[52:55], v[32:47]
  ds_read_b64_tr_b16 v[64:65], v6 offset:36864
  ds_read_b64_tr_b16 v[66:67], v6 offset:37888
  ds_read_b64_tr_b16 v[68:69], v7 offset:36864
  s_add_u32 s30, s30, 262144
  v_mfma_f32_32x32x16_bf16 v[16:31], v[96:99], a[56:59], v[16:31]
  ds_read_b64_tr_b16 v[70:71], v7 offset:37888
  ds_read_b64_tr_b16 v[72:73], v6 offset:38912
  ds_read_b64_tr_b16 v[74:75], v6 offset:39936
  buffer_load_dwordx4 a[32:35], v12, s[68:71], s32 offen offset:0 sc1
  v_mfma_f32_32x32x16_bf16 v[32:47], v[100:103], a[56:59], v[32:47]
  ds_read_b64_tr_b16 v[76:77], v7 offset:38912
  ds_read_b64_tr_b16 v[78:79], v7 offset:39936
  buffer_load_dwordx4 a[36:39], v12, s[68:71], s32 offen offset:1024 sc1
  v_mfma_f32_32x32x16_bf16 v[16:31], v[104:107], a[60:63], v[16:31]
  buffer_load_dwordx4 a[40:43], v12, s[68:71], s32 offen offset:2048 sc1
  v_mfma_f32_32x32x16_bf16 v[32:47], v[108:111], a[60:63], v[32:47]
  buffer_load_dwordx4 a[44:47], v12, s[68:71], s32 offen offset:3072 sc1
  s_waitcnt lgkmcnt(0)
  v_mfma_f32_32x32x16_bf16 v[16:31], v[48:51], a[64:67], v[16:31]
  ds_read_b64_tr_b16 v[80:81], v6 offset:40960
  ds_read_b64_tr_b16 v[82:83], v6 offset:41984
  ds_read_b64_tr_b16 v[84:85], v7 offset:40960
  s_add_u32 s32, s32, 4096
  buffer_load_dwordx4 a[48:51], v12, s[68:71], s32 offen offset:0 sc1
  v_mfma_f32_32x32x16_bf16 v[32:47], v[52:55], a[64:67], v[32:47]
  ds_read_b64_tr_b16 v[86:87], v7 offset:41984
  ds_read_b64_tr_b16 v[88:89], v6 offset:43008
  ds_read_b64_tr_b16 v[90:91], v6 offset:44032
  buffer_load_dwordx4 a[52:55], v12, s[68:71], s32 offen offset:1024 sc1
  v_mfma_f32_32x32x16_bf16 v[16:31], v[56:59], a[68:71], v[16:31]
  ds_read_b64_tr_b16 v[92:93], v7 offset:43008
  ds_read_b64_tr_b16 v[94:95], v7 offset:44032
  buffer_load_dwordx4 a[56:59], v12, s[68:71], s32 offen offset:2048 sc1
  v_mfma_f32_32x32x16_bf16 v[32:47], v[60:63], a[68:71], v[32:47]
  ds_read_b64_tr_b16 v[96:97], v6 offset:45056
  ds_read_b64_tr_b16 v[98:99], v6 offset:46080
  ds_read_b64_tr_b16 v[100:101], v7 offset:45056
  buffer_load_dwordx4 a[60:63], v12, s[68:71], s32 offen offset:3072 sc1
  s_add_u32 s32, s32, 4096
  v_mfma_f32_32x32x16_bf16 v[16:31], v[64:67], a[72:75], v[16:31]
  ds_read_b64_tr_b16 v[102:103], v7 offset:46080
  ds_read_b64_tr_b16 v[104:105], v6 offset:47104
  ds_read_b64_tr_b16 v[106:107], v6 offset:48128
  v_mfma_f32_32x32x16_bf16 v[32:47], v[68:71], a[72:75], v[32:47]
  ds_read_b64_tr_b16 v[108:109], v7 offset:47104
  ds_read_b64_tr_b16 v[110:111], v7 offset:48128
  v_mfma_f32_32x32x16_bf16 v[16:31], v[72:75], a[76:79], v[16:31]
  v_mfma_f32_32x32x16_bf16 v[32:47], v[76:79], a[76:79], v[32:47]
  s_waitcnt vmcnt(24) lgkmcnt(0)
  s_barrier
  v_mfma_f32_32x32x16_bf16 v[16:31], v[80:83], a[80:83], v[16:31]
  ds_read_b64_tr_b16 v[48:49], v6 offset:49152
  ds_read_b64_tr_b16 v[50:51], v6 offset:50176
  ds_read_b64_tr_b16 v[52:53], v7 offset:49152
  s_add_u32 m0, s31, 32768
  s_nop 0
  buffer_load_dwordx4 v8, s[48:51], s30 offen offset:0 lds
  buffer_load_dwordx4 v9, s[48:51], s30 offen offset:1024 lds
  v_mfma_f32_32x32x16_bf16 v[32:47], v[84:87], a[80:83], v[32:47]
  ds_read_b64_tr_b16 v[54:55], v7 offset:50176
  ds_read_b64_tr_b16 v[56:57], v6 offset:51200
  ds_read_b64_tr_b16 v[58:59], v6 offset:52224
  buffer_load_dwordx4 v10, s[48:51], s30 offen offset:2048 lds
  v_mfma_f32_32x32x16_bf16 v[16:31], v[88:91], a[84:87], v[16:31]
  ds_read_b64_tr_b16 v[60:61], v7 offset:51200
  ds_read_b64_tr_b16 v[62:63], v7 offset:52224
  buffer_load_dwordx4 v11, s[48:51], s30 offen offset:3072 lds
  v_mfma_f32_32x32x16_bf16 v[32:47], v[92:95], a[84:87], v[32:47]
  ds_read_b64_tr_b16 v[64:65], v6 offset:53248
  ds_read_b64_tr_b16 v[66:67], v6 offset:54272
  ds_read_b64_tr_b16 v[68:69], v7 offset:53248
  s_add_u32 s30, s30, 262144
  v_mfma_f32_32x32x16_bf16 v[16:31], v[96:99], a[88:91], v[16:31]
  ds_read_b64_tr_b16 v[70:71], v7 offset:54272
  ds_read_b64_tr_b16 v[72:73], v6 offset:55296
  ds_read_b64_tr_b16 v[74:75], v6 offset:56320
  buffer_load_dwordx4 a[64:67], v12, s[68:71], s32 offen offset:0 sc1
  v_mfma_f32_32x32x16_bf16 v[32:47], v[100:103], a[88:91], v[32:47]
  ds_read_b64_tr_b16 v[76:77], v7 offset:55296
  ds_read_b64_tr_b16 v[78:79], v7 offset:56320
  buffer_load_dwordx4 a[68:71], v12, s[68:71], s32 offen offset:1024 sc1
  v_mfma_f32_32x32x16_bf16 v[16:31], v[104:107], a[92:95], v[16:31]
  buffer_load_dwordx4 a[72:75], v12, s[68:71], s32 offen offset:2048 sc1
  v_mfma_f32_32x32x16_bf16 v[32:47], v[108:111], a[92:95], v[32:47]
  buffer_load_dwordx4 a[76:79], v12, s[68:71], s32 offen offset:3072 sc1
  s_waitcnt lgkmcnt(0)
  v_mfma_f32_32x32x16_bf16 v[16:31], v[48:51], a[96:99], v[16:31]
  ds_read_b64_tr_b16 v[80:81], v6 offset:57344
  ds_read_b64_tr_b16 v[82:83], v6 offset:58368
  ds_read_b64_tr_b16 v[84:85], v7 offset:57344
  s_add_u32 s32, s32, 4096
  buffer_load_dwordx4 a[80:83], v12, s[68:71], s32 offen offset:0 sc1
  v_mfma_f32_32x32x16_bf16 v[32:47], v[52:55], a[96:99], v[32:47]
  ds_read_b64_tr_b16 v[86:87], v7 offset:58368
  ds_read_b64_tr_b16 v[88:89], v6 offset:59392
  ds_read_b64_tr_b16 v[90:91], v6 offset:60416
  buffer_load_dwordx4 a[84:87], v12, s[68:71], s32 offen offset:1024 sc1
  v_mfma_f32_32x32x16_bf16 v[16:31], v[56:59], a[100:103], v[16:31]
  ds_read_b64_tr_b16 v[92:93], v7 offset:59392
  ds_read_b64_tr_b16 v[94:95], v7 offset:60416
  buffer_load_dwordx4 a[88:91], v12, s[68:71], s32 offen offset:2048 sc1
  v_mfma_f32_32x32x16_bf16 v[32:47], v[60:63], a[100:103], v[32:47]
  ds_read_b64_tr_b16 v[96:97], v6 offset:61440
  ds_read_b64_tr_b16 v[98:99], v6 offset:62464
  ds_read_b64_tr_b16 v[100:101], v7 offset:61440
  buffer_load_dwordx4 a[92:95], v12, s[68:71], s32 offen offset:3072 sc1
  s_add_u32 s32, s32, 4096
  v_mfma_f32_32x32x16_bf16 v[16:31], v[64:67], a[104:107], v[16:31]
  ds_read_b64_tr_b16 v[102:103], v7 offset:62464
  ds_read_b64_tr_b16 v[104:105], v6 offset:63488
  ds_read_b64_tr_b16 v[106:107], v6 offset:64512
  v_mfma_f32_32x32x16_bf16 v[32:47], v[68:71], a[104:107], v[32:47]
  ds_read_b64_tr_b16 v[108:109], v7 offset:63488
  ds_read_b64_tr_b16 v[110:111], v7 offset:64512
  v_mfma_f32_32x32x16_bf16 v[16:31], v[72:75], a[108:111], v[16:31]
  v_mfma_f32_32x32x16_bf16 v[32:47], v[76:79], a[108:111], v[32:47]
  s_waitcnt vmcnt(24) lgkmcnt(0)
  s_barrier
  v_mfma_f32_32x32x16_bf16 v[16:31], v[80:83], a[112:115], v[16:31]
  ds_read_b64_tr_b16 v[48:49], v6 offset:0
  ds_read_b64_tr_b16 v[50:51], v6 offset:1024
  ds_read_b64_tr_b16 v[52:53], v7 offset:0
  s_add_u32 m0, s31, 49152
  s_nop 0
  buffer_load_dwordx4 v8, s[48:51], s30 offen offset:0 lds
  buffer_load_dwordx4 v9, s[48:51], s30 offen offset:1024 lds
  v_mfma_f32_32x32x16_bf16 v[32:47], v[84:87], a[112:115], v[32:47]
  ds_read_b64_tr_b16 v[54:55], v7 offset:1024
  ds_read_b64_tr_b16 v[56:57], v6 offset:2048
  ds_read_b64_tr_b16 v[58:59], v6 offset:3072
  buffer_load_dwordx4 v10, s[48:51], s30 offen offset:2048 lds
  v_mfma_f32_32x32x16_bf16 v[16:31], v[88:91], a[116:119], v[16:31]
  ds_read_b64_tr_b16 v[60:61], v7 offset:2048
  ds_read_b64_tr_b16 v[62:63], v7 offset:3072
  buffer_load_dwordx4 v11, s[48:51], s30 offen offset:3072 lds
  v_mfma_f32_32x32x16_bf16 v[32:47], v[92:95], a[116:119], v[32:47]
  ds_read_b64_tr_b16 v[64:65], v6 offset:4096
  ds_read_b64_tr_b16 v[66:67], v6 offset:5120
  ds_read_b64_tr_b16 v[68:69], v7 offset:4096
  s_add_u32 s30, s30, 262144
  v_mfma_f32_32x32x16_bf16 v[16:31], v[96:99], a[120:123], v[16:31]
  ds_read_b64_tr_b16 v[70:71], v7 offset:5120
  ds_read_b64_tr_b16 v[72:73], v6 offset:6144
  ds_read_b64_tr_b16 v[74:75], v6 offset:7168
  buffer_load_dwordx4 a[96:99], v12, s[68:71], s32 offen offset:0 sc1
  v_mfma_f32_32x32x16_bf16 v[32:47], v[100:103], a[120:123], v[32:47]
  ds_read_b64_tr_b16 v[76:77], v7 offset:6144
  ds_read_b64_tr_b16 v[78:79], v7 offset:7168
  buffer_load_dwordx4 a[100:103], v12, s[68:71], s32 offen offset:1024 sc1
  v_mfma_f32_32x32x16_bf16 v[16:31], v[104:107], a[124:127], v[16:31]
  buffer_load_dwordx4 a[104:107], v12, s[68:71], s32 offen offset:2048 sc1
  v_mfma_f32_32x32x16_bf16 v[32:47], v[108:111], a[124:127], v[32:47]
  buffer_load_dwordx4 a[108:111], v12, s[68:71], s32 offen offset:3072 sc1
  s_mov_b32 s20, 6
.p2align 3
op_l:
  s_waitcnt lgkmcnt(0)
  v_mfma_f32_32x32x16_bf16 v[16:31], v[48:51], a[0:3], v[16:31]
  ds_read_b64_tr_b16 v[80:81], v6 offset:8192
  ds_read_b64_tr_b16 v[82:83], v6 offset:9216
  ds_read_b64_tr_b16 v[84:85], v7 offset:8192
  s_add_u32 s32, s32, 4096
  buffer_load_dwordx4 a[112:115], v12, s[68:71], s32 offen offset:0 sc1
  v_mfma_f32_32x32x16_bf16 v[32:47], v[52:55], a[0:3], v[32:47]
  ds_read_b64_tr_b16 v[86:87], v7 offset:9216
  ds_read_b64_tr_b16 v[88:89], v6 offset:10240
  ds_read_b64_tr_b16 v[90:91], v6 offset:11264
  buffer_load_dwordx4 a[116:119], v12, s[68:71], s32 offen offset:1024 sc1
  v_mfma_f32_32x32x16_bf16 v[16:31], v[56:59], a[4:7], v[16:31]
  ds_read_b64_tr_b16 v[92:93], v7 offset:10240
  ds_read_b64_tr_b16 v[94:95], v7 offset:11264
  buffer_load_dwordx4 a[120:123], v12, s[68:71], s32 offen offset:2048 sc1
  v_mfma_f32_32x32x16_bf16 v[32:47], v[60:63], a[4:7], v[32:47]
  ds_read_b64_tr_b16 v[96:97], v6 offset:12288
  ds_read_b64_tr_b16 v[98:99], v6 offset:13312
  ds_read_b64_tr_b16 v[100:101], v7 offset:12288
  buffer_load_dwordx4 a[124:127], v12, s[68:71], s32 offen offset:3072 sc1
  s_add_u32 s32, s32, 4096
  v_mfma_f32_32x32x16_bf16 v[16:31], v[64:67], a[8:11], v[16:31]
  ds_read_b64_tr_b16 v[102:103], v7 offset:13312
  ds_read_b64_tr_b16 v[104:105], v6 offset:14336
  ds_read_b64_tr_b16 v[106:107], v6 offset:15360
  v_mfma_f32_32x32x16_bf16 v[32:47], v[68:71], a[8:11], v[32:47]
  ds_read_b64_tr_b16 v[108:109], v7 offset:14336
  ds_read_b64_tr_b16 v[110:111], v7 offset:15360
  v_mfma_f32_32x32x16_bf16 v[16:31], v[72:75], a[12:15], v[16:31]
  v_mfma_f32_32x32x16_bf16 v[32:47], v[76:79], a[12:15], v[32:47]
  s_waitcnt vmcnt(24) lgkmcnt(0)
  s_barrier
  v_mfma_f32_32x32x16_bf16 v[16:31], v[80:83], a[16:19], v[16:31]
  ds_read_b64_tr_b16 v[48:49], v6 offset:16384
  ds_read_b64_tr_b16 v[50:51], v6 offset:17408
  ds_read_b64_tr_b16 v[52:53], v7 offset:16384
  s_add_u32 m0, s31, 0
  s_nop 0
  buffer_load_dwordx4 v8, s[48:51], s30 offen offset:0 lds
  buffer_load_dwordx4 v9, s[48:51], s30 offen offset:1024 lds
  v_mfma_f32_32x32x16_bf16 v[32:47], v[84:87], a[16:19], v[32:47]
  ds_read_b64_tr_b16 v[54:55], v7 offset:17408
  ds_read_b64_tr_b16 v[56:57], v6 offset:18432
  ds_read_b64_tr_b16 v[58:59], v6 offset:19456
  buffer_load_dwordx4 v10, s[48:51], s30 offen offset:2048 lds
  v_mfma_f32_32x32x16_bf16 v[16:31], v[88:91], a[20:23], v[16:31]
  ds_read_b64_tr_b16 v[60:61], v7 offset:18432
  ds_read_b64_tr_b16 v[62:63], v7 offset:19456
  buffer_load_dwordx4 v11, s[48:51], s30 offen offset:3072 lds
  v_mfma_f32_32x32x16_bf16 v[32:47], v[92:95], a[20:23], v[32:47]
  ds_read_b64_tr_b16 v[64:65], v6 offset:20480
  ds_read_b64_tr_b16 v[66:67], v6 offset:21504
  ds_read_b64_tr_b16 v[68:69], v7 offset:20480
  s_add_u32 s30, s30, 262144
  v_mfma_f32_32x32x16_bf16 v[16:31], v[96:99], a[24:27], v[16:31]
  ds_read_b64_tr_b16 v[70:71], v7 offset:21504
  ds_read_b64_tr_b16 v[72:73], v6 offset:22528
  ds_read_b64_tr_b16 v[74:75], v6 offset:23552
  buffer_load_dwordx4 a[0:3], v12, s[68:71], s32 offen offset:0 sc1
  v_mfma_f32_32x32x16_bf16 v[32:47], v[100:103], a[24:27], v[32:47]
  ds_read_b64_tr_b16 v[76:77], v7 offset:22528
  ds_read_b64_tr_b16 v[78:79], v7 offset:23552
  buffer_load_dwordx4 a[4:7], v12, s[68:71], s32 offen offset:1024 sc1
  v_mfma_f32_32x32x16_bf16 v[16:31], v[104:107], a[28:31], v[16:31]
  buffer_load_dwordx4 a[8:11], v12, s[68:71], s32 offen offset:2048 sc1
  v_mfma_f32_32x32x16_bf16 v[32:47], v[108:111], a[28:31], v[32:47]
  buffer_load_dwordx4 a[12:15], v12, s[68:71], s32 offen offset:3072 sc1
  s_waitcnt lgkmcnt(0)
  v_mfma_f32_32x32x16_bf16 v[16:31], v[48:51], a[32:35], v[16:31]
  ds_read_b64_tr_b16 v[80:81], v6 offset:24576
  ds_read_b64_tr_b16 v[82:83], v6 offset:25600
  ds_read_b64_tr_b16 v[84:85], v7 offset:24576
  s_add_u32 s32, s32, 4096
  buffer_load_dwordx4 a[16:19], v12, s[68:71], s32 offen offset:0 sc1
  v_mfma_f32_32x32x16_bf16 v[32:47], v[52:55], a[32:35], v[32:47]
  ds_read_b64_tr_b16 v[86:87], v7 offset:25600
  ds_read_b64_tr_b16 v[88:89], v6 offset:26624
  ds_read_b64_tr_b16 v[90:91], v6 offset:27648
  buffer_load_dwordx4 a[20:23], v12, s[68:71], s32 offen offset:1024 sc1
  v_mfma_f32_32x32x16_bf16 v[16:31], v[56:59], a[36:39], v[16:31]
  ds_read_b64_tr_b16 v[92:93], v7 offset:26624
  ds_read_b64_tr_b16 v[94:95], v7 offset:27648
  buffer_load_dwordx4 a[24:27], v12, s[68:71], s32 offen offset:2048 sc1
  v_mfma_f32_32x32x16_bf16 v[32:47], v[60:63], a[36:39], v[32:47]
  ds_read_b64_tr_b16 v[96:97], v6 offset:28672
  ds_read_b64_tr_b16 v[98:99], v6 offset:29696
  ds_read_b64_tr_b16 v[100:101], v7 offset:28672
  buffer_load_dwordx4 a[28:31], v12, s[68:71], s32 offen offset:3072 sc1
  s_add_u32 s32, s32, 4096
  v_mfma_f32_32x32x16_bf16 v[16:31], v[64:67], a[40:43], v[16:31]
  ds_read_b64_tr_b16 v[102:103], v7 offset:29696
  ds_read_b64_tr_b16 v[104:105], v6 offset:30720
  ds_read_b64_tr_b16 v[106:107], v6 offset:31744
  v_mfma_f32_32x32x16_bf16 v[32:47], v[68:71], a[40:43], v[32:47]
  ds_read_b64_tr_b16 v[108:109], v7 offset:30720
  ds_read_b64_tr_b16 v[110:111], v7 offset:31744
  v_mfma_f32_32x32x16_bf16 v[16:31], v[72:75], a[44:47], v[16:31]
  v_mfma_f32_32x32x16_bf16 v[32:47], v[76:79], a[44:47], v[32:47]
  s_waitcnt vmcnt(24) lgkmcnt(0)
  s_barrier
  v_mfma_f32_32x32x16_bf16 v[16:31], v[80:83], a[48:51], v[16:31]
  ds_read_b64_tr_b16 v[48:49], v6 offset:32768
  ds_read_b64_tr_b16 v[50:51], v6 offset:33792
  ds_read_b64_tr_b16 v[52:53], v7 offset:32768
  s_add_u32 m0, s31, 16384
  s_nop 0
  buffer_load_dwordx4 v8, s[48:51], s30 offen offset:0 lds
  buffer_load_dwordx4 v9, s[48:51], s30 offen offset:1024 lds
  v_mfma_f32_32x32x16_bf16 v[32:47], v[84:87], a[48:51], v[32:47]
  ds_read_b64_tr_b16 v[54:55], v7 offset:33792
  ds_read_b64_tr_b16 v[56:57], v6 offset:34816
  ds_read_b64_tr_b16 v[58:59], v6 offset:35840
  buffer_load_dwordx4 v10, s[48:51], s30 offen offset:2048 lds
  v_mfma_f32_32x32x16_bf16 v[16:31], v[88:91], a[52:55], v[16:31]
  ds_read_b64_tr_b16 v[60:61], v7 offset:34816
  ds_read_b64_tr_b16 v[62:63], v7 offset:35840
  buffer_load_dwordx4 v11, s[48:51], s30 offen offset:3072 lds
  v_mfma_f32_32x32x16_bf16 v[32:47], v[92:95], a[52:55], v[32:47]
  ds_read_b64_tr_b16 v[64:65], v6 offset:36864
  ds_read_b64_tr_b16 v[66:67], v6 offset:37888
  ds_read_b64_tr_b16 v[68:69], v7 offset:36864
  s_add_u32 s30, s30, 262144
  v_mfma_f32_32x32x16_bf16 v[16:31], v[96:99], a[56:59], v[16:31]
  ds_read_b64_tr_b16 v[70:71], v7 offset:37888
  ds_read_b64_tr_b16 v[72:73], v6 offset:38912
  ds_read_b64_tr_b16 v[74:75], v6 offset:39936
  buffer_load_dwordx4 a[32:35], v12, s[68:71], s32 offen offset:0 sc1
  v_mfma_f32_32x32x16_bf16 v[32:47], v[100:103], a[56:59], v[32:47]
  ds_read_b64_tr_b16 v[76:77], v7 offset:38912
  ds_read_b64_tr_b16 v[78:79], v7 offset:39936
  buffer_load_dwordx4 a[36:39], v12, s[68:71], s32 offen offset:1024 sc1
  v_mfma_f32_32x32x16_bf16 v[16:31], v[104:107], a[60:63], v[16:31]
  buffer_load_dwordx4 a[40:43], v12, s[68:71], s32 offen offset:2048 sc1
  v_mfma_f32_32x32x16_bf16 v[32:47], v[108:111], a[60:63], v[32:47]
  buffer_load_dwordx4 a[44:47], v12, s[68:71], s32 offen offset:3072 sc1
  s_waitcnt lgkmcnt(0)
  v_mfma_f32_32x32x16_bf16 v[16:31], v[48:51], a[64:67], v[16:31]
  ds_read_b64_tr_b16 v[80:81], v6 offset:40960
  ds_read_b64_tr_b16 v[82:83], v6 offset:41984
  ds_read_b64_tr_b16 v[84:85], v7 offset:40960
  s_add_u32 s32, s32, 4096
  buffer_load_dwordx4 a[48:51], v12, s[68:71], s32 offen offset:0 sc1
  v_mfma_f32_32x32x16_bf16 v[32:47], v[52:55], a[64:67], v[32:47]
  ds_read_b64_tr_b16 v[86:87], v7 offset:41984
  ds_read_b64_tr_b16 v[88:89], v6 offset:43008
  ds_read_b64_tr_b16 v[90:91], v6 offset:44032
  buffer_load_dwordx4 a[52:55], v12, s[68:71], s32 offen offset:1024 sc1
  v_mfma_f32_32x32x16_bf16 v[16:31], v[56:59], a[68:71], v[16:31]
  ds_read_b64_tr_b16 v[92:93], v7 offset:43008
  ds_read_b64_tr_b16 v[94:95], v7 offset:44032
  buffer_load_dwordx4 a[56:59], v12, s[68:71], s32 offen offset:2048 sc1
  v_mfma_f32_32x32x16_bf16 v[32:47], v[60:63], a[68:71], v[32:47]
  ds_read_b64_tr_b16 v[96:97], v6 offset:45056
  ds_read_b64_tr_b16 v[98:99], v6 offset:46080
  ds_read_b64_tr_b16 v[100:101], v7 offset:45056
  buffer_load_dwordx4 a[60:63], v12, s[68:71], s32 offen offset:3072 sc1
  s_add_u32 s32, s32, 4096
  v_mfma_f32_32x32x16_bf16 v[16:31], v[64:67], a[72:75], v[16:31]
  ds_read_b64_tr_b16 v[102:103], v7 offset:46080
  ds_read_b64_tr_b16 v[104:105], v6 offset:47104
  ds_read_b64_tr_b16 v[106:107], v6 offset:48128
  v_mfma_f32_32x32x16_bf16 v[32:47], v[68:71], a[72:75], v[32:47]
  ds_read_b64_tr_b16 v[108:109], v7 offset:47104
  ds_read_b64_tr_b16 v[110:111], v7 offset:48128
  v_mfma_f32_32x32x16_bf16 v[16:31], v[72:75], a[76:79], v[16:31]
  v_mfma_f32_32x32x16_bf16 v[32:47], v[76:79], a[76:79], v[32:47]
  s_waitcnt vmcnt(24) lgkmcnt(0)
  s_barrier
  v_mfma_f32_32x32x16_bf16 v[16:31], v[80:83], a[80:83], v[16:31]
  ds_read_b64_tr_b16 v[48:49], v6 offset:49152
  ds_read_b64_tr_b16 v[50:51], v6 offset:50176
  ds_read_b64_tr_b16 v[52:53], v7 offset:49152
  s_add_u32 m0, s31, 32768
  s_nop 0
  buffer_load_dwordx4 v8, s[48:51], s30 offen offset:0 lds
  buffer_load_dwordx4 v9, s[48:51], s30 offen offset:1024 lds
  v_mfma_f32_32x32x16_bf16 v[32:47], v[84:87], a[80:83], v[32:47]
  ds_read_b64_tr_b16 v[54:55], v7 offset:50176
  ds_read_b64_tr_b16 v[56:57], v6 offset:51200
  ds_read_b64_tr_b16 v[58:59], v6 offset:52224
  buffer_load_dwordx4 v10, s[48:51], s30 offen offset:2048 lds
  v_mfma_f32_32x32x16_bf16 v[16:31], v[88:91], a[84:87], v[16:31]
  ds_read_b64_tr_b16 v[60:61], v7 offset:51200
  ds_read_b64_tr_b16 v[62:63], v7 offset:52224
  buffer_load_dwordx4 v11, s[48:51], s30 offen offset:3072 lds
  v_mfma_f32_32x32x16_bf16 v[32:47], v[92:95], a[84:87], v[32:47]
  ds_read_b64_tr_b16 v[64:65], v6 offset:53248
  ds_read_b64_tr_b16 v[66:67], v6 offset:54272
  ds_read_b64_tr_b16 v[68:69], v7 offset:53248
  s_add_u32 s30, s30, 262144
  v_mfma_f32_32x32x16_bf16 v[16:31], v[96:99], a[88:91], v[16:31]
  ds_read_b64_tr_b16 v[70:71], v7 offset:54272
  ds_read_b64_tr_b16 v[72:73], v6 offset:55296
  ds_read_b64_tr_b16 v[74:75], v6 offset:56320
  buffer_load_dwordx4 a[64:67], v12, s[68:71], s32 offen offset:0 sc1
  v_mfma_f32_32x32x16_bf16 v[32:47], v[100:103], a[88:91], v[32:47]
  ds_read_b64_tr_b16 v[76:77], v7 offset:55296
  ds_read_b64_tr_b16 v[78:79], v7 offset:56320
  buffer_load_dwordx4 a[68:71], v12, s[68:71], s32 offen offset:1024 sc1
  v_mfma_f32_32x32x16_bf16 v[16:31], v[104:107], a[92:95], v[16:31]
  buffer_load_dwordx4 a[72:75], v12, s[68:71], s32 offen offset:2048 sc1
  v_mfma_f32_32x32x16_bf16 v[32:47], v[108:111], a[92:95], v[32:47]
  buffer_load_dwordx4 a[76:79], v12, s[68:71], s32 offen offset:3072 sc1
  s_waitcnt lgkmcnt(0)
  v_mfma_f32_32x32x16_bf16 v[16:31], v[48:51], a[96:99], v[16:31]
  ds_read_b64_tr_b16 v[80:81], v6 offset:57344
  ds_read_b64_tr_b16 v[82:83], v6 offset:58368
  ds_read_b64_tr_b16 v[84:85], v7 offset:57344
  s_add_u32 s32, s32, 4096
  buffer_load_dwordx4 a[80:83], v12, s[68:71], s32 offen offset:0 sc1
  v_mfma_f32_32x32x16_bf16 v[32:47], v[52:55], a[96:99], v[32:47]
  ds_read_b64_tr_b16 v[86:87], v7 offset:58368
  ds_read_b64_tr_b16 v[88:89], v6 offset:59392
  ds_read_b64_tr_b16 v[90:91], v6 offset:60416
  buffer_load_dwordx4 a[84:87], v12, s[68:71], s32 offen offset:1024 sc1
  v_mfma_f32_32x32x16_bf16 v[16:31], v[56:59], a[100:103], v[16:31]
  ds_read_b64_tr_b16 v[92:93], v7 offset:59392
  ds_read_b64_tr_b16 v[94:95], v7 offset:60416
  buffer_load_dwordx4 a[88:91], v12, s[68:71], s32 offen offset:2048 sc1
  v_mfma_f32_32x32x16_bf16 v[32:47], v[60:63], a[100:103], v[32:47]
  ds_read_b64_tr_b16 v[96:97], v6 offset:61440
  ds_read_b64_tr_b16 v[98:99], v6 offset:62464
  ds_read_b64_tr_b16 v[100:101], v7 offset:61440
  buffer_load_dwordx4 a[92:95], v12, s[68:71], s32 offen offset:3072 sc1
  s_add_u32 s32, s32, 4096
  v_mfma_f32_32x32x16_bf16 v[16:31], v[64:67], a[104:107], v[16:31]
  ds_read_b64_tr_b16 v[102:103], v7 offset:62464
  ds_read_b64_tr_b16 v[104:105], v6 offset:63488
  ds_read_b64_tr_b16 v[106:107], v6 offset:64512
  v_mfma_f32_32x32x16_bf16 v[32:47], v[68:71], a[104:107], v[32:47]
  ds_read_b64_tr_b16 v[108:109], v7 offset:63488
  ds_read_b64_tr_b16 v[110:111], v7 offset:64512
  v_mfma_f32_32x32x16_bf16 v[16:31], v[72:75], a[108:111], v[16:31]
  v_mfma_f32_32x32x16_bf16 v[32:47], v[76:79], a[108:111], v[32:47]
  s_waitcnt vmcnt(24) lgkmcnt(0)
  s_barrier
  v_mfma_f32_32x32x16_bf16 v[16:31], v[80:83], a[112:115], v[16:31]
  ds_read_b64_tr_b16 v[48:49], v6 offset:0
  ds_read_b64_tr_b16 v[50:51], v6 offset:1024
  ds_read_b64_tr_b16 v[52:53], v7 offset:0
  s_add_u32 m0, s31, 49152
  s_nop 0
  buffer_load_dwordx4 v8, s[48:51], s30 offen offset:0 lds
  buffer_load_dwordx4 v9, s[48:51], s30 offen offset:1024 lds
  v_mfma_f32_32x32x16_bf16 v[32:47], v[84:87], a[112:115], v[32:47]
  ds_read_b64_tr_b16 v[54:55], v7 offset:1024
  ds_read_b64_tr_b16 v[56:57], v6 offset:2048
  ds_read_b64_tr_b16 v[58:59], v6 offset:3072
  buffer_load_dwordx4 v10, s[48:51], s30 offen offset:2048 lds
  v_mfma_f32_32x32x16_bf16 v[16:31], v[88:91], a[116:119], v[16:31]
  ds_read_b64_tr_b16 v[60:61], v7 offset:2048
  ds_read_b64_tr_b16 v[62:63], v7 offset:3072
  buffer_load_dwordx4 v11, s[48:51], s30 offen offset:3072 lds
  v_mfma_f32_32x32x16_bf16 v[32:47], v[92:95], a[116:119], v[32:47]
  ds_read_b64_tr_b16 v[64:65], v6 offset:4096
  ds_read_b64_tr_b16 v[66:67], v6 offset:5120
  ds_read_b64_tr_b16 v[68:69], v7 offset:4096
  s_add_u32 s30, s30, 262144
  v_mfma_f32_32x32x16_bf16 v[16:31], v[96:99], a[120:123], v[16:31]
  ds_read_b64_tr_b16 v[70:71], v7 offset:5120
  ds_read_b64_tr_b16 v[72:73], v6 offset:6144
  ds_read_b64_tr_b16 v[74:75], v6 offset:7168
  buffer_load_dwordx4 a[96:99], v12, s[68:71], s32 offen offset:0 sc1
  v_mfma_f32_32x32x16_bf16 v[32:47], v[100:103], a[120:123], v[32:47]
  ds_read_b64_tr_b16 v[76:77], v7 offset:6144
  ds_read_b64_tr_b16 v[78:79], v7 offset:7168
  buffer_load_dwordx4 a[100:103], v12, s[68:71], s32 offen offset:1024 sc1
  v_mfma_f32_32x32x16_bf16 v[16:31], v[104:107], a[124:127], v[16:31]
  buffer_load_dwordx4 a[104:107], v12, s[68:71], s32 offen offset:2048 sc1
  v_mfma_f32_32x32x16_bf16 v[32:47], v[108:111], a[124:127], v[32:47]
  buffer_load_dwordx4 a[108:111], v12, s[68:71], s32 offen offset:3072 sc1
  s_sub_u32 s20, s20, 1
  s_cmp_lg_u32 s20, 0
  s_cbranch_scc1 op_l
  s_waitcnt lgkmcnt(0)
  v_mfma_f32_32x32x16_bf16 v[16:31], v[48:51], a[0:3], v[16:31]
  ds_read_b64_tr_b16 v[80:81], v6 offset:8192
  ds_read_b64_tr_b16 v[82:83], v6 offset:9216
  ds_read_b64_tr_b16 v[84:85], v7 offset:8192
  s_add_u32 s32, s32, 4096
  buffer_load_dwordx4 a[112:115], v12, s[68:71], s32 offen offset:0 sc1
  v_lshlrev_b32 v251, 7, v1
  v_add_u32 v251, 720896, v251
  buffer_load_dword v250, v251, s[68:71], 0 offen sc1
  v_mfma_f32_32x32x16_bf16 v[32:47], v[52:55], a[0:3], v[32:47]
  ds_read_b64_tr_b16 v[86:87], v7 offset:9216
  ds_read_b64_tr_b16 v[88:89], v6 offset:10240
  ds_read_b64_tr_b16 v[90:91], v6 offset:11264
  buffer_load_dwordx4 a[116:119], v12, s[68:71], s32 offen offset:1024 sc1
  v_mfma_f32_32x32x16_bf16 v[16:31], v[56:59], a[4:7], v[16:31]
  ds_read_b64_tr_b16 v[92:93], v7 offset:10240
  ds_read_b64_tr_b16 v[94:95], v7 offset:11264
  buffer_load_dwordx4 a[120:123], v12, s[68:71], s32 offen offset:2048 sc1
  v_mfma_f32_32x32x16_bf16 v[32:47], v[60:63], a[4:7], v[32:47]
  ds_read_b64_tr_b16 v[96:97], v6 offset:12288
  ds_read_b64_tr_b16 v[98:99], v6 offset:13312
  ds_read_b64_tr_b16 v[100:101], v7 offset:12288
  buffer_load_dwordx4 a[124:127], v12, s[68:71], s32 offen offset:3072 sc1
  s_add_u32 s32, s32, 4096
  v_mfma_f32_32x32x16_bf16 v[16:31], v[64:67], a[8:11], v[16:31]
  ds_read_b64_tr_b16 v[102:103], v7 offset:13312
  ds_read_b64_tr_b16 v[104:105], v6 offset:14336
  ds_read_b64_tr_b16 v[106:107], v6 offset:15360
  v_mfma_f32_32x32x16_bf16 v[32:47], v[68:71], a[8:11], v[32:47]
  ds_read_b64_tr_b16 v[108:109], v7 offset:14336
  ds_read_b64_tr_b16 v[110:111], v7 offset:15360
  v_mfma_f32_32x32x16_bf16 v[16:31], v[72:75], a[12:15], v[16:31]
  v_mfma_f32_32x32x16_bf16 v[32:47], v[76:79], a[12:15], v[32:47]
  s_waitcnt vmcnt(24) lgkmcnt(0)
  s_barrier
  v_mfma_f32_32x32x16_bf16 v[16:31], v[80:83], a[16:19], v[16:31]
  ds_read_b64_tr_b16 v[48:49], v6 offset:16384
  ds_read_b64_tr_b16 v[50:51], v6 offset:17408
  ds_read_b64_tr_b16 v[52:53], v7 offset:16384
  v_and_b32 v2, 3, v0
  v_lshlrev_b32 v2, 7, v2
  s_mul_i32 s21, s25, 512
  s_add_u32 s21, s21, kn_f1-kn_cb
  v_add_u32 v2, s21, v2
  v_min_u32 v2, kn_ce-kn_cb-4, v2
  global_load_dword v249, v2, s[0:1]
  v_mfma_f32_32x32x16_bf16 v[32:47], v[84:87], a[16:19], v[32:47]
  ds_read_b64_tr_b16 v[54:55], v7 offset:17408
  ds_read_b64_tr_b16 v[56:57], v6 offset:18432
  ds_read_b64_tr_b16 v[58:59], v6 offset:19456
  v_mfma_f32_32x32x16_bf16 v[16:31], v[88:91], a[20:23], v[16:31]
  ds_read_b64_tr_b16 v[60:61], v7 offset:18432
  ds_read_b64_tr_b16 v[62:63], v7 offset:19456
  v_mfma_f32_32x32x16_bf16 v[32:47], v[92:95], a[20:23], v[32:47]
  ds_read_b64_tr_b16 v[64:65], v6 offset:20480
  ds_read_b64_tr_b16 v[66:67], v6 offset:21504
  ds_read_b64_tr_b16 v[68:69], v7 offset:20480
  v_mfma_f32_32x32x16_bf16 v[16:31], v[96:99], a[24:27], v[16:31]
  ds_read_b64_tr_b16 v[70:71], v7 offset:21504
  ds_read_b64_tr_b16 v[72:73], v6 offset:22528
  ds_read_b64_tr_b16 v[74:75], v6 offset:23552
  v_mfma_f32_32x32x16_bf16 v[32:47], v[100:103], a[24:27], v[32:47]
  ds_read_b64_tr_b16 v[76:77], v7 offset:22528
  ds_read_b64_tr_b16 v[78:79], v7 offset:23552
  v_mfma_f32_32x32x16_bf16 v[16:31], v[104:107], a[28:31], v[16:31]
  v_mfma_f32_32x32x16_bf16 v[32:47], v[108:111], a[28:31], v[32:47]
  s_waitcnt lgkmcnt(0)
  v_mfma_f32_32x32x16_bf16 v[16:31], v[48:51], a[32:35], v[16:31]
  ds_read_b64_tr_b16 v[80:81], v6 offset:24576
  ds_read_b64_tr_b16 v[82:83], v6 offset:25600
  ds_read_b64_tr_b16 v[84:85], v7 offset:24576
  v_mfma_f32_32x32x16_bf16 v[32:47], v[52:55], a[32:35], v[32:47]
  ds_read_b64_tr_b16 v[86:87], v7 offset:25600
  ds_read_b64_tr_b16 v[88:89], v6 offset:26624
  ds_read_b64_tr_b16 v[90:91], v6 offset:27648
  v_mfma_f32_32x32x16_bf16 v[16:31], v[56:59], a[36:39], v[16:31]
  ds_read_b64_tr_b16 v[92:93], v7 offset:26624
  ds_read_b64_tr_b16 v[94:95], v7 offset:27648
  v_mfma_f32_32x32x16_bf16 v[32:47], v[60:63], a[36:39], v[32:47]
  ds_read_b64_tr_b16 v[96:97], v6 offset:28672
  ds_read_b64_tr_b16 v[98:99], v6 offset:29696
  ds_read_b64_tr_b16 v[100:101], v7 offset:28672
  v_mfma_f32_32x32x16_bf16 v[16:31], v[64:67], a[40:43], v[16:31]
  ds_read_b64_tr_b16 v[102:103], v7 offset:29696
  ds_read_b64_tr_b16 v[104:105], v6 offset:30720
  ds_read_b64_tr_b16 v[106:107], v6 offset:31744
  v_mfma_f32_32x32x16_bf16 v[32:47], v[68:71], a[40:43], v[32:47]
  ds_read_b64_tr_b16 v[108:109], v7 offset:30720
  ds_read_b64_tr_b16 v[110:111], v7 offset:31744
  v_mfma_f32_32x32x16_bf16 v[16:31], v[72:75], a[44:47], v[16:31]
  v_mfma_f32_32x32x16_bf16 v[32:47], v[76:79], a[44:47], v[32:47]
  s_waitcnt vmcnt(12) lgkmcnt(0)
  s_barrier
  v_mfma_f32_32x32x16_bf16 v[16:31], v[80:83], a[48:51], v[16:31]
  ds_read_b64_tr_b16 v[48:49], v6 offset:32768
  ds_read_b64_tr_b16 v[50:51], v6 offset:33792
  ds_read_b64_tr_b16 v[52:53], v7 offset:32768
  v_mfma_f32_32x32x16_bf16 v[32:47], v[84:87], a[48:51], v[32:47]
  ds_read_b64_tr_b16 v[54:55], v7 offset:33792
  ds_read_b64_tr_b16 v[56:57], v6 offset:34816
  ds_read_b64_tr_b16 v[58:59], v6 offset:35840
  v_mfma_f32_32x32x16_bf16 v[16:31], v[88:91], a[52:55], v[16:31]
  ds_read_b64_tr_b16 v[60:61], v7 offset:34816
  ds_read_b64_tr_b16 v[62:63], v7 offset:35840
  v_mfma_f32_32x32x16_bf16 v[32:47], v[92:95], a[52:55], v[32:47]
  ds_read_b64_tr_b16 v[64:65], v6 offset:36864
  ds_read_b64_tr_b16 v[66:67], v6 offset:37888
  ds_read_b64_tr_b16 v[68:69], v7 offset:36864
  v_mfma_f32_32x32x16_bf16 v[16:31], v[96:99], a[56:59], v[16:31]
  ds_read_b64_tr_b16 v[70:71], v7 offset:37888
  ds_read_b64_tr_b16 v[72:73], v6 offset:38912
  ds_read_b64_tr_b16 v[74:75], v6 offset:39936
  v_mfma_f32_32x32x16_bf16 v[32:47], v[100:103], a[56:59], v[32:47]
  ds_read_b64_tr_b16 v[76:77], v7 offset:38912
  ds_read_b64_tr_b16 v[78:79], v7 offset:39936
  v_mfma_f32_32x32x16_bf16 v[16:31], v[104:107], a[60:63], v[16:31]
  v_mfma_f32_32x32x16_bf16 v[32:47], v[108:111], a[60:63], v[32:47]
  s_waitcnt lgkmcnt(0)
  v_mfma_f32_32x32x16_bf16 v[16:31], v[48:51], a[64:67], v[16:31]
  ds_read_b64_tr_b16 v[80:81], v6 offset:40960
  ds_read_b64_tr_b16 v[82:83], v6 offset:41984
  ds_read_b64_tr_b16 v[84:85], v7 offset:40960
  v_mfma_f32_32x32x16_bf16 v[32:47], v[52:55], a[64:67], v[32:47]
  ds_read_b64_tr_b16 v[86:87], v7 offset:41984
  ds_read_b64_tr_b16 v[88:89], v6 offset:43008
  ds_read_b64_tr_b16 v[90:91], v6 offset:44032
  v_mfma_f32_32x32x16_bf16 v[16:31], v[56:59], a[68:71], v[16:31]
  ds_read_b64_tr_b16 v[92:93], v7 offset:43008
  ds_read_b64_tr_b16 v[94:95], v7 offset:44032
  v_mfma_f32_32x32x16_bf16 v[32:47], v[60:63], a[68:71], v[32:47]
  ds_read_b64_tr_b16 v[96:97], v6 offset:45056
  ds_read_b64_tr_b16 v[98:99], v6 offset:46080
  ds_read_b64_tr_b16 v[100:101], v7 offset:45056
  v_mfma_f32_32x32x16_bf16 v[16:31], v[64:67], a[72:75], v[16:31]
  ds_read_b64_tr_b16 v[102:103], v7 offset:46080
  ds_read_b64_tr_b16 v[104:105], v6 offset:47104
  ds_read_b64_tr_b16 v[106:107], v6 offset:48128
  v_mfma_f32_32x32x16_bf16 v[32:47], v[68:71], a[72:75], v[32:47]
  ds_read_b64_tr_b16 v[108:109], v7 offset:47104
  ds_read_b64_tr_b16 v[110:111], v7 offset:48128
  v_mfma_f32_32x32x16_bf16 v[16:31], v[72:75], a[76:79], v[16:31]
  v_mfma_f32_32x32x16_bf16 v[32:47], v[76:79], a[76:79], v[32:47]
  s_waitcnt vmcnt(0) lgkmcnt(0)
  s_barrier
  v_cmp_ne_u32 vcc, 0x01010101, v250
  s_cbranch_vccnz op_m_sp
op_m_ok:
  v_mfma_f32_32x32x16_bf16 v[16:31], v[80:83], a[80:83], v[16:31]
  ds_read_b64_tr_b16 v[48:49], v6 offset:49152
  ds_read_b64_tr_b16 v[50:51], v6 offset:50176
  ds_read_b64_tr_b16 v[52:53], v7 offset:49152
  s_add_u32 s34, s33, 8192
  buffer_load_dwordx4 v[128:131], v15, s[68:71], s34 offen offset:0 sc1
  buffer_load_dwordx4 v[132:135], v15, s[68:71], s34 offen offset:32 sc1
  v_mfma_f32_32x32x16_bf16 v[32:47], v[84:87], a[80:83], v[32:47]
  ds_read_b64_tr_b16 v[54:55], v7 offset:50176
  ds_read_b64_tr_b16 v[56:57], v6 offset:51200
  ds_read_b64_tr_b16 v[58:59], v6 offset:52224
  buffer_load_dwordx4 v[136:139], v15, s[68:71], s34 offen offset:64 sc1
  buffer_load_dwordx4 v[140:143], v15, s[68:71], s34 offen offset:96 sc1
  v_mfma_f32_32x32x16_bf16 v[16:31], v[88:91], a[84:87], v[16:31]
  ds_read_b64_tr_b16 v[60:61], v7 offset:51200
  ds_read_b64_tr_b16 v[62:63], v7 offset:52224
  buffer_load_dwordx4 v[144:147], v15, s[68:71], s34 offen offset:128 sc1
  buffer_load_dwordx4 v[148:151], v15, s[68:71], s34 offen offset:160 sc1
  v_mfma_f32_32x32x16_bf16 v[32:47], v[92:95], a[84:87], v[32:47]
  ds_read_b64_tr_b16 v[64:65], v6 offset:53248
  ds_read_b64_tr_b16 v[66:67], v6 offset:54272
  ds_read_b64_tr_b16 v[68:69], v7 offset:53248
  buffer_load_dwordx4 v[152:155], v15, s[68:71], s34 offen offset:192 sc1
  buffer_load_dwordx4 v[156:159], v15, s[68:71], s34 offen offset:224 sc1
  v_mfma_f32_32x32x16_bf16 v[16:31], v[96:99], a[88:91], v[16:31]
  ds_read_b64_tr_b16 v[70:71], v7 offset:54272
  ds_read_b64_tr_b16 v[72:73], v6 offset:55296
  ds_read_b64_tr_b16 v[74:75], v6 offset:56320
  s_add_u32 s34, s33, 16384
  buffer_load_dwordx4 v[160:163], v15, s[68:71], s34 offen offset:0 sc1
  buffer_load_dwordx4 v[164:167], v15, s[68:71], s34 offen offset:32 sc1
  v_mfma_f32_32x32x16_bf16 v[32:47], v[100:103], a[88:91], v[32:47]
  ds_read_b64_tr_b16 v[76:77], v7 offset:55296
  ds_read_b64_tr_b16 v[78:79], v7 offset:56320
  buffer_load_dwordx4 v[168:171], v15, s[68:71], s34 offen offset:64 sc1
  buffer_load_dwordx4 v[172:175], v15, s[68:71], s34 offen offset:96 sc1
  v_mfma_f32_32x32x16_bf16 v[16:31], v[104:107], a[92:95], v[16:31]
  buffer_load_dwordx4 v[176:179], v15, s[68:71], s34 offen offset:128 sc1
  buffer_load_dwordx4 v[180:183], v15, s[68:71], s34 offen offset:160 sc1
  v_mfma_f32_32x32x16_bf16 v[32:47], v[108:111], a[92:95], v[32:47]
  buffer_load_dwordx4 v[184:187], v15, s[68:71], s34 offen offset:192 sc1
  buffer_load_dwordx4 v[188:191], v15, s[68:71], s34 offen offset:224 sc1
  s_waitcnt lgkmcnt(0)
  v_mfma_f32_32x32x16_bf16 v[16:31], v[48:51], a[96:99], v[16:31]
  ds_read_b64_tr_b16 v[80:81], v6 offset:57344
  ds_read_b64_tr_b16 v[82:83], v6 offset:58368
  ds_read_b64_tr_b16 v[84:85], v7 offset:57344
  v_mfma_f32_32x32x16_bf16 v[32:47], v[52:55], a[96:99], v[32:47]
  ds_read_b64_tr_b16 v[86:87], v7 offset:58368
  ds_read_b64_tr_b16 v[88:89], v6 offset:59392
  ds_read_b64_tr_b16 v[90:91], v6 offset:60416
  v_mfma_f32_32x32x16_bf16 v[16:31], v[56:59], a[100:103], v[16:31]
  ds_read_b64_tr_b16 v[92:93], v7 offset:59392
  ds_read_b64_tr_b16 v[94:95], v7 offset:60416
  v_mfma_f32_32x32x16_bf16 v[32:47], v[60:63], a[100:103], v[32:47]
  ds_read_b64_tr_b16 v[96:97], v6 offset:61440
  ds_read_b64_tr_b16 v[98:99], v6 offset:62464
  ds_read_b64_tr_b16 v[100:101], v7 offset:61440
  v_mfma_f32_32x32x16_bf16 v[16:31], v[64:67], a[104:107], v[16:31]
  ds_read_b64_tr_b16 v[102:103], v7 offset:62464
  ds_read_b64_tr_b16 v[104:105], v6 offset:63488
  ds_read_b64_tr_b16 v[106:107], v6 offset:64512
  v_mfma_f32_32x32x16_bf16 v[32:47], v[68:71], a[104:107], v[32:47]
  ds_read_b64_tr_b16 v[108:109], v7 offset:63488
  ds_read_b64_tr_b16 v[110:111], v7 offset:64512
  v_mfma_f32_32x32x16_bf16 v[16:31], v[72:75], a[108:111], v[16:31]
  v_mfma_f32_32x32x16_bf16 v[32:47], v[76:79], a[108:111], v[32:47]
  s_waitcnt lgkmcnt(0)
  v_mfma_f32_32x32x16_bf16 v[16:31], v[80:83], a[112:115], v[16:31]
  v_mfma_f32_32x32x16_bf16 v[32:47], v[84:87], a[112:115], v[32:47]
  v_mfma_f32_32x32x16_bf16 v[16:31], v[88:91], a[116:119], v[16:31]
  v_mfma_f32_32x32x16_bf16 v[32:47], v[92:95], a[116:119], v[32:47]
  v_mfma_f32_32x32x16_bf16 v[16:31], v[96:99], a[120:123], v[16:31]
  v_mfma_f32_32x32x16_bf16 v[32:47], v[100:103], a[120:123], v[32:47]
  v_mfma_f32_32x32x16_bf16 v[16:31], v[104:107], a[124:127], v[16:31]
  v_mfma_f32_32x32x16_bf16 v[32:47], v[108:111], a[124:127], v[32:47]
  s_waitcnt vmcnt(0)
  v_lshlrev_b32 v48, 16, v112
  v_and_b32 v49, 0xffff0000, v112
  v_lshlrev_b32 v50, 16, v113
  v_and_b32 v51, 0xffff0000, v113
  v_lshlrev_b32 v52, 16, v114
  v_and_b32 v53, 0xffff0000, v114
  v_lshlrev_b32 v54, 16, v115
  v_and_b32 v55, 0xffff0000, v115
  v_lshlrev_b32 v56, 16, v116
  v_and_b32 v57, 0xffff0000, v116
  v_lshlrev_b32 v58, 16, v117
  v_and_b32 v59, 0xffff0000, v117
  v_lshlrev_b32 v60, 16, v118
  v_and_b32 v61, 0xffff0000, v118
  v_lshlrev_b32 v62, 16, v119
  v_and_b32 v63, 0xffff0000, v119
  v_lshlrev_b32 v64, 16, v120
  v_and_b32 v65, 0xffff0000, v120
  v_lshlrev_b32 v66, 16, v121
  v_and_b32 v67, 0xffff0000, v121
  v_lshlrev_b32 v68, 16, v122
  v_and_b32 v69, 0xffff0000, v122
  v_lshlrev_b32 v70, 16, v123
  v_and_b32 v71, 0xffff0000, v123
  v_lshlrev_b32 v72, 16, v124
  v_and_b32 v73, 0xffff0000, v124
  v_lshlrev_b32 v74, 16, v125
  v_and_b32 v75, 0xffff0000, v125
  v_lshlrev_b32 v76, 16, v126
  v_and_b32 v77, 0xffff0000, v126
  v_lshlrev_b32 v78, 16, v127
  v_and_b32 v79, 0xffff0000, v127
  v_fmac_f32 v48, v16, v128
  v_fmac_f32 v49, v17, v129
  v_fmac_f32 v50, v18, v130
  v_fmac_f32 v51, v19, v131
  v_fmac_f32 v52, v20, v132
  v_fmac_f32 v53, v21, v133
  v_fmac_f32 v54, v22, v134
  v_fmac_f32 v55, v23, v135
  v_fmac_f32 v56, v24, v136
  v_fmac_f32 v57, v25, v137
  v_fmac_f32 v58, v26, v138
  v_fmac_f32 v59, v27, v139
  v_fmac_f32 v60, v28, v140
  v_fmac_f32 v61, v29, v141
  v_fmac_f32 v62, v30, v142
  v_fmac_f32 v63, v31, v143
  v_fmac_f32 v64, v32, v144
  v_fmac_f32 v65, v33, v145
  v_fmac_f32 v66, v34, v146
  v_fmac_f32 v67, v35, v147
  v_fmac_f32 v68, v36, v148
  v_fmac_f32 v69, v37, v149
  v_fmac_f32 v70, v38, v150
  v_fmac_f32 v71, v39, v151
  v_fmac_f32 v72, v40, v152
  v_fmac_f32 v73, v41, v153
  v_fmac_f32 v74, v42, v154
  v_fmac_f32 v75, v43, v155
  v_fmac_f32 v76, v44, v156
  v_fmac_f32 v77, v45, v157
  v_fmac_f32 v78, v46, v158
  v_fmac_f32 v79, v47, v159
  v_cvt_pk_bf16_f32 v112, v48, v49
  v_cvt_pk_bf16_f32 v113, v50, v51
  v_cvt_pk_bf16_f32 v114, v52, v53
  v_cvt_pk_bf16_f32 v115, v54, v55
  v_cvt_pk_bf16_f32 v116, v56, v57
  v_cvt_pk_bf16_f32 v117, v58, v59
  v_cvt_pk_bf16_f32 v118, v60, v61
  v_cvt_pk_bf16_f32 v119, v62, v63
  v_cvt_pk_bf16_f32 v120, v64, v65
  v_cvt_pk_bf16_f32 v121, v66, v67
  v_cvt_pk_bf16_f32 v122, v68, v69
  v_cvt_pk_bf16_f32 v123, v70, v71
  v_cvt_pk_bf16_f32 v124, v72, v73
  v_cvt_pk_bf16_f32 v125, v74, v75
  v_cvt_pk_bf16_f32 v126, v76, v77
  v_cvt_pk_bf16_f32 v127, v78, v79
  v_lshlrev_b32 v48, 16, v112
  v_and_b32 v49, 0xffff0000, v112
  v_accvgpr_write_b32 a128, v112
  v_lshlrev_b32 v50, 16, v113
  v_and_b32 v51, 0xffff0000, v113
  v_accvgpr_write_b32 a129, v113
  v_lshlrev_b32 v52, 16, v114
  v_and_b32 v53, 0xffff0000, v114
  v_accvgpr_write_b32 a130, v114
  v_lshlrev_b32 v54, 16, v115
  v_and_b32 v55, 0xffff0000, v115
  v_accvgpr_write_b32 a131, v115
  v_lshlrev_b32 v56, 16, v116
  v_and_b32 v57, 0xffff0000, v116
  v_accvgpr_write_b32 a132, v116
  v_lshlrev_b32 v58, 16, v117
  v_and_b32 v59, 0xffff0000, v117
  v_accvgpr_write_b32 a133, v117
  v_lshlrev_b32 v60, 16, v118
  v_and_b32 v61, 0xffff0000, v118
  v_accvgpr_write_b32 a134, v118
  v_lshlrev_b32 v62, 16, v119
  v_and_b32 v63, 0xffff0000, v119
  v_accvgpr_write_b32 a135, v119
  v_lshlrev_b32 v64, 16, v120
  v_and_b32 v65, 0xffff0000, v120
  v_accvgpr_write_b32 a136, v120
  v_lshlrev_b32 v66, 16, v121
  v_and_b32 v67, 0xffff0000, v121
  v_accvgpr_write_b32 a137, v121
  v_lshlrev_b32 v68, 16, v122
  v_and_b32 v69, 0xffff0000, v122
  v_accvgpr_write_b32 a138, v122
  v_lshlrev_b32 v70, 16, v123
  v_and_b32 v71, 0xffff0000, v123
  v_accvgpr_write_b32 a139, v123
  v_lshlrev_b32 v72, 16, v124
  v_and_b32 v73, 0xffff0000, v124
  v_accvgpr_write_b32 a140, v124
  v_lshlrev_b32 v74, 16, v125
  v_and_b32 v75, 0xffff0000, v125
  v_accvgpr_write_b32 a141, v125
  v_lshlrev_b32 v76, 16, v126
  v_and_b32 v77, 0xffff0000, v126
  v_accvgpr_write_b32 a142, v126
  v_lshlrev_b32 v78, 16, v127
  v_and_b32 v79, 0xffff0000, v127
  v_accvgpr_write_b32 a143, v127
  v_add_f32 v160, 1.0, v160
  v_cvt_pk_bf16_f32 v160, v160, v160
  v_and_b32 v160, 0xffff0000, v160
  v_mul_f32 v160, v160, v48
  v_add_f32 v161, 1.0, v161
  v_cvt_pk_bf16_f32 v161, v161, v161
  v_and_b32 v161, 0xffff0000, v161
  v_mul_f32 v161, v161, v49
  v_add_f32 v162, 1.0, v162
  v_cvt_pk_bf16_f32 v162, v162, v162
  v_and_b32 v162, 0xffff0000, v162
  v_mul_f32 v162, v162, v50
  v_add_f32 v163, 1.0, v163
  v_cvt_pk_bf16_f32 v163, v163, v163
  v_and_b32 v163, 0xffff0000, v163
  v_mul_f32 v163, v163, v51
  v_add_f32 v164, 1.0, v164
  v_cvt_pk_bf16_f32 v164, v164, v164
  v_and_b32 v164, 0xffff0000, v164
  v_mul_f32 v164, v164, v52
  v_add_f32 v165, 1.0, v165
  v_cvt_pk_bf16_f32 v165, v165, v165
  v_and_b32 v165, 0xffff0000, v165
  v_mul_f32 v165, v165, v53
  v_add_f32 v166, 1.0, v166
  v_cvt_pk_bf16_f32 v166, v166, v166
  v_and_b32 v166, 0xffff0000, v166
  v_mul_f32 v166, v166, v54
  v_add_f32 v167, 1.0, v167
  v_cvt_pk_bf16_f32 v167, v167, v167
  v_and_b32 v167, 0xffff0000, v167
  v_mul_f32 v167, v167, v55
  v_add_f32 v168, 1.0, v168
  v_cvt_pk_bf16_f32 v168, v168, v168
  v_and_b32 v168, 0xffff0000, v168
  v_mul_f32 v168, v168, v56
  v_add_f32 v169, 1.0, v169
  v_cvt_pk_bf16_f32 v169, v169, v169
  v_and_b32 v169, 0xffff0000, v169
  v_mul_f32 v169, v169, v57
  v_add_f32 v170, 1.0, v170
  v_cvt_pk_bf16_f32 v170, v170, v170
  v_and_b32 v170, 0xffff0000, v170
  v_mul_f32 v170, v170, v58
  v_add_f32 v171, 1.0, v171
  v_cvt_pk_bf16_f32 v171, v171, v171
  v_and_b32 v171, 0xffff0000, v171
  v_mul_f32 v171, v171, v59
  v_add_f32 v172, 1.0, v172
  v_cvt_pk_bf16_f32 v172, v172, v172
  v_and_b32 v172, 0xffff0000, v172
  v_mul_f32 v172, v172, v60
  v_add_f32 v173, 1.0, v173
  v_cvt_pk_bf16_f32 v173, v173, v173
  v_and_b32 v173, 0xffff0000, v173
  v_mul_f32 v173, v173, v61
  v_add_f32 v174, 1.0, v174
  v_cvt_pk_bf16_f32 v174, v174, v174
  v_and_b32 v174, 0xffff0000, v174
  v_mul_f32 v174, v174, v62
  v_add_f32 v175, 1.0, v175
  v_cvt_pk_bf16_f32 v175, v175, v175
  v_and_b32 v175, 0xffff0000, v175
  v_mul_f32 v175, v175, v63
  v_add_f32 v176, 1.0, v176
  v_cvt_pk_bf16_f32 v176, v176, v176
  v_and_b32 v176, 0xffff0000, v176
  v_mul_f32 v176, v176, v64
  v_add_f32 v177, 1.0, v177
  v_cvt_pk_bf16_f32 v177, v177, v177
  v_and_b32 v177, 0xffff0000, v177
  v_mul_f32 v177, v177, v65
  v_add_f32 v178, 1.0, v178
  v_cvt_pk_bf16_f32 v178, v178, v178
  v_and_b32 v178, 0xffff0000, v178
  v_mul_f32 v178, v178, v66
  v_add_f32 v179, 1.0, v179
  v_cvt_pk_bf16_f32 v179, v179, v179
  v_and_b32 v179, 0xffff0000, v179
  v_mul_f32 v179, v179, v67
  v_add_f32 v180, 1.0, v180
  v_cvt_pk_bf16_f32 v180, v180, v180
  v_and_b32 v180, 0xffff0000, v180
  v_mul_f32 v180, v180, v68
  v_add_f32 v181, 1.0, v181
  v_cvt_pk_bf16_f32 v181, v181, v181
  v_and_b32 v181, 0xffff0000, v181
  v_mul_f32 v181, v181, v69
  v_add_f32 v182, 1.0, v182
  v_cvt_pk_bf16_f32 v182, v182, v182
  v_and_b32 v182, 0xffff0000, v182
  v_mul_f32 v182, v182, v70
  v_add_f32 v183, 1.0, v183
  v_cvt_pk_bf16_f32 v183, v183, v183
  v_and_b32 v183, 0xffff0000, v183
  v_mul_f32 v183, v183, v71
  v_add_f32 v184, 1.0, v184
  v_cvt_pk_bf16_f32 v184, v184, v184
  v_and_b32 v184, 0xffff0000, v184
  v_mul_f32 v184, v184, v72
  v_add_f32 v185, 1.0, v185
  v_cvt_pk_bf16_f32 v185, v185, v185
  v_and_b32 v185, 0xffff0000, v185
  v_mul_f32 v185, v185, v73
  v_add_f32 v186, 1.0, v186
  v_cvt_pk_bf16_f32 v186, v186, v186
  v_and_b32 v186, 0xffff0000, v186
  v_mul_f32 v186, v186, v74
  v_add_f32 v187, 1.0, v187
  v_cvt_pk_bf16_f32 v187, v187, v187
  v_and_b32 v187, 0xffff0000, v187
  v_mul_f32 v187, v187, v75
  v_add_f32 v188, 1.0, v188
  v_cvt_pk_bf16_f32 v188, v188, v188
  v_and_b32 v188, 0xffff0000, v188
  v_mul_f32 v188, v188, v76
  v_add_f32 v189, 1.0, v189
  v_cvt_pk_bf16_f32 v189, v189, v189
  v_and_b32 v189, 0xffff0000, v189
  v_mul_f32 v189, v189, v77
  v_add_f32 v190, 1.0, v190
  v_cvt_pk_bf16_f32 v190, v190, v190
  v_and_b32 v190, 0xffff0000, v190
  v_mul_f32 v190, v190, v78
  v_add_f32 v191, 1.0, v191
  v_cvt_pk_bf16_f32 v191, v191, v191
  v_and_b32 v191, 0xffff0000, v191
  v_mul_f32 v191, v191, v79
  v_cvt_pk_bf16_f32 v16, v160, v161
  v_cvt_pk_bf16_f32 v17, v162, v163
  v_cvt_pk_bf16_f32 v18, v164, v165
  v_cvt_pk_bf16_f32 v19, v166, v167
  v_cvt_pk_bf16_f32 v20, v168, v169
  v_cvt_pk_bf16_f32 v21, v170, v171
  v_cvt_pk_bf16_f32 v22, v172, v173
  v_cvt_pk_bf16_f32 v23, v174, v175
  v_cvt_pk_bf16_f32 v24, v176, v177
  v_cvt_pk_bf16_f32 v25, v178, v179
  v_cvt_pk_bf16_f32 v26, v180, v181
  v_cvt_pk_bf16_f32 v27, v182, v183
  v_cvt_pk_bf16_f32 v28, v184, v185
  v_cvt_pk_bf16_f32 v29, v186, v187
  v_cvt_pk_bf16_f32 v30, v188, v189
  v_cvt_pk_bf16_f32 v31, v190, v191
  s_lshl_b32 s36, s28, 16
  s_lshl_b32 s37, s27, 12
  s_add_u32 s36, s36, s37
  s_add_u32 s36, s36, 62914560
  buffer_store_dwordx4 v[16:19], v12, s[68:71], s36 offen offset:0 sc1
  buffer_store_dwordx4 v[20:23], v12, s[68:71], s36 offen offset:1024 sc1
  buffer_store_dwordx4 v[24:27], v12, s[68:71], s36 offen offset:2048 sc1
  buffer_store_dwordx4 v[28:31], v12, s[68:71], s36 offen offset:3072 sc1
  v_add_f32 v2, v48, v49
  v_add_f32 v3, v50, v51
  v_add_f32 v2, v2, v52
  v_add_f32 v3, v3, v53
  v_add_f32 v2, v2, v54
  v_add_f32 v3, v3, v55
  v_add_f32 v2, v2, v56
  v_add_f32 v3, v3, v57
  v_add_f32 v2, v2, v58
  v_add_f32 v3, v3, v59
  v_add_f32 v2, v2, v60
  v_add_f32 v3, v3, v61
  v_add_f32 v2, v2, v62
  v_add_f32 v3, v3, v63
  v_add_f32 v2, v2, v64
  v_add_f32 v3, v3, v65
  v_add_f32 v2, v2, v66
  v_add_f32 v3, v3, v67
  v_add_f32 v2, v2, v68
  v_add_f32 v3, v3, v69
  v_add_f32 v2, v2, v70
  v_add_f32 v3, v3, v71
  v_add_f32 v2, v2, v72
  v_add_f32 v3, v3, v73
  v_add_f32 v2, v2, v74
  v_add_f32 v3, v3, v75
  v_add_f32 v2, v2, v76
  v_add_f32 v3, v3, v77
  v_add_f32 v2, v2, v78
  v_add_f32 v3, v3, v79
  v_add_f32 v2, v2, v3
  v_mov_b32 v4, v2
  s_nop 1
  v_permlane32_swap_b32 v2, v4
  s_nop 1
  v_add_f32 v2, v2, v4
  v_mul_f32 v2, 0x3c800000, v2
  v_sub_f32 v48, v48, v2
  v_sub_f32 v49, v49, v2
  v_sub_f32 v50, v50, v2
  v_sub_f32 v51, v51, v2
  v_sub_f32 v52, v52, v2
  v_sub_f32 v53, v53, v2
  v_sub_f32 v54, v54, v2
  v_sub_f32 v55, v55, v2
  v_sub_f32 v56, v56, v2
  v_sub_f32 v57, v57, v2
  v_sub_f32 v58, v58, v2
  v_sub_f32 v59, v59, v2
  v_sub_f32 v60, v60, v2
  v_sub_f32 v61, v61, v2
  v_sub_f32 v62, v62, v2
  v_sub_f32 v63, v63, v2
  v_sub_f32 v64, v64, v2
  v_sub_f32 v65, v65, v2
  v_sub_f32 v66, v66, v2
  v_sub_f32 v67, v67, v2
  v_sub_f32 v68, v68, v2
  v_sub_f32 v69, v69, v2
  v_sub_f32 v70, v70, v2
  v_sub_f32 v71, v71, v2
  v_sub_f32 v72, v72, v2
  v_sub_f32 v73, v73, v2
  v_sub_f32 v74, v74, v2
  v_sub_f32 v75, v75, v2
  v_sub_f32 v76, v76, v2
  v_sub_f32 v77, v77, v2
  v_sub_f32 v78, v78, v2
  v_sub_f32 v79, v79, v2
  v_mul_f32 v3, v48, v48
  v_mul_f32 v4, v49, v49
  v_fmac_f32 v3, v50, v50
  v_fmac_f32 v4, v51, v51
  v_fmac_f32 v3, v52, v52
  v_fmac_f32 v4, v53, v53
  v_fmac_f32 v3, v54, v54
  v_fmac_f32 v4, v55, v55
  v_fmac_f32 v3, v56, v56
  v_fmac_f32 v4, v57, v57
  v_fmac_f32 v3, v58, v58
  v_fmac_f32 v4, v59, v59
  v_fmac_f32 v3, v60, v60
  v_fmac_f32 v4, v61, v61
  v_fmac_f32 v3, v62, v62
  v_fmac_f32 v4, v63, v63
  v_fmac_f32 v3, v64, v64
  v_fmac_f32 v4, v65, v65
  v_fmac_f32 v3, v66, v66
  v_fmac_f32 v4, v67, v67
  v_fmac_f32 v3, v68, v68
  v_fmac_f32 v4, v69, v69
  v_fmac_f32 v3, v70, v70
  v_fmac_f32 v4, v71, v71
  v_fmac_f32 v3, v72, v72
  v_fmac_f32 v4, v73, v73
  v_fmac_f32 v3, v74, v74
  v_fmac_f32 v4, v75, v75
  v_fmac_f32 v3, v76, v76
  v_fmac_f32 v4, v77, v77
  v_fmac_f32 v3, v78, v78
  v_fmac_f32 v4, v79, v79
  v_add_f32 v3, v3, v4
  v_mov_b32 v4, v3
  s_nop 1
  v_permlane32_swap_b32 v3, v4
  s_nop 1
  v_add_f32 v3, v3, v4
  s_lshl_b32 s36, s28, 8
  s_lshl_b32 s37, s27, 14
  s_add_u32 s36, s36, s37
  s_add_u32 s36, s36, 67108864
  v_lshlrev_b32 v4, 3, v14
  v_lshl_or_b32 v4, v13, 30, v4
  buffer_store_dwordx2 v[2:3], v4, s[68:71], s36 offen sc1
kn_f1:
  s_lshl_b32 s38, s26, 11
  s_lshl_b32 s39, s27, 7
  s_add_u32 s38, s38, s39
  s_add_u32 s38, s38, 655360
  s_cmp_lt_u32 s25, 28
  s_cbranch_scc1 f1_go
  s_waitcnt vmcnt(0)
  s_barrier
  v_cmp_eq_u32 vcc, 0, v0
  v_mov_b32 v2, 2130706432
  v_mov_b32 v3, 1
  v_cndmask_b32 v2, v2, v0, vcc
  buffer_store_dword v3, v2, s[68:71], s38 offen sc0 sc1
  s_mov_b32 s38, 2130706432
  s_branch f1_skip
f1_go:
  s_and_b32 s26, s24, 1
  s_lshl_b32 s26, s26, 2
  s_and_b32 s27, s25, 3
  s_add_u32 s26, s26, s27
  s_lshr_b32 s27, s24, 1
  s_mul_i32 s27, s27, 7
  s_lshr_b32 s28, s25, 2
  s_add_u32 s27, s27, s28
  s_lshl_b32 s28, s26, 3
  s_lshl_b32 s29, s3, 1
  s_add_u32 s28, s28, s29
  v_bfe_u32 v2, v1, 2, 2
  v_lshlrev_b32 v6, 7, v2
  v_bfe_u32 v2, v1, 3, 1
  v_lshl_add_u32 v6, v2, 6, v6
  v_bfe_u32 v2, v1, 4, 1
  v_lshl_add_u32 v6, v2, 5, v6
  v_and_b32 v2, 3, v1
  v_lshl_add_u32 v6, v2, 3, v6
  v_lshrrev_b32 v2, 5, v1
  v_mul_u32_u24 v2, 512, v2
  v_add_u32 v6, v6, v2
  v_xor_b32 v7, 64, v6
  v_lshrrev_b32 v2, 3, v1
  v_mul_u32_u24 v2, 7168, v2
  v_bfe_u32 v3, v1, 4, 1
  v_lshlrev_b32 v3, 2, v3
  v_and_b32 v4, 7, v1
  v_xor_b32 v3, v3, v4
  v_lshl_add_u32 v2, v3, 4, v2
  s_mul_i32 s31, s3, 114688
  v_add_u32 v2, s31, v2
  v_add_u32 v8, 4096, v2
  v_add_u32 v9, 3200, v2
  v_add_u32 v10, 59392, v2
  v_add_u32 v11, 58496, v2
  s_mul_i32 s31, s3, 4096
  s_add_u32 s31, s31, 0
  s_lshl_b32 s30, s27, 8
  s_lshl_b32 s32, s28, 16
  s_add_u32 s32, s32, 62914560
  v_lshlrev_b32 v12, 4, v1
  v_add_u32 v13, 65536, v12
  s_barrier
  s_add_u32 m0, s31, 0
  s_nop 0
  buffer_load_dwordx4 v8, s[52:55], s30 offen offset:0 lds
  buffer_load_dwordx4 v9, s[52:55], s30 offen offset:1024 lds
  buffer_load_dwordx4 v10, s[52:55], s30 offen offset:2048 lds
  buffer_load_dwordx4 v11, s[52:55], s30 offen offset:3072 lds
  s_add_u32 s30, s30, 458752
  s_add_u32 m0, s31, 16384
  s_nop 0
  buffer_load_dwordx4 v8, s[52:55], s30 offen offset:0 lds
  buffer_load_dwordx4 v9, s[52:55], s30 offen offset:1024 lds
  buffer_load_dwordx4 v10, s[52:55], s30 offen offset:2048 lds
  buffer_load_dwordx4 v11, s[52:55], s30 offen offset:3072 lds
  s_add_u32 s30, s30, 458752
  s_add_u32 m0, s31, 32768
  s_nop 0
  buffer_load_dwordx4 v8, s[52:55], s30 offen offset:0 lds
  buffer_load_dwordx4 v9, s[52:55], s30 offen offset:1024 lds
  buffer_load_dwordx4 v10, s[52:55], s30 offen offset:2048 lds
  buffer_load_dwordx4 v11, s[52:55], s30 offen offset:3072 lds
  s_add_u32 s30, s30, 458752
  s_add_u32 m0, s31, 49152
  s_nop 0
  buffer_load_dwordx4 v8, s[52:55], s30 offen offset:0 lds
  buffer_load_dwordx4 v9, s[52:55], s30 offen offset:1024 lds
  buffer_load_dwordx4 v10, s[52:55], s30 offen offset:2048 lds
  buffer_load_dwordx4 v11, s[52:55], s30 offen offset:3072 lds
  s_add_u32 s30, s30, 458752
  v_bfe_u32 v2, v0, 1, 6
  v_lshlrev_b32 v2, 6, v2
  v_and_b32 v3, 1, v0
  v_lshl_add_u32 v2, v3, 4, v2
  v_lshrrev_b32 v3, 7, v0
  v_lshlrev_b32 v3, 12, v3
  v_sub_u32 v2, v2, v3
  v_add_u32 v2, 16384, v2
  buffer_load_dwordx4 v[16:19], v2, s[68:71], 0 offen sc1
  buffer_load_dwordx4 v[20:23], v2, s[68:71], 0 offen offset:32 sc1
  s_waitcnt vmcnt(18)
  s_barrier
  v_cmp_eq_u32 vcc, 0, v0
  v_mov_b32 v2, 2130706432
  v_mov_b32 v3, 1
  v_cndmask_b32 v2, v2, v0, vcc
  buffer_store_dword v3, v2, s[68:71], s38 offen sc0 sc1
  s_lshl_b32 s34, s26, 12
  s_add_u32 s34, s34, 655360
  v_and_b32 v2, 7, v1
  v_lshl_add_u32 v2, s3, 3, v2
  v_min_u32 v2, 31, v2
  v_lshlrev_b32 v2, 7, v2
  v_add_u32 v251, s34, v2
  buffer_load_dword v250, v251, s[68:71], 0 offen sc1
  s_waitcnt vmcnt(0)
  v_cmp_ne_u32 vcc, 1, v250
  s_cbranch_vccnz f1_w_sp
f1_w_ok:
  s_barrier
  v_and_b32 v2, 31, v1
  v_lshlrev_b32 v2, 3, v2
  v_lshrrev_b32 v3, 5, v1
  v_lshl_add_u32 v2, v3, 17, v2
  s_lshl_b32 s33, s28, 8
  s_add_u32 s33, s33, 67108864
  buffer_load_dwordx2 v[32:33], v2, s[68:71], s33 offen offset:0 sc1
  buffer_load_dwordx2 v[48:49], v2, s[68:71], s33 offen offset:256 sc1
  s_add_u32 s33, s33, 16384
  buffer_load_dwordx2 v[34:35], v2, s[68:71], s33 offen offset:0 sc1
  buffer_load_dwordx2 v[50:51], v2, s[68:71], s33 offen offset:256 sc1
  s_add_u32 s33, s33, 16384
  buffer_load_dwordx2 v[36:37], v2, s[68:71], s33 offen offset:0 sc1
  buffer_load_dwordx2 v[52:53], v2, s[68:71], s33 offen offset:256 sc1
  s_add_u32 s33, s33, 16384
  buffer_load_dwordx2 v[38:39], v2, s[68:71], s33 offen offset:0 sc1
  buffer_load_dwordx2 v[54:55], v2, s[68:71], s33 offen offset:256 sc1
  s_add_u32 s33, s33, 16384
  buffer_load_dwordx2 v[40:41], v2, s[68:71], s33 offen offset:0 sc1
  buffer_load_dwordx2 v[56:57], v2, s[68:71], s33 offen offset:256 sc1
  s_add_u32 s33, s33, 16384
  buffer_load_dwordx2 v[42:43], v2, s[68:71], s33 offen offset:0 sc1
  buffer_load_dwordx2 v[58:59], v2, s[68:71], s33 offen offset:256 sc1
  s_add_u32 s33, s33, 16384
  buffer_load_dwordx2 v[44:45], v2, s[68:71], s33 offen offset:0 sc1
  buffer_load_dwordx2 v[60:61], v2, s[68:71], s33 offen offset:256 sc1
  s_add_u32 s33, s33, 16384
  buffer_load_dwordx2 v[46:47], v2, s[68:71], s33 offen offset:0 sc1
  buffer_load_dwordx2 v[62:63], v2, s[68:71], s33 offen offset:256 sc1
  s_add_u32 s33, s33, 16384
  buffer_load_dwordx4 a[0:3], v12, s[68:71], s32 offen offset:0 sc1
  buffer_load_dwordx4 a[4:7], v13, s[68:71], s32 offen offset:0 sc1
  buffer_load_dwordx4 a[8:11], v12, s[68:71], s32 offen offset:1024 sc1
  buffer_load_dwordx4 a[12:15], v13, s[68:71], s32 offen offset:1024 sc1
  buffer_load_dwordx4 a[16:19], v12, s[68:71], s32 offen offset:2048 sc1
  buffer_load_dwordx4 a[20:23], v13, s[68:71], s32 offen offset:2048 sc1
  buffer_load_dwordx4 a[24:27], v12, s[68:71], s32 offen offset:3072 sc1
  buffer_load_dwordx4 a[28:31], v13, s[68:71], s32 offen offset:3072 sc1
  s_add_u32 s32, s32, 4096
  buffer_load_dwordx4 a[32:35], v12, s[68:71], s32 offen offset:0 sc1
  buffer_load_dwordx4 a[36:39], v13, s[68:71], s32 offen offset:0 sc1
  buffer_load_dwordx4 a[40:43], v12, s[68:71], s32 offen offset:1024 sc1
  buffer_load_dwordx4 a[44:47], v13, s[68:71], s32 offen offset:1024 sc1
  buffer_load_dwordx4 a[48:51], v12, s[68:71], s32 offen offset:2048 sc1
  buffer_load_dwordx4 a[52:55], v13, s[68:71], s32 offen offset:2048 sc1
  buffer_load_dwordx4 a[56:59], v12, s[68:71], s32 offen offset:3072 sc1
  buffer_load_dwordx4 a[60:63], v13, s[68:71], s32 offen offset:3072 sc1
  s_add_u32 s32, s32, 4096
  buffer_load_dwordx4 a[64:67], v12, s[68:71], s32 offen offset:0 sc1
  buffer_load_dwordx4 a[68:71], v13, s[68:71], s32 offen offset:0 sc1
  buffer_load_dwordx4 a[72:75], v12, s[68:71], s32 offen offset:1024 sc1
  buffer_load_dwordx4 a[76:79], v13, s[68:71], s32 offen offset:1024 sc1
  buffer_load_dwordx4 a[80:83], v12, s[68:71], s32 offen offset:2048 sc1
  buffer_load_dwordx4 a[84:87], v13, s[68:71], s32 offen offset:2048 sc1
  buffer_load_dwordx4 a[88:91], v12, s[68:71], s32 offen offset:3072 sc1
  buffer_load_dwordx4 a[92:95], v13, s[68:71], s32 offen offset:3072 sc1
  s_add_u32 s32, s32, 4096
  buffer_load_dwordx4 a[96:99], v12, s[68:71], s32 offen offset:0 sc1
  buffer_load_dwordx4 a[100:103], v13, s[68:71], s32 offen offset:0 sc1
  buffer_load_dwordx4 a[104:107], v12, s[68:71], s32 offen offset:1024 sc1
  buffer_load_dwordx4 a[108:111], v13, s[68:71], s32 offen offset:1024 sc1
  v_cmp_gt_u32 vcc, 128, v0
  v_mov_b32 v3, 0
  v_mov_b32 v4, 1.0
  v_cndmask_b32 v3, v3, v4, vcc
  v_add_f32 v16, v16, v3
  v_add_f32 v17, v17, v3
  v_add_f32 v18, v18, v3
  v_add_f32 v19, v19, v3
  v_add_f32 v20, v20, v3
  v_add_f32 v21, v21, v3
  v_add_f32 v22, v22, v3
  v_add_f32 v23, v23, v3
  v_cvt_pk_bf16_f32 v24, v16, v17
  v_cvt_pk_bf16_f32 v25, v18, v19
  v_cvt_pk_bf16_f32 v26, v20, v21
  v_cvt_pk_bf16_f32 v27, v22, v23
  v_lshlrev_b32 v2, 4, v0
  v_add_u32 v2, 65536, v2
  ds_write_b128 v2, v[24:27]
  v_and_b32 v2, 1, v1
  v_lshlrev_b32 v2, 11, v2
  v_lshrrev_b32 v3, 5, v1
  v_lshl_add_u32 v2, v3, 4, v2
  v_add_u32 v14, 65536, v2
  s_and_b32 s33, s3, 1
  s_lshl_b32 s33, s33, 6
  v_xor_b32 v15, s33, v6
  s_lshr_b32 s33, s3, 1
  s_lshl_b32 s33, s33, 10
  v_add_u32 v15, s33, v15
  v_mov_b32 v208, 0
  v_mov_b32 v209, 0
  v_mov_b32 v210, 0
  v_mov_b32 v211, 0
  v_mov_b32 v212, 0
  v_mov_b32 v213, 0
  v_mov_b32 v214, 0
  v_mov_b32 v215, 0
  v_mov_b32 v216, 0
  v_mov_b32 v217, 0
  v_mov_b32 v218, 0
  v_mov_b32 v219, 0
  v_mov_b32 v220, 0
  v_mov_b32 v221, 0
  v_mov_b32 v222, 0
  v_mov_b32 v223, 0
  s_waitcnt vmcnt(28)
  v_add_f32 v2, v32, v34
  v_add_f32 v2, v2, v36
  v_add_f32 v2, v2, v38
  v_add_f32 v2, v2, v40
  v_add_f32 v2, v2, v42
  v_add_f32 v2, v2, v44
  v_add_f32 v2, v2, v46
  v_mov_b32 v4, v2
  s_nop 1
  v_permlane32_swap_b32 v2, v4
  s_nop 1
  v_add_f32 v2, v2, v4
  v_mul_f32 v2, 0x3d800000, v2
  v_sub_f32 v32, v32, v2
  v_sub_f32 v34, v34, v2
  v_sub_f32 v36, v36, v2
  v_sub_f32 v38, v38, v2
  v_sub_f32 v40, v40, v2
  v_sub_f32 v42, v42, v2
  v_sub_f32 v44, v44, v2
  v_sub_f32 v46, v46, v2
  v_mul_f32 v3, v32, v32
  v_fmac_f32 v3, v34, v34
  v_fmac_f32 v3, v36, v36
  v_fmac_f32 v3, v38, v38
  v_fmac_f32 v3, v40, v40
  v_fmac_f32 v3, v42, v42
  v_fmac_f32 v3, v44, v44
  v_fmac_f32 v3, v46, v46
  v_mul_f32 v3, 0x42800000, v3
  v_add_f32 v3, v3, v33
  v_add_f32 v3, v3, v35
  v_add_f32 v3, v3, v37
  v_add_f32 v3, v3, v39
  v_add_f32 v3, v3, v41
  v_add_f32 v3, v3, v43
  v_add_f32 v3, v3, v45
  v_add_f32 v3, v3, v47
  v_mov_b32 v4, v3
  s_nop 1
  v_permlane32_swap_b32 v3, v4
  s_nop 1
  v_add_f32 v3, v3, v4
  v_mov_b32 v4, 0x3727c5ac
  v_fmac_f32 v4, 0x3a800000, v3
  v_rsq_f32 v4, v4
  s_nop 0
  v_mov_b32 v240, v4
  v_mov_b32 v241, v4
  v_mul_f32 v4, v4, v2
  v_sub_f32 v244, 0, v4
  v_sub_f32 v245, 0, v4
  v_add_f32 v2, v48, v50
  v_add_f32 v2, v2, v52
  v_add_f32 v2, v2, v54
  v_add_f32 v2, v2, v56
  v_add_f32 v2, v2, v58
  v_add_f32 v2, v2, v60
  v_add_f32 v2, v2, v62
  v_mov_b32 v4, v2
  s_nop 1
  v_permlane32_swap_b32 v2, v4
  s_nop 1
  v_add_f32 v2, v2, v4
  v_mul_f32 v2, 0x3d800000, v2
  v_sub_f32 v48, v48, v2
  v_sub_f32 v50, v50, v2
  v_sub_f32 v52, v52, v2
  v_sub_f32 v54, v54, v2
  v_sub_f32 v56, v56, v2
  v_sub_f32 v58, v58, v2
  v_sub_f32 v60, v60, v2
  v_sub_f32 v62, v62, v2
  v_mul_f32 v3, v48, v48
  v_fmac_f32 v3, v50, v50
  v_fmac_f32 v3, v52, v52
  v_fmac_f32 v3, v54, v54
  v_fmac_f32 v3, v56, v56
  v_fmac_f32 v3, v58, v58
  v_fmac_f32 v3, v60, v60
  v_fmac_f32 v3, v62, v62
  v_mul_f32 v3, 0x42800000, v3
  v_add_f32 v3, v3, v49
  v_add_f32 v3, v3, v51
  v_add_f32 v3, v3, v53
  v_add_f32 v3, v3, v55
  v_add_f32 v3, v3, v57
  v_add_f32 v3, v3, v59
  v_add_f32 v3, v3, v61
  v_add_f32 v3, v3, v63
  v_mov_b32 v4, v3
  s_nop 1
  v_permlane32_swap_b32 v3, v4
  s_nop 1
  v_add_f32 v3, v3, v4
  v_mov_b32 v4, 0x3727c5ac
  v_fmac_f32 v4, 0x3a800000, v3
  v_rsq_f32 v4, v4
  s_nop 0
  v_mov_b32 v242, v4
  v_mov_b32 v243, v4
  v_mul_f32 v4, v4, v2
  v_sub_f32 v246, 0, v4
  v_sub_f32 v247, 0, v4
  s_waitcnt vmcnt(20) lgkmcnt(0)
  s_barrier
  ds_read_b64_tr_b16 v[144:145], v6 offset:0
  ds_read_b64_tr_b16 v[146:147], v6 offset:2048
  ds_read_b64_tr_b16 v[148:149], v7 offset:0
  ds_read_b64_tr_b16 v[150:151], v7 offset:2048
  ds_read_b64_tr_b16 v[152:153], v6 offset:1024
  ds_read_b64_tr_b16 v[154:155], v6 offset:3072
  ds_read_b64_tr_b16 v[156:157], v7 offset:1024
  ds_read_b64_tr_b16 v[158:159], v7 offset:3072
  ds_read_b64_tr_b16 v[160:161], v6 offset:4096
  ds_read_b64_tr_b16 v[162:163], v6 offset:6144
  ds_read_b64_tr_b16 v[164:165], v7 offset:4096
  ds_read_b64_tr_b16 v[166:167], v7 offset:6144
  ds_read_b64_tr_b16 v[168:169], v6 offset:5120
  ds_read_b64_tr_b16 v[170:171], v6 offset:7168
  ds_read_b64_tr_b16 v[172:173], v7 offset:5120
  ds_read_b64_tr_b16 v[174:175], v7 offset:7168
  ds_read_b128 v[224:227], v14 offset:0
  ds_read_b64_tr_b16 v[232:233], v15 offset:0
  ds_read_b64_tr_b16 v[234:235], v15 offset:2048
  ds_read_b128 v[228:231], v14 offset:32
  ds_read_b64_tr_b16 v[236:237], v15 offset:4096
  ds_read_b64_tr_b16 v[238:239], v15 offset:6144
  s_waitcnt lgkmcnt(0)
  v_mfma_f32_32x32x16_bf16 v[16:31], v[144:147], a[0:3], 0
  ds_read_b64_tr_b16 v[176:177], v6 offset:8192
  ds_read_b64_tr_b16 v[178:179], v6 offset:10240
  buffer_load_dwordx4 a[112:115], v12, s[68:71], s32 offen offset:2048 sc1
  v_mfma_f32_32x32x16_bf16 v[208:223], v[232:235], v[224:227], v[208:223]
  v_mfma_f32_32x32x16_bf16 v[80:95], v[144:147], a[4:7], 0
  ds_read_b64_tr_b16 v[180:181], v7 offset:8192
  buffer_load_dwordx4 a[116:119], v13, s[68:71], s32 offen offset:2048 sc1
  v_mfma_f32_32x32x16_bf16 v[32:47], v[148:151], a[0:3], 0
  ds_read_b64_tr_b16 v[182:183], v7 offset:10240
  v_mfma_f32_32x32x16_bf16 v[208:223], v[236:239], v[228:231], v[208:223]
  v_mfma_f32_32x32x16_bf16 v[96:111], v[148:151], a[4:7], 0
  ds_read_b64_tr_b16 v[184:185], v6 offset:9216
  ds_read_b64_tr_b16 v[186:187], v6 offset:11264
  buffer_load_dwordx4 a[120:123], v12, s[68:71], s32 offen offset:3072 sc1
  v_mfma_f32_32x32x16_bf16 v[48:63], v[152:155], a[0:3], 0
  ds_read_b64_tr_b16 v[188:189], v7 offset:9216
  ds_read_b128 v[224:227], v14 offset:64
  v_mfma_f32_32x32x16_bf16 v[112:127], v[152:155], a[4:7], 0
  ds_read_b64_tr_b16 v[190:191], v7 offset:11264
  buffer_load_dwordx4 a[124:127], v13, s[68:71], s32 offen offset:3072 sc1
  s_add_u32 s32, s32, 4096
  v_mfma_f32_32x32x16_bf16 v[64:79], v[156:159], a[0:3], 0
  ds_read_b64_tr_b16 v[192:193], v6 offset:12288
  ds_read_b64_tr_b16 v[194:195], v6 offset:14336
  ds_read_b64_tr_b16 v[232:233], v15 offset:8192
  v_mfma_f32_32x32x16_bf16 v[128:143], v[156:159], a[4:7], 0
  ds_read_b64_tr_b16 v[196:197], v7 offset:12288
  v_mfma_f32_32x32x16_bf16 v[16:31], v[160:163], a[8:11], v[16:31]
  ds_read_b64_tr_b16 v[198:199], v7 offset:14336
  ds_read_b64_tr_b16 v[234:235], v15 offset:10240
  v_mfma_f32_32x32x16_bf16 v[80:95], v[160:163], a[12:15], v[80:95]
  ds_read_b64_tr_b16 v[200:201], v6 offset:13312
  ds_read_b64_tr_b16 v[202:203], v6 offset:15360
  v_mfma_f32_32x32x16_bf16 v[32:47], v[164:167], a[8:11], v[32:47]
  ds_read_b64_tr_b16 v[204:205], v7 offset:13312
  ds_read_b128 v[228:231], v14 offset:96
  v_mfma_f32_32x32x16_bf16 v[96:111], v[164:167], a[12:15], v[96:111]
  ds_read_b64_tr_b16 v[206:207], v7 offset:15360
  v_mfma_f32_32x32x16_bf16 v[48:63], v[168:171], a[8:11], v[48:63]
  ds_read_b64_tr_b16 v[236:237], v15 offset:12288
  v_mfma_f32_32x32x16_bf16 v[112:127], v[168:171], a[12:15], v[112:127]
  v_mfma_f32_32x32x16_bf16 v[64:79], v[172:175], a[8:11], v[64:79]
  ds_read_b64_tr_b16 v[238:239], v15 offset:14336
  v_mfma_f32_32x32x16_bf16 v[128:143], v[172:175], a[12:15], v[128:143]
  s_waitcnt vmcnt(16) lgkmcnt(0)
  s_barrier
  v_mfma_f32_32x32x16_bf16 v[16:31], v[176:179], a[16:19], v[16:31]
  ds_read_b64_tr_b16 v[144:145], v6 offset:16384
  ds_read_b64_tr_b16 v[146:147], v6 offset:18432
  s_add_u32 m0, s31, 0
  s_nop 0
  buffer_load_dwordx4 v8, s[52:55], s30 offen offset:0 lds
  v_mfma_f32_32x32x16_bf16 v[208:223], v[232:235], v[224:227], v[208:223]
  v_mfma_f32_32x32x16_bf16 v[80:95], v[176:179], a[20:23], v[80:95]
  ds_read_b64_tr_b16 v[148:149], v7 offset:16384
  buffer_load_dwordx4 v9, s[52:55], s30 offen offset:1024 lds
  v_mfma_f32_32x32x16_bf16 v[32:47], v[180:183], a[16:19], v[32:47]
  ds_read_b64_tr_b16 v[150:151], v7 offset:18432
  v_mfma_f32_32x32x16_bf16 v[208:223], v[236:239], v[228:231], v[208:223]
  v_mfma_f32_32x32x16_bf16 v[96:111], v[180:183], a[20:23], v[96:111]
  ds_read_b64_tr_b16 v[152:153], v6 offset:17408
  ds_read_b64_tr_b16 v[154:155], v6 offset:19456
  buffer_load_dwordx4 v10, s[52:55], s30 offen offset:2048 lds
  v_mfma_f32_32x32x16_bf16 v[48:63], v[184:187], a[16:19], v[48:63]
  ds_read_b64_tr_b16 v[156:157], v7 offset:17408
  ds_read_b128 v[224:227], v14 offset:128
  v_mfma_f32_32x32x16_bf16 v[112:127], v[184:187], a[20:23], v[112:127]
  ds_read_b64_tr_b16 v[158:159], v7 offset:19456
  buffer_load_dwordx4 v11, s[52:55], s30 offen offset:3072 lds
  v_mfma_f32_32x32x16_bf16 v[64:79], v[188:191], a[16:19], v[64:79]
  ds_read_b64_tr_b16 v[160:161], v6 offset:20480
  ds_read_b64_tr_b16 v[162:163], v6 offset:22528
  ds_read_b64_tr_b16 v[232:233], v15 offset:16384
  v_mfma_f32_32x32x16_bf16 v[128:143], v[188:191], a[20:23], v[128:143]
  ds_read_b64_tr_b16 v[164:165], v7 offset:20480
  s_add_u32 s30, s30, 458752
  v_mfma_f32_32x32x16_bf16 v[16:31], v[192:195], a[24:27], v[16:31]
  ds_read_b64_tr_b16 v[166:167], v7 offset:22528
  buffer_load_dwordx4 a[0:3], v12, s[68:71], s32 offen offset:0 sc1
  ds_read_b64_tr_b16 v[234:235], v15 offset:18432
  v_mfma_f32_32x32x16_bf16 v[80:95], v[192:195], a[28:31], v[80:95]
  ds_read_b64_tr_b16 v[168:169], v6 offset:21504
  ds_read_b64_tr_b16 v[170:171], v6 offset:23552
  v_mfma_f32_32x32x16_bf16 v[32:47], v[196:199], a[24:27], v[32:47]
  ds_read_b64_tr_b16 v[172:173], v7 offset:21504
  buffer_load_dwordx4 a[4:7], v13, s[68:71], s32 offen offset:0 sc1
  ds_read_b128 v[228:231], v14 offset:160
  v_mfma_f32_32x32x16_bf16 v[96:111], v[196:199], a[28:31], v[96:111]
  ds_read_b64_tr_b16 v[174:175], v7 offset:23552
  v_mfma_f32_32x32x16_bf16 v[48:63], v[200:203], a[24:27], v[48:63]
  buffer_load_dwordx4 a[8:11], v12, s[68:71], s32 offen offset:1024 sc1
  ds_read_b64_tr_b16 v[236:237], v15 offset:20480
  v_mfma_f32_32x32x16_bf16 v[112:127], v[200:203], a[28:31], v[112:127]
  v_mfma_f32_32x32x16_bf16 v[64:79], v[204:207], a[24:27], v[64:79]
  buffer_load_dwordx4 a[12:15], v13, s[68:71], s32 offen offset:1024 sc1
  ds_read_b64_tr_b16 v[238:239], v15 offset:22528
  v_mfma_f32_32x32x16_bf16 v[128:143], v[204:207], a[28:31], v[128:143]
  s_waitcnt lgkmcnt(0)
  v_mfma_f32_32x32x16_bf16 v[16:31], v[144:147], a[32:35], v[16:31]
  ds_read_b64_tr_b16 v[176:177], v6 offset:24576
  ds_read_b64_tr_b16 v[178:179], v6 offset:26624
  buffer_load_dwordx4 a[16:19], v12, s[68:71], s32 offen offset:2048 sc1
  v_mfma_f32_32x32x16_bf16 v[208:223], v[232:235], v[224:227], v[208:223]
  v_mfma_f32_32x32x16_bf16 v[80:95], v[144:147], a[36:39], v[80:95]
  ds_read_b64_tr_b16 v[180:181], v7 offset:24576
  buffer_load_dwordx4 a[20:23], v13, s[68:71], s32 offen offset:2048 sc1
  v_mfma_f32_32x32x16_bf16 v[32:47], v[148:151], a[32:35], v[32:47]
  ds_read_b64_tr_b16 v[182:183], v7 offset:26624
  v_mfma_f32_32x32x16_bf16 v[208:223], v[236:239], v[228:231], v[208:223]
  v_mfma_f32_32x32x16_bf16 v[96:111], v[148:151], a[36:39], v[96:111]
  ds_read_b64_tr_b16 v[184:185], v6 offset:25600
  ds_read_b64_tr_b16 v[186:187], v6 offset:27648
  buffer_load_dwordx4 a[24:27], v12, s[68:71], s32 offen offset:3072 sc1
  v_mfma_f32_32x32x16_bf16 v[48:63], v[152:155], a[32:35], v[48:63]
  ds_read_b64_tr_b16 v[188:189], v7 offset:25600
  ds_read_b128 v[224:227], v14 offset:192
  v_mfma_f32_32x32x16_bf16 v[112:127], v[152:155], a[36:39], v[112:127]
  ds_read_b64_tr_b16 v[190:191], v7 offset:27648
  buffer_load_dwordx4 a[28:31], v13, s[68:71], s32 offen offset:3072 sc1
  s_add_u32 s32, s32, 4096
  v_mfma_f32_32x32x16_bf16 v[64:79], v[156:159], a[32:35], v[64:79]
  ds_read_b64_tr_b16 v[192:193], v6 offset:28672
  ds_read_b64_tr_b16 v[194:195], v6 offset:30720
  ds_read_b64_tr_b16 v[232:233], v15 offset:24576
  v_mfma_f32_32x32x16_bf16 v[128:143], v[156:159], a[36:39], v[128:143]
  ds_read_b64_tr_b16 v[196:197], v7 offset:28672
  v_mfma_f32_32x32x16_bf16 v[16:31], v[160:163], a[40:43], v[16:31]
  ds_read_b64_tr_b16 v[198:199], v7 offset:30720
  ds_read_b64_tr_b16 v[234:235], v15 offset:26624
  v_mfma_f32_32x32x16_bf16 v[80:95], v[160:163], a[44:47], v[80:95]
  ds_read_b64_tr_b16 v[200:201], v6 offset:29696
  ds_read_b64_tr_b16 v[202:203], v6 offset:31744
  v_mfma_f32_32x32x16_bf16 v[32:47], v[164:167], a[40:43], v[32:47]
  ds_read_b64_tr_b16 v[204:205], v7 offset:29696
  ds_read_b128 v[228:231], v14 offset:224
  v_mfma_f32_32x32x16_bf16 v[96:111], v[164:167], a[44:47], v[96:111]
  ds_read_b64_tr_b16 v[206:207], v7 offset:31744
  v_mfma_f32_32x32x16_bf16 v[48:63], v[168:171], a[40:43], v[48:63]
  ds_read_b64_tr_b16 v[236:237], v15 offset:28672
  v_mfma_f32_32x32x16_bf16 v[112:127], v[168:171], a[44:47], v[112:127]
  v_mfma_f32_32x32x16_bf16 v[64:79], v[172:175], a[40:43], v[64:79]
  ds_read_b64_tr_b16 v[238:239], v15 offset:30720
  v_mfma_f32_32x32x16_bf16 v[128:143], v[172:175], a[44:47], v[128:143]
  s_waitcnt vmcnt(20) lgkmcnt(0)
  s_barrier
  v_mfma_f32_32x32x16_bf16 v[16:31], v[176:179], a[48:51], v[16:31]
  ds_read_b64_tr_b16 v[144:145], v6 offset:32768
  ds_read_b64_tr_b16 v[146:147], v6 offset:34816
  s_add_u32 m0, s31, 16384
  s_nop 0
  buffer_load_dwordx4 v8, s[52:55], s30 offen offset:0 lds
  v_mfma_f32_32x32x16_bf16 v[208:223], v[232:235], v[224:227], v[208:223]
  v_mfma_f32_32x32x16_bf16 v[80:95], v[176:179], a[52:55], v[80:95]
  ds_read_b64_tr_b16 v[148:149], v7 offset:32768
  buffer_load_dwordx4 v9, s[52:55], s30 offen offset:1024 lds
  v_mfma_f32_32x32x16_bf16 v[32:47], v[180:183], a[48:51], v[32:47]
  ds_read_b64_tr_b16 v[150:151], v7 offset:34816
  v_mfma_f32_32x32x16_bf16 v[208:223], v[236:239], v[228:231], v[208:223]
  v_mfma_f32_32x32x16_bf16 v[96:111], v[180:183], a[52:55], v[96:111]
  ds_read_b64_tr_b16 v[152:153], v6 offset:33792
  ds_read_b64_tr_b16 v[154:155], v6 offset:35840
  buffer_load_dwordx4 v10, s[52:55], s30 offen offset:2048 lds
  v_mfma_f32_32x32x16_bf16 v[48:63], v[184:187], a[48:51], v[48:63]
  ds_read_b64_tr_b16 v[156:157], v7 offset:33792
  ds_read_b128 v[224:227], v14 offset:256
  v_mfma_f32_32x32x16_bf16 v[112:127], v[184:187], a[52:55], v[112:127]
  ds_read_b64_tr_b16 v[158:159], v7 offset:35840
  buffer_load_dwordx4 v11, s[52:55], s30 offen offset:3072 lds
  v_mfma_f32_32x32x16_bf16 v[64:79], v[188:191], a[48:51], v[64:79]
  ds_read_b64_tr_b16 v[160:161], v6 offset:36864
  ds_read_b64_tr_b16 v[162:163], v6 offset:38912
  ds_read_b64_tr_b16 v[232:233], v15 offset:32768
  v_mfma_f32_32x32x16_bf16 v[128:143], v[188:191], a[52:55], v[128:143]
  ds_read_b64_tr_b16 v[164:165], v7 offset:36864
  s_add_u32 s30, s30, 458752
  v_mfma_f32_32x32x16_bf16 v[16:31], v[192:195], a[56:59], v[16:31]
  ds_read_b64_tr_b16 v[166:167], v7 offset:38912
  buffer_load_dwordx4 a[32:35], v12, s[68:71], s32 offen offset:0 sc1
  ds_read_b64_tr_b16 v[234:235], v15 offset:34816
  v_mfma_f32_32x32x16_bf16 v[80:95], v[192:195], a[60:63], v[80:95]
  ds_read_b64_tr_b16 v[168:169], v6 offset:37888
  ds_read_b64_tr_b16 v[170:171], v6 offset:39936
  v_mfma_f32_32x32x16_bf16 v[32:47], v[196:199], a[56:59], v[32:47]
  ds_read_b64_tr_b16 v[172:173], v7 offset:37888
  buffer_load_dwordx4 a[36:39], v13, s[68:71], s32 offen offset:0 sc1
  ds_read_b128 v[228:231], v14 offset:288
  v_mfma_f32_32x32x16_bf16 v[96:111], v[196:199], a[60:63], v[96:111]
  ds_read_b64_tr_b16 v[174:175], v7 offset:39936
  v_mfma_f32_32x32x16_bf16 v[48:63], v[200:203], a[56:59], v[48:63]
  buffer_load_dwordx4 a[40:43], v12, s[68:71], s32 offen offset:1024 sc1
  ds_read_b64_tr_b16 v[236:237], v15 offset:36864
  v_mfma_f32_32x32x16_bf16 v[112:127], v[200:203], a[60:63], v[112:127]
  v_mfma_f32_32x32x16_bf16 v[64:79], v[204:207], a[56:59], v[64:79]
  buffer_load_dwordx4 a[44:47], v13, s[68:71], s32 offen offset:1024 sc1
  ds_read_b64_tr_b16 v[238:239], v15 offset:38912
  v_mfma_f32_32x32x16_bf16 v[128:143], v[204:207], a[60:63], v[128:143]
  s_waitcnt lgkmcnt(0)
  v_mfma_f32_32x32x16_bf16 v[16:31], v[144:147], a[64:67], v[16:31]
  ds_read_b64_tr_b16 v[176:177], v6 offset:40960
  ds_read_b64_tr_b16 v[178:179], v6 offset:43008
  buffer_load_dwordx4 a[48:51], v12, s[68:71], s32 offen offset:2048 sc1
  v_mfma_f32_32x32x16_bf16 v[208:223], v[232:235], v[224:227], v[208:223]
  v_mfma_f32_32x32x16_bf16 v[80:95], v[144:147], a[68:71], v[80:95]
  ds_read_b64_tr_b16 v[180:181], v7 offset:40960
  buffer_load_dwordx4 a[52:55], v13, s[68:71], s32 offen offset:2048 sc1
  v_mfma_f32_32x32x16_bf16 v[32:47], v[148:151], a[64:67], v[32:47]
  ds_read_b64_tr_b16 v[182:183], v7 offset:43008
  v_mfma_f32_32x32x16_bf16 v[208:223], v[236:239], v[228:231], v[208:223]
  v_mfma_f32_32x32x16_bf16 v[96:111], v[148:151], a[68:71], v[96:111]
  ds_read_b64_tr_b16 v[184:185], v6 offset:41984
  ds_read_b64_tr_b16 v[186:187], v6 offset:44032
  buffer_load_dwordx4 a[56:59], v12, s[68:71], s32 offen offset:3072 sc1
  v_mfma_f32_32x32x16_bf16 v[48:63], v[152:155], a[64:67], v[48:63]
  ds_read_b64_tr_b16 v[188:189], v7 offset:41984
  ds_read_b128 v[224:227], v14 offset:320
  v_mfma_f32_32x32x16_bf16 v[112:127], v[152:155], a[68:71], v[112:127]
  ds_read_b64_tr_b16 v[190:191], v7 offset:44032
  buffer_load_dwordx4 a[60:63], v13, s[68:71], s32 offen offset:3072 sc1
  s_add_u32 s32, s32, 4096
  v_mfma_f32_32x32x16_bf16 v[64:79], v[156:159], a[64:67], v[64:79]
  ds_read_b64_tr_b16 v[192:193], v6 offset:45056
  ds_read_b64_tr_b16 v[194:195], v6 offset:47104
  ds_read_b64_tr_b16 v[232:233], v15 offset:40960
  v_mfma_f32_32x32x16_bf16 v[128:143], v[156:159], a[68:71], v[128:143]
  ds_read_b64_tr_b16 v[196:197], v7 offset:45056
  v_mfma_f32_32x32x16_bf16 v[16:31], v[160:163], a[72:75], v[16:31]
  ds_read_b64_tr_b16 v[198:199], v7 offset:47104
  ds_read_b64_tr_b16 v[234:235], v15 offset:43008
  v_mfma_f32_32x32x16_bf16 v[80:95], v[160:163], a[76:79], v[80:95]
  ds_read_b64_tr_b16 v[200:201], v6 offset:46080
  ds_read_b64_tr_b16 v[202:203], v6 offset:48128
  v_mfma_f32_32x32x16_bf16 v[32:47], v[164:167], a[72:75], v[32:47]
  ds_read_b64_tr_b16 v[204:205], v7 offset:46080
  ds_read_b128 v[228:231], v14 offset:352
  v_mfma_f32_32x32x16_bf16 v[96:111], v[164:167], a[76:79], v[96:111]
  ds_read_b64_tr_b16 v[206:207], v7 offset:48128
  v_mfma_f32_32x32x16_bf16 v[48:63], v[168:171], a[72:75], v[48:63]
  ds_read_b64_tr_b16 v[236:237], v15 offset:45056
  v_mfma_f32_32x32x16_bf16 v[112:127], v[168:171], a[76:79], v[112:127]
  v_mfma_f32_32x32x16_bf16 v[64:79], v[172:175], a[72:75], v[64:79]
  ds_read_b64_tr_b16 v[238:239], v15 offset:47104
  v_mfma_f32_32x32x16_bf16 v[128:143], v[172:175], a[76:79], v[128:143]
  s_waitcnt vmcnt(24) lgkmcnt(0)
  s_barrier
  v_mfma_f32_32x32x16_bf16 v[16:31], v[176:179], a[80:83], v[16:31]
  ds_read_b64_tr_b16 v[144:145], v6 offset:49152
  ds_read_b64_tr_b16 v[146:147], v6 offset:51200
  s_add_u32 m0, s31, 32768
  s_nop 0
  buffer_load_dwordx4 v8, s[52:55], s30 offen offset:0 lds
  v_mfma_f32_32x32x16_bf16 v[208:223], v[232:235], v[224:227], v[208:223]
  v_mfma_f32_32x32x16_bf16 v[80:95], v[176:179], a[84:87], v[80:95]
  ds_read_b64_tr_b16 v[148:149], v7 offset:49152
  buffer_load_dwordx4 v9, s[52:55], s30 offen offset:1024 lds
  v_mfma_f32_32x32x16_bf16 v[32:47], v[180:183], a[80:83], v[32:47]
  ds_read_b64_tr_b16 v[150:151], v7 offset:51200
  v_mfma_f32_32x32x16_bf16 v[208:223], v[236:239], v[228:231], v[208:223]
  v_mfma_f32_32x32x16_bf16 v[96:111], v[180:183], a[84:87], v[96:111]
  ds_read_b64_tr_b16 v[152:153], v6 offset:50176
  ds_read_b64_tr_b16 v[154:155], v6 offset:52224
  buffer_load_dwordx4 v10, s[52:55], s30 offen offset:2048 lds
  v_mfma_f32_32x32x16_bf16 v[48:63], v[184:187], a[80:83], v[48:63]
  ds_read_b64_tr_b16 v[156:157], v7 offset:50176
  ds_read_b128 v[224:227], v14 offset:384
  v_mfma_f32_32x32x16_bf16 v[112:127], v[184:187], a[84:87], v[112:127]
  ds_read_b64_tr_b16 v[158:159], v7 offset:52224
  buffer_load_dwordx4 v11, s[52:55], s30 offen offset:3072 lds
  v_mfma_f32_32x32x16_bf16 v[64:79], v[188:191], a[80:83], v[64:79]
  ds_read_b64_tr_b16 v[160:161], v6 offset:53248
  ds_read_b64_tr_b16 v[162:163], v6 offset:55296
  ds_read_b64_tr_b16 v[232:233], v15 offset:49152
  v_mfma_f32_32x32x16_bf16 v[128:143], v[188:191], a[84:87], v[128:143]
  ds_read_b64_tr_b16 v[164:165], v7 offset:53248
  s_add_u32 s30, s30, 458752
  v_mfma_f32_32x32x16_bf16 v[16:31], v[192:195], a[88:91], v[16:31]
  ds_read_b64_tr_b16 v[166:167], v7 offset:55296
  buffer_load_dwordx4 a[64:67], v12, s[68:71], s32 offen offset:0 sc1
  ds_read_b64_tr_b16 v[234:235], v15 offset:51200
  v_mfma_f32_32x32x16_bf16 v[80:95], v[192:195], a[92:95], v[80:95]
  ds_read_b64_tr_b16 v[168:169], v6 offset:54272
  ds_read_b64_tr_b16 v[170:171], v6 offset:56320
  v_mfma_f32_32x32x16_bf16 v[32:47], v[196:199], a[88:91], v[32:47]
  ds_read_b64_tr_b16 v[172:173], v7 offset:54272
  buffer_load_dwordx4 a[68:71], v13, s[68:71], s32 offen offset:0 sc1
  ds_read_b128 v[228:231], v14 offset:416
  v_mfma_f32_32x32x16_bf16 v[96:111], v[196:199], a[92:95], v[96:111]
  ds_read_b64_tr_b16 v[174:175], v7 offset:56320
  v_mfma_f32_32x32x16_bf16 v[48:63], v[200:203], a[88:91], v[48:63]
  buffer_load_dwordx4 a[72:75], v12, s[68:71], s32 offen offset:1024 sc1
  ds_read_b64_tr_b16 v[236:237], v15 offset:53248
  v_mfma_f32_32x32x16_bf16 v[112:127], v[200:203], a[92:95], v[112:127]
  v_mfma_f32_32x32x16_bf16 v[64:79], v[204:207], a[88:91], v[64:79]
  buffer_load_dwordx4 a[76:79], v13, s[68:71], s32 offen offset:1024 sc1
  ds_read_b64_tr_b16 v[238:239], v15 offset:55296
  v_mfma_f32_32x32x16_bf16 v[128:143], v[204:207], a[92:95], v[128:143]
  s_waitcnt lgkmcnt(0)
  v_mfma_f32_32x32x16_bf16 v[16:31], v[144:147], a[96:99], v[16:31]
  ds_read_b64_tr_b16 v[176:177], v6 offset:57344
  ds_read_b64_tr_b16 v[178:179], v6 offset:59392
  buffer_load_dwordx4 a[80:83], v12, s[68:71], s32 offen offset:2048 sc1
  v_mfma_f32_32x32x16_bf16 v[208:223], v[232:235], v[224:227], v[208:223]
  v_mfma_f32_32x32x16_bf16 v[80:95], v[144:147], a[100:103], v[80:95]
  ds_read_b64_tr_b16 v[180:181], v7 offset:57344
  buffer_load_dwordx4 a[84:87], v13, s[68:71], s32 offen offset:2048 sc1
  v_mfma_f32_32x32x16_bf16 v[32:47], v[148:151], a[96:99], v[32:47]
  ds_read_b64_tr_b16 v[182:183], v7 offset:59392
  v_mfma_f32_32x32x16_bf16 v[208:223], v[236:239], v[228:231], v[208:223]
  v_mfma_f32_32x32x16_bf16 v[96:111], v[148:151], a[100:103], v[96:111]
  ds_read_b64_tr_b16 v[184:185], v6 offset:58368
  ds_read_b64_tr_b16 v[186:187], v6 offset:60416
  buffer_load_dwordx4 a[88:91], v12, s[68:71], s32 offen offset:3072 sc1
  v_mfma_f32_32x32x16_bf16 v[48:63], v[152:155], a[96:99], v[48:63]
  ds_read_b64_tr_b16 v[188:189], v7 offset:58368
  ds_read_b128 v[224:227], v14 offset:448
  v_mfma_f32_32x32x16_bf16 v[112:127], v[152:155], a[100:103], v[112:127]
  ds_read_b64_tr_b16 v[190:191], v7 offset:60416
  buffer_load_dwordx4 a[92:95], v13, s[68:71], s32 offen offset:3072 sc1
  s_add_u32 s32, s32, 4096
  v_mfma_f32_32x32x16_bf16 v[64:79], v[156:159], a[96:99], v[64:79]
  ds_read_b64_tr_b16 v[192:193], v6 offset:61440
  ds_read_b64_tr_b16 v[194:195], v6 offset:63488
  ds_read_b64_tr_b16 v[232:233], v15 offset:57344
  v_mfma_f32_32x32x16_bf16 v[128:143], v[156:159], a[100:103], v[128:143]
  ds_read_b64_tr_b16 v[196:197], v7 offset:61440
  v_mfma_f32_32x32x16_bf16 v[16:31], v[160:163], a[104:107], v[16:31]
  ds_read_b64_tr_b16 v[198:199], v7 offset:63488
  ds_read_b64_tr_b16 v[234:235], v15 offset:59392
  v_mfma_f32_32x32x16_bf16 v[80:95], v[160:163], a[108:111], v[80:95]
  ds_read_b64_tr_b16 v[200:201], v6 offset:62464
  ds_read_b64_tr_b16 v[202:203], v6 offset:64512
  v_mfma_f32_32x32x16_bf16 v[32:47], v[164:167], a[104:107], v[32:47]
  ds_read_b64_tr_b16 v[204:205], v7 offset:62464
  ds_read_b128 v[228:231], v14 offset:480
  v_mfma_f32_32x32x16_bf16 v[96:111], v[164:167], a[108:111], v[96:111]
  ds_read_b64_tr_b16 v[206:207], v7 offset:64512
  v_mfma_f32_32x32x16_bf16 v[48:63], v[168:171], a[104:107], v[48:63]
  ds_read_b64_tr_b16 v[236:237], v15 offset:61440
  v_mfma_f32_32x32x16_bf16 v[112:127], v[168:171], a[108:111], v[112:127]
  v_mfma_f32_32x32x16_bf16 v[64:79], v[172:175], a[104:107], v[64:79]
  ds_read_b64_tr_b16 v[238:239], v15 offset:63488
  v_mfma_f32_32x32x16_bf16 v[128:143], v[172:175], a[108:111], v[128:143]
  s_waitcnt vmcnt(24) lgkmcnt(0)
  s_barrier
  v_mfma_f32_32x32x16_bf16 v[16:31], v[176:179], a[112:115], v[16:31]
  ds_read_b64_tr_b16 v[144:145], v6 offset:0
  ds_read_b64_tr_b16 v[146:147], v6 offset:2048
  s_add_u32 m0, s31, 49152
  s_nop 0
  buffer_load_dwordx4 v8, s[52:55], s30 offen offset:0 lds
  v_mfma_f32_32x32x16_bf16 v[208:223], v[232:235], v[224:227], v[208:223]
  v_mfma_f32_32x32x16_bf16 v[80:95], v[176:179], a[116:119], v[80:95]
  ds_read_b64_tr_b16 v[148:149], v7 offset:0
  buffer_load_dwordx4 v9, s[52:55], s30 offen offset:1024 lds
  v_mfma_f32_32x32x16_bf16 v[208:223], v[236:239], v[228:231], v[208:223]
  v_mfma_f32_32x32x16_bf16 v[32:47], v[180:183], a[112:115], v[32:47]
  ds_read_b64_tr_b16 v[150:151], v7 offset:2048
  v_mfma_f32_32x32x16_bf16 v[96:111], v[180:183], a[116:119], v[96:111]
  ds_read_b64_tr_b16 v[152:153], v6 offset:1024
  ds_read_b64_tr_b16 v[154:155], v6 offset:3072
  buffer_load_dwordx4 v10, s[52:55], s30 offen offset:2048 lds
  v_add_u32 v14, 512, v14
  v_mfma_f32_32x32x16_bf16 v[48:63], v[184:187], a[112:115], v[48:63]
  ds_read_b64_tr_b16 v[156:157], v7 offset:1024
  v_mfma_f32_32x32x16_bf16 v[112:127], v[184:187], a[116:119], v[112:127]
  ds_read_b64_tr_b16 v[158:159], v7 offset:3072
  buffer_load_dwordx4 v11, s[52:55], s30 offen offset:3072 lds
  ds_read_b128 v[224:227], v14 offset:0
  v_mfma_f32_32x32x16_bf16 v[64:79], v[188:191], a[112:115], v[64:79]
  ds_read_b64_tr_b16 v[160:161], v6 offset:4096
  ds_read_b64_tr_b16 v[162:163], v6 offset:6144
  v_mfma_f32_32x32x16_bf16 v[128:143], v[188:191], a[116:119], v[128:143]
  ds_read_b64_tr_b16 v[164:165], v7 offset:4096
  s_add_u32 s30, s30, 458752
  ds_read_b64_tr_b16 v[232:233], v15 offset:0
  v_mfma_f32_32x32x16_bf16 v[16:31], v[192:195], a[120:123], v[16:31]
  ds_read_b64_tr_b16 v[166:167], v7 offset:6144
  buffer_load_dwordx4 a[96:99], v12, s[68:71], s32 offen offset:0 sc1
  ds_read_b64_tr_b16 v[234:235], v15 offset:2048
  v_mfma_f32_32x32x16_bf16 v[80:95], v[192:195], a[124:127], v[80:95]
  ds_read_b64_tr_b16 v[168:169], v6 offset:5120
  ds_read_b64_tr_b16 v[170:171], v6 offset:7168
  v_mfma_f32_32x32x16_bf16 v[32:47], v[196:199], a[120:123], v[32:47]
  ds_read_b64_tr_b16 v[172:173], v7 offset:5120
  buffer_load_dwordx4 a[100:103], v13, s[68:71], s32 offen offset:0 sc1
  ds_read_b128 v[228:231], v14 offset:32
  v_mfma_f32_32x32x16_bf16 v[96:111], v[196:199], a[124:127], v[96:111]
  ds_read_b64_tr_b16 v[174:175], v7 offset:7168
  v_mfma_f32_32x32x16_bf16 v[48:63], v[200:203], a[120:123], v[48:63]
  buffer_load_dwordx4 a[104:107], v12, s[68:71], s32 offen offset:1024 sc1
  ds_read_b64_tr_b16 v[236:237], v15 offset:4096
  v_mfma_f32_32x32x16_bf16 v[112:127], v[200:203], a[124:127], v[112:127]
  v_mfma_f32_32x32x16_bf16 v[64:79], v[204:207], a[120:123], v[64:79]
  buffer_load_dwordx4 a[108:111], v13, s[68:71], s32 offen offset:1024 sc1
  ds_read_b64_tr_b16 v[238:239], v15 offset:6144
  v_mfma_f32_32x32x16_bf16 v[128:143], v[204:207], a[124:127], v[128:143]
  s_mov_b32 s20, 2
.p2align 3
f1_l:
  s_waitcnt lgkmcnt(0)
  v_mfma_f32_32x32x16_bf16 v[16:31], v[144:147], a[0:3], v[16:31]
  ds_read_b64_tr_b16 v[176:177], v6 offset:8192
  ds_read_b64_tr_b16 v[178:179], v6 offset:10240
  buffer_load_dwordx4 a[112:115], v12, s[68:71], s32 offen offset:2048 sc1
  v_mfma_f32_32x32x16_bf16 v[208:223], v[232:235], v[224:227], v[208:223]
  v_mfma_f32_32x32x16_bf16 v[80:95], v[144:147], a[4:7], v[80:95]
  ds_read_b64_tr_b16 v[180:181], v7 offset:8192
  buffer_load_dwordx4 a[116:119], v13, s[68:71], s32 offen offset:2048 sc1
  v_mfma_f32_32x32x16_bf16 v[32:47], v[148:151], a[0:3], v[32:47]
  ds_read_b64_tr_b16 v[182:183], v7 offset:10240
  v_mfma_f32_32x32x16_bf16 v[208:223], v[236:239], v[228:231], v[208:223]
  v_mfma_f32_32x32x16_bf16 v[96:111], v[148:151], a[4:7], v[96:111]
  ds_read_b64_tr_b16 v[184:185], v6 offset:9216
  ds_read_b64_tr_b16 v[186:187], v6 offset:11264
  buffer_load_dwordx4 a[120:123], v12, s[68:71], s32 offen offset:3072 sc1
  v_mfma_f32_32x32x16_bf16 v[48:63], v[152:155], a[0:3], v[48:63]
  ds_read_b64_tr_b16 v[188:189], v7 offset:9216
  ds_read_b128 v[224:227], v14 offset:64
  v_mfma_f32_32x32x16_bf16 v[112:127], v[152:155], a[4:7], v[112:127]
  ds_read_b64_tr_b16 v[190:191], v7 offset:11264
  buffer_load_dwordx4 a[124:127], v13, s[68:71], s32 offen offset:3072 sc1
  s_add_u32 s32, s32, 4096
  v_mfma_f32_32x32x16_bf16 v[64:79], v[156:159], a[0:3], v[64:79]
  ds_read_b64_tr_b16 v[192:193], v6 offset:12288
  ds_read_b64_tr_b16 v[194:195], v6 offset:14336
  ds_read_b64_tr_b16 v[232:233], v15 offset:8192
  v_mfma_f32_32x32x16_bf16 v[128:143], v[156:159], a[4:7], v[128:143]
  ds_read_b64_tr_b16 v[196:197], v7 offset:12288
  v_mfma_f32_32x32x16_bf16 v[16:31], v[160:163], a[8:11], v[16:31]
  ds_read_b64_tr_b16 v[198:199], v7 offset:14336
  ds_read_b64_tr_b16 v[234:235], v15 offset:10240
  v_mfma_f32_32x32x16_bf16 v[80:95], v[160:163], a[12:15], v[80:95]
  ds_read_b64_tr_b16 v[200:201], v6 offset:13312
  ds_read_b64_tr_b16 v[202:203], v6 offset:15360
  v_mfma_f32_32x32x16_bf16 v[32:47], v[164:167], a[8:11], v[32:47]
  ds_read_b64_tr_b16 v[204:205], v7 offset:13312
  ds_read_b128 v[228:231], v14 offset:96
  v_mfma_f32_32x32x16_bf16 v[96:111], v[164:167], a[12:15], v[96:111]
  ds_read_b64_tr_b16 v[206:207], v7 offset:15360
  v_mfma_f32_32x32x16_bf16 v[48:63], v[168:171], a[8:11], v[48:63]
  ds_read_b64_tr_b16 v[236:237], v15 offset:12288
  v_mfma_f32_32x32x16_bf16 v[112:127], v[168:171], a[12:15], v[112:127]
  v_mfma_f32_32x32x16_bf16 v[64:79], v[172:175], a[8:11], v[64:79]
  ds_read_b64_tr_b16 v[238:239], v15 offset:14336
  v_mfma_f32_32x32x16_bf16 v[128:143], v[172:175], a[12:15], v[128:143]
  s_waitcnt vmcnt(24) lgkmcnt(0)
  s_barrier
  v_mfma_f32_32x32x16_bf16 v[16:31], v[176:179], a[16:19], v[16:31]
  ds_read_b64_tr_b16 v[144:145], v6 offset:16384
  ds_read_b64_tr_b16 v[146:147], v6 offset:18432
  s_add_u32 m0, s31, 0
  s_nop 0
  buffer_load_dwordx4 v8, s[52:55], s30 offen offset:0 lds
  v_mfma_f32_32x32x16_bf16 v[208:223], v[232:235], v[224:227], v[208:223]
  v_mfma_f32_32x32x16_bf16 v[80:95], v[176:179], a[20:23], v[80:95]
  ds_read_b64_tr_b16 v[148:149], v7 offset:16384
  buffer_load_dwordx4 v9, s[52:55], s30 offen offset:1024 lds
  v_mfma_f32_32x32x16_bf16 v[32:47], v[180:183], a[16:19], v[32:47]
  ds_read_b64_tr_b16 v[150:151], v7 offset:18432
  v_mfma_f32_32x32x16_bf16 v[208:223], v[236:239], v[228:231], v[208:223]
  v_mfma_f32_32x32x16_bf16 v[96:111], v[180:183], a[20:23], v[96:111]
  ds_read_b64_tr_b16 v[152:153], v6 offset:17408
  ds_read_b64_tr_b16 v[154:155], v6 offset:19456
  buffer_load_dwordx4 v10, s[52:55], s30 offen offset:2048 lds
  v_mfma_f32_32x32x16_bf16 v[48:63], v[184:187], a[16:19], v[48:63]
  ds_read_b64_tr_b16 v[156:157], v7 offset:17408
  ds_read_b128 v[224:227], v14 offset:128
  v_mfma_f32_32x32x16_bf16 v[112:127], v[184:187], a[20:23], v[112:127]
  ds_read_b64_tr_b16 v[158:159], v7 offset:19456
  buffer_load_dwordx4 v11, s[52:55], s30 offen offset:3072 lds
  v_mfma_f32_32x32x16_bf16 v[64:79], v[188:191], a[16:19], v[64:79]
  ds_read_b64_tr_b16 v[160:161], v6 offset:20480
  ds_read_b64_tr_b16 v[162:163], v6 offset:22528
  ds_read_b64_tr_b16 v[232:233], v15 offset:16384
  v_mfma_f32_32x32x16_bf16 v[128:143], v[188:191], a[20:23], v[128:143]
  ds_read_b64_tr_b16 v[164:165], v7 offset:20480
  s_add_u32 s30, s30, 458752
  v_mfma_f32_32x32x16_bf16 v[16:31], v[192:195], a[24:27], v[16:31]
  ds_read_b64_tr_b16 v[166:167], v7 offset:22528
  buffer_load_dwordx4 a[0:3], v12, s[68:71], s32 offen offset:0 sc1
  ds_read_b64_tr_b16 v[234:235], v15 offset:18432
  v_mfma_f32_32x32x16_bf16 v[80:95], v[192:195], a[28:31], v[80:95]
  ds_read_b64_tr_b16 v[168:169], v6 offset:21504
  ds_read_b64_tr_b16 v[170:171], v6 offset:23552
  v_mfma_f32_32x32x16_bf16 v[32:47], v[196:199], a[24:27], v[32:47]
  ds_read_b64_tr_b16 v[172:173], v7 offset:21504
  buffer_load_dwordx4 a[4:7], v13, s[68:71], s32 offen offset:0 sc1
  ds_read_b128 v[228:231], v14 offset:160
  v_mfma_f32_32x32x16_bf16 v[96:111], v[196:199], a[28:31], v[96:111]
  ds_read_b64_tr_b16 v[174:175], v7 offset:23552
  v_mfma_f32_32x32x16_bf16 v[48:63], v[200:203], a[24:27], v[48:63]
  buffer_load_dwordx4 a[8:11], v12, s[68:71], s32 offen offset:1024 sc1
  ds_read_b64_tr_b16 v[236:237], v15 offset:20480
  v_mfma_f32_32x32x16_bf16 v[112:127], v[200:203], a[28:31], v[112:127]
  v_mfma_f32_32x32x16_bf16 v[64:79], v[204:207], a[24:27], v[64:79]
  buffer_load_dwordx4 a[12:15], v13, s[68:71], s32 offen offset:1024 sc1
  ds_read_b64_tr_b16 v[238:239], v15 offset:22528
  v_mfma_f32_32x32x16_bf16 v[128:143], v[204:207], a[28:31], v[128:143]
  s_waitcnt lgkmcnt(0)
  v_mfma_f32_32x32x16_bf16 v[16:31], v[144:147], a[32:35], v[16:31]
  ds_read_b64_tr_b16 v[176:177], v6 offset:24576
  ds_read_b64_tr_b16 v[178:179], v6 offset:26624
  buffer_load_dwordx4 a[16:19], v12, s[68:71], s32 offen offset:2048 sc1
  v_mfma_f32_32x32x16_bf16 v[208:223], v[232:235], v[224:227], v[208:223]
  v_mfma_f32_32x32x16_bf16 v[80:95], v[144:147], a[36:39], v[80:95]
  ds_read_b64_tr_b16 v[180:181], v7 offset:24576
  buffer_load_dwordx4 a[20:23], v13, s[68:71], s32 offen offset:2048 sc1
  v_mfma_f32_32x32x16_bf16 v[32:47], v[148:151], a[32:35], v[32:47]
  ds_read_b64_tr_b16 v[182:183], v7 offset:26624
  v_mfma_f32_32x32x16_bf16 v[208:223], v[236:239], v[228:231], v[208:223]
  v_mfma_f32_32x32x16_bf16 v[96:111], v[148:151], a[36:39], v[96:111]
  ds_read_b64_tr_b16 v[184:185], v6 offset:25600
  ds_read_b64_tr_b16 v[186:187], v6 offset:27648
  buffer_load_dwordx4 a[24:27], v12, s[68:71], s32 offen offset:3072 sc1
  v_mfma_f32_32x32x16_bf16 v[48:63], v[152:155], a[32:35], v[48:63]
  ds_read_b64_tr_b16 v[188:189], v7 offset:25600
  ds_read_b128 v[224:227], v14 offset:192
  v_mfma_f32_32x32x16_bf16 v[112:127], v[152:155], a[36:39], v[112:127]
  ds_read_b64_tr_b16 v[190:191], v7 offset:27648
  buffer_load_dwordx4 a[28:31], v13, s[68:71], s32 offen offset:3072 sc1
  s_add_u32 s32, s32, 4096
  v_mfma_f32_32x32x16_bf16 v[64:79], v[156:159], a[32:35], v[64:79]
  ds_read_b64_tr_b16 v[192:193], v6 offset:28672
  ds_read_b64_tr_b16 v[194:195], v6 offset:30720
  ds_read_b64_tr_b16 v[232:233], v15 offset:24576
  v_mfma_f32_32x32x16_bf16 v[128:143], v[156:159], a[36:39], v[128:143]
  ds_read_b64_tr_b16 v[196:197], v7 offset:28672
  v_mfma_f32_32x32x16_bf16 v[16:31], v[160:163], a[40:43], v[16:31]
  ds_read_b64_tr_b16 v[198:199], v7 offset:30720
  ds_read_b64_tr_b16 v[234:235], v15 offset:26624
  v_mfma_f32_32x32x16_bf16 v[80:95], v[160:163], a[44:47], v[80:95]
  ds_read_b64_tr_b16 v[200:201], v6 offset:29696
  ds_read_b64_tr_b16 v[202:203], v6 offset:31744
  v_mfma_f32_32x32x16_bf16 v[32:47], v[164:167], a[40:43], v[32:47]
  ds_read_b64_tr_b16 v[204:205], v7 offset:29696
  ds_read_b128 v[228:231], v14 offset:224
  v_mfma_f32_32x32x16_bf16 v[96:111], v[164:167], a[44:47], v[96:111]
  ds_read_b64_tr_b16 v[206:207], v7 offset:31744
  v_mfma_f32_32x32x16_bf16 v[48:63], v[168:171], a[40:43], v[48:63]
  ds_read_b64_tr_b16 v[236:237], v15 offset:28672
  v_mfma_f32_32x32x16_bf16 v[112:127], v[168:171], a[44:47], v[112:127]
  v_mfma_f32_32x32x16_bf16 v[64:79], v[172:175], a[40:43], v[64:79]
  ds_read_b64_tr_b16 v[238:239], v15 offset:30720
  v_mfma_f32_32x32x16_bf16 v[128:143], v[172:175], a[44:47], v[128:143]
  s_waitcnt vmcnt(24) lgkmcnt(0)
  s_barrier
  v_mfma_f32_32x32x16_bf16 v[16:31], v[176:179], a[48:51], v[16:31]
  ds_read_b64_tr_b16 v[144:145], v6 offset:32768
  ds_read_b64_tr_b16 v[146:147], v6 offset:34816
  s_add_u32 m0, s31, 16384
  s_nop 0
  buffer_load_dwordx4 v8, s[52:55], s30 offen offset:0 lds
  v_mfma_f32_32x32x16_bf16 v[208:223], v[232:235], v[224:227], v[208:223]
  v_mfma_f32_32x32x16_bf16 v[80:95], v[176:179], a[52:55], v[80:95]
  ds_read_b64_tr_b16 v[148:149], v7 offset:32768
  buffer_load_dwordx4 v9, s[52:55], s30 offen offset:1024 lds
  v_mfma_f32_32x32x16_bf16 v[32:47], v[180:183], a[48:51], v[32:47]
  ds_read_b64_tr_b16 v[150:151], v7 offset:34816
  v_mfma_f32_32x32x16_bf16 v[208:223], v[236:239], v[228:231], v[208:223]
  v_mfma_f32_32x32x16_bf16 v[96:111], v[180:183], a[52:55], v[96:111]
  ds_read_b64_tr_b16 v[152:153], v6 offset:33792
  ds_read_b64_tr_b16 v[154:155], v6 offset:35840
  buffer_load_dwordx4 v10, s[52:55], s30 offen offset:2048 lds
  v_mfma_f32_32x32x16_bf16 v[48:63], v[184:187], a[48:51], v[48:63]
  ds_read_b64_tr_b16 v[156:157], v7 offset:33792
  ds_read_b128 v[224:227], v14 offset:256
  v_mfma_f32_32x32x16_bf16 v[112:127], v[184:187], a[52:55], v[112:127]
  ds_read_b64_tr_b16 v[158:159], v7 offset:35840
  buffer_load_dwordx4 v11, s[52:55], s30 offen offset:3072 lds
  v_mfma_f32_32x32x16_bf16 v[64:79], v[188:191], a[48:51], v[64:79]
  ds_read_b64_tr_b16 v[160:161], v6 offset:36864
  ds_read_b64_tr_b16 v[162:163], v6 offset:38912
  ds_read_b64_tr_b16 v[232:233], v15 offset:32768
  v_mfma_f32_32x32x16_bf16 v[128:143], v[188:191], a[52:55], v[128:143]
  ds_read_b64_tr_b16 v[164:165], v7 offset:36864
  s_add_u32 s30, s30, 458752
  v_mfma_f32_32x32x16_bf16 v[16:31], v[192:195], a[56:59], v[16:31]
  ds_read_b64_tr_b16 v[166:167], v7 offset:38912
  buffer_load_dwordx4 a[32:35], v12, s[68:71], s32 offen offset:0 sc1
  ds_read_b64_tr_b16 v[234:235], v15 offset:34816
  v_mfma_f32_32x32x16_bf16 v[80:95], v[192:195], a[60:63], v[80:95]
  ds_read_b64_tr_b16 v[168:169], v6 offset:37888
  ds_read_b64_tr_b16 v[170:171], v6 offset:39936
  v_mfma_f32_32x32x16_bf16 v[32:47], v[196:199], a[56:59], v[32:47]
  ds_read_b64_tr_b16 v[172:173], v7 offset:37888
  buffer_load_dwordx4 a[36:39], v13, s[68:71], s32 offen offset:0 sc1
  ds_read_b128 v[228:231], v14 offset:288
  v_mfma_f32_32x32x16_bf16 v[96:111], v[196:199], a[60:63], v[96:111]
  ds_read_b64_tr_b16 v[174:175], v7 offset:39936
  v_mfma_f32_32x32x16_bf16 v[48:63], v[200:203], a[56:59], v[48:63]
  buffer_load_dwordx4 a[40:43], v12, s[68:71], s32 offen offset:1024 sc1
  ds_read_b64_tr_b16 v[236:237], v15 offset:36864
  v_mfma_f32_32x32x16_bf16 v[112:127], v[200:203], a[60:63], v[112:127]
  v_mfma_f32_32x32x16_bf16 v[64:79], v[204:207], a[56:59], v[64:79]
  buffer_load_dwordx4 a[44:47], v13, s[68:71], s32 offen offset:1024 sc1
  ds_read_b64_tr_b16 v[238:239], v15 offset:38912
  v_mfma_f32_32x32x16_bf16 v[128:143], v[204:207], a[60:63], v[128:143]
  s_waitcnt lgkmcnt(0)
  v_mfma_f32_32x32x16_bf16 v[16:31], v[144:147], a[64:67], v[16:31]
  ds_read_b64_tr_b16 v[176:177], v6 offset:40960
  ds_read_b64_tr_b16 v[178:179], v6 offset:43008
  buffer_load_dwordx4 a[48:51], v12, s[68:71], s32 offen offset:2048 sc1
  v_mfma_f32_32x32x16_bf16 v[208:223], v[232:235], v[224:227], v[208:223]
  v_mfma_f32_32x32x16_bf16 v[80:95], v[144:147], a[68:71], v[80:95]
  ds_read_b64_tr_b16 v[180:181], v7 offset:40960
  buffer_load_dwordx4 a[52:55], v13, s[68:71], s32 offen offset:2048 sc1
  v_mfma_f32_32x32x16_bf16 v[32:47], v[148:151], a[64:67], v[32:47]
  ds_read_b64_tr_b16 v[182:183], v7 offset:43008
  v_mfma_f32_32x32x16_bf16 v[208:223], v[236:239], v[228:231], v[208:223]
  v_mfma_f32_32x32x16_bf16 v[96:111], v[148:151], a[68:71], v[96:111]
  ds_read_b64_tr_b16 v[184:185], v6 offset:41984
  ds_read_b64_tr_b16 v[186:187], v6 offset:44032
  buffer_load_dwordx4 a[56:59], v12, s[68:71], s32 offen offset:3072 sc1
  v_mfma_f32_32x32x16_bf16 v[48:63], v[152:155], a[64:67], v[48:63]
  ds_read_b64_tr_b16 v[188:189], v7 offset:41984
  ds_read_b128 v[224:227], v14 offset:320
  v_mfma_f32_32x32x16_bf16 v[112:127], v[152:155], a[68:71], v[112:127]
  ds_read_b64_tr_b16 v[190:191], v7 offset:44032
  buffer_load_dwordx4 a[60:63], v13, s[68:71], s32 offen offset:3072 sc1
  s_add_u32 s32, s32, 4096
  v_mfma_f32_32x32x16_bf16 v[64:79], v[156:159], a[64:67], v[64:79]
  ds_read_b64_tr_b16 v[192:193], v6 offset:45056
  ds_read_b64_tr_b16 v[194:195], v6 offset:47104
  ds_read_b64_tr_b16 v[232:233], v15 offset:40960
  v_mfma_f32_32x32x16_bf16 v[128:143], v[156:159], a[68:71], v[128:143]
  ds_read_b64_tr_b16 v[196:197], v7 offset:45056
  v_mfma_f32_32x32x16_bf16 v[16:31], v[160:163], a[72:75], v[16:31]
  ds_read_b64_tr_b16 v[198:199], v7 offset:47104
  ds_read_b64_tr_b16 v[234:235], v15 offset:43008
  v_mfma_f32_32x32x16_bf16 v[80:95], v[160:163], a[76:79], v[80:95]
  ds_read_b64_tr_b16 v[200:201], v6 offset:46080
  ds_read_b64_tr_b16 v[202:203], v6 offset:48128
  v_mfma_f32_32x32x16_bf16 v[32:47], v[164:167], a[72:75], v[32:47]
  ds_read_b64_tr_b16 v[204:205], v7 offset:46080
  ds_read_b128 v[228:231], v14 offset:352
  v_mfma_f32_32x32x16_bf16 v[96:111], v[164:167], a[76:79], v[96:111]
  ds_read_b64_tr_b16 v[206:207], v7 offset:48128
  v_mfma_f32_32x32x16_bf16 v[48:63], v[168:171], a[72:75], v[48:63]
  ds_read_b64_tr_b16 v[236:237], v15 offset:45056
  v_mfma_f32_32x32x16_bf16 v[112:127], v[168:171], a[76:79], v[112:127]
  v_mfma_f32_32x32x16_bf16 v[64:79], v[172:175], a[72:75], v[64:79]
  ds_read_b64_tr_b16 v[238:239], v15 offset:47104
  v_mfma_f32_32x32x16_bf16 v[128:143], v[172:175], a[76:79], v[128:143]
  s_waitcnt vmcnt(24) lgkmcnt(0)
  s_barrier
  v_mfma_f32_32x32x16_bf16 v[16:31], v[176:179], a[80:83], v[16:31]
  ds_read_b64_tr_b16 v[144:145], v6 offset:49152
  ds_read_b64_tr_b16 v[146:147], v6 offset:51200
  s_add_u32 m0, s31, 32768
  s_nop 0
  buffer_load_dwordx4 v8, s[52:55], s30 offen offset:0 lds
  v_mfma_f32_32x32x16_bf16 v[208:223], v[232:235], v[224:227], v[208:223]
  v_mfma_f32_32x32x16_bf16 v[80:95], v[176:179], a[84:87], v[80:95]
  ds_read_b64_tr_b16 v[148:149], v7 offset:49152
  buffer_load_dwordx4 v9, s[52:55], s30 offen offset:1024 lds
  v_mfma_f32_32x32x16_bf16 v[32:47], v[180:183], a[80:83], v[32:47]
  ds_read_b64_tr_b16 v[150:151], v7 offset:51200
  v_mfma_f32_32x32x16_bf16 v[208:223], v[236:239], v[228:231], v[208:223]
  v_mfma_f32_32x32x16_bf16 v[96:111], v[180:183], a[84:87], v[96:111]
  ds_read_b64_tr_b16 v[152:153], v6 offset:50176
  ds_read_b64_tr_b16 v[154:155], v6 offset:52224
  buffer_load_dwordx4 v10, s[52:55], s30 offen offset:2048 lds
  v_mfma_f32_32x32x16_bf16 v[48:63], v[184:187], a[80:83], v[48:63]
  ds_read_b64_tr_b16 v[156:157], v7 offset:50176
  ds_read_b128 v[224:227], v14 offset:384
  v_mfma_f32_32x32x16_bf16 v[112:127], v[184:187], a[84:87], v[112:127]
  ds_read_b64_tr_b16 v[158:159], v7 offset:52224
  buffer_load_dwordx4 v11, s[52:55], s30 offen offset:3072 lds
  v_mfma_f32_32x32x16_bf16 v[64:79], v[188:191], a[80:83], v[64:79]
  ds_read_b64_tr_b16 v[160:161], v6 offset:53248
  ds_read_b64_tr_b16 v[162:163], v6 offset:55296
  ds_read_b64_tr_b16 v[232:233], v15 offset:49152
  v_mfma_f32_32x32x16_bf16 v[128:143], v[188:191], a[84:87], v[128:143]
  ds_read_b64_tr_b16 v[164:165], v7 offset:53248
  s_add_u32 s30, s30, 458752
  v_mfma_f32_32x32x16_bf16 v[16:31], v[192:195], a[88:91], v[16:31]
  ds_read_b64_tr_b16 v[166:167], v7 offset:55296
  buffer_load_dwordx4 a[64:67], v12, s[68:71], s32 offen offset:0 sc1
  ds_read_b64_tr_b16 v[234:235], v15 offset:51200
  v_mfma_f32_32x32x16_bf16 v[80:95], v[192:195], a[92:95], v[80:95]
  ds_read_b64_tr_b16 v[168:169], v6 offset:54272
  ds_read_b64_tr_b16 v[170:171], v6 offset:56320
  v_mfma_f32_32x32x16_bf16 v[32:47], v[196:199], a[88:91], v[32:47]
  ds_read_b64_tr_b16 v[172:173], v7 offset:54272
  buffer_load_dwordx4 a[68:71], v13, s[68:71], s32 offen offset:0 sc1
  ds_read_b128 v[228:231], v14 offset:416
  v_mfma_f32_32x32x16_bf16 v[96:111], v[196:199], a[92:95], v[96:111]
  ds_read_b64_tr_b16 v[174:175], v7 offset:56320
  v_mfma_f32_32x32x16_bf16 v[48:63], v[200:203], a[88:91], v[48:63]
  buffer_load_dwordx4 a[72:75], v12, s[68:71], s32 offen offset:1024 sc1
  ds_read_b64_tr_b16 v[236:237], v15 offset:53248
  v_mfma_f32_32x32x16_bf16 v[112:127], v[200:203], a[92:95], v[112:127]
  v_mfma_f32_32x32x16_bf16 v[64:79], v[204:207], a[88:91], v[64:79]
  buffer_load_dwordx4 a[76:79], v13, s[68:71], s32 offen offset:1024 sc1
  ds_read_b64_tr_b16 v[238:239], v15 offset:55296
  v_mfma_f32_32x32x16_bf16 v[128:143], v[204:207], a[92:95], v[128:143]
  s_waitcnt lgkmcnt(0)
  v_mfma_f32_32x32x16_bf16 v[16:31], v[144:147], a[96:99], v[16:31]
  ds_read_b64_tr_b16 v[176:177], v6 offset:57344
  ds_read_b64_tr_b16 v[178:179], v6 offset:59392
  buffer_load_dwordx4 a[80:83], v12, s[68:71], s32 offen offset:2048 sc1
  v_mfma_f32_32x32x16_bf16 v[208:223], v[232:235], v[224:227], v[208:223]
  v_mfma_f32_32x32x16_bf16 v[80:95], v[144:147], a[100:103], v[80:95]
  ds_read_b64_tr_b16 v[180:181], v7 offset:57344
  buffer_load_dwordx4 a[84:87], v13, s[68:71], s32 offen offset:2048 sc1
  v_mfma_f32_32x32x16_bf16 v[32:47], v[148:151], a[96:99], v[32:47]
  ds_read_b64_tr_b16 v[182:183], v7 offset:59392
  v_mfma_f32_32x32x16_bf16 v[208:223], v[236:239], v[228:231], v[208:223]
  v_mfma_f32_32x32x16_bf16 v[96:111], v[148:151], a[100:103], v[96:111]
  ds_read_b64_tr_b16 v[184:185], v6 offset:58368
  ds_read_b64_tr_b16 v[186:187], v6 offset:60416
  buffer_load_dwordx4 a[88:91], v12, s[68:71], s32 offen offset:3072 sc1
  v_mfma_f32_32x32x16_bf16 v[48:63], v[152:155], a[96:99], v[48:63]
  ds_read_b64_tr_b16 v[188:189], v7 offset:58368
  ds_read_b128 v[224:227], v14 offset:448
  v_mfma_f32_32x32x16_bf16 v[112:127], v[152:155], a[100:103], v[112:127]
  ds_read_b64_tr_b16 v[190:191], v7 offset:60416
  buffer_load_dwordx4 a[92:95], v13, s[68:71], s32 offen offset:3072 sc1
  s_add_u32 s32, s32, 4096
  v_mfma_f32_32x32x16_bf16 v[64:79], v[156:159], a[96:99], v[64:79]
  ds_read_b64_tr_b16 v[192:193], v6 offset:61440
  ds_read_b64_tr_b16 v[194:195], v6 offset:63488
  ds_read_b64_tr_b16 v[232:233], v15 offset:57344
  v_mfma_f32_32x32x16_bf16 v[128:143], v[156:159], a[100:103], v[128:143]
  ds_read_b64_tr_b16 v[196:197], v7 offset:61440
  v_mfma_f32_32x32x16_bf16 v[16:31], v[160:163], a[104:107], v[16:31]
  ds_read_b64_tr_b16 v[198:199], v7 offset:63488
  ds_read_b64_tr_b16 v[234:235], v15 offset:59392
  v_mfma_f32_32x32x16_bf16 v[80:95], v[160:163], a[108:111], v[80:95]
  ds_read_b64_tr_b16 v[200:201], v6 offset:62464
  ds_read_b64_tr_b16 v[202:203], v6 offset:64512
  v_mfma_f32_32x32x16_bf16 v[32:47], v[164:167], a[104:107], v[32:47]
  ds_read_b64_tr_b16 v[204:205], v7 offset:62464
  ds_read_b128 v[228:231], v14 offset:480
  v_mfma_f32_32x32x16_bf16 v[96:111], v[164:167], a[108:111], v[96:111]
  ds_read_b64_tr_b16 v[206:207], v7 offset:64512
  v_mfma_f32_32x32x16_bf16 v[48:63], v[168:171], a[104:107], v[48:63]
  ds_read_b64_tr_b16 v[236:237], v15 offset:61440
  v_mfma_f32_32x32x16_bf16 v[112:127], v[168:171], a[108:111], v[112:127]
  v_mfma_f32_32x32x16_bf16 v[64:79], v[172:175], a[104:107], v[64:79]
  ds_read_b64_tr_b16 v[238:239], v15 offset:63488
  v_mfma_f32_32x32x16_bf16 v[128:143], v[172:175], a[108:111], v[128:143]
  s_waitcnt vmcnt(24) lgkmcnt(0)
  s_barrier
  v_mfma_f32_32x32x16_bf16 v[16:31], v[176:179], a[112:115], v[16:31]
  ds_read_b64_tr_b16 v[144:145], v6 offset:0
  ds_read_b64_tr_b16 v[146:147], v6 offset:2048
  s_add_u32 m0, s31, 49152
  s_nop 0
  buffer_load_dwordx4 v8, s[52:55], s30 offen offset:0 lds
  v_mfma_f32_32x32x16_bf16 v[208:223], v[232:235], v[224:227], v[208:223]
  v_mfma_f32_32x32x16_bf16 v[80:95], v[176:179], a[116:119], v[80:95]
  ds_read_b64_tr_b16 v[148:149], v7 offset:0
  buffer_load_dwordx4 v9, s[52:55], s30 offen offset:1024 lds
  v_mfma_f32_32x32x16_bf16 v[208:223], v[236:239], v[228:231], v[208:223]
  v_mfma_f32_32x32x16_bf16 v[32:47], v[180:183], a[112:115], v[32:47]
  ds_read_b64_tr_b16 v[150:151], v7 offset:2048
  v_mfma_f32_32x32x16_bf16 v[96:111], v[180:183], a[116:119], v[96:111]
  ds_read_b64_tr_b16 v[152:153], v6 offset:1024
  ds_read_b64_tr_b16 v[154:155], v6 offset:3072
  buffer_load_dwordx4 v10, s[52:55], s30 offen offset:2048 lds
  v_add_u32 v14, 512, v14
  v_mfma_f32_32x32x16_bf16 v[48:63], v[184:187], a[112:115], v[48:63]
  ds_read_b64_tr_b16 v[156:157], v7 offset:1024
  v_mfma_f32_32x32x16_bf16 v[112:127], v[184:187], a[116:119], v[112:127]
  ds_read_b64_tr_b16 v[158:159], v7 offset:3072
  buffer_load_dwordx4 v11, s[52:55], s30 offen offset:3072 lds
  ds_read_b128 v[224:227], v14 offset:0
  v_mfma_f32_32x32x16_bf16 v[64:79], v[188:191], a[112:115], v[64:79]
  ds_read_b64_tr_b16 v[160:161], v6 offset:4096
  ds_read_b64_tr_b16 v[162:163], v6 offset:6144
  v_mfma_f32_32x32x16_bf16 v[128:143], v[188:191], a[116:119], v[128:143]
  ds_read_b64_tr_b16 v[164:165], v7 offset:4096
  s_add_u32 s30, s30, 458752
  ds_read_b64_tr_b16 v[232:233], v15 offset:0
  v_mfma_f32_32x32x16_bf16 v[16:31], v[192:195], a[120:123], v[16:31]
  ds_read_b64_tr_b16 v[166:167], v7 offset:6144
  buffer_load_dwordx4 a[96:99], v12, s[68:71], s32 offen offset:0 sc1
  ds_read_b64_tr_b16 v[234:235], v15 offset:2048
  v_mfma_f32_32x32x16_bf16 v[80:95], v[192:195], a[124:127], v[80:95]
  ds_read_b64_tr_b16 v[168:169], v6 offset:5120
  ds_read_b64_tr_b16 v[170:171], v6 offset:7168
  v_mfma_f32_32x32x16_bf16 v[32:47], v[196:199], a[120:123], v[32:47]
  ds_read_b64_tr_b16 v[172:173], v7 offset:5120
  buffer_load_dwordx4 a[100:103], v13, s[68:71], s32 offen offset:0 sc1
  ds_read_b128 v[228:231], v14 offset:32
  v_mfma_f32_32x32x16_bf16 v[96:111], v[196:199], a[124:127], v[96:111]
  ds_read_b64_tr_b16 v[174:175], v7 offset:7168
  v_mfma_f32_32x32x16_bf16 v[48:63], v[200:203], a[120:123], v[48:63]
  buffer_load_dwordx4 a[104:107], v12, s[68:71], s32 offen offset:1024 sc1
  ds_read_b64_tr_b16 v[236:237], v15 offset:4096
  v_mfma_f32_32x32x16_bf16 v[112:127], v[200:203], a[124:127], v[112:127]
  v_mfma_f32_32x32x16_bf16 v[64:79], v[204:207], a[120:123], v[64:79]
  buffer_load_dwordx4 a[108:111], v13, s[68:71], s32 offen offset:1024 sc1
  ds_read_b64_tr_b16 v[238:239], v15 offset:6144
  v_mfma_f32_32x32x16_bf16 v[128:143], v[204:207], a[124:127], v[128:143]
  s_sub_u32 s20, s20, 1
  s_cmp_lg_u32 s20, 0
  s_cbranch_scc1 f1_l
  s_waitcnt lgkmcnt(0)
  v_mfma_f32_32x32x16_bf16 v[16:31], v[144:147], a[0:3], v[16:31]
  ds_read_b64_tr_b16 v[176:177], v6 offset:8192
  ds_read_b64_tr_b16 v[178:179], v6 offset:10240
  buffer_load_dwordx4 a[112:115], v12, s[68:71], s32 offen offset:2048 sc1
  v_mfma_f32_32x32x16_bf16 v[208:223], v[232:235], v[224:227], v[208:223]
  v_mfma_f32_32x32x16_bf16 v[80:95], v[144:147], a[4:7], v[80:95]
  ds_read_b64_tr_b16 v[180:181], v7 offset:8192
  buffer_load_dwordx4 a[116:119], v13, s[68:71], s32 offen offset:2048 sc1
  v_mfma_f32_32x32x16_bf16 v[32:47], v[148:151], a[0:3], v[32:47]
  ds_read_b64_tr_b16 v[182:183], v7 offset:10240
  v_mfma_f32_32x32x16_bf16 v[208:223], v[236:239], v[228:231], v[208:223]
  v_mfma_f32_32x32x16_bf16 v[96:111], v[148:151], a[4:7], v[96:111]
  ds_read_b64_tr_b16 v[184:185], v6 offset:9216
  ds_read_b64_tr_b16 v[186:187], v6 offset:11264
  buffer_load_dwordx4 a[120:123], v12, s[68:71], s32 offen offset:3072 sc1
  v_mfma_f32_32x32x16_bf16 v[48:63], v[152:155], a[0:3], v[48:63]
  ds_read_b64_tr_b16 v[188:189], v7 offset:9216
  ds_read_b128 v[224:227], v14 offset:64
  v_mfma_f32_32x32x16_bf16 v[112:127], v[152:155], a[4:7], v[112:127]
  ds_read_b64_tr_b16 v[190:191], v7 offset:11264
  buffer_load_dwordx4 a[124:127], v13, s[68:71], s32 offen offset:3072 sc1
  s_add_u32 s32, s32, 4096
  v_mfma_f32_32x32x16_bf16 v[64:79], v[156:159], a[0:3], v[64:79]
  ds_read_b64_tr_b16 v[192:193], v6 offset:12288
  ds_read_b64_tr_b16 v[194:195], v6 offset:14336
  ds_read_b64_tr_b16 v[232:233], v15 offset:8192
  v_mfma_f32_32x32x16_bf16 v[128:143], v[156:159], a[4:7], v[128:143]
  ds_read_b64_tr_b16 v[196:197], v7 offset:12288
  v_mfma_f32_32x32x16_bf16 v[16:31], v[160:163], a[8:11], v[16:31]
  ds_read_b64_tr_b16 v[198:199], v7 offset:14336
  ds_read_b64_tr_b16 v[234:235], v15 offset:10240
  v_mfma_f32_32x32x16_bf16 v[80:95], v[160:163], a[12:15], v[80:95]
  ds_read_b64_tr_b16 v[200:201], v6 offset:13312
  ds_read_b64_tr_b16 v[202:203], v6 offset:15360
  v_mfma_f32_32x32x16_bf16 v[32:47], v[164:167], a[8:11], v[32:47]
  ds_read_b64_tr_b16 v[204:205], v7 offset:13312
  ds_read_b128 v[228:231], v14 offset:96
  v_mfma_f32_32x32x16_bf16 v[96:111], v[164:167], a[12:15], v[96:111]
  ds_read_b64_tr_b16 v[206:207], v7 offset:15360
  v_mfma_f32_32x32x16_bf16 v[48:63], v[168:171], a[8:11], v[48:63]
  ds_read_b64_tr_b16 v[236:237], v15 offset:12288
  v_mfma_f32_32x32x16_bf16 v[112:127], v[168:171], a[12:15], v[112:127]
  v_mfma_f32_32x32x16_bf16 v[64:79], v[172:175], a[8:11], v[64:79]
  ds_read_b64_tr_b16 v[238:239], v15 offset:14336
  v_mfma_f32_32x32x16_bf16 v[128:143], v[172:175], a[12:15], v[128:143]
  s_waitcnt vmcnt(24) lgkmcnt(0)
  s_barrier
  v_mfma_f32_32x32x16_bf16 v[16:31], v[176:179], a[16:19], v[16:31]
  ds_read_b64_tr_b16 v[144:145], v6 offset:16384
  ds_read_b64_tr_b16 v[146:147], v6 offset:18432
  v_mfma_f32_32x32x16_bf16 v[208:223], v[232:235], v[224:227], v[208:223]
  v_mfma_f32_32x32x16_bf16 v[80:95], v[176:179], a[20:23], v[80:95]
  ds_read_b64_tr_b16 v[148:149], v7 offset:16384
  v_mfma_f32_32x32x16_bf16 v[32:47], v[180:183], a[16:19], v[32:47]
  ds_read_b64_tr_b16 v[150:151], v7 offset:18432
  v_mfma_f32_32x32x16_bf16 v[208:223], v[236:239], v[228:231], v[208:223]
  v_mfma_f32_32x32x16_bf16 v[96:111], v[180:183], a[20:23], v[96:111]
  ds_read_b64_tr_b16 v[152:153], v6 offset:17408
  ds_read_b64_tr_b16 v[154:155], v6 offset:19456
  v_mfma_f32_32x32x16_bf16 v[48:63], v[184:187], a[16:19], v[48:63]
  ds_read_b64_tr_b16 v[156:157], v7 offset:17408
  ds_read_b128 v[224:227], v14 offset:128
  v_mfma_f32_32x32x16_bf16 v[112:127], v[184:187], a[20:23], v[112:127]
  ds_read_b64_tr_b16 v[158:159], v7 offset:19456
  v_mfma_f32_32x32x16_bf16 v[64:79], v[188:191], a[16:19], v[64:79]
  ds_read_b64_tr_b16 v[160:161], v6 offset:20480
  ds_read_b64_tr_b16 v[162:163], v6 offset:22528
  ds_read_b64_tr_b16 v[232:233], v15 offset:16384
  v_mfma_f32_32x32x16_bf16 v[128:143], v[188:191], a[20:23], v[128:143]
  ds_read_b64_tr_b16 v[164:165], v7 offset:20480
  v_mfma_f32_32x32x16_bf16 v[16:31], v[192:195], a[24:27], v[16:31]
  ds_read_b64_tr_b16 v[166:167], v7 offset:22528
  ds_read_b64_tr_b16 v[234:235], v15 offset:18432
  v_mfma_f32_32x32x16_bf16 v[80:95], v[192:195], a[28:31], v[80:95]
  ds_read_b64_tr_b16 v[168:169], v6 offset:21504
  ds_read_b64_tr_b16 v[170:171], v6 offset:23552
  v_mfma_f32_32x32x16_bf16 v[32:47], v[196:199], a[24:27], v[32:47]
  ds_read_b64_tr_b16 v[172:173], v7 offset:21504
  ds_read_b128 v[228:231], v14 offset:160
  v_mfma_f32_32x32x16_bf16 v[96:111], v[196:199], a[28:31], v[96:111]
  ds_read_b64_tr_b16 v[174:175], v7 offset:23552
  v_mfma_f32_32x32x16_bf16 v[48:63], v[200:203], a[24:27], v[48:63]
  ds_read_b64_tr_b16 v[236:237], v15 offset:20480
  v_mfma_f32_32x32x16_bf16 v[112:127], v[200:203], a[28:31], v[112:127]
  v_mfma_f32_32x32x16_bf16 v[64:79], v[204:207], a[24:27], v[64:79]
  ds_read_b64_tr_b16 v[238:239], v15 offset:22528
  v_mfma_f32_32x32x16_bf16 v[128:143], v[204:207], a[28:31], v[128:143]
  s_waitcnt lgkmcnt(0)
  v_mfma_f32_32x32x16_bf16 v[16:31], v[144:147], a[32:35], v[16:31]
  ds_read_b64_tr_b16 v[176:177], v6 offset:24576
  ds_read_b64_tr_b16 v[178:179], v6 offset:26624
  v_mfma_f32_32x32x16_bf16 v[208:223], v[232:235], v[224:227], v[208:223]
  v_mfma_f32_32x32x16_bf16 v[80:95], v[144:147], a[36:39], v[80:95]
  ds_read_b64_tr_b16 v[180:181], v7 offset:24576
  v_mfma_f32_32x32x16_bf16 v[32:47], v[148:151], a[32:35], v[32:47]
  ds_read_b64_tr_b16 v[182:183], v7 offset:26624
  v_mfma_f32_32x32x16_bf16 v[208:223], v[236:239], v[228:231], v[208:223]
  v_mfma_f32_32x32x16_bf16 v[96:111], v[148:151], a[36:39], v[96:111]
  ds_read_b64_tr_b16 v[184:185], v6 offset:25600
  ds_read_b64_tr_b16 v[186:187], v6 offset:27648
  v_mfma_f32_32x32x16_bf16 v[48:63], v[152:155], a[32:35], v[48:63]
  ds_read_b64_tr_b16 v[188:189], v7 offset:25600
  ds_read_b128 v[224:227], v14 offset:192
  v_mfma_f32_32x32x16_bf16 v[112:127], v[152:155], a[36:39], v[112:127]
  ds_read_b64_tr_b16 v[190:191], v7 offset:27648
  v_mfma_f32_32x32x16_bf16 v[64:79], v[156:159], a[32:35], v[64:79]
  ds_read_b64_tr_b16 v[192:193], v6 offset:28672
  ds_read_b64_tr_b16 v[194:195], v6 offset:30720
  ds_read_b64_tr_b16 v[232:233], v15 offset:24576
  v_mfma_f32_32x32x16_bf16 v[128:143], v[156:159], a[36:39], v[128:143]
  ds_read_b64_tr_b16 v[196:197], v7 offset:28672
  v_mfma_f32_32x32x16_bf16 v[16:31], v[160:163], a[40:43], v[16:31]
  ds_read_b64_tr_b16 v[198:199], v7 offset:30720
  ds_read_b64_tr_b16 v[234:235], v15 offset:26624
  v_mfma_f32_32x32x16_bf16 v[80:95], v[160:163], a[44:47], v[80:95]
  ds_read_b64_tr_b16 v[200:201], v6 offset:29696
  ds_read_b64_tr_b16 v[202:203], v6 offset:31744
  v_mfma_f32_32x32x16_bf16 v[32:47], v[164:167], a[40:43], v[32:47]
  ds_read_b64_tr_b16 v[204:205], v7 offset:29696
  ds_read_b128 v[228:231], v14 offset:224
  v_mfma_f32_32x32x16_bf16 v[96:111], v[164:167], a[44:47], v[96:111]
  ds_read_b64_tr_b16 v[206:207], v7 offset:31744
  v_mfma_f32_32x32x16_bf16 v[48:63], v[168:171], a[40:43], v[48:63]
  ds_read_b64_tr_b16 v[236:237], v15 offset:28672
  v_mfma_f32_32x32x16_bf16 v[112:127], v[168:171], a[44:47], v[112:127]
  v_mfma_f32_32x32x16_bf16 v[64:79], v[172:175], a[40:43], v[64:79]
  ds_read_b64_tr_b16 v[238:239], v15 offset:30720
  v_mfma_f32_32x32x16_bf16 v[128:143], v[172:175], a[44:47], v[128:143]
  s_waitcnt vmcnt(12) lgkmcnt(0)
  s_barrier
  v_mfma_f32_32x32x16_bf16 v[16:31], v[176:179], a[48:51], v[16:31]
  ds_read_b64_tr_b16 v[144:145], v6 offset:32768
  ds_read_b64_tr_b16 v[146:147], v6 offset:34816
  v_mfma_f32_32x32x16_bf16 v[208:223], v[232:235], v[224:227], v[208:223]
  v_mfma_f32_32x32x16_bf16 v[80:95], v[176:179], a[52:55], v[80:95]
  ds_read_b64_tr_b16 v[148:149], v7 offset:32768
  v_mfma_f32_32x32x16_bf16 v[32:47], v[180:183], a[48:51], v[32:47]
  ds_read_b64_tr_b16 v[150:151], v7 offset:34816
  v_mfma_f32_32x32x16_bf16 v[208:223], v[236:239], v[228:231], v[208:223]
  v_mfma_f32_32x32x16_bf16 v[96:111], v[180:183], a[52:55], v[96:111]
  ds_read_b64_tr_b16 v[152:153], v6 offset:33792
  ds_read_b64_tr_b16 v[154:155], v6 offset:35840
  v_mfma_f32_32x32x16_bf16 v[48:63], v[184:187], a[48:51], v[48:63]
  ds_read_b64_tr_b16 v[156:157], v7 offset:33792
  ds_read_b128 v[224:227], v14 offset:256
  v_mfma_f32_32x32x16_bf16 v[112:127], v[184:187], a[52:55], v[112:127]
  ds_read_b64_tr_b16 v[158:159], v7 offset:35840
  v_mfma_f32_32x32x16_bf16 v[64:79], v[188:191], a[48:51], v[64:79]
  ds_read_b64_tr_b16 v[160:161], v6 offset:36864
  ds_read_b64_tr_b16 v[162:163], v6 offset:38912
  ds_read_b64_tr_b16 v[232:233], v15 offset:32768
  v_mfma_f32_32x32x16_bf16 v[128:143], v[188:191], a[52:55], v[128:143]
  ds_read_b64_tr_b16 v[164:165], v7 offset:36864
  v_mfma_f32_32x32x16_bf16 v[16:31], v[192:195], a[56:59], v[16:31]
  ds_read_b64_tr_b16 v[166:167], v7 offset:38912
  ds_read_b64_tr_b16 v[234:235], v15 offset:34816
  v_mfma_f32_32x32x16_bf16 v[80:95], v[192:195], a[60:63], v[80:95]
  ds_read_b64_tr_b16 v[168:169], v6 offset:37888
  ds_read_b64_tr_b16 v[170:171], v6 offset:39936
  v_mfma_f32_32x32x16_bf16 v[32:47], v[196:199], a[56:59], v[32:47]
  ds_read_b64_tr_b16 v[172:173], v7 offset:37888
  ds_read_b128 v[228:231], v14 offset:288
  v_mfma_f32_32x32x16_bf16 v[96:111], v[196:199], a[60:63], v[96:111]
  ds_read_b64_tr_b16 v[174:175], v7 offset:39936
  v_mfma_f32_32x32x16_bf16 v[48:63], v[200:203], a[56:59], v[48:63]
  ds_read_b64_tr_b16 v[236:237], v15 offset:36864
  v_mfma_f32_32x32x16_bf16 v[112:127], v[200:203], a[60:63], v[112:127]
  v_mfma_f32_32x32x16_bf16 v[64:79], v[204:207], a[56:59], v[64:79]
  ds_read_b64_tr_b16 v[238:239], v15 offset:38912
  v_mfma_f32_32x32x16_bf16 v[128:143], v[204:207], a[60:63], v[128:143]
  s_waitcnt lgkmcnt(0)
  v_mfma_f32_32x32x16_bf16 v[16:31], v[144:147], a[64:67], v[16:31]
  ds_read_b64_tr_b16 v[176:177], v6 offset:40960
  ds_read_b64_tr_b16 v[178:179], v6 offset:43008
  v_mfma_f32_32x32x16_bf16 v[208:223], v[232:235], v[224:227], v[208:223]
  v_mfma_f32_32x32x16_bf16 v[80:95], v[144:147], a[68:71], v[80:95]
  ds_read_b64_tr_b16 v[180:181], v7 offset:40960
  v_mfma_f32_32x32x16_bf16 v[32:47], v[148:151], a[64:67], v[32:47]
  ds_read_b64_tr_b16 v[182:183], v7 offset:43008
  v_mfma_f32_32x32x16_bf16 v[208:223], v[236:239], v[228:231], v[208:223]
  v_mfma_f32_32x32x16_bf16 v[96:111], v[148:151], a[68:71], v[96:111]
  ds_read_b64_tr_b16 v[184:185], v6 offset:41984
  ds_read_b64_tr_b16 v[186:187], v6 offset:44032
  v_mfma_f32_32x32x16_bf16 v[48:63], v[152:155], a[64:67], v[48:63]
  ds_read_b64_tr_b16 v[188:189], v7 offset:41984
  ds_read_b128 v[224:227], v14 offset:320
  v_mfma_f32_32x32x16_bf16 v[112:127], v[152:155], a[68:71], v[112:127]
  ds_read_b64_tr_b16 v[190:191], v7 offset:44032
  v_mfma_f32_32x32x16_bf16 v[64:79], v[156:159], a[64:67], v[64:79]
  ds_read_b64_tr_b16 v[192:193], v6 offset:45056
  ds_read_b64_tr_b16 v[194:195], v6 offset:47104
  ds_read_b64_tr_b16 v[232:233], v15 offset:40960
  v_mfma_f32_32x32x16_bf16 v[128:143], v[156:159], a[68:71], v[128:143]
  ds_read_b64_tr_b16 v[196:197], v7 offset:45056
  v_mfma_f32_32x32x16_bf16 v[16:31], v[160:163], a[72:75], v[16:31]
  ds_read_b64_tr_b16 v[198:199], v7 offset:47104
  ds_read_b64_tr_b16 v[234:235], v15 offset:43008
  v_mfma_f32_32x32x16_bf16 v[80:95], v[160:163], a[76:79], v[80:95]
  ds_read_b64_tr_b16 v[200:201], v6 offset:46080
  ds_read_b64_tr_b16 v[202:203], v6 offset:48128
  v_mfma_f32_32x32x16_bf16 v[32:47], v[164:167], a[72:75], v[32:47]
  ds_read_b64_tr_b16 v[204:205], v7 offset:46080
  ds_read_b128 v[228:231], v14 offset:352
  v_mfma_f32_32x32x16_bf16 v[96:111], v[164:167], a[76:79], v[96:111]
  ds_read_b64_tr_b16 v[206:207], v7 offset:48128
  v_mfma_f32_32x32x16_bf16 v[48:63], v[168:171], a[72:75], v[48:63]
  ds_read_b64_tr_b16 v[236:237], v15 offset:45056
  v_mfma_f32_32x32x16_bf16 v[112:127], v[168:171], a[76:79], v[112:127]
  v_mfma_f32_32x32x16_bf16 v[64:79], v[172:175], a[72:75], v[64:79]
  ds_read_b64_tr_b16 v[238:239], v15 offset:47104
  v_mfma_f32_32x32x16_bf16 v[128:143], v[172:175], a[76:79], v[128:143]
  s_waitcnt vmcnt(0) lgkmcnt(0)
  s_barrier
  v_mfma_f32_32x32x16_bf16 v[16:31], v[176:179], a[80:83], v[16:31]
  ds_read_b64_tr_b16 v[144:145], v6 offset:49152
  ds_read_b64_tr_b16 v[146:147], v6 offset:51200
  v_mfma_f32_32x32x16_bf16 v[208:223], v[232:235], v[224:227], v[208:223]
  v_mfma_f32_32x32x16_bf16 v[80:95], v[176:179], a[84:87], v[80:95]
  ds_read_b64_tr_b16 v[148:149], v7 offset:49152
  v_mfma_f32_32x32x16_bf16 v[32:47], v[180:183], a[80:83], v[32:47]
  ds_read_b64_tr_b16 v[150:151], v7 offset:51200
  v_mfma_f32_32x32x16_bf16 v[208:223], v[236:239], v[228:231], v[208:223]
  v_mfma_f32_32x32x16_bf16 v[96:111], v[180:183], a[84:87], v[96:111]
  ds_read_b64_tr_b16 v[152:153], v6 offset:50176
  ds_read_b64_tr_b16 v[154:155], v6 offset:52224
  v_mfma_f32_32x32x16_bf16 v[48:63], v[184:187], a[80:83], v[48:63]
  ds_read_b64_tr_b16 v[156:157], v7 offset:50176
  ds_read_b128 v[224:227], v14 offset:384
  v_mfma_f32_32x32x16_bf16 v[112:127], v[184:187], a[84:87], v[112:127]
  ds_read_b64_tr_b16 v[158:159], v7 offset:52224
  v_mfma_f32_32x32x16_bf16 v[64:79], v[188:191], a[80:83], v[64:79]
  ds_read_b64_tr_b16 v[160:161], v6 offset:53248
  ds_read_b64_tr_b16 v[162:163], v6 offset:55296
  ds_read_b64_tr_b16 v[232:233], v15 offset:49152
  v_mfma_f32_32x32x16_bf16 v[128:143], v[188:191], a[84:87], v[128:143]
  ds_read_b64_tr_b16 v[164:165], v7 offset:53248
  v_mfma_f32_32x32x16_bf16 v[16:31], v[192:195], a[88:91], v[16:31]
  ds_read_b64_tr_b16 v[166:167], v7 offset:55296
  ds_read_b64_tr_b16 v[234:235], v15 offset:51200
  v_mfma_f32_32x32x16_bf16 v[80:95], v[192:195], a[92:95], v[80:95]
  ds_read_b64_tr_b16 v[168:169], v6 offset:54272
  ds_read_b64_tr_b16 v[170:171], v6 offset:56320
  v_mfma_f32_32x32x16_bf16 v[32:47], v[196:199], a[88:91], v[32:47]
  ds_read_b64_tr_b16 v[172:173], v7 offset:54272
  ds_read_b128 v[228:231], v14 offset:416
  v_mfma_f32_32x32x16_bf16 v[96:111], v[196:199], a[92:95], v[96:111]
  ds_read_b64_tr_b16 v[174:175], v7 offset:56320
  v_mfma_f32_32x32x16_bf16 v[48:63], v[200:203], a[88:91], v[48:63]
  ds_read_b64_tr_b16 v[236:237], v15 offset:53248
  v_mfma_f32_32x32x16_bf16 v[112:127], v[200:203], a[92:95], v[112:127]
  v_mfma_f32_32x32x16_bf16 v[64:79], v[204:207], a[88:91], v[64:79]
  ds_read_b64_tr_b16 v[238:239], v15 offset:55296
  v_mfma_f32_32x32x16_bf16 v[128:143], v[204:207], a[92:95], v[128:143]
  s_waitcnt lgkmcnt(0)
  v_mfma_f32_32x32x16_bf16 v[16:31], v[144:147], a[96:99], v[16:31]
  ds_read_b64_tr_b16 v[176:177], v6 offset:57344
  ds_read_b64_tr_b16 v[178:179], v6 offset:59392
  v_mfma_f32_32x32x16_bf16 v[208:223], v[232:235], v[224:227], v[208:223]
  v_mfma_f32_32x32x16_bf16 v[80:95], v[144:147], a[100:103], v[80:95]
  ds_read_b64_tr_b16 v[180:181], v7 offset:57344
  v_mfma_f32_32x32x16_bf16 v[208:223], v[236:239], v[228:231], v[208:223]
  v_mfma_f32_32x32x16_bf16 v[32:47], v[148:151], a[96:99], v[32:47]
  ds_read_b64_tr_b16 v[182:183], v7 offset:59392
  v_mfma_f32_32x32x16_bf16 v[96:111], v[148:151], a[100:103], v[96:111]
  ds_read_b64_tr_b16 v[184:185], v6 offset:58368
  ds_read_b64_tr_b16 v[186:187], v6 offset:60416
  v_and_b32 v2, 3, v0
  v_lshlrev_b32 v2, 7, v2
  s_mul_i32 s21, s25, 512
  s_add_u32 s21, s21, kn_f2-kn_cb
  v_add_u32 v2, s21, v2
  v_min_u32 v2, kn_ce-kn_cb-4, v2
  global_load_dword v249, v2, s[0:1]
  v_mfma_f32_32x32x16_bf16 v[48:63], v[152:155], a[96:99], v[48:63]
  ds_read_b64_tr_b16 v[188:189], v7 offset:58368
  v_mfma_f32_32x32x16_bf16 v[112:127], v[152:155], a[100:103], v[112:127]
  ds_read_b64_tr_b16 v[190:191], v7 offset:60416
  ds_read_b128 v[224:227], v14 offset:448
  v_mfma_f32_32x32x16_bf16 v[64:79], v[156:159], a[96:99], v[64:79]
  ds_read_b64_tr_b16 v[192:193], v6 offset:61440
  ds_read_b64_tr_b16 v[194:195], v6 offset:63488
  v_mfma_f32_32x32x16_bf16 v[128:143], v[156:159], a[100:103], v[128:143]
  ds_read_b64_tr_b16 v[196:197], v7 offset:61440
  ds_read_b64_tr_b16 v[232:233], v15 offset:57344
  v_mfma_f32_32x32x16_bf16 v[16:31], v[160:163], a[104:107], v[16:31]
  ds_read_b64_tr_b16 v[198:199], v7 offset:63488
  ds_read_b64_tr_b16 v[234:235], v15 offset:59392
  v_mfma_f32_32x32x16_bf16 v[80:95], v[160:163], a[108:111], v[80:95]
  ds_read_b64_tr_b16 v[200:201], v6 offset:62464
  ds_read_b64_tr_b16 v[202:203], v6 offset:64512
  v_mfma_f32_32x32x16_bf16 v[32:47], v[164:167], a[104:107], v[32:47]
  ds_read_b64_tr_b16 v[204:205], v7 offset:62464
  ds_read_b128 v[228:231], v14 offset:480
  v_mfma_f32_32x32x16_bf16 v[96:111], v[164:167], a[108:111], v[96:111]
  ds_read_b64_tr_b16 v[206:207], v7 offset:64512
  v_mfma_f32_32x32x16_bf16 v[48:63], v[168:171], a[104:107], v[48:63]
  ds_read_b64_tr_b16 v[236:237], v15 offset:61440
  v_mfma_f32_32x32x16_bf16 v[112:127], v[168:171], a[108:111], v[112:127]
  v_mfma_f32_32x32x16_bf16 v[64:79], v[172:175], a[104:107], v[64:79]
  ds_read_b64_tr_b16 v[238:239], v15 offset:63488
  v_mfma_f32_32x32x16_bf16 v[128:143], v[172:175], a[108:111], v[128:143]
  s_waitcnt lgkmcnt(0)
  v_mfma_f32_32x32x16_bf16 v[16:31], v[176:179], a[112:115], v[16:31]
  v_mfma_f32_32x32x16_bf16 v[208:223], v[232:235], v[224:227], v[208:223]
  v_mfma_f32_32x32x16_bf16 v[80:95], v[176:179], a[116:119], v[80:95]
  v_mfma_f32_32x32x16_bf16 v[32:47], v[180:183], a[112:115], v[32:47]
  v_mfma_f32_32x32x16_bf16 v[96:111], v[180:183], a[116:119], v[96:111]
  v_mfma_f32_32x32x16_bf16 v[48:63], v[184:187], a[112:115], v[48:63]
  v_mfma_f32_32x32x16_bf16 v[112:127], v[184:187], a[116:119], v[112:127]
  v_mfma_f32_32x32x16_bf16 v[64:79], v[188:191], a[112:115], v[64:79]
  v_mfma_f32_32x32x16_bf16 v[128:143], v[188:191], a[116:119], v[128:143]
  v_mfma_f32_32x32x16_bf16 v[16:31], v[192:195], a[120:123], v[16:31]
  v_mfma_f32_32x32x16_bf16 v[208:223], v[236:239], v[228:231], v[208:223]
  v_mfma_f32_32x32x16_bf16 v[80:95], v[192:195], a[124:127], v[80:95]
  v_mfma_f32_32x32x16_bf16 v[32:47], v[196:199], a[120:123], v[32:47]
  v_mfma_f32_32x32x16_bf16 v[96:111], v[196:199], a[124:127], v[96:111]
  v_mfma_f32_32x32x16_bf16 v[48:63], v[200:203], a[120:123], v[48:63]
  v_mfma_f32_32x32x16_bf16 v[112:127], v[200:203], a[124:127], v[112:127]
  v_mfma_f32_32x32x16_bf16 v[64:79], v[204:207], a[120:123], v[64:79]
  v_mfma_f32_32x32x16_bf16 v[128:143], v[204:207], a[124:127], v[128:143]
  v_and_b32 v2, 1, v1
  v_lshlrev_b32 v2, 9, v2
  v_lshrrev_b32 v3, 5, v1
  v_lshlrev_b32 v3, 6, v3
  s_lshl_b32 s33, s3, 7
  v_add3_u32 v2, v2, v3, s33
  v_add_u32 v2, 69632, v2
  v_add_u32 v3, 69632, v3
  s_nop 7
  ds_write_b128 v2, v[208:211] offset:0
  ds_write_b128 v2, v[212:215] offset:16
  ds_write_b128 v2, v[216:219] offset:32
  ds_write_b128 v2, v[220:223] offset:48
  s_waitcnt lgkmcnt(0)
  s_barrier
  ds_read_b128 v[144:147], v3 offset:0
  ds_read_b128 v[148:151], v3 offset:16
  ds_read_b128 v[152:155], v3 offset:32
  ds_read_b128 v[156:159], v3 offset:48
  ds_read_b128 v[160:163], v3 offset:512
  ds_read_b128 v[164:167], v3 offset:528
  ds_read_b128 v[168:171], v3 offset:544
  ds_read_b128 v[172:175], v3 offset:560
  ds_read_b128 v[176:179], v3 offset:128
  ds_read_b128 v[180:183], v3 offset:144
  ds_read_b128 v[184:187], v3 offset:160
  ds_read_b128 v[188:191], v3 offset:176
  ds_read_b128 v[192:195], v3 offset:640
  ds_read_b128 v[196:199], v3 offset:656
  ds_read_b128 v[200:203], v3 offset:672
  ds_read_b128 v[204:207], v3 offset:688
  s_mul_i32 s33, s28, 229376
  s_lshl_b32 s34, s27, 13
  s_add_u32 s33, s33, s34
  s_add_u32 s33, s33, 75497472
  s_add_u32 s34, s33, 229376
  s_waitcnt lgkmcnt(8)
  v_pk_fma_f32 v[208:209], v[144:145], v[244:245], v[160:161]
  v_pk_fma_f32 v[210:211], v[146:147], v[244:245], v[162:163]
  v_pk_fma_f32 v[212:213], v[148:149], v[244:245], v[164:165]
  v_pk_fma_f32 v[214:215], v[150:151], v[244:245], v[166:167]
  v_pk_fma_f32 v[216:217], v[152:153], v[244:245], v[168:169]
  v_pk_fma_f32 v[218:219], v[154:155], v[244:245], v[170:171]
  v_pk_fma_f32 v[220:221], v[156:157], v[244:245], v[172:173]
  v_pk_fma_f32 v[222:223], v[158:159], v[244:245], v[174:175]
  v_pk_fma_f32 v[16:17], v[16:17], v[240:241], v[208:209]
  v_pk_fma_f32 v[18:19], v[18:19], v[240:241], v[210:211]
  v_pk_fma_f32 v[20:21], v[20:21], v[240:241], v[212:213]
  v_pk_fma_f32 v[22:23], v[22:23], v[240:241], v[214:215]
  v_pk_fma_f32 v[24:25], v[24:25], v[240:241], v[216:217]
  v_pk_fma_f32 v[26:27], v[26:27], v[240:241], v[218:219]
  v_pk_fma_f32 v[28:29], v[28:29], v[240:241], v[220:221]
  v_pk_fma_f32 v[30:31], v[30:31], v[240:241], v[222:223]
  v_cvt_pk_bf16_f32 v16, v16, v17
  v_cvt_pk_bf16_f32 v17, v18, v19
  v_cvt_pk_bf16_f32 v18, v20, v21
  v_cvt_pk_bf16_f32 v19, v22, v23
  v_cvt_pk_bf16_f32 v20, v24, v25
  v_cvt_pk_bf16_f32 v21, v26, v27
  v_cvt_pk_bf16_f32 v22, v28, v29
  v_cvt_pk_bf16_f32 v23, v30, v31
  v_pk_max_i16 v16, v16, 0
  v_pk_max_i16 v17, v17, 0
  v_pk_max_i16 v18, v18, 0
  v_pk_max_i16 v19, v19, 0
  v_pk_max_i16 v20, v20, 0
  v_pk_max_i16 v21, v21, 0
  v_pk_max_i16 v22, v22, 0
  v_pk_max_i16 v23, v23, 0
  buffer_store_dwordx4 v[16:19], v12, s[68:71], s33 offen offset:0 sc1
  buffer_store_dwordx4 v[20:23], v12, s[68:71], s33 offen offset:1024 sc1
  v_pk_fma_f32 v[208:209], v[144:145], v[246:247], v[160:161]
  v_pk_fma_f32 v[210:211], v[146:147], v[246:247], v[162:163]
  v_pk_fma_f32 v[212:213], v[148:149], v[246:247], v[164:165]
  v_pk_fma_f32 v[214:215], v[150:151], v[246:247], v[166:167]
  v_pk_fma_f32 v[216:217], v[152:153], v[246:247], v[168:169]
  v_pk_fma_f32 v[218:219], v[154:155], v[246:247], v[170:171]
  v_pk_fma_f32 v[220:221], v[156:157], v[246:247], v[172:173]
  v_pk_fma_f32 v[222:223], v[158:159], v[246:247], v[174:175]
  v_pk_fma_f32 v[80:81], v[80:81], v[242:243], v[208:209]
  v_pk_fma_f32 v[82:83], v[82:83], v[242:243], v[210:211]
  v_pk_fma_f32 v[84:85], v[84:85], v[242:243], v[212:213]
  v_pk_fma_f32 v[86:87], v[86:87], v[242:243], v[214:215]
  v_pk_fma_f32 v[88:89], v[88:89], v[242:243], v[216:217]
  v_pk_fma_f32 v[90:91], v[90:91], v[242:243], v[218:219]
  v_pk_fma_f32 v[92:93], v[92:93], v[242:243], v[220:221]
  v_pk_fma_f32 v[94:95], v[94:95], v[242:243], v[222:223]
  v_cvt_pk_bf16_f32 v80, v80, v81
  v_cvt_pk_bf16_f32 v81, v82, v83
  v_cvt_pk_bf16_f32 v82, v84, v85
  v_cvt_pk_bf16_f32 v83, v86, v87
  v_cvt_pk_bf16_f32 v84, v88, v89
  v_cvt_pk_bf16_f32 v85, v90, v91
  v_cvt_pk_bf16_f32 v86, v92, v93
  v_cvt_pk_bf16_f32 v87, v94, v95
  v_pk_max_i16 v80, v80, 0
  v_pk_max_i16 v81, v81, 0
  v_pk_max_i16 v82, v82, 0
  v_pk_max_i16 v83, v83, 0
  v_pk_max_i16 v84, v84, 0
  v_pk_max_i16 v85, v85, 0
  v_pk_max_i16 v86, v86, 0
  v_pk_max_i16 v87, v87, 0
  buffer_store_dwordx4 v[80:83], v12, s[68:71], s34 offen offset:0 sc1
  buffer_store_dwordx4 v[84:87], v12, s[68:71], s34 offen offset:1024 sc1
  ds_read_b128 v[144:147], v3 offset:256
  ds_read_b128 v[148:151], v3 offset:272
  ds_read_b128 v[152:155], v3 offset:288
  ds_read_b128 v[156:159], v3 offset:304
  ds_read_b128 v[160:163], v3 offset:768
  ds_read_b128 v[164:167], v3 offset:784
  ds_read_b128 v[168:171], v3 offset:800
  ds_read_b128 v[172:175], v3 offset:816
  s_waitcnt lgkmcnt(8)
  v_pk_fma_f32 v[208:209], v[176:177], v[244:245], v[192:193]
  v_pk_fma_f32 v[210:211], v[178:179], v[244:245], v[194:195]
  v_pk_fma_f32 v[212:213], v[180:181], v[244:245], v[196:197]
  v_pk_fma_f32 v[214:215], v[182:183], v[244:245], v[198:199]
  v_pk_fma_f32 v[216:217], v[184:185], v[244:245], v[200:201]
  v_pk_fma_f32 v[218:219], v[186:187], v[244:245], v[202:203]
  v_pk_fma_f32 v[220:221], v[188:189], v[244:245], v[204:205]
  v_pk_fma_f32 v[222:223], v[190:191], v[244:245], v[206:207]
  v_pk_fma_f32 v[32:33], v[32:33], v[240:241], v[208:209]
  v_pk_fma_f32 v[34:35], v[34:35], v[240:241], v[210:211]
  v_pk_fma_f32 v[36:37], v[36:37], v[240:241], v[212:213]
  v_pk_fma_f32 v[38:39], v[38:39], v[240:241], v[214:215]
  v_pk_fma_f32 v[40:41], v[40:41], v[240:241], v[216:217]
  v_pk_fma_f32 v[42:43], v[42:43], v[240:241], v[218:219]
  v_pk_fma_f32 v[44:45], v[44:45], v[240:241], v[220:221]
  v_pk_fma_f32 v[46:47], v[46:47], v[240:241], v[222:223]
  v_cvt_pk_bf16_f32 v32, v32, v33
  v_cvt_pk_bf16_f32 v33, v34, v35
  v_cvt_pk_bf16_f32 v34, v36, v37
  v_cvt_pk_bf16_f32 v35, v38, v39
  v_cvt_pk_bf16_f32 v36, v40, v41
  v_cvt_pk_bf16_f32 v37, v42, v43
  v_cvt_pk_bf16_f32 v38, v44, v45
  v_cvt_pk_bf16_f32 v39, v46, v47
  v_pk_max_i16 v32, v32, 0
  v_pk_max_i16 v33, v33, 0
  v_pk_max_i16 v34, v34, 0
  v_pk_max_i16 v35, v35, 0
  v_pk_max_i16 v36, v36, 0
  v_pk_max_i16 v37, v37, 0
  v_pk_max_i16 v38, v38, 0
  v_pk_max_i16 v39, v39, 0
  buffer_store_dwordx4 v[32:35], v12, s[68:71], s33 offen offset:2048 sc1
  buffer_store_dwordx4 v[36:39], v12, s[68:71], s33 offen offset:3072 sc1
  v_pk_fma_f32 v[208:209], v[176:177], v[246:247], v[192:193]
  v_pk_fma_f32 v[210:211], v[178:179], v[246:247], v[194:195]
  v_pk_fma_f32 v[212:213], v[180:181], v[246:247], v[196:197]
  v_pk_fma_f32 v[214:215], v[182:183], v[246:247], v[198:199]
  v_pk_fma_f32 v[216:217], v[184:185], v[246:247], v[200:201]
  v_pk_fma_f32 v[218:219], v[186:187], v[246:247], v[202:203]
  v_pk_fma_f32 v[220:221], v[188:189], v[246:247], v[204:205]
  v_pk_fma_f32 v[222:223], v[190:191], v[246:247], v[206:207]
  v_pk_fma_f32 v[96:97], v[96:97], v[242:243], v[208:209]
  v_pk_fma_f32 v[98:99], v[98:99], v[242:243], v[210:211]
  v_pk_fma_f32 v[100:101], v[100:101], v[242:243], v[212:213]
  v_pk_fma_f32 v[102:103], v[102:103], v[242:243], v[214:215]
  v_pk_fma_f32 v[104:105], v[104:105], v[242:243], v[216:217]
  v_pk_fma_f32 v[106:107], v[106:107], v[242:243], v[218:219]
  v_pk_fma_f32 v[108:109], v[108:109], v[242:243], v[220:221]
  v_pk_fma_f32 v[110:111], v[110:111], v[242:243], v[222:223]
  v_cvt_pk_bf16_f32 v96, v96, v97
  v_cvt_pk_bf16_f32 v97, v98, v99
  v_cvt_pk_bf16_f32 v98, v100, v101
  v_cvt_pk_bf16_f32 v99, v102, v103
  v_cvt_pk_bf16_f32 v100, v104, v105
  v_cvt_pk_bf16_f32 v101, v106, v107
  v_cvt_pk_bf16_f32 v102, v108, v109
  v_cvt_pk_bf16_f32 v103, v110, v111
  v_pk_max_i16 v96, v96, 0
  v_pk_max_i16 v97, v97, 0
  v_pk_max_i16 v98, v98, 0
  v_pk_max_i16 v99, v99, 0
  v_pk_max_i16 v100, v100, 0
  v_pk_max_i16 v101, v101, 0
  v_pk_max_i16 v102, v102, 0
  v_pk_max_i16 v103, v103, 0
  buffer_store_dwordx4 v[96:99], v12, s[68:71], s34 offen offset:2048 sc1
  buffer_store_dwordx4 v[100:103], v12, s[68:71], s34 offen offset:3072 sc1
  ds_read_b128 v[176:179], v3 offset:384
  ds_read_b128 v[180:183], v3 offset:400
  ds_read_b128 v[184:187], v3 offset:416
  ds_read_b128 v[188:191], v3 offset:432
  ds_read_b128 v[192:195], v3 offset:896
  ds_read_b128 v[196:199], v3 offset:912
  ds_read_b128 v[200:203], v3 offset:928
  ds_read_b128 v[204:207], v3 offset:944
  s_waitcnt lgkmcnt(8)
  v_pk_fma_f32 v[208:209], v[144:145], v[244:245], v[160:161]
  v_pk_fma_f32 v[210:211], v[146:147], v[244:245], v[162:163]
  v_pk_fma_f32 v[212:213], v[148:149], v[244:245], v[164:165]
  v_pk_fma_f32 v[214:215], v[150:151], v[244:245], v[166:167]
  v_pk_fma_f32 v[216:217], v[152:153], v[244:245], v[168:169]
  v_pk_fma_f32 v[218:219], v[154:155], v[244:245], v[170:171]
  v_pk_fma_f32 v[220:221], v[156:157], v[244:245], v[172:173]
  v_pk_fma_f32 v[222:223], v[158:159], v[244:245], v[174:175]
  v_pk_fma_f32 v[48:49], v[48:49], v[240:241], v[208:209]
  v_pk_fma_f32 v[50:51], v[50:51], v[240:241], v[210:211]
  v_pk_fma_f32 v[52:53], v[52:53], v[240:241], v[212:213]
  v_pk_fma_f32 v[54:55], v[54:55], v[240:241], v[214:215]
  v_pk_fma_f32 v[56:57], v[56:57], v[240:241], v[216:217]
  v_pk_fma_f32 v[58:59], v[58:59], v[240:241], v[218:219]
  v_pk_fma_f32 v[60:61], v[60:61], v[240:241], v[220:221]
  v_pk_fma_f32 v[62:63], v[62:63], v[240:241], v[222:223]
  v_cvt_pk_bf16_f32 v48, v48, v49
  v_cvt_pk_bf16_f32 v49, v50, v51
  v_cvt_pk_bf16_f32 v50, v52, v53
  v_cvt_pk_bf16_f32 v51, v54, v55
  v_cvt_pk_bf16_f32 v52, v56, v57
  v_cvt_pk_bf16_f32 v53, v58, v59
  v_cvt_pk_bf16_f32 v54, v60, v61
  v_cvt_pk_bf16_f32 v55, v62, v63
  v_pk_max_i16 v48, v48, 0
  v_pk_max_i16 v49, v49, 0
  v_pk_max_i16 v50, v50, 0
  v_pk_max_i16 v51, v51, 0
  v_pk_max_i16 v52, v52, 0
  v_pk_max_i16 v53, v53, 0
  v_pk_max_i16 v54, v54, 0
  v_pk_max_i16 v55, v55, 0
  s_add_u32 s33, s33, 4096
  s_add_u32 s34, s34, 4096
  buffer_store_dwordx4 v[48:51], v12, s[68:71], s33 offen offset:0 sc1
  buffer_store_dwordx4 v[52:55], v12, s[68:71], s33 offen offset:1024 sc1
  v_pk_fma_f32 v[208:209], v[144:145], v[246:247], v[160:161]
  v_pk_fma_f32 v[210:211], v[146:147], v[246:247], v[162:163]
  v_pk_fma_f32 v[212:213], v[148:149], v[246:247], v[164:165]
  v_pk_fma_f32 v[214:215], v[150:151], v[246:247], v[166:167]
  v_pk_fma_f32 v[216:217], v[152:153], v[246:247], v[168:169]
  v_pk_fma_f32 v[218:219], v[154:155], v[246:247], v[170:171]
  v_pk_fma_f32 v[220:221], v[156:157], v[246:247], v[172:173]
  v_pk_fma_f32 v[222:223], v[158:159], v[246:247], v[174:175]
  v_pk_fma_f32 v[112:113], v[112:113], v[242:243], v[208:209]
  v_pk_fma_f32 v[114:115], v[114:115], v[242:243], v[210:211]
  v_pk_fma_f32 v[116:117], v[116:117], v[242:243], v[212:213]
  v_pk_fma_f32 v[118:119], v[118:119], v[242:243], v[214:215]
  v_pk_fma_f32 v[120:121], v[120:121], v[242:243], v[216:217]
  v_pk_fma_f32 v[122:123], v[122:123], v[242:243], v[218:219]
  v_pk_fma_f32 v[124:125], v[124:125], v[242:243], v[220:221]
  v_pk_fma_f32 v[126:127], v[126:127], v[242:243], v[222:223]
  v_cvt_pk_bf16_f32 v112, v112, v113
  v_cvt_pk_bf16_f32 v113, v114, v115
  v_cvt_pk_bf16_f32 v114, v116, v117
  v_cvt_pk_bf16_f32 v115, v118, v119
  v_cvt_pk_bf16_f32 v116, v120, v121
  v_cvt_pk_bf16_f32 v117, v122, v123
  v_cvt_pk_bf16_f32 v118, v124, v125
  v_cvt_pk_bf16_f32 v119, v126, v127
  v_pk_max_i16 v112, v112, 0
  v_pk_max_i16 v113, v113, 0
  v_pk_max_i16 v114, v114, 0
  v_pk_max_i16 v115, v115, 0
  v_pk_max_i16 v116, v116, 0
  v_pk_max_i16 v117, v117, 0
  v_pk_max_i16 v118, v118, 0
  v_pk_max_i16 v119, v119, 0
  buffer_store_dwordx4 v[112:115], v12, s[68:71], s34 offen offset:0 sc1
  buffer_store_dwordx4 v[116:119], v12, s[68:71], s34 offen offset:1024 sc1
  s_waitcnt lgkmcnt(0)
  v_pk_fma_f32 v[208:209], v[176:177], v[244:245], v[192:193]
  v_pk_fma_f32 v[210:211], v[178:179], v[244:245], v[194:195]
  v_pk_fma_f32 v[212:213], v[180:181], v[244:245], v[196:197]
  v_pk_fma_f32 v[214:215], v[182:183], v[244:245], v[198:199]
  v_pk_fma_f32 v[216:217], v[184:185], v[244:245], v[200:201]
  v_pk_fma_f32 v[218:219], v[186:187], v[244:245], v[202:203]
  v_pk_fma_f32 v[220:221], v[188:189], v[244:245], v[204:205]
  v_pk_fma_f32 v[222:223], v[190:191], v[244:245], v[206:207]
  v_pk_fma_f32 v[64:65], v[64:65], v[240:241], v[208:209]
  v_pk_fma_f32 v[66:67], v[66:67], v[240:241], v[210:211]
  v_pk_fma_f32 v[68:69], v[68:69], v[240:241], v[212:213]
  v_pk_fma_f32 v[70:71], v[70:71], v[240:241], v[214:215]
  v_pk_fma_f32 v[72:73], v[72:73], v[240:241], v[216:217]
  v_pk_fma_f32 v[74:75], v[74:75], v[240:241], v[218:219]
  v_pk_fma_f32 v[76:77], v[76:77], v[240:241], v[220:221]
  v_pk_fma_f32 v[78:79], v[78:79], v[240:241], v[222:223]
  v_cvt_pk_bf16_f32 v64, v64, v65
  v_cvt_pk_bf16_f32 v65, v66, v67
  v_cvt_pk_bf16_f32 v66, v68, v69
  v_cvt_pk_bf16_f32 v67, v70, v71
  v_cvt_pk_bf16_f32 v68, v72, v73
  v_cvt_pk_bf16_f32 v69, v74, v75
  v_cvt_pk_bf16_f32 v70, v76, v77
  v_cvt_pk_bf16_f32 v71, v78, v79
  v_pk_max_i16 v64, v64, 0
  v_pk_max_i16 v65, v65, 0
  v_pk_max_i16 v66, v66, 0
  v_pk_max_i16 v67, v67, 0
  v_pk_max_i16 v68, v68, 0
  v_pk_max_i16 v69, v69, 0
  v_pk_max_i16 v70, v70, 0
  v_pk_max_i16 v71, v71, 0
  buffer_store_dwordx4 v[64:67], v12, s[68:71], s33 offen offset:2048 sc1
  buffer_store_dwordx4 v[68:71], v12, s[68:71], s33 offen offset:3072 sc1
  v_pk_fma_f32 v[208:209], v[176:177], v[246:247], v[192:193]
  v_pk_fma_f32 v[210:211], v[178:179], v[246:247], v[194:195]
  v_pk_fma_f32 v[212:213], v[180:181], v[246:247], v[196:197]
  v_pk_fma_f32 v[214:215], v[182:183], v[246:247], v[198:199]
  v_pk_fma_f32 v[216:217], v[184:185], v[246:247], v[200:201]
  v_pk_fma_f32 v[218:219], v[186:187], v[246:247], v[202:203]
  v_pk_fma_f32 v[220:221], v[188:189], v[246:247], v[204:205]
  v_pk_fma_f32 v[222:223], v[190:191], v[246:247], v[206:207]
  v_pk_fma_f32 v[128:129], v[128:129], v[242:243], v[208:209]
  v_pk_fma_f32 v[130:131], v[130:131], v[242:243], v[210:211]
  v_pk_fma_f32 v[132:133], v[132:133], v[242:243], v[212:213]
  v_pk_fma_f32 v[134:135], v[134:135], v[242:243], v[214:215]
  v_pk_fma_f32 v[136:137], v[136:137], v[242:243], v[216:217]
  v_pk_fma_f32 v[138:139], v[138:139], v[242:243], v[218:219]
  v_pk_fma_f32 v[140:141], v[140:141], v[242:243], v[220:221]
  v_pk_fma_f32 v[142:143], v[142:143], v[242:243], v[222:223]
  v_cvt_pk_bf16_f32 v128, v128, v129
  v_cvt_pk_bf16_f32 v129, v130, v131
  v_cvt_pk_bf16_f32 v130, v132, v133
  v_cvt_pk_bf16_f32 v131, v134, v135
  v_cvt_pk_bf16_f32 v132, v136, v137
  v_cvt_pk_bf16_f32 v133, v138, v139
  v_cvt_pk_bf16_f32 v134, v140, v141
  v_cvt_pk_bf16_f32 v135, v142, v143
  v_pk_max_i16 v128, v128, 0
  v_pk_max_i16 v129, v129, 0
  v_pk_max_i16 v130, v130, 0
  v_pk_max_i16 v131, v131, 0
  v_pk_max_i16 v132, v132, 0
  v_pk_max_i16 v133, v133, 0
  v_pk_max_i16 v134, v134, 0
  v_pk_max_i16 v135, v135, 0
  buffer_store_dwordx4 v[128:131], v12, s[68:71], s34 offen offset:2048 sc1
  buffer_store_dwordx4 v[132:135], v12, s[68:71], s34 offen offset:3072 sc1
  s_lshl_b32 s38, s26, 12
  s_lshl_b32 s39, s27, 7
  s_add_u32 s38, s38, s39
  s_add_u32 s38, s38, 688128
f1_skip:
kn_f2:
  s_and_b32 s26, s24, 3
  s_lshl_b32 s26, s26, 2
  s_and_b32 s27, s25, 3
  s_add_u32 s26, s26, s27
  s_lshr_b32 s27, s24, 2
  s_lshl_b32 s27, s27, 3
  s_lshr_b32 s28, s25, 2
  s_add_u32 s27, s27, s28
  s_lshl_b32 s28, s26, 2
  s_add_u32 s28, s28, s3
  v_bfe_u32 v2, v1, 2, 2
  v_lshlrev_b32 v6, 7, v2
  v_bfe_u32 v2, v1, 3, 1
  v_lshl_add_u32 v6, v2, 6, v6
  v_bfe_u32 v2, v1, 4, 1
  v_lshl_add_u32 v6, v2, 5, v6
  v_and_b32 v2, 3, v1
  v_lshl_add_u32 v6, v2, 3, v6
  v_lshrrev_b32 v2, 5, v1
  v_mul_u32_u24 v2, 512, v2
  v_add_u32 v6, v6, v2
  v_xor_b32 v7, 64, v6
  v_lshrrev_b32 v2, 3, v1
  v_mul_u32_u24 v2, 2048, v2
  v_bfe_u32 v3, v1, 4, 1
  v_lshlrev_b32 v3, 2, v3
  v_and_b32 v4, 7, v1
  v_xor_b32 v3, v3, v4
  v_lshl_add_u32 v2, v3, 4, v2
  s_mul_i32 s31, s3, 65536
  v_add_u32 v2, s31, v2
  v_add_u32 v8, 4096, v2
  v_add_u32 v9, 19456, v2
  v_add_u32 v10, 34816, v2
  v_add_u32 v11, 50176, v2
  s_mul_i32 s31, s3, 4096
  s_add_u32 s31, s31, 0
  s_lshl_b32 s30, s27, 7
  s_mul_i32 s32, s28, 229376
  s_add_u32 s32, s32, 75497472
  v_lshlrev_b32 v12, 4, v1
  s_barrier
  s_add_u32 m0, s31, 0
  s_nop 0
  buffer_load_dwordx4 v8, s[56:59], s30 offen offset:0 lds
  buffer_load_dwordx4 v9, s[56:59], s30 offen offset:1024 lds
  buffer_load_dwordx4 v10, s[56:59], s30 offen offset:2048 lds
  buffer_load_dwordx4 v11, s[56:59], s30 offen offset:3072 lds
  s_add_u32 s30, s30, 262144
  s_add_u32 m0, s31, 16384
  s_nop 0
  buffer_load_dwordx4 v8, s[56:59], s30 offen offset:0 lds
  buffer_load_dwordx4 v9, s[56:59], s30 offen offset:1024 lds
  buffer_load_dwordx4 v10, s[56:59], s30 offen offset:2048 lds
  buffer_load_dwordx4 v11, s[56:59], s30 offen offset:3072 lds
  s_add_u32 s30, s30, 262144
  s_add_u32 m0, s31, 32768
  s_nop 0
  buffer_load_dwordx4 v8, s[56:59], s30 offen offset:0 lds
  buffer_load_dwordx4 v9, s[56:59], s30 offen offset:1024 lds
  buffer_load_dwordx4 v10, s[56:59], s30 offen offset:2048 lds
  buffer_load_dwordx4 v11, s[56:59], s30 offen offset:3072 lds
  s_add_u32 s30, s30, 262144
  s_add_u32 m0, s31, 49152
  s_nop 0
  buffer_load_dwordx4 v8, s[56:59], s30 offen offset:0 lds
  buffer_load_dwordx4 v9, s[56:59], s30 offen offset:1024 lds
  buffer_load_dwordx4 v10, s[56:59], s30 offen offset:2048 lds
  buffer_load_dwordx4 v11, s[56:59], s30 offen offset:3072 lds
  s_add_u32 s30, s30, 262144
  v_lshrrev_b32 v13, 5, v1
  v_and_b32 v14, 31, v1
  v_lshlrev_b32 v15, 4, v13
  s_lshl_b32 s33, s27, 8
  s_lshl_b32 s36, s28, 16
  s_lshl_b32 s37, s27, 7
  s_add_u32 s36, s36, s37
  s_add_u32 s40, s90, 0
  s_addc_u32 s41, s91, 0
  s_and_b32 s41, s41, 0xffff
  s_mov_b32 s42, 4194304
  s_mov_b32 s43, 0x20000
  s_waitcnt vmcnt(16) lgkmcnt(0)
  s_barrier
  v_cmp_eq_u32 vcc, 0, v0
  v_mov_b32 v2, 2130706432
  v_mov_b32 v3, 1
  v_cndmask_b32 v2, v2, v0, vcc
  buffer_store_dword v3, v2, s[68:71], s38 offen sc0 sc1
  s_lshr_b32 s34, s26, 1
  s_lshl_b32 s34, s34, 12
  s_add_u32 s34, s34, 688128
  v_and_b32 v2, 7, v1
  v_lshl_add_u32 v2, s3, 3, v2
  v_min_u32 v2, 27, v2
  v_lshlrev_b32 v2, 7, v2
  v_add_u32 v251, s34, v2
  buffer_load_dword v250, v251, s[68:71], 0 offen sc1
  s_waitcnt vmcnt(0)
  v_cmp_ne_u32 vcc, 1, v250
  s_cbranch_vccnz f2_w_sp
f2_w_ok:
  s_barrier
  buffer_load_dwordx4 a[0:3], v12, s[68:71], s32 offen offset:0 sc1
  buffer_load_dwordx4 a[4:7], v12, s[68:71], s32 offen offset:1024 sc1
  buffer_load_dwordx4 a[8:11], v12, s[68:71], s32 offen offset:2048 sc1
  buffer_load_dwordx4 a[12:15], v12, s[68:71], s32 offen offset:3072 sc1
  s_add_u32 s32, s32, 4096
  buffer_load_dwordx4 a[16:19], v12, s[68:71], s32 offen offset:0 sc1
  buffer_load_dwordx4 a[20:23], v12, s[68:71], s32 offen offset:1024 sc1
  buffer_load_dwordx4 a[24:27], v12, s[68:71], s32 offen offset:2048 sc1
  buffer_load_dwordx4 a[28:31], v12, s[68:71], s32 offen offset:3072 sc1
  s_add_u32 s32, s32, 4096
  buffer_load_dwordx4 a[32:35], v12, s[68:71], s32 offen offset:0 sc1
  buffer_load_dwordx4 a[36:39], v12, s[68:71], s32 offen offset:1024 sc1
  buffer_load_dwordx4 a[40:43], v12, s[68:71], s32 offen offset:2048 sc1
  buffer_load_dwordx4 a[44:47], v12, s[68:71], s32 offen offset:3072 sc1
  s_add_u32 s32, s32, 4096
  buffer_load_dwordx4 a[48:51], v12, s[68:71], s32 offen offset:0 sc1
  buffer_load_dwordx4 a[52:55], v12, s[68:71], s32 offen offset:1024 sc1
  buffer_load_dwordx4 a[56:59], v12, s[68:71], s32 offen offset:2048 sc1
  buffer_load_dwordx4 a[60:63], v12, s[68:71], s32 offen offset:3072 sc1
  s_add_u32 s32, s32, 4096
  buffer_load_dwordx4 a[64:67], v12, s[68:71], s32 offen offset:0 sc1
  buffer_load_dwordx4 a[68:71], v12, s[68:71], s32 offen offset:1024 sc1
  buffer_load_dwordx4 a[72:75], v12, s[68:71], s32 offen offset:2048 sc1
  buffer_load_dwordx4 a[76:79], v12, s[68:71], s32 offen offset:3072 sc1
  s_add_u32 s32, s32, 4096
  buffer_load_dwordx4 a[80:83], v12, s[68:71], s32 offen offset:0 sc1
  buffer_load_dwordx4 a[84:87], v12, s[68:71], s32 offen offset:1024 sc1
  buffer_load_dwordx4 a[88:91], v12, s[68:71], s32 offen offset:2048 sc1
  buffer_load_dwordx4 a[92:95], v12, s[68:71], s32 offen offset:3072 sc1
  s_add_u32 s32, s32, 4096
  buffer_load_dwordx4 a[96:99], v12, s[68:71], s32 offen offset:0 sc1
  buffer_load_dwordx4 a[100:103], v12, s[68:71], s32 offen offset:1024 sc1
  buffer_load_dwordx4 a[104:107], v12, s[68:71], s32 offen offset:2048 sc1
  buffer_load_dwordx4 a[108:111], v12, s[68:71], s32 offen offset:3072 sc1
  s_add_u32 s34, s33, 20480
  buffer_load_dwordx4 v[128:131], v15, s[68:71], s34 offen offset:0 sc1
  buffer_load_dwordx4 v[132:135], v15, s[68:71], s34 offen offset:32 sc1
  buffer_load_dwordx4 v[136:139], v15, s[68:71], s34 offen offset:64 sc1
  buffer_load_dwordx4 v[140:143], v15, s[68:71], s34 offen offset:96 sc1
  buffer_load_dwordx4 v[144:147], v15, s[68:71], s34 offen offset:128 sc1
  buffer_load_dwordx4 v[148:151], v15, s[68:71], s34 offen offset:160 sc1
  buffer_load_dwordx4 v[152:155], v15, s[68:71], s34 offen offset:192 sc1
  buffer_load_dwordx4 v[156:159], v15, s[68:71], s34 offen offset:224 sc1
  s_waitcnt vmcnt(28) lgkmcnt(0)
  s_barrier
  ds_read_b64_tr_b16 v[48:49], v6 offset:0
  ds_read_b64_tr_b16 v[50:51], v6 offset:1024
  ds_read_b64_tr_b16 v[52:53], v7 offset:0
  ds_read_b64_tr_b16 v[54:55], v7 offset:1024
  ds_read_b64_tr_b16 v[56:57], v6 offset:2048
  ds_read_b64_tr_b16 v[58:59], v6 offset:3072
  ds_read_b64_tr_b16 v[60:61], v7 offset:2048
  ds_read_b64_tr_b16 v[62:63], v7 offset:3072
  ds_read_b64_tr_b16 v[64:65], v6 offset:4096
  ds_read_b64_tr_b16 v[66:67], v6 offset:5120
  ds_read_b64_tr_b16 v[68:69], v7 offset:4096
  ds_read_b64_tr_b16 v[70:71], v7 offset:5120
  ds_read_b64_tr_b16 v[72:73], v6 offset:6144
  ds_read_b64_tr_b16 v[74:75], v6 offset:7168
  ds_read_b64_tr_b16 v[76:77], v7 offset:6144
  ds_read_b64_tr_b16 v[78:79], v7 offset:7168
  s_waitcnt lgkmcnt(0)
  v_mfma_f32_32x32x16_bf16 v[16:31], v[48:51], a[0:3], 0
  ds_read_b64_tr_b16 v[80:81], v6 offset:8192
  ds_read_b64_tr_b16 v[82:83], v6 offset:9216
  ds_read_b64_tr_b16 v[84:85], v7 offset:8192
  s_add_u32 s32, s32, 4096
  buffer_load_dwordx4 a[112:115], v12, s[68:71], s32 offen offset:0 sc1
  v_mfma_f32_32x32x16_bf16 v[32:47], v[52:55], a[0:3], 0
  ds_read_b64_tr_b16 v[86:87], v7 offset:9216
  ds_read_b64_tr_b16 v[88:89], v6 offset:10240
  ds_read_b64_tr_b16 v[90:91], v6 offset:11264
  buffer_load_dwordx4 a[116:119], v12, s[68:71], s32 offen offset:1024 sc1
  v_mfma_f32_32x32x16_bf16 v[16:31], v[56:59], a[4:7], v[16:31]
  ds_read_b64_tr_b16 v[92:93], v7 offset:10240
  ds_read_b64_tr_b16 v[94:95], v7 offset:11264
  buffer_load_dwordx4 a[120:123], v12, s[68:71], s32 offen offset:2048 sc1
  v_mfma_f32_32x32x16_bf16 v[32:47], v[60:63], a[4:7], v[32:47]
  ds_read_b64_tr_b16 v[96:97], v6 offset:12288
  ds_read_b64_tr_b16 v[98:99], v6 offset:13312
  ds_read_b64_tr_b16 v[100:101], v7 offset:12288
  buffer_load_dwordx4 a[124:127], v12, s[68:71], s32 offen offset:3072 sc1
  s_add_u32 s32, s32, 4096
  v_mfma_f32_32x32x16_bf16 v[16:31], v[64:67], a[8:11], v[16:31]
  ds_read_b64_tr_b16 v[102:103], v7 offset:13312
  ds_read_b64_tr_b16 v[104:105], v6 offset:14336
  ds_read_b64_tr_b16 v[106:107], v6 offset:15360
  v_mfma_f32_32x32x16_bf16 v[32:47], v[68:71], a[8:11], v[32:47]
  ds_read_b64_tr_b16 v[108:109], v7 offset:14336
  ds_read_b64_tr_b16 v[110:111], v7 offset:15360
  v_mfma_f32_32x32x16_bf16 v[16:31], v[72:75], a[12:15], v[16:31]
  v_mfma_f32_32x32x16_bf16 v[32:47], v[76:79], a[12:15], v[32:47]
  s_waitcnt vmcnt(24) lgkmcnt(0)
  s_barrier
  v_mfma_f32_32x32x16_bf16 v[16:31], v[80:83], a[16:19], v[16:31]
  ds_read_b64_tr_b16 v[48:49], v6 offset:16384
  ds_read_b64_tr_b16 v[50:51], v6 offset:17408
  ds_read_b64_tr_b16 v[52:53], v7 offset:16384
  s_add_u32 m0, s31, 0
  s_nop 0
  buffer_load_dwordx4 v8, s[56:59], s30 offen offset:0 lds
  buffer_load_dwordx4 v9, s[56:59], s30 offen offset:1024 lds
  v_mfma_f32_32x32x16_bf16 v[32:47], v[84:87], a[16:19], v[32:47]
  ds_read_b64_tr_b16 v[54:55], v7 offset:17408
  ds_read_b64_tr_b16 v[56:57], v6 offset:18432
  ds_read_b64_tr_b16 v[58:59], v6 offset:19456
  buffer_load_dwordx4 v10, s[56:59], s30 offen offset:2048 lds
  v_mfma_f32_32x32x16_bf16 v[16:31], v[88:91], a[20:23], v[16:31]
  ds_read_b64_tr_b16 v[60:61], v7 offset:18432
  ds_read_b64_tr_b16 v[62:63], v7 offset:19456
  buffer_load_dwordx4 v11, s[56:59], s30 offen offset:3072 lds
  v_mfma_f32_32x32x16_bf16 v[32:47], v[92:95], a[20:23], v[32:47]
  ds_read_b64_tr_b16 v[64:65], v6 offset:20480
  ds_read_b64_tr_b16 v[66:67], v6 offset:21504
  ds_read_b64_tr_b16 v[68:69], v7 offset:20480
  s_add_u32 s30, s30, 262144
  v_mfma_f32_32x32x16_bf16 v[16:31], v[96:99], a[24:27], v[16:31]
  ds_read_b64_tr_b16 v[70:71], v7 offset:21504
  ds_read_b64_tr_b16 v[72:73], v6 offset:22528
  ds_read_b64_tr_b16 v[74:75], v6 offset:23552
  buffer_load_dwordx4 a[0:3], v12, s[68:71], s32 offen offset:0 sc1
  v_mfma_f32_32x32x16_bf16 v[32:47], v[100:103], a[24:27], v[32:47]
  ds_read_b64_tr_b16 v[76:77], v7 offset:22528
  ds_read_b64_tr_b16 v[78:79], v7 offset:23552
  buffer_load_dwordx4 a[4:7], v12, s[68:71], s32 offen offset:1024 sc1
  v_mfma_f32_32x32x16_bf16 v[16:31], v[104:107], a[28:31], v[16:31]
  buffer_load_dwordx4 a[8:11], v12, s[68:71], s32 offen offset:2048 sc1
  v_mfma_f32_32x32x16_bf16 v[32:47], v[108:111], a[28:31], v[32:47]
  buffer_load_dwordx4 a[12:15], v12, s[68:71], s32 offen offset:3072 sc1
  s_waitcnt lgkmcnt(0)
  v_mfma_f32_32x32x16_bf16 v[16:31], v[48:51], a[32:35], v[16:31]
  ds_read_b64_tr_b16 v[80:81], v6 offset:24576
  ds_read_b64_tr_b16 v[82:83], v6 offset:25600
  ds_read_b64_tr_b16 v[84:85], v7 offset:24576
  s_add_u32 s32, s32, 4096
  buffer_load_dwordx4 a[16:19], v12, s[68:71], s32 offen offset:0 sc1
  v_mfma_f32_32x32x16_bf16 v[32:47], v[52:55], a[32:35], v[32:47]
  ds_read_b64_tr_b16 v[86:87], v7 offset:25600
  ds_read_b64_tr_b16 v[88:89], v6 offset:26624
  ds_read_b64_tr_b16 v[90:91], v6 offset:27648
  buffer_load_dwordx4 a[20:23], v12, s[68:71], s32 offen offset:1024 sc1
  v_mfma_f32_32x32x16_bf16 v[16:31], v[56:59], a[36:39], v[16:31]
  ds_read_b64_tr_b16 v[92:93], v7 offset:26624
  ds_read_b64_tr_b16 v[94:95], v7 offset:27648
  buffer_load_dwordx4 a[24:27], v12, s[68:71], s32 offen offset:2048 sc1
  v_mfma_f32_32x32x16_bf16 v[32:47], v[60:63], a[36:39], v[32:47]
  ds_read_b64_tr_b16 v[96:97], v6 offset:28672
  ds_read_b64_tr_b16 v[98:99], v6 offset:29696
  ds_read_b64_tr_b16 v[100:101], v7 offset:28672
  buffer_load_dwordx4 a[28:31], v12, s[68:71], s32 offen offset:3072 sc1
  s_add_u32 s32, s32, 4096
  v_mfma_f32_32x32x16_bf16 v[16:31], v[64:67], a[40:43], v[16:31]
  ds_read_b64_tr_b16 v[102:103], v7 offset:29696
  ds_read_b64_tr_b16 v[104:105], v6 offset:30720
  ds_read_b64_tr_b16 v[106:107], v6 offset:31744
  v_mfma_f32_32x32x16_bf16 v[32:47], v[68:71], a[40:43], v[32:47]
  ds_read_b64_tr_b16 v[108:109], v7 offset:30720
  ds_read_b64_tr_b16 v[110:111], v7 offset:31744
  v_mfma_f32_32x32x16_bf16 v[16:31], v[72:75], a[44:47], v[16:31]
  v_mfma_f32_32x32x16_bf16 v[32:47], v[76:79], a[44:47], v[32:47]
  s_waitcnt vmcnt(28) lgkmcnt(0)
  s_barrier
  v_mfma_f32_32x32x16_bf16 v[16:31], v[80:83], a[48:51], v[16:31]
  ds_read_b64_tr_b16 v[48:49], v6 offset:32768
  ds_read_b64_tr_b16 v[50:51], v6 offset:33792
  ds_read_b64_tr_b16 v[52:53], v7 offset:32768
  s_add_u32 m0, s31, 16384
  s_nop 0
  buffer_load_dwordx4 v8, s[56:59], s30 offen offset:0 lds
  buffer_load_dwordx4 v9, s[56:59], s30 offen offset:1024 lds
  v_mfma_f32_32x32x16_bf16 v[32:47], v[84:87], a[48:51], v[32:47]
  ds_read_b64_tr_b16 v[54:55], v7 offset:33792
  ds_read_b64_tr_b16 v[56:57], v6 offset:34816
  ds_read_b64_tr_b16 v[58:59], v6 offset:35840
  buffer_load_dwordx4 v10, s[56:59], s30 offen offset:2048 lds
  v_mfma_f32_32x32x16_bf16 v[16:31], v[88:91], a[52:55], v[16:31]
  ds_read_b64_tr_b16 v[60:61], v7 offset:34816
  ds_read_b64_tr_b16 v[62:63], v7 offset:35840
  buffer_load_dwordx4 v11, s[56:59], s30 offen offset:3072 lds
  v_mfma_f32_32x32x16_bf16 v[32:47], v[92:95], a[52:55], v[32:47]
  ds_read_b64_tr_b16 v[64:65], v6 offset:36864
  ds_read_b64_tr_b16 v[66:67], v6 offset:37888
  ds_read_b64_tr_b16 v[68:69], v7 offset:36864
  s_add_u32 s30, s30, 262144
  v_mfma_f32_32x32x16_bf16 v[16:31], v[96:99], a[56:59], v[16:31]
  ds_read_b64_tr_b16 v[70:71], v7 offset:37888
  ds_read_b64_tr_b16 v[72:73], v6 offset:38912
  ds_read_b64_tr_b16 v[74:75], v6 offset:39936
  buffer_load_dwordx4 a[32:35], v12, s[68:71], s32 offen offset:0 sc1
  v_mfma_f32_32x32x16_bf16 v[32:47], v[100:103], a[56:59], v[32:47]
  ds_read_b64_tr_b16 v[76:77], v7 offset:38912
  ds_read_b64_tr_b16 v[78:79], v7 offset:39936
  buffer_load_dwordx4 a[36:39], v12, s[68:71], s32 offen offset:1024 sc1
  v_mfma_f32_32x32x16_bf16 v[16:31], v[104:107], a[60:63], v[16:31]
  buffer_load_dwordx4 a[40:43], v12, s[68:71], s32 offen offset:2048 sc1
  v_mfma_f32_32x32x16_bf16 v[32:47], v[108:111], a[60:63], v[32:47]
  buffer_load_dwordx4 a[44:47], v12, s[68:71], s32 offen offset:3072 sc1
  s_waitcnt lgkmcnt(0)
  v_mfma_f32_32x32x16_bf16 v[16:31], v[48:51], a[64:67], v[16:31]
  ds_read_b64_tr_b16 v[80:81], v6 offset:40960
  ds_read_b64_tr_b16 v[82:83], v6 offset:41984
  ds_read_b64_tr_b16 v[84:85], v7 offset:40960
  s_add_u32 s32, s32, 4096
  buffer_load_dwordx4 a[48:51], v12, s[68:71], s32 offen offset:0 sc1
  v_mfma_f32_32x32x16_bf16 v[32:47], v[52:55], a[64:67], v[32:47]
  ds_read_b64_tr_b16 v[86:87], v7 offset:41984
  ds_read_b64_tr_b16 v[88:89], v6 offset:43008
  ds_read_b64_tr_b16 v[90:91], v6 offset:44032
  buffer_load_dwordx4 a[52:55], v12, s[68:71], s32 offen offset:1024 sc1
  v_mfma_f32_32x32x16_bf16 v[16:31], v[56:59], a[68:71], v[16:31]
  ds_read_b64_tr_b16 v[92:93], v7 offset:43008
  ds_read_b64_tr_b16 v[94:95], v7 offset:44032
  buffer_load_dwordx4 a[56:59], v12, s[68:71], s32 offen offset:2048 sc1
  v_mfma_f32_32x32x16_bf16 v[32:47], v[60:63], a[68:71], v[32:47]
  ds_read_b64_tr_b16 v[96:97], v6 offset:45056
  ds_read_b64_tr_b16 v[98:99], v6 offset:46080
  ds_read_b64_tr_b16 v[100:101], v7 offset:45056
  buffer_load_dwordx4 a[60:63], v12, s[68:71], s32 offen offset:3072 sc1
  s_add_u32 s32, s32, 4096
  v_mfma_f32_32x32x16_bf16 v[16:31], v[64:67], a[72:75], v[16:31]
  ds_read_b64_tr_b16 v[102:103], v7 offset:46080
  ds_read_b64_tr_b16 v[104:105], v6 offset:47104
  ds_read_b64_tr_b16 v[106:107], v6 offset:48128
  v_mfma_f32_32x32x16_bf16 v[32:47], v[68:71], a[72:75], v[32:47]
  ds_read_b64_tr_b16 v[108:109], v7 offset:47104
  ds_read_b64_tr_b16 v[110:111], v7 offset:48128
  v_mfma_f32_32x32x16_bf16 v[16:31], v[72:75], a[76:79], v[16:31]
  v_mfma_f32_32x32x16_bf16 v[32:47], v[76:79], a[76:79], v[32:47]
  s_waitcnt vmcnt(24) lgkmcnt(0)
  s_barrier
  v_mfma_f32_32x32x16_bf16 v[16:31], v[80:83], a[80:83], v[16:31]
  ds_read_b64_tr_b16 v[48:49], v6 offset:49152
  ds_read_b64_tr_b16 v[50:51], v6 offset:50176
  ds_read_b64_tr_b16 v[52:53], v7 offset:49152
  s_add_u32 m0, s31, 32768
  s_nop 0
  buffer_load_dwordx4 v8, s[56:59], s30 offen offset:0 lds
  buffer_load_dwordx4 v9, s[56:59], s30 offen offset:1024 lds
  v_mfma_f32_32x32x16_bf16 v[32:47], v[84:87], a[80:83], v[32:47]
  ds_read_b64_tr_b16 v[54:55], v7 offset:50176
  ds_read_b64_tr_b16 v[56:57], v6 offset:51200
  ds_read_b64_tr_b16 v[58:59], v6 offset:52224
  buffer_load_dwordx4 v10, s[56:59], s30 offen offset:2048 lds
  v_mfma_f32_32x32x16_bf16 v[16:31], v[88:91], a[84:87], v[16:31]
  ds_read_b64_tr_b16 v[60:61], v7 offset:51200
  ds_read_b64_tr_b16 v[62:63], v7 offset:52224
  buffer_load_dwordx4 v11, s[56:59], s30 offen offset:3072 lds
  v_mfma_f32_32x32x16_bf16 v[32:47], v[92:95], a[84:87], v[32:47]
  ds_read_b64_tr_b16 v[64:65], v6 offset:53248
  ds_read_b64_tr_b16 v[66:67], v6 offset:54272
  ds_read_b64_tr_b16 v[68:69], v7 offset:53248
  s_add_u32 s30, s30, 262144
  v_mfma_f32_32x32x16_bf16 v[16:31], v[96:99], a[88:91], v[16:31]
  ds_read_b64_tr_b16 v[70:71], v7 offset:54272
  ds_read_b64_tr_b16 v[72:73], v6 offset:55296
  ds_read_b64_tr_b16 v[74:75], v6 offset:56320
  buffer_load_dwordx4 a[64:67], v12, s[68:71], s32 offen offset:0 sc1
  v_mfma_f32_32x32x16_bf16 v[32:47], v[100:103], a[88:91], v[32:47]
  ds_read_b64_tr_b16 v[76:77], v7 offset:55296
  ds_read_b64_tr_b16 v[78:79], v7 offset:56320
  buffer_load_dwordx4 a[68:71], v12, s[68:71], s32 offen offset:1024 sc1
  v_mfma_f32_32x32x16_bf16 v[16:31], v[104:107], a[92:95], v[16:31]
  buffer_load_dwordx4 a[72:75], v12, s[68:71], s32 offen offset:2048 sc1
  v_mfma_f32_32x32x16_bf16 v[32:47], v[108:111], a[92:95], v[32:47]
  buffer_load_dwordx4 a[76:79], v12, s[68:71], s32 offen offset:3072 sc1
  s_waitcnt lgkmcnt(0)
  v_mfma_f32_32x32x16_bf16 v[16:31], v[48:51], a[96:99], v[16:31]
  ds_read_b64_tr_b16 v[80:81], v6 offset:57344
  ds_read_b64_tr_b16 v[82:83], v6 offset:58368
  ds_read_b64_tr_b16 v[84:85], v7 offset:57344
  s_add_u32 s32, s32, 4096
  buffer_load_dwordx4 a[80:83], v12, s[68:71], s32 offen offset:0 sc1
  v_mfma_f32_32x32x16_bf16 v[32:47], v[52:55], a[96:99], v[32:47]
  ds_read_b64_tr_b16 v[86:87], v7 offset:58368
  ds_read_b64_tr_b16 v[88:89], v6 offset:59392
  ds_read_b64_tr_b16 v[90:91], v6 offset:60416
  buffer_load_dwordx4 a[84:87], v12, s[68:71], s32 offen offset:1024 sc1
  v_mfma_f32_32x32x16_bf16 v[16:31], v[56:59], a[100:103], v[16:31]
  ds_read_b64_tr_b16 v[92:93], v7 offset:59392
  ds_read_b64_tr_b16 v[94:95], v7 offset:60416
  buffer_load_dwordx4 a[88:91], v12, s[68:71], s32 offen offset:2048 sc1
  v_mfma_f32_32x32x16_bf16 v[32:47], v[60:63], a[100:103], v[32:47]
  ds_read_b64_tr_b16 v[96:97], v6 offset:61440
  ds_read_b64_tr_b16 v[98:99], v6 offset:62464
  ds_read_b64_tr_b16 v[100:101], v7 offset:61440
  buffer_load_dwordx4 a[92:95], v12, s[68:71], s32 offen offset:3072 sc1
  s_add_u32 s32, s32, 4096
  v_mfma_f32_32x32x16_bf16 v[16:31], v[64:67], a[104:107], v[16:31]
  ds_read_b64_tr_b16 v[102:103], v7 offset:62464
  ds_read_b64_tr_b16 v[104:105], v6 offset:63488
  ds_read_b64_tr_b16 v[106:107], v6 offset:64512
  v_mfma_f32_32x32x16_bf16 v[32:47], v[68:71], a[104:107], v[32:47]
  ds_read_b64_tr_b16 v[108:109], v7 offset:63488
  ds_read_b64_tr_b16 v[110:111], v7 offset:64512
  v_mfma_f32_32x32x16_bf16 v[16:31], v[72:75], a[108:111], v[16:31]
  v_mfma_f32_32x32x16_bf16 v[32:47], v[76:79], a[108:111], v[32:47]
  s_waitcnt vmcnt(24) lgkmcnt(0)
  s_barrier
  v_mfma_f32_32x32x16_bf16 v[16:31], v[80:83], a[112:115], v[16:31]
  ds_read_b64_tr_b16 v[48:49], v6 offset:0
  ds_read_b64_tr_b16 v[50:51], v6 offset:1024
  ds_read_b64_tr_b16 v[52:53], v7 offset:0
  s_add_u32 m0, s31, 49152
  s_nop 0
  buffer_load_dwordx4 v8, s[56:59], s30 offen offset:0 lds
  buffer_load_dwordx4 v9, s[56:59], s30 offen offset:1024 lds
  v_mfma_f32_32x32x16_bf16 v[32:47], v[84:87], a[112:115], v[32:47]
  ds_read_b64_tr_b16 v[54:55], v7 offset:1024
  ds_read_b64_tr_b16 v[56:57], v6 offset:2048
  ds_read_b64_tr_b16 v[58:59], v6 offset:3072
  buffer_load_dwordx4 v10, s[56:59], s30 offen offset:2048 lds
  v_mfma_f32_32x32x16_bf16 v[16:31], v[88:91], a[116:119], v[16:31]
  ds_read_b64_tr_b16 v[60:61], v7 offset:2048
  ds_read_b64_tr_b16 v[62:63], v7 offset:3072
  buffer_load_dwordx4 v11, s[56:59], s30 offen offset:3072 lds
  v_mfma_f32_32x32x16_bf16 v[32:47], v[92:95], a[116:119], v[32:47]
  ds_read_b64_tr_b16 v[64:65], v6 offset:4096
  ds_read_b64_tr_b16 v[66:67], v6 offset:5120
  ds_read_b64_tr_b16 v[68:69], v7 offset:4096
  s_add_u32 s30, s30, 262144
  v_mfma_f32_32x32x16_bf16 v[16:31], v[96:99], a[120:123], v[16:31]
  ds_read_b64_tr_b16 v[70:71], v7 offset:5120
  ds_read_b64_tr_b16 v[72:73], v6 offset:6144
  ds_read_b64_tr_b16 v[74:75], v6 offset:7168
  buffer_load_dwordx4 a[96:99], v12, s[68:71], s32 offen offset:0 sc1
  v_mfma_f32_32x32x16_bf16 v[32:47], v[100:103], a[120:123], v[32:47]
  ds_read_b64_tr_b16 v[76:77], v7 offset:6144
  ds_read_b64_tr_b16 v[78:79], v7 offset:7168
  buffer_load_dwordx4 a[100:103], v12, s[68:71], s32 offen offset:1024 sc1
  v_mfma_f32_32x32x16_bf16 v[16:31], v[104:107], a[124:127], v[16:31]
  buffer_load_dwordx4 a[104:107], v12, s[68:71], s32 offen offset:2048 sc1
  v_mfma_f32_32x32x16_bf16 v[32:47], v[108:111], a[124:127], v[32:47]
  buffer_load_dwordx4 a[108:111], v12, s[68:71], s32 offen offset:3072 sc1
  s_mov_b32 s20, 5
.p2align 3
f2_l:
  s_waitcnt lgkmcnt(0)
  v_mfma_f32_32x32x16_bf16 v[16:31], v[48:51], a[0:3], v[16:31]
  ds_read_b64_tr_b16 v[80:81], v6 offset:8192
  ds_read_b64_tr_b16 v[82:83], v6 offset:9216
  ds_read_b64_tr_b16 v[84:85], v7 offset:8192
  s_add_u32 s32, s32, 4096
  buffer_load_dwordx4 a[112:115], v12, s[68:71], s32 offen offset:0 sc1
  v_mfma_f32_32x32x16_bf16 v[32:47], v[52:55], a[0:3], v[32:47]
  ds_read_b64_tr_b16 v[86:87], v7 offset:9216
  ds_read_b64_tr_b16 v[88:89], v6 offset:10240
  ds_read_b64_tr_b16 v[90:91], v6 offset:11264
  buffer_load_dwordx4 a[116:119], v12, s[68:71], s32 offen offset:1024 sc1
  v_mfma_f32_32x32x16_bf16 v[16:31], v[56:59], a[4:7], v[16:31]
  ds_read_b64_tr_b16 v[92:93], v7 offset:10240
  ds_read_b64_tr_b16 v[94:95], v7 offset:11264
  buffer_load_dwordx4 a[120:123], v12, s[68:71], s32 offen offset:2048 sc1
  v_mfma_f32_32x32x16_bf16 v[32:47], v[60:63], a[4:7], v[32:47]
  ds_read_b64_tr_b16 v[96:97], v6 offset:12288
  ds_read_b64_tr_b16 v[98:99], v6 offset:13312
  ds_read_b64_tr_b16 v[100:101], v7 offset:12288
  buffer_load_dwordx4 a[124:127], v12, s[68:71], s32 offen offset:3072 sc1
  s_add_u32 s32, s32, 4096
  v_mfma_f32_32x32x16_bf16 v[16:31], v[64:67], a[8:11], v[16:31]
  ds_read_b64_tr_b16 v[102:103], v7 offset:13312
  ds_read_b64_tr_b16 v[104:105], v6 offset:14336
  ds_read_b64_tr_b16 v[106:107], v6 offset:15360
  v_mfma_f32_32x32x16_bf16 v[32:47], v[68:71], a[8:11], v[32:47]
  ds_read_b64_tr_b16 v[108:109], v7 offset:14336
  ds_read_b64_tr_b16 v[110:111], v7 offset:15360
  v_mfma_f32_32x32x16_bf16 v[16:31], v[72:75], a[12:15], v[16:31]
  v_mfma_f32_32x32x16_bf16 v[32:47], v[76:79], a[12:15], v[32:47]
  s_waitcnt vmcnt(24) lgkmcnt(0)
  s_barrier
  v_mfma_f32_32x32x16_bf16 v[16:31], v[80:83], a[16:19], v[16:31]
  ds_read_b64_tr_b16 v[48:49], v6 offset:16384
  ds_read_b64_tr_b16 v[50:51], v6 offset:17408
  ds_read_b64_tr_b16 v[52:53], v7 offset:16384
  s_add_u32 m0, s31, 0
  s_nop 0
  buffer_load_dwordx4 v8, s[56:59], s30 offen offset:0 lds
  buffer_load_dwordx4 v9, s[56:59], s30 offen offset:1024 lds
  v_mfma_f32_32x32x16_bf16 v[32:47], v[84:87], a[16:19], v[32:47]
  ds_read_b64_tr_b16 v[54:55], v7 offset:17408
  ds_read_b64_tr_b16 v[56:57], v6 offset:18432
  ds_read_b64_tr_b16 v[58:59], v6 offset:19456
  buffer_load_dwordx4 v10, s[56:59], s30 offen offset:2048 lds
  v_mfma_f32_32x32x16_bf16 v[16:31], v[88:91], a[20:23], v[16:31]
  ds_read_b64_tr_b16 v[60:61], v7 offset:18432
  ds_read_b64_tr_b16 v[62:63], v7 offset:19456
  buffer_load_dwordx4 v11, s[56:59], s30 offen offset:3072 lds
  v_mfma_f32_32x32x16_bf16 v[32:47], v[92:95], a[20:23], v[32:47]
  ds_read_b64_tr_b16 v[64:65], v6 offset:20480
  ds_read_b64_tr_b16 v[66:67], v6 offset:21504
  ds_read_b64_tr_b16 v[68:69], v7 offset:20480
  s_add_u32 s30, s30, 262144
  v_mfma_f32_32x32x16_bf16 v[16:31], v[96:99], a[24:27], v[16:31]
  ds_read_b64_tr_b16 v[70:71], v7 offset:21504
  ds_read_b64_tr_b16 v[72:73], v6 offset:22528
  ds_read_b64_tr_b16 v[74:75], v6 offset:23552
  buffer_load_dwordx4 a[0:3], v12, s[68:71], s32 offen offset:0 sc1
  v_mfma_f32_32x32x16_bf16 v[32:47], v[100:103], a[24:27], v[32:47]
  ds_read_b64_tr_b16 v[76:77], v7 offset:22528
  ds_read_b64_tr_b16 v[78:79], v7 offset:23552
  buffer_load_dwordx4 a[4:7], v12, s[68:71], s32 offen offset:1024 sc1
  v_mfma_f32_32x32x16_bf16 v[16:31], v[104:107], a[28:31], v[16:31]
  buffer_load_dwordx4 a[8:11], v12, s[68:71], s32 offen offset:2048 sc1
  v_mfma_f32_32x32x16_bf16 v[32:47], v[108:111], a[28:31], v[32:47]
  buffer_load_dwordx4 a[12:15], v12, s[68:71], s32 offen offset:3072 sc1
  s_waitcnt lgkmcnt(0)
  v_mfma_f32_32x32x16_bf16 v[16:31], v[48:51], a[32:35], v[16:31]
  ds_read_b64_tr_b16 v[80:81], v6 offset:24576
  ds_read_b64_tr_b16 v[82:83], v6 offset:25600
  ds_read_b64_tr_b16 v[84:85], v7 offset:24576
  s_add_u32 s32, s32, 4096
  buffer_load_dwordx4 a[16:19], v12, s[68:71], s32 offen offset:0 sc1
  v_mfma_f32_32x32x16_bf16 v[32:47], v[52:55], a[32:35], v[32:47]
  ds_read_b64_tr_b16 v[86:87], v7 offset:25600
  ds_read_b64_tr_b16 v[88:89], v6 offset:26624
  ds_read_b64_tr_b16 v[90:91], v6 offset:27648
  buffer_load_dwordx4 a[20:23], v12, s[68:71], s32 offen offset:1024 sc1
  v_mfma_f32_32x32x16_bf16 v[16:31], v[56:59], a[36:39], v[16:31]
  ds_read_b64_tr_b16 v[92:93], v7 offset:26624
  ds_read_b64_tr_b16 v[94:95], v7 offset:27648
  buffer_load_dwordx4 a[24:27], v12, s[68:71], s32 offen offset:2048 sc1
  v_mfma_f32_32x32x16_bf16 v[32:47], v[60:63], a[36:39], v[32:47]
  ds_read_b64_tr_b16 v[96:97], v6 offset:28672
  ds_read_b64_tr_b16 v[98:99], v6 offset:29696
  ds_read_b64_tr_b16 v[100:101], v7 offset:28672
  buffer_load_dwordx4 a[28:31], v12, s[68:71], s32 offen offset:3072 sc1
  s_add_u32 s32, s32, 4096
  v_mfma_f32_32x32x16_bf16 v[16:31], v[64:67], a[40:43], v[16:31]
  ds_read_b64_tr_b16 v[102:103], v7 offset:29696
  ds_read_b64_tr_b16 v[104:105], v6 offset:30720
  ds_read_b64_tr_b16 v[106:107], v6 offset:31744
  v_mfma_f32_32x32x16_bf16 v[32:47], v[68:71], a[40:43], v[32:47]
  ds_read_b64_tr_b16 v[108:109], v7 offset:30720
  ds_read_b64_tr_b16 v[110:111], v7 offset:31744
  v_mfma_f32_32x32x16_bf16 v[16:31], v[72:75], a[44:47], v[16:31]
  v_mfma_f32_32x32x16_bf16 v[32:47], v[76:79], a[44:47], v[32:47]
  s_waitcnt vmcnt(24) lgkmcnt(0)
  s_barrier
  v_mfma_f32_32x32x16_bf16 v[16:31], v[80:83], a[48:51], v[16:31]
  ds_read_b64_tr_b16 v[48:49], v6 offset:32768
  ds_read_b64_tr_b16 v[50:51], v6 offset:33792
  ds_read_b64_tr_b16 v[52:53], v7 offset:32768
  s_add_u32 m0, s31, 16384
  s_nop 0
  buffer_load_dwordx4 v8, s[56:59], s30 offen offset:0 lds
  buffer_load_dwordx4 v9, s[56:59], s30 offen offset:1024 lds
  v_mfma_f32_32x32x16_bf16 v[32:47], v[84:87], a[48:51], v[32:47]
  ds_read_b64_tr_b16 v[54:55], v7 offset:33792
  ds_read_b64_tr_b16 v[56:57], v6 offset:34816
  ds_read_b64_tr_b16 v[58:59], v6 offset:35840
  buffer_load_dwordx4 v10, s[56:59], s30 offen offset:2048 lds
  v_mfma_f32_32x32x16_bf16 v[16:31], v[88:91], a[52:55], v[16:31]
  ds_read_b64_tr_b16 v[60:61], v7 offset:34816
  ds_read_b64_tr_b16 v[62:63], v7 offset:35840
  buffer_load_dwordx4 v11, s[56:59], s30 offen offset:3072 lds
  v_mfma_f32_32x32x16_bf16 v[32:47], v[92:95], a[52:55], v[32:47]
  ds_read_b64_tr_b16 v[64:65], v6 offset:36864
  ds_read_b64_tr_b16 v[66:67], v6 offset:37888
  ds_read_b64_tr_b16 v[68:69], v7 offset:36864
  s_add_u32 s30, s30, 262144
  v_mfma_f32_32x32x16_bf16 v[16:31], v[96:99], a[56:59], v[16:31]
  ds_read_b64_tr_b16 v[70:71], v7 offset:37888
  ds_read_b64_tr_b16 v[72:73], v6 offset:38912
  ds_read_b64_tr_b16 v[74:75], v6 offset:39936
  buffer_load_dwordx4 a[32:35], v12, s[68:71], s32 offen offset:0 sc1
  v_mfma_f32_32x32x16_bf16 v[32:47], v[100:103], a[56:59], v[32:47]
  ds_read_b64_tr_b16 v[76:77], v7 offset:38912
  ds_read_b64_tr_b16 v[78:79], v7 offset:39936
  buffer_load_dwordx4 a[36:39], v12, s[68:71], s32 offen offset:1024 sc1
  v_mfma_f32_32x32x16_bf16 v[16:31], v[104:107], a[60:63], v[16:31]
  buffer_load_dwordx4 a[40:43], v12, s[68:71], s32 offen offset:2048 sc1
  v_mfma_f32_32x32x16_bf16 v[32:47], v[108:111], a[60:63], v[32:47]
  buffer_load_dwordx4 a[44:47], v12, s[68:71], s32 offen offset:3072 sc1
  s_waitcnt lgkmcnt(0)
  v_mfma_f32_32x32x16_bf16 v[16:31], v[48:51], a[64:67], v[16:31]
  ds_read_b64_tr_b16 v[80:81], v6 offset:40960
  ds_read_b64_tr_b16 v[82:83], v6 offset:41984
  ds_read_b64_tr_b16 v[84:85], v7 offset:40960
  s_add_u32 s32, s32, 4096
  buffer_load_dwordx4 a[48:51], v12, s[68:71], s32 offen offset:0 sc1
  v_mfma_f32_32x32x16_bf16 v[32:47], v[52:55], a[64:67], v[32:47]
  ds_read_b64_tr_b16 v[86:87], v7 offset:41984
  ds_read_b64_tr_b16 v[88:89], v6 offset:43008
  ds_read_b64_tr_b16 v[90:91], v6 offset:44032
  buffer_load_dwordx4 a[52:55], v12, s[68:71], s32 offen offset:1024 sc1
  v_mfma_f32_32x32x16_bf16 v[16:31], v[56:59], a[68:71], v[16:31]
  ds_read_b64_tr_b16 v[92:93], v7 offset:43008
  ds_read_b64_tr_b16 v[94:95], v7 offset:44032
  buffer_load_dwordx4 a[56:59], v12, s[68:71], s32 offen offset:2048 sc1
  v_mfma_f32_32x32x16_bf16 v[32:47], v[60:63], a[68:71], v[32:47]
  ds_read_b64_tr_b16 v[96:97], v6 offset:45056
  ds_read_b64_tr_b16 v[98:99], v6 offset:46080
  ds_read_b64_tr_b16 v[100:101], v7 offset:45056
  buffer_load_dwordx4 a[60:63], v12, s[68:71], s32 offen offset:3072 sc1
  s_add_u32 s32, s32, 4096
  v_mfma_f32_32x32x16_bf16 v[16:31], v[64:67], a[72:75], v[16:31]
  ds_read_b64_tr_b16 v[102:103], v7 offset:46080
  ds_read_b64_tr_b16 v[104:105], v6 offset:47104
  ds_read_b64_tr_b16 v[106:107], v6 offset:48128
  v_mfma_f32_32x32x16_bf16 v[32:47], v[68:71], a[72:75], v[32:47]
  ds_read_b64_tr_b16 v[108:109], v7 offset:47104
  ds_read_b64_tr_b16 v[110:111], v7 offset:48128
  v_mfma_f32_32x32x16_bf16 v[16:31], v[72:75], a[76:79], v[16:31]
  v_mfma_f32_32x32x16_bf16 v[32:47], v[76:79], a[76:79], v[32:47]
  s_waitcnt vmcnt(24) lgkmcnt(0)
  s_barrier
  v_mfma_f32_32x32x16_bf16 v[16:31], v[80:83], a[80:83], v[16:31]
  ds_read_b64_tr_b16 v[48:49], v6 offset:49152
  ds_read_b64_tr_b16 v[50:51], v6 offset:50176
  ds_read_b64_tr_b16 v[52:53], v7 offset:49152
  s_add_u32 m0, s31, 32768
  s_nop 0
  buffer_load_dwordx4 v8, s[56:59], s30 offen offset:0 lds
  buffer_load_dwordx4 v9, s[56:59], s30 offen offset:1024 lds
  v_mfma_f32_32x32x16_bf16 v[32:47], v[84:87], a[80:83], v[32:47]
  ds_read_b64_tr_b16 v[54:55], v7 offset:50176
  ds_read_b64_tr_b16 v[56:57], v6 offset:51200
  ds_read_b64_tr_b16 v[58:59], v6 offset:52224
  buffer_load_dwordx4 v10, s[56:59], s30 offen offset:2048 lds
  v_mfma_f32_32x32x16_bf16 v[16:31], v[88:91], a[84:87], v[16:31]
  ds_read_b64_tr_b16 v[60:61], v7 offset:51200
  ds_read_b64_tr_b16 v[62:63], v7 offset:52224
  buffer_load_dwordx4 v11, s[56:59], s30 offen offset:3072 lds
  v_mfma_f32_32x32x16_bf16 v[32:47], v[92:95], a[84:87], v[32:47]
  ds_read_b64_tr_b16 v[64:65], v6 offset:53248
  ds_read_b64_tr_b16 v[66:67], v6 offset:54272
  ds_read_b64_tr_b16 v[68:69], v7 offset:53248
  s_add_u32 s30, s30, 262144
  v_mfma_f32_32x32x16_bf16 v[16:31], v[96:99], a[88:91], v[16:31]
  ds_read_b64_tr_b16 v[70:71], v7 offset:54272
  ds_read_b64_tr_b16 v[72:73], v6 offset:55296
  ds_read_b64_tr_b16 v[74:75], v6 offset:56320
  buffer_load_dwordx4 a[64:67], v12, s[68:71], s32 offen offset:0 sc1
  v_mfma_f32_32x32x16_bf16 v[32:47], v[100:103], a[88:91], v[32:47]
  ds_read_b64_tr_b16 v[76:77], v7 offset:55296
  ds_read_b64_tr_b16 v[78:79], v7 offset:56320
  buffer_load_dwordx4 a[68:71], v12, s[68:71], s32 offen offset:1024 sc1
  v_mfma_f32_32x32x16_bf16 v[16:31], v[104:107], a[92:95], v[16:31]
  buffer_load_dwordx4 a[72:75], v12, s[68:71], s32 offen offset:2048 sc1
  v_mfma_f32_32x32x16_bf16 v[32:47], v[108:111], a[92:95], v[32:47]
  buffer_load_dwordx4 a[76:79], v12, s[68:71], s32 offen offset:3072 sc1
  s_waitcnt lgkmcnt(0)
  v_mfma_f32_32x32x16_bf16 v[16:31], v[48:51], a[96:99], v[16:31]
  ds_read_b64_tr_b16 v[80:81], v6 offset:57344
  ds_read_b64_tr_b16 v[82:83], v6 offset:58368
  ds_read_b64_tr_b16 v[84:85], v7 offset:57344
  s_add_u32 s32, s32, 4096
  buffer_load_dwordx4 a[80:83], v12, s[68:71], s32 offen offset:0 sc1
  v_mfma_f32_32x32x16_bf16 v[32:47], v[52:55], a[96:99], v[32:47]
  ds_read_b64_tr_b16 v[86:87], v7 offset:58368
  ds_read_b64_tr_b16 v[88:89], v6 offset:59392
  ds_read_b64_tr_b16 v[90:91], v6 offset:60416
  buffer_load_dwordx4 a[84:87], v12, s[68:71], s32 offen offset:1024 sc1
  v_mfma_f32_32x32x16_bf16 v[16:31], v[56:59], a[100:103], v[16:31]
  ds_read_b64_tr_b16 v[92:93], v7 offset:59392
  ds_read_b64_tr_b16 v[94:95], v7 offset:60416
  buffer_load_dwordx4 a[88:91], v12, s[68:71], s32 offen offset:2048 sc1
  v_mfma_f32_32x32x16_bf16 v[32:47], v[60:63], a[100:103], v[32:47]
  ds_read_b64_tr_b16 v[96:97], v6 offset:61440
  ds_read_b64_tr_b16 v[98:99], v6 offset:62464
  ds_read_b64_tr_b16 v[100:101], v7 offset:61440
  buffer_load_dwordx4 a[92:95], v12, s[68:71], s32 offen offset:3072 sc1
  s_add_u32 s32, s32, 4096
  v_mfma_f32_32x32x16_bf16 v[16:31], v[64:67], a[104:107], v[16:31]
  ds_read_b64_tr_b16 v[102:103], v7 offset:62464
  ds_read_b64_tr_b16 v[104:105], v6 offset:63488
  ds_read_b64_tr_b16 v[106:107], v6 offset:64512
  v_mfma_f32_32x32x16_bf16 v[32:47], v[68:71], a[104:107], v[32:47]
  ds_read_b64_tr_b16 v[108:109], v7 offset:63488
  ds_read_b64_tr_b16 v[110:111], v7 offset:64512
  v_mfma_f32_32x32x16_bf16 v[16:31], v[72:75], a[108:111], v[16:31]
  v_mfma_f32_32x32x16_bf16 v[32:47], v[76:79], a[108:111], v[32:47]
  s_waitcnt vmcnt(24) lgkmcnt(0)
  s_barrier
  v_mfma_f32_32x32x16_bf16 v[16:31], v[80:83], a[112:115], v[16:31]
  ds_read_b64_tr_b16 v[48:49], v6 offset:0
  ds_read_b64_tr_b16 v[50:51], v6 offset:1024
  ds_read_b64_tr_b16 v[52:53], v7 offset:0
  s_add_u32 m0, s31, 49152
  s_nop 0
  buffer_load_dwordx4 v8, s[56:59], s30 offen offset:0 lds
  buffer_load_dwordx4 v9, s[56:59], s30 offen offset:1024 lds
  v_mfma_f32_32x32x16_bf16 v[32:47], v[84:87], a[112:115], v[32:47]
  ds_read_b64_tr_b16 v[54:55], v7 offset:1024
  ds_read_b64_tr_b16 v[56:57], v6 offset:2048
  ds_read_b64_tr_b16 v[58:59], v6 offset:3072
  buffer_load_dwordx4 v10, s[56:59], s30 offen offset:2048 lds
  v_mfma_f32_32x32x16_bf16 v[16:31], v[88:91], a[116:119], v[16:31]
  ds_read_b64_tr_b16 v[60:61], v7 offset:2048
  ds_read_b64_tr_b16 v[62:63], v7 offset:3072
  buffer_load_dwordx4 v11, s[56:59], s30 offen offset:3072 lds
  v_mfma_f32_32x32x16_bf16 v[32:47], v[92:95], a[116:119], v[32:47]
  ds_read_b64_tr_b16 v[64:65], v6 offset:4096
  ds_read_b64_tr_b16 v[66:67], v6 offset:5120
  ds_read_b64_tr_b16 v[68:69], v7 offset:4096
  s_add_u32 s30, s30, 262144
  v_mfma_f32_32x32x16_bf16 v[16:31], v[96:99], a[120:123], v[16:31]
  ds_read_b64_tr_b16 v[70:71], v7 offset:5120
  ds_read_b64_tr_b16 v[72:73], v6 offset:6144
  ds_read_b64_tr_b16 v[74:75], v6 offset:7168
  buffer_load_dwordx4 a[96:99], v12, s[68:71], s32 offen offset:0 sc1
  v_mfma_f32_32x32x16_bf16 v[32:47], v[100:103], a[120:123], v[32:47]
  ds_read_b64_tr_b16 v[76:77], v7 offset:6144
  ds_read_b64_tr_b16 v[78:79], v7 offset:7168
  buffer_load_dwordx4 a[100:103], v12, s[68:71], s32 offen offset:1024 sc1
  v_mfma_f32_32x32x16_bf16 v[16:31], v[104:107], a[124:127], v[16:31]
  buffer_load_dwordx4 a[104:107], v12, s[68:71], s32 offen offset:2048 sc1
  v_mfma_f32_32x32x16_bf16 v[32:47], v[108:111], a[124:127], v[32:47]
  buffer_load_dwordx4 a[108:111], v12, s[68:71], s32 offen offset:3072 sc1
  s_sub_u32 s20, s20, 1
  s_cmp_lg_u32 s20, 0
  s_cbranch_scc1 f2_l
  s_waitcnt lgkmcnt(0)
  v_mfma_f32_32x32x16_bf16 v[16:31], v[48:51], a[0:3], v[16:31]
  ds_read_b64_tr_b16 v[80:81], v6 offset:8192
  ds_read_b64_tr_b16 v[82:83], v6 offset:9216
  ds_read_b64_tr_b16 v[84:85], v7 offset:8192
  s_add_u32 s32, s32, 4096
  buffer_load_dwordx4 a[112:115], v12, s[68:71], s32 offen offset:0 sc1
  v_mfma_f32_32x32x16_bf16 v[32:47], v[52:55], a[0:3], v[32:47]
  ds_read_b64_tr_b16 v[86:87], v7 offset:9216
  ds_read_b64_tr_b16 v[88:89], v6 offset:10240
  ds_read_b64_tr_b16 v[90:91], v6 offset:11264
  buffer_load_dwordx4 a[116:119], v12, s[68:71], s32 offen offset:1024 sc1
  v_mfma_f32_32x32x16_bf16 v[16:31], v[56:59], a[4:7], v[16:31]
  ds_read_b64_tr_b16 v[92:93], v7 offset:10240
  ds_read_b64_tr_b16 v[94:95], v7 offset:11264
  buffer_load_dwordx4 a[120:123], v12, s[68:71], s32 offen offset:2048 sc1
  v_mfma_f32_32x32x16_bf16 v[32:47], v[60:63], a[4:7], v[32:47]
  ds_read_b64_tr_b16 v[96:97], v6 offset:12288
  ds_read_b64_tr_b16 v[98:99], v6 offset:13312
  ds_read_b64_tr_b16 v[100:101], v7 offset:12288
  buffer_load_dwordx4 a[124:127], v12, s[68:71], s32 offen offset:3072 sc1
  s_add_u32 s32, s32, 4096
  v_mfma_f32_32x32x16_bf16 v[16:31], v[64:67], a[8:11], v[16:31]
  ds_read_b64_tr_b16 v[102:103], v7 offset:13312
  ds_read_b64_tr_b16 v[104:105], v6 offset:14336
  ds_read_b64_tr_b16 v[106:107], v6 offset:15360
  v_mfma_f32_32x32x16_bf16 v[32:47], v[68:71], a[8:11], v[32:47]
  ds_read_b64_tr_b16 v[108:109], v7 offset:14336
  ds_read_b64_tr_b16 v[110:111], v7 offset:15360
  v_mfma_f32_32x32x16_bf16 v[16:31], v[72:75], a[12:15], v[16:31]
  v_mfma_f32_32x32x16_bf16 v[32:47], v[76:79], a[12:15], v[32:47]
  s_waitcnt vmcnt(24) lgkmcnt(0)
  s_barrier
  v_mfma_f32_32x32x16_bf16 v[16:31], v[80:83], a[16:19], v[16:31]
  ds_read_b64_tr_b16 v[48:49], v6 offset:16384
  ds_read_b64_tr_b16 v[50:51], v6 offset:17408
  ds_read_b64_tr_b16 v[52:53], v7 offset:16384
  v_mfma_f32_32x32x16_bf16 v[32:47], v[84:87], a[16:19], v[32:47]
  ds_read_b64_tr_b16 v[54:55], v7 offset:17408
  ds_read_b64_tr_b16 v[56:57], v6 offset:18432
  ds_read_b64_tr_b16 v[58:59], v6 offset:19456
  v_mfma_f32_32x32x16_bf16 v[16:31], v[88:91], a[20:23], v[16:31]
  ds_read_b64_tr_b16 v[60:61], v7 offset:18432
  ds_read_b64_tr_b16 v[62:63], v7 offset:19456
  v_mfma_f32_32x32x16_bf16 v[32:47], v[92:95], a[20:23], v[32:47]
  ds_read_b64_tr_b16 v[64:65], v6 offset:20480
  ds_read_b64_tr_b16 v[66:67], v6 offset:21504
  ds_read_b64_tr_b16 v[68:69], v7 offset:20480
  v_mfma_f32_32x32x16_bf16 v[16:31], v[96:99], a[24:27], v[16:31]
  ds_read_b64_tr_b16 v[70:71], v7 offset:21504
  ds_read_b64_tr_b16 v[72:73], v6 offset:22528
  ds_read_b64_tr_b16 v[74:75], v6 offset:23552
  v_mfma_f32_32x32x16_bf16 v[32:47], v[100:103], a[24:27], v[32:47]
  ds_read_b64_tr_b16 v[76:77], v7 offset:22528
  ds_read_b64_tr_b16 v[78:79], v7 offset:23552
  v_mfma_f32_32x32x16_bf16 v[16:31], v[104:107], a[28:31], v[16:31]
  v_mfma_f32_32x32x16_bf16 v[32:47], v[108:111], a[28:31], v[32:47]
  s_waitcnt lgkmcnt(0)
  v_mfma_f32_32x32x16_bf16 v[16:31], v[48:51], a[32:35], v[16:31]
  ds_read_b64_tr_b16 v[80:81], v6 offset:24576
  ds_read_b64_tr_b16 v[82:83], v6 offset:25600
  ds_read_b64_tr_b16 v[84:85], v7 offset:24576
  v_mfma_f32_32x32x16_bf16 v[32:47], v[52:55], a[32:35], v[32:47]
  ds_read_b64_tr_b16 v[86:87], v7 offset:25600
  ds_read_b64_tr_b16 v[88:89], v6 offset:26624
  ds_read_b64_tr_b16 v[90:91], v6 offset:27648
  v_mfma_f32_32x32x16_bf16 v[16:31], v[56:59], a[36:39], v[16:31]
  ds_read_b64_tr_b16 v[92:93], v7 offset:26624
  ds_read_b64_tr_b16 v[94:95], v7 offset:27648
  v_mfma_f32_32x32x16_bf16 v[32:47], v[60:63], a[36:39], v[32:47]
  ds_read_b64_tr_b16 v[96:97], v6 offset:28672
  ds_read_b64_tr_b16 v[98:99], v6 offset:29696
  ds_read_b64_tr_b16 v[100:101], v7 offset:28672
  v_mfma_f32_32x32x16_bf16 v[16:31], v[64:67], a[40:43], v[16:31]
  ds_read_b64_tr_b16 v[102:103], v7 offset:29696
  ds_read_b64_tr_b16 v[104:105], v6 offset:30720
  ds_read_b64_tr_b16 v[106:107], v6 offset:31744
  v_mfma_f32_32x32x16_bf16 v[32:47], v[68:71], a[40:43], v[32:47]
  ds_read_b64_tr_b16 v[108:109], v7 offset:30720
  ds_read_b64_tr_b16 v[110:111], v7 offset:31744
  v_mfma_f32_32x32x16_bf16 v[16:31], v[72:75], a[44:47], v[16:31]
  v_mfma_f32_32x32x16_bf16 v[32:47], v[76:79], a[44:47], v[32:47]
  s_waitcnt vmcnt(12) lgkmcnt(0)
  s_barrier
  v_mfma_f32_32x32x16_bf16 v[16:31], v[80:83], a[48:51], v[16:31]
  ds_read_b64_tr_b16 v[48:49], v6 offset:32768
  ds_read_b64_tr_b16 v[50:51], v6 offset:33792
  ds_read_b64_tr_b16 v[52:53], v7 offset:32768
  v_mfma_f32_32x32x16_bf16 v[32:47], v[84:87], a[48:51], v[32:47]
  ds_read_b64_tr_b16 v[54:55], v7 offset:33792
  ds_read_b64_tr_b16 v[56:57], v6 offset:34816
  ds_read_b64_tr_b16 v[58:59], v6 offset:35840
  v_mfma_f32_32x32x16_bf16 v[16:31], v[88:91], a[52:55], v[16:31]
  ds_read_b64_tr_b16 v[60:61], v7 offset:34816
  ds_read_b64_tr_b16 v[62:63], v7 offset:35840
  v_mfma_f32_32x32x16_bf16 v[32:47], v[92:95], a[52:55], v[32:47]
  ds_read_b64_tr_b16 v[64:65], v6 offset:36864
  ds_read_b64_tr_b16 v[66:67], v6 offset:37888
  ds_read_b64_tr_b16 v[68:69], v7 offset:36864
  v_mfma_f32_32x32x16_bf16 v[16:31], v[96:99], a[56:59], v[16:31]
  ds_read_b64_tr_b16 v[70:71], v7 offset:37888
  ds_read_b64_tr_b16 v[72:73], v6 offset:38912
  ds_read_b64_tr_b16 v[74:75], v6 offset:39936
  v_mfma_f32_32x32x16_bf16 v[32:47], v[100:103], a[56:59], v[32:47]
  ds_read_b64_tr_b16 v[76:77], v7 offset:38912
  ds_read_b64_tr_b16 v[78:79], v7 offset:39936
  v_mfma_f32_32x32x16_bf16 v[16:31], v[104:107], a[60:63], v[16:31]
  v_mfma_f32_32x32x16_bf16 v[32:47], v[108:111], a[60:63], v[32:47]
  s_waitcnt lgkmcnt(0)
  v_mfma_f32_32x32x16_bf16 v[16:31], v[48:51], a[64:67], v[16:31]
  ds_read_b64_tr_b16 v[80:81], v6 offset:40960
  ds_read_b64_tr_b16 v[82:83], v6 offset:41984
  ds_read_b64_tr_b16 v[84:85], v7 offset:40960
  v_mfma_f32_32x32x16_bf16 v[32:47], v[52:55], a[64:67], v[32:47]
  ds_read_b64_tr_b16 v[86:87], v7 offset:41984
  ds_read_b64_tr_b16 v[88:89], v6 offset:43008
  ds_read_b64_tr_b16 v[90:91], v6 offset:44032
  v_mfma_f32_32x32x16_bf16 v[16:31], v[56:59], a[68:71], v[16:31]
  ds_read_b64_tr_b16 v[92:93], v7 offset:43008
  ds_read_b64_tr_b16 v[94:95], v7 offset:44032
  v_mfma_f32_32x32x16_bf16 v[32:47], v[60:63], a[68:71], v[32:47]
  ds_read_b64_tr_b16 v[96:97], v6 offset:45056
  ds_read_b64_tr_b16 v[98:99], v6 offset:46080
  ds_read_b64_tr_b16 v[100:101], v7 offset:45056
  v_mfma_f32_32x32x16_bf16 v[16:31], v[64:67], a[72:75], v[16:31]
  ds_read_b64_tr_b16 v[102:103], v7 offset:46080
  ds_read_b64_tr_b16 v[104:105], v6 offset:47104
  ds_read_b64_tr_b16 v[106:107], v6 offset:48128
  v_mfma_f32_32x32x16_bf16 v[32:47], v[68:71], a[72:75], v[32:47]
  ds_read_b64_tr_b16 v[108:109], v7 offset:47104
  ds_read_b64_tr_b16 v[110:111], v7 offset:48128
  v_mfma_f32_32x32x16_bf16 v[16:31], v[72:75], a[76:79], v[16:31]
  v_mfma_f32_32x32x16_bf16 v[32:47], v[76:79], a[76:79], v[32:47]
  s_waitcnt vmcnt(0) lgkmcnt(0)
  s_barrier
  v_mfma_f32_32x32x16_bf16 v[16:31], v[80:83], a[80:83], v[16:31]
  ds_read_b64_tr_b16 v[48:49], v6 offset:49152
  ds_read_b64_tr_b16 v[50:51], v6 offset:50176
  ds_read_b64_tr_b16 v[52:53], v7 offset:49152
  v_mfma_f32_32x32x16_bf16 v[32:47], v[84:87], a[80:83], v[32:47]
  ds_read_b64_tr_b16 v[54:55], v7 offset:50176
  ds_read_b64_tr_b16 v[56:57], v6 offset:51200
  ds_read_b64_tr_b16 v[58:59], v6 offset:52224
  v_mfma_f32_32x32x16_bf16 v[16:31], v[88:91], a[84:87], v[16:31]
  ds_read_b64_tr_b16 v[60:61], v7 offset:51200
  ds_read_b64_tr_b16 v[62:63], v7 offset:52224
  v_mfma_f32_32x32x16_bf16 v[32:47], v[92:95], a[84:87], v[32:47]
  ds_read_b64_tr_b16 v[64:65], v6 offset:53248
  ds_read_b64_tr_b16 v[66:67], v6 offset:54272
  ds_read_b64_tr_b16 v[68:69], v7 offset:53248
  v_mfma_f32_32x32x16_bf16 v[16:31], v[96:99], a[88:91], v[16:31]
  ds_read_b64_tr_b16 v[70:71], v7 offset:54272
  ds_read_b64_tr_b16 v[72:73], v6 offset:55296
  ds_read_b64_tr_b16 v[74:75], v6 offset:56320
  v_mfma_f32_32x32x16_bf16 v[32:47], v[100:103], a[88:91], v[32:47]
  ds_read_b64_tr_b16 v[76:77], v7 offset:55296
  ds_read_b64_tr_b16 v[78:79], v7 offset:56320
  v_mfma_f32_32x32x16_bf16 v[16:31], v[104:107], a[92:95], v[16:31]
  v_mfma_f32_32x32x16_bf16 v[32:47], v[108:111], a[92:95], v[32:47]
  s_waitcnt lgkmcnt(0)
  v_mfma_f32_32x32x16_bf16 v[16:31], v[48:51], a[96:99], v[16:31]
  ds_read_b64_tr_b16 v[80:81], v6 offset:57344
  ds_read_b64_tr_b16 v[82:83], v6 offset:58368
  ds_read_b64_tr_b16 v[84:85], v7 offset:57344
  v_mfma_f32_32x32x16_bf16 v[32:47], v[52:55], a[96:99], v[32:47]
  ds_read_b64_tr_b16 v[86:87], v7 offset:58368
  ds_read_b64_tr_b16 v[88:89], v6 offset:59392
  ds_read_b64_tr_b16 v[90:91], v6 offset:60416
  v_mfma_f32_32x32x16_bf16 v[16:31], v[56:59], a[100:103], v[16:31]
  ds_read_b64_tr_b16 v[92:93], v7 offset:59392
  ds_read_b64_tr_b16 v[94:95], v7 offset:60416
  v_mfma_f32_32x32x16_bf16 v[32:47], v[60:63], a[100:103], v[32:47]
  ds_read_b64_tr_b16 v[96:97], v6 offset:61440
  ds_read_b64_tr_b16 v[98:99], v6 offset:62464
  ds_read_b64_tr_b16 v[100:101], v7 offset:61440
  v_mfma_f32_32x32x16_bf16 v[16:31], v[64:67], a[104:107], v[16:31]
  ds_read_b64_tr_b16 v[102:103], v7 offset:62464
  ds_read_b64_tr_b16 v[104:105], v6 offset:63488
  ds_read_b64_tr_b16 v[106:107], v6 offset:64512
  v_mfma_f32_32x32x16_bf16 v[32:47], v[68:71], a[104:107], v[32:47]
  ds_read_b64_tr_b16 v[108:109], v7 offset:63488
  ds_read_b64_tr_b16 v[110:111], v7 offset:64512
  v_mfma_f32_32x32x16_bf16 v[16:31], v[72:75], a[108:111], v[16:31]
  v_mfma_f32_32x32x16_bf16 v[32:47], v[76:79], a[108:111], v[32:47]
  s_waitcnt lgkmcnt(0)
  v_mfma_f32_32x32x16_bf16 v[16:31], v[80:83], a[112:115], v[16:31]
  v_mfma_f32_32x32x16_bf16 v[32:47], v[84:87], a[112:115], v[32:47]
  v_mfma_f32_32x32x16_bf16 v[16:31], v[88:91], a[116:119], v[16:31]
  v_mfma_f32_32x32x16_bf16 v[32:47], v[92:95], a[116:119], v[32:47]
  v_mfma_f32_32x32x16_bf16 v[16:31], v[96:99], a[120:123], v[16:31]
  v_mfma_f32_32x32x16_bf16 v[32:47], v[100:103], a[120:123], v[32:47]
  v_mfma_f32_32x32x16_bf16 v[16:31], v[104:107], a[124:127], v[16:31]
  v_mfma_f32_32x32x16_bf16 v[32:47], v[108:111], a[124:127], v[32:47]
  v_accvgpr_read_b32 v112, a128
  v_accvgpr_read_b32 v113, a129
  v_accvgpr_read_b32 v114, a130
  v_accvgpr_read_b32 v115, a131
  v_accvgpr_read_b32 v116, a132
  v_accvgpr_read_b32 v117, a133
  v_accvgpr_read_b32 v118, a134
  v_accvgpr_read_b32 v119, a135
  v_accvgpr_read_b32 v120, a136
  v_accvgpr_read_b32 v121, a137
  v_accvgpr_read_b32 v122, a138
  v_accvgpr_read_b32 v123, a139
  v_accvgpr_read_b32 v124, a140
  v_accvgpr_read_b32 v125, a141
  v_accvgpr_read_b32 v126, a142
  v_accvgpr_read_b32 v127, a143
  v_lshlrev_b32 v48, 16, v112
  v_and_b32 v49, 0xffff0000, v112
  v_lshlrev_b32 v50, 16, v113
  v_and_b32 v51, 0xffff0000, v113
  v_lshlrev_b32 v52, 16, v114
  v_and_b32 v53, 0xffff0000, v114
  v_lshlrev_b32 v54, 16, v115
  v_and_b32 v55, 0xffff0000, v115
  v_lshlrev_b32 v56, 16, v116
  v_and_b32 v57, 0xffff0000, v116
  v_lshlrev_b32 v58, 16, v117
  v_and_b32 v59, 0xffff0000, v117
  v_lshlrev_b32 v60, 16, v118
  v_and_b32 v61, 0xffff0000, v118
  v_lshlrev_b32 v62, 16, v119
  v_and_b32 v63, 0xffff0000, v119
  v_lshlrev_b32 v64, 16, v120
  v_and_b32 v65, 0xffff0000, v120
  v_lshlrev_b32 v66, 16, v121
  v_and_b32 v67, 0xffff0000, v121
  v_lshlrev_b32 v68, 16, v122
  v_and_b32 v69, 0xffff0000, v122
  v_lshlrev_b32 v70, 16, v123
  v_and_b32 v71, 0xffff0000, v123
  v_lshlrev_b32 v72, 16, v124
  v_and_b32 v73, 0xffff0000, v124
  v_lshlrev_b32 v74, 16, v125
  v_and_b32 v75, 0xffff0000, v125
  v_lshlrev_b32 v76, 16, v126
  v_and_b32 v77, 0xffff0000, v126
  v_lshlrev_b32 v78, 16, v127
  v_and_b32 v79, 0xffff0000, v127
  v_fmac_f32 v48, v16, v128
  v_fmac_f32 v49, v17, v129
  v_fmac_f32 v50, v18, v130
  v_fmac_f32 v51, v19, v131
  v_fmac_f32 v52, v20, v132
  v_fmac_f32 v53, v21, v133
  v_fmac_f32 v54, v22, v134
  v_fmac_f32 v55, v23, v135
  v_fmac_f32 v56, v24, v136
  v_fmac_f32 v57, v25, v137
  v_fmac_f32 v58, v26, v138
  v_fmac_f32 v59, v27, v139
  v_fmac_f32 v60, v28, v140
  v_fmac_f32 v61, v29, v141
  v_fmac_f32 v62, v30, v142
  v_fmac_f32 v63, v31, v143
  v_fmac_f32 v64, v32, v144
  v_fmac_f32 v65, v33, v145
  v_fmac_f32 v66, v34, v146
  v_fmac_f32 v67, v35, v147
  v_fmac_f32 v68, v36, v148
  v_fmac_f32 v69, v37, v149
  v_fmac_f32 v70, v38, v150
  v_fmac_f32 v71, v39, v151
  v_fmac_f32 v72, v40, v152
  v_fmac_f32 v73, v41, v153
  v_fmac_f32 v74, v42, v154
  v_fmac_f32 v75, v43, v155
  v_fmac_f32 v76, v44, v156
  v_fmac_f32 v77, v45, v157
  v_fmac_f32 v78, v46, v158
  v_fmac_f32 v79, v47, v159
  v_cvt_pk_bf16_f32 v112, v48, v49
  v_cvt_pk_bf16_f32 v113, v50, v51
  v_cvt_pk_bf16_f32 v114, v52, v53
  v_cvt_pk_bf16_f32 v115, v54, v55
  v_cvt_pk_bf16_f32 v116, v56, v57
  v_cvt_pk_bf16_f32 v117, v58, v59
  v_cvt_pk_bf16_f32 v118, v60, v61
  v_cvt_pk_bf16_f32 v119, v62, v63
  v_cvt_pk_bf16_f32 v120, v64, v65
  v_cvt_pk_bf16_f32 v121, v66, v67
  v_cvt_pk_bf16_f32 v122, v68, v69
  v_cvt_pk_bf16_f32 v123, v70, v71
  v_cvt_pk_bf16_f32 v124, v72, v73
  v_cvt_pk_bf16_f32 v125, v74, v75
  v_cvt_pk_bf16_f32 v126, v76, v77
  v_cvt_pk_bf16_f32 v127, v78, v79
  v_lshlrev_b32 v3, 11, v14
  v_lshl_add_u32 v3, v13, 4, v3
  v_permlane32_swap_b32 v112, v114
  v_permlane32_swap_b32 v113, v115
  v_permlane32_swap_b32 v116, v118
  v_permlane32_swap_b32 v117, v119
  v_permlane32_swap_b32 v120, v122
  v_permlane32_swap_b32 v121, v123
  v_permlane32_swap_b32 v124, v126
  v_permlane32_swap_b32 v125, v127
  buffer_store_dwordx4 v[112:115], v3, s[40:43], s36 offen offset:0 nt
  buffer_store_dwordx4 v[116:119], v3, s[40:43], s36 offen offset:32 nt
  buffer_store_dwordx4 v[120:123], v3, s[40:43], s36 offen offset:64 nt
  buffer_store_dwordx4 v[124:127], v3, s[40:43], s36 offen offset:96 nt
adaLN_cond__compressed_kv_cla__dense_activation_relu__prompt_kernel_end:
  s_endpgm
kn_st:
kv_m_sp:
  buffer_load_dword v250, v31, s[64:67], 0 offen sc1
  s_waitcnt vmcnt(0)
  v_cmp_ne_u32 vcc, 0x01010101, v250
  s_add_u32 s97, s97, 1
  s_cmp_gt_u32 s97, 400000
  s_cbranch_scc1 kv_m_ok
  s_cbranch_vccnz kv_m_sp
  s_branch kv_m_ok
at_h_sp:
  buffer_load_dword v250, v251, s[68:71], 0 offen sc1
  s_waitcnt vmcnt(0)
  v_cmp_ne_u32 vcc, 0x01010101, v250
  s_add_u32 s97, s97, 1
  s_cmp_gt_u32 s97, 400000
  s_cbranch_scc1 at_h_ok
  s_cbranch_vccnz at_h_sp
  s_branch at_h_ok
at_k_sp:
  buffer_load_dword v250, v251, s[68:71], 0 offen sc1
  s_waitcnt vmcnt(0)
  v_cmp_ne_u32 vcc, 1, v250
  s_add_u32 s97, s97, 1
  s_cmp_gt_u32 s97, 400000
  s_cbranch_scc1 at_k_ok
  s_cbranch_vccnz at_k_sp
  s_branch at_k_ok
at_s0:
  s_call_b64 s[80:81], at_fix000
  s_branch at_s0r
at_s1:
  s_call_b64 s[80:81], at_fix110
  s_branch at_s1r
at_s2:
  s_call_b64 s[80:81], at_fix000
  s_branch at_s2r
at_s3:
  s_call_b64 s[80:81], at_fix110
  s_branch at_s3r
at_s4:
  s_call_b64 s[80:81], at_fix000
  s_branch at_s4r
at_s5:
  s_call_b64 s[80:81], at_fix110
  s_branch at_s5r
at_s6:
  s_call_b64 s[80:81], at_fix000
  s_branch at_s6r
at_s7:
  s_call_b64 s[80:81], at_fix110
  s_branch at_s7r
at_s8:
  s_call_b64 s[80:81], at_fix000
  s_branch at_s8r
at_s9:
  s_call_b64 s[80:81], at_fix110
  s_branch at_s9r
at_s10:
  s_call_b64 s[80:81], at_fix000
  s_branch at_s10r
at_s11:
  s_call_b64 s[80:81], at_fix110
  s_branch at_s11r
at_s12:
  s_call_b64 s[80:81], at_fix001
  s_branch at_s12r
at_s13:
  s_call_b64 s[80:81], at_fix011
  s_branch at_s13r
at_s14:
  s_call_b64 s[80:81], at_fix001
  s_branch at_s14r
at_s15:
  s_call_b64 s[80:81], at_fix011
  s_branch at_s15r
at_s16:
  s_call_b64 s[80:81], at_fix001
  s_branch at_s16r
at_s17:
  s_call_b64 s[80:81], at_fix011
  s_branch at_s17r
at_s18:
  s_call_b64 s[80:81], at_fix001
  s_branch at_s18r
at_s19:
  s_call_b64 s[80:81], at_fix011
  s_branch at_s19r
at_fix000:
  s_nop 15
  v_max3_f32 v2, v80, v81, v82
  v_max3_f32 v2, v2, v83, v84
  v_max3_f32 v2, v2, v85, v86
  v_max3_f32 v2, v2, v87, v88
  v_max3_f32 v2, v2, v89, v90
  v_max3_f32 v2, v2, v91, v92
  v_max3_f32 v2, v2, v93, v94
  v_max_f32 v2, v2, v95
  v_mov_b32 v3, v2
  s_nop 1
  v_permlane32_swap_b32 v2, v3
  s_nop 1
  v_max_f32 v2, v2, v3
  v_max_f32 v2, s78, v2
  v_sub_f32 v112, v112, v2
  v_sub_f32 v80, v80, v2
  v_sub_f32 v113, v113, v2
  v_sub_f32 v81, v81, v2
  v_sub_f32 v114, v114, v2
  v_sub_f32 v82, v82, v2
  v_sub_f32 v115, v115, v2
  v_sub_f32 v83, v83, v2
  v_sub_f32 v116, v116, v2
  v_sub_f32 v84, v84, v2
  v_sub_f32 v117, v117, v2
  v_sub_f32 v85, v85, v2
  v_sub_f32 v118, v118, v2
  v_sub_f32 v86, v86, v2
  v_sub_f32 v119, v119, v2
  v_sub_f32 v87, v87, v2
  v_sub_f32 v120, v120, v2
  v_sub_f32 v88, v88, v2
  v_sub_f32 v121, v121, v2
  v_sub_f32 v89, v89, v2
  v_sub_f32 v122, v122, v2
  v_sub_f32 v90, v90, v2
  v_sub_f32 v123, v123, v2
  v_sub_f32 v91, v91, v2
  v_sub_f32 v124, v124, v2
  v_sub_f32 v92, v92, v2
  v_sub_f32 v125, v125, v2
  v_sub_f32 v93, v93, v2
  v_sub_f32 v126, v126, v2
  v_sub_f32 v94, v94, v2
  v_sub_f32 v127, v127, v2
  v_sub_f32 v95, v95, v2
  s_cmp_lg_u32 s78, 0
  s_cbranch_scc1 at_fx000
  v_sub_f32 v3, 0, v2
  v_exp_f32 v3, v3
  s_nop 0
  v_mul_f32 v232, v232, v3
  v_accvgpr_read_b32 v4, a0
  v_accvgpr_read_b32 v5, a1
  v_mul_f32 v4, v4, v3
  v_mul_f32 v5, v5, v3
  v_accvgpr_write_b32 a0, v4
  v_accvgpr_write_b32 a1, v5
  v_accvgpr_read_b32 v4, a2
  v_accvgpr_read_b32 v5, a3
  v_mul_f32 v4, v4, v3
  v_mul_f32 v5, v5, v3
  v_accvgpr_write_b32 a2, v4
  v_accvgpr_write_b32 a3, v5
  v_accvgpr_read_b32 v4, a4
  v_accvgpr_read_b32 v5, a5
  v_mul_f32 v4, v4, v3
  v_mul_f32 v5, v5, v3
  v_accvgpr_write_b32 a4, v4
  v_accvgpr_write_b32 a5, v5
  v_accvgpr_read_b32 v4, a6
  v_accvgpr_read_b32 v5, a7
  v_mul_f32 v4, v4, v3
  v_mul_f32 v5, v5, v3
  v_accvgpr_write_b32 a6, v4
  v_accvgpr_write_b32 a7, v5
  v_accvgpr_read_b32 v4, a8
  v_accvgpr_read_b32 v5, a9
  v_mul_f32 v4, v4, v3
  v_mul_f32 v5, v5, v3
  v_accvgpr_write_b32 a8, v4
  v_accvgpr_write_b32 a9, v5
  v_accvgpr_read_b32 v4, a10
  v_accvgpr_read_b32 v5, a11
  v_mul_f32 v4, v4, v3
  v_mul_f32 v5, v5, v3
  v_accvgpr_write_b32 a10, v4
  v_accvgpr_write_b32 a11, v5
  v_accvgpr_read_b32 v4, a12
  v_accvgpr_read_b32 v5, a13
  v_mul_f32 v4, v4, v3
  v_mul_f32 v5, v5, v3
  v_accvgpr_write_b32 a12, v4
  v_accvgpr_write_b32 a13, v5
  v_accvgpr_read_b32 v4, a14
  v_accvgpr_read_b32 v5, a15
  v_mul_f32 v4, v4, v3
  v_mul_f32 v5, v5, v3
  v_accvgpr_write_b32 a14, v4
  v_accvgpr_write_b32 a15, v5
  v_accvgpr_read_b32 v4, a16
  v_accvgpr_read_b32 v5, a17
  v_mul_f32 v4, v4, v3
  v_mul_f32 v5, v5, v3
  v_accvgpr_write_b32 a16, v4
  v_accvgpr_write_b32 a17, v5
  v_accvgpr_read_b32 v4, a18
  v_accvgpr_read_b32 v5, a19
  v_mul_f32 v4, v4, v3
  v_mul_f32 v5, v5, v3
  v_accvgpr_write_b32 a18, v4
  v_accvgpr_write_b32 a19, v5
  v_accvgpr_read_b32 v4, a20
  v_accvgpr_read_b32 v5, a21
  v_mul_f32 v4, v4, v3
  v_mul_f32 v5, v5, v3
  v_accvgpr_write_b32 a20, v4
  v_accvgpr_write_b32 a21, v5
  v_accvgpr_read_b32 v4, a22
  v_accvgpr_read_b32 v5, a23
  v_mul_f32 v4, v4, v3
  v_mul_f32 v5, v5, v3
  v_accvgpr_write_b32 a22, v4
  v_accvgpr_write_b32 a23, v5
  v_accvgpr_read_b32 v4, a24
  v_accvgpr_read_b32 v5, a25
  v_mul_f32 v4, v4, v3
  v_mul_f32 v5, v5, v3
  v_accvgpr_write_b32 a24, v4
  v_accvgpr_write_b32 a25, v5
  v_accvgpr_read_b32 v4, a26
  v_accvgpr_read_b32 v5, a27
  v_mul_f32 v4, v4, v3
  v_mul_f32 v5, v5, v3
  v_accvgpr_write_b32 a26, v4
  v_accvgpr_write_b32 a27, v5
  v_accvgpr_read_b32 v4, a28
  v_accvgpr_read_b32 v5, a29
  v_mul_f32 v4, v4, v3
  v_mul_f32 v5, v5, v3
  v_accvgpr_write_b32 a28, v4
  v_accvgpr_write_b32 a29, v5
  v_accvgpr_read_b32 v4, a30
  v_accvgpr_read_b32 v5, a31
  v_mul_f32 v4, v4, v3
  v_mul_f32 v5, v5, v3
  v_accvgpr_write_b32 a30, v4
  v_accvgpr_write_b32 a31, v5
  v_accvgpr_read_b32 v4, a32
  v_accvgpr_read_b32 v5, a33
  v_mul_f32 v4, v4, v3
  v_mul_f32 v5, v5, v3
  v_accvgpr_write_b32 a32, v4
  v_accvgpr_write_b32 a33, v5
  v_accvgpr_read_b32 v4, a34
  v_accvgpr_read_b32 v5, a35
  v_mul_f32 v4, v4, v3
  v_mul_f32 v5, v5, v3
  v_accvgpr_write_b32 a34, v4
  v_accvgpr_write_b32 a35, v5
  v_accvgpr_read_b32 v4, a36
  v_accvgpr_read_b32 v5, a37
  v_mul_f32 v4, v4, v3
  v_mul_f32 v5, v5, v3
  v_accvgpr_write_b32 a36, v4
  v_accvgpr_write_b32 a37, v5
  v_accvgpr_read_b32 v4, a38
  v_accvgpr_read_b32 v5, a39
  v_mul_f32 v4, v4, v3
  v_mul_f32 v5, v5, v3
  v_accvgpr_write_b32 a38, v4
  v_accvgpr_write_b32 a39, v5
  v_accvgpr_read_b32 v4, a40
  v_accvgpr_read_b32 v5, a41
  v_mul_f32 v4, v4, v3
  v_mul_f32 v5, v5, v3
  v_accvgpr_write_b32 a40, v4
  v_accvgpr_write_b32 a41, v5
  v_accvgpr_read_b32 v4, a42
  v_accvgpr_read_b32 v5, a43
  v_mul_f32 v4, v4, v3
  v_mul_f32 v5, v5, v3
  v_accvgpr_write_b32 a42, v4
  v_accvgpr_write_b32 a43, v5
  v_accvgpr_read_b32 v4, a44
  v_accvgpr_read_b32 v5, a45
  v_mul_f32 v4, v4, v3
  v_mul_f32 v5, v5, v3
  v_accvgpr_write_b32 a44, v4
  v_accvgpr_write_b32 a45, v5
  v_accvgpr_read_b32 v4, a46
  v_accvgpr_read_b32 v5, a47
  v_mul_f32 v4, v4, v3
  v_mul_f32 v5, v5, v3
  v_accvgpr_write_b32 a46, v4
  v_accvgpr_write_b32 a47, v5
  v_accvgpr_read_b32 v4, a48
  v_accvgpr_read_b32 v5, a49
  v_mul_f32 v4, v4, v3
  v_mul_f32 v5, v5, v3
  v_accvgpr_write_b32 a48, v4
  v_accvgpr_write_b32 a49, v5
  v_accvgpr_read_b32 v4, a50
  v_accvgpr_read_b32 v5, a51
  v_mul_f32 v4, v4, v3
  v_mul_f32 v5, v5, v3
  v_accvgpr_write_b32 a50, v4
  v_accvgpr_write_b32 a51, v5
  v_accvgpr_read_b32 v4, a52
  v_accvgpr_read_b32 v5, a53
  v_mul_f32 v4, v4, v3
  v_mul_f32 v5, v5, v3
  v_accvgpr_write_b32 a52, v4
  v_accvgpr_write_b32 a53, v5
  v_accvgpr_read_b32 v4, a54
  v_accvgpr_read_b32 v5, a55
  v_mul_f32 v4, v4, v3
  v_mul_f32 v5, v5, v3
  v_accvgpr_write_b32 a54, v4
  v_accvgpr_write_b32 a55, v5
  v_accvgpr_read_b32 v4, a56
  v_accvgpr_read_b32 v5, a57
  v_mul_f32 v4, v4, v3
  v_mul_f32 v5, v5, v3
  v_accvgpr_write_b32 a56, v4
  v_accvgpr_write_b32 a57, v5
  v_accvgpr_read_b32 v4, a58
  v_accvgpr_read_b32 v5, a59
  v_mul_f32 v4, v4, v3
  v_mul_f32 v5, v5, v3
  v_accvgpr_write_b32 a58, v4
  v_accvgpr_write_b32 a59, v5
  v_accvgpr_read_b32 v4, a60
  v_accvgpr_read_b32 v5, a61
  v_mul_f32 v4, v4, v3
  v_mul_f32 v5, v5, v3
  v_accvgpr_write_b32 a60, v4
  v_accvgpr_write_b32 a61, v5
  v_accvgpr_read_b32 v4, a62
  v_accvgpr_read_b32 v5, a63
  v_mul_f32 v4, v4, v3
  v_mul_f32 v5, v5, v3
  v_accvgpr_write_b32 a62, v4
  v_accvgpr_write_b32 a63, v5
at_fx000:
  v_exp_f32 v224, v80
  v_exp_f32 v225, v81
  v_exp_f32 v226, v82
  v_add_f32 v234, v224, v225
  v_cvt_pk_bf16_f32 v208, v224, v225
  v_exp_f32 v227, v83
  v_add_f32 v234, v234, v226
  v_exp_f32 v224, v84
  v_add_f32 v234, v234, v227
  v_cvt_pk_bf16_f32 v209, v226, v227
  v_exp_f32 v225, v85
  v_add_f32 v234, v234, v224
  v_exp_f32 v226, v86
  v_add_f32 v234, v234, v225
  v_cvt_pk_bf16_f32 v210, v224, v225
  v_exp_f32 v227, v87
  v_add_f32 v234, v234, v226
  v_exp_f32 v224, v88
  v_add_f32 v234, v234, v227
  v_cvt_pk_bf16_f32 v211, v226, v227
  v_exp_f32 v225, v89
  v_add_f32 v234, v234, v224
  v_exp_f32 v226, v90
  v_add_f32 v234, v234, v225
  v_cvt_pk_bf16_f32 v212, v224, v225
  v_exp_f32 v227, v91
  v_add_f32 v234, v234, v226
  v_exp_f32 v224, v92
  v_add_f32 v234, v234, v227
  v_cvt_pk_bf16_f32 v213, v226, v227
  v_exp_f32 v225, v93
  v_add_f32 v234, v234, v224
  v_exp_f32 v226, v94
  v_add_f32 v234, v234, v225
  v_cvt_pk_bf16_f32 v214, v224, v225
  v_exp_f32 v227, v95
  v_add_f32 v234, v234, v226
  v_add_f32 v234, v234, v227
  v_cvt_pk_bf16_f32 v215, v226, v227
  s_mov_b32 s76, 0x45800000
  s_mov_b32 s78, 0
  s_setpc_b64 s[80:81]
at_fix110:
  s_nop 15
  v_max3_f32 v2, v96, v97, v98
  v_max3_f32 v2, v2, v99, v100
  v_max3_f32 v2, v2, v101, v102
  v_max3_f32 v2, v2, v103, v104
  v_max3_f32 v2, v2, v105, v106
  v_max3_f32 v2, v2, v107, v108
  v_max3_f32 v2, v2, v109, v110
  v_max_f32 v2, v2, v111
  v_mov_b32 v3, v2
  s_nop 1
  v_permlane32_swap_b32 v2, v3
  s_nop 1
  v_max_f32 v2, v2, v3
  v_max_f32 v2, s79, v2
  v_sub_f32 v128, v128, v2
  v_sub_f32 v96, v96, v2
  v_sub_f32 v129, v129, v2
  v_sub_f32 v97, v97, v2
  v_sub_f32 v130, v130, v2
  v_sub_f32 v98, v98, v2
  v_sub_f32 v131, v131, v2
  v_sub_f32 v99, v99, v2
  v_sub_f32 v132, v132, v2
  v_sub_f32 v100, v100, v2
  v_sub_f32 v133, v133, v2
  v_sub_f32 v101, v101, v2
  v_sub_f32 v134, v134, v2
  v_sub_f32 v102, v102, v2
  v_sub_f32 v135, v135, v2
  v_sub_f32 v103, v103, v2
  v_sub_f32 v136, v136, v2
  v_sub_f32 v104, v104, v2
  v_sub_f32 v137, v137, v2
  v_sub_f32 v105, v105, v2
  v_sub_f32 v138, v138, v2
  v_sub_f32 v106, v106, v2
  v_sub_f32 v139, v139, v2
  v_sub_f32 v107, v107, v2
  v_sub_f32 v140, v140, v2
  v_sub_f32 v108, v108, v2
  v_sub_f32 v141, v141, v2
  v_sub_f32 v109, v109, v2
  v_sub_f32 v142, v142, v2
  v_sub_f32 v110, v110, v2
  v_sub_f32 v143, v143, v2
  v_sub_f32 v111, v111, v2
  s_cmp_lg_u32 s79, 0
  s_cbranch_scc1 at_fx110
  v_sub_f32 v3, 0, v2
  v_exp_f32 v3, v3
  s_nop 0
  v_mul_f32 v233, v233, v3
  v_accvgpr_read_b32 v4, a64
  v_accvgpr_read_b32 v5, a65
  v_mul_f32 v4, v4, v3
  v_mul_f32 v5, v5, v3
  v_accvgpr_write_b32 a64, v4
  v_accvgpr_write_b32 a65, v5
  v_accvgpr_read_b32 v4, a66
  v_accvgpr_read_b32 v5, a67
  v_mul_f32 v4, v4, v3
  v_mul_f32 v5, v5, v3
  v_accvgpr_write_b32 a66, v4
  v_accvgpr_write_b32 a67, v5
  v_accvgpr_read_b32 v4, a68
  v_accvgpr_read_b32 v5, a69
  v_mul_f32 v4, v4, v3
  v_mul_f32 v5, v5, v3
  v_accvgpr_write_b32 a68, v4
  v_accvgpr_write_b32 a69, v5
  v_accvgpr_read_b32 v4, a70
  v_accvgpr_read_b32 v5, a71
  v_mul_f32 v4, v4, v3
  v_mul_f32 v5, v5, v3
  v_accvgpr_write_b32 a70, v4
  v_accvgpr_write_b32 a71, v5
  v_accvgpr_read_b32 v4, a72
  v_accvgpr_read_b32 v5, a73
  v_mul_f32 v4, v4, v3
  v_mul_f32 v5, v5, v3
  v_accvgpr_write_b32 a72, v4
  v_accvgpr_write_b32 a73, v5
  v_accvgpr_read_b32 v4, a74
  v_accvgpr_read_b32 v5, a75
  v_mul_f32 v4, v4, v3
  v_mul_f32 v5, v5, v3
  v_accvgpr_write_b32 a74, v4
  v_accvgpr_write_b32 a75, v5
  v_accvgpr_read_b32 v4, a76
  v_accvgpr_read_b32 v5, a77
  v_mul_f32 v4, v4, v3
  v_mul_f32 v5, v5, v3
  v_accvgpr_write_b32 a76, v4
  v_accvgpr_write_b32 a77, v5
  v_accvgpr_read_b32 v4, a78
  v_accvgpr_read_b32 v5, a79
  v_mul_f32 v4, v4, v3
  v_mul_f32 v5, v5, v3
  v_accvgpr_write_b32 a78, v4
  v_accvgpr_write_b32 a79, v5
  v_accvgpr_read_b32 v4, a80
  v_accvgpr_read_b32 v5, a81
  v_mul_f32 v4, v4, v3
  v_mul_f32 v5, v5, v3
  v_accvgpr_write_b32 a80, v4
  v_accvgpr_write_b32 a81, v5
  v_accvgpr_read_b32 v4, a82
  v_accvgpr_read_b32 v5, a83
  v_mul_f32 v4, v4, v3
  v_mul_f32 v5, v5, v3
  v_accvgpr_write_b32 a82, v4
  v_accvgpr_write_b32 a83, v5
  v_accvgpr_read_b32 v4, a84
  v_accvgpr_read_b32 v5, a85
  v_mul_f32 v4, v4, v3
  v_mul_f32 v5, v5, v3
  v_accvgpr_write_b32 a84, v4
  v_accvgpr_write_b32 a85, v5
  v_accvgpr_read_b32 v4, a86
  v_accvgpr_read_b32 v5, a87
  v_mul_f32 v4, v4, v3
  v_mul_f32 v5, v5, v3
  v_accvgpr_write_b32 a86, v4
  v_accvgpr_write_b32 a87, v5
  v_accvgpr_read_b32 v4, a88
  v_accvgpr_read_b32 v5, a89
  v_mul_f32 v4, v4, v3
  v_mul_f32 v5, v5, v3
  v_accvgpr_write_b32 a88, v4
  v_accvgpr_write_b32 a89, v5
  v_accvgpr_read_b32 v4, a90
  v_accvgpr_read_b32 v5, a91
  v_mul_f32 v4, v4, v3
  v_mul_f32 v5, v5, v3
  v_accvgpr_write_b32 a90, v4
  v_accvgpr_write_b32 a91, v5
  v_accvgpr_read_b32 v4, a92
  v_accvgpr_read_b32 v5, a93
  v_mul_f32 v4, v4, v3
  v_mul_f32 v5, v5, v3
  v_accvgpr_write_b32 a92, v4
  v_accvgpr_write_b32 a93, v5
  v_accvgpr_read_b32 v4, a94
  v_accvgpr_read_b32 v5, a95
  v_mul_f32 v4, v4, v3
  v_mul_f32 v5, v5, v3
  v_accvgpr_write_b32 a94, v4
  v_accvgpr_write_b32 a95, v5
  v_accvgpr_read_b32 v4, a96
  v_accvgpr_read_b32 v5, a97
  v_mul_f32 v4, v4, v3
  v_mul_f32 v5, v5, v3
  v_accvgpr_write_b32 a96, v4
  v_accvgpr_write_b32 a97, v5
  v_accvgpr_read_b32 v4, a98
  v_accvgpr_read_b32 v5, a99
  v_mul_f32 v4, v4, v3
  v_mul_f32 v5, v5, v3
  v_accvgpr_write_b32 a98, v4
  v_accvgpr_write_b32 a99, v5
  v_accvgpr_read_b32 v4, a100
  v_accvgpr_read_b32 v5, a101
  v_mul_f32 v4, v4, v3
  v_mul_f32 v5, v5, v3
  v_accvgpr_write_b32 a100, v4
  v_accvgpr_write_b32 a101, v5
  v_accvgpr_read_b32 v4, a102
  v_accvgpr_read_b32 v5, a103
  v_mul_f32 v4, v4, v3
  v_mul_f32 v5, v5, v3
  v_accvgpr_write_b32 a102, v4
  v_accvgpr_write_b32 a103, v5
  v_accvgpr_read_b32 v4, a104
  v_accvgpr_read_b32 v5, a105
  v_mul_f32 v4, v4, v3
  v_mul_f32 v5, v5, v3
  v_accvgpr_write_b32 a104, v4
  v_accvgpr_write_b32 a105, v5
  v_accvgpr_read_b32 v4, a106
  v_accvgpr_read_b32 v5, a107
  v_mul_f32 v4, v4, v3
  v_mul_f32 v5, v5, v3
  v_accvgpr_write_b32 a106, v4
  v_accvgpr_write_b32 a107, v5
  v_accvgpr_read_b32 v4, a108
  v_accvgpr_read_b32 v5, a109
  v_mul_f32 v4, v4, v3
  v_mul_f32 v5, v5, v3
  v_accvgpr_write_b32 a108, v4
  v_accvgpr_write_b32 a109, v5
  v_accvgpr_read_b32 v4, a110
  v_accvgpr_read_b32 v5, a111
  v_mul_f32 v4, v4, v3
  v_mul_f32 v5, v5, v3
  v_accvgpr_write_b32 a110, v4
  v_accvgpr_write_b32 a111, v5
  v_accvgpr_read_b32 v4, a112
  v_accvgpr_read_b32 v5, a113
  v_mul_f32 v4, v4, v3
  v_mul_f32 v5, v5, v3
  v_accvgpr_write_b32 a112, v4
  v_accvgpr_write_b32 a113, v5
  v_accvgpr_read_b32 v4, a114
  v_accvgpr_read_b32 v5, a115
  v_mul_f32 v4, v4, v3
  v_mul_f32 v5, v5, v3
  v_accvgpr_write_b32 a114, v4
  v_accvgpr_write_b32 a115, v5
  v_accvgpr_read_b32 v4, a116
  v_accvgpr_read_b32 v5, a117
  v_mul_f32 v4, v4, v3
  v_mul_f32 v5, v5, v3
  v_accvgpr_write_b32 a116, v4
  v_accvgpr_write_b32 a117, v5
  v_accvgpr_read_b32 v4, a118
  v_accvgpr_read_b32 v5, a119
  v_mul_f32 v4, v4, v3
  v_mul_f32 v5, v5, v3
  v_accvgpr_write_b32 a118, v4
  v_accvgpr_write_b32 a119, v5
  v_accvgpr_read_b32 v4, a120
  v_accvgpr_read_b32 v5, a121
  v_mul_f32 v4, v4, v3
  v_mul_f32 v5, v5, v3
  v_accvgpr_write_b32 a120, v4
  v_accvgpr_write_b32 a121, v5
  v_accvgpr_read_b32 v4, a122
  v_accvgpr_read_b32 v5, a123
  v_mul_f32 v4, v4, v3
  v_mul_f32 v5, v5, v3
  v_accvgpr_write_b32 a122, v4
  v_accvgpr_write_b32 a123, v5
  v_accvgpr_read_b32 v4, a124
  v_accvgpr_read_b32 v5, a125
  v_mul_f32 v4, v4, v3
  v_mul_f32 v5, v5, v3
  v_accvgpr_write_b32 a124, v4
  v_accvgpr_write_b32 a125, v5
  v_accvgpr_read_b32 v4, a126
  v_accvgpr_read_b32 v5, a127
  v_mul_f32 v4, v4, v3
  v_mul_f32 v5, v5, v3
  v_accvgpr_write_b32 a126, v4
  v_accvgpr_write_b32 a127, v5
at_fx110:
  v_exp_f32 v224, v96
  v_exp_f32 v225, v97
  v_exp_f32 v226, v98
  v_add_f32 v234, v224, v225
  v_cvt_pk_bf16_f32 v216, v224, v225
  v_exp_f32 v227, v99
  v_add_f32 v234, v234, v226
  v_exp_f32 v224, v100
  v_add_f32 v234, v234, v227
  v_cvt_pk_bf16_f32 v217, v226, v227
  v_exp_f32 v225, v101
  v_add_f32 v234, v234, v224
  v_exp_f32 v226, v102
  v_add_f32 v234, v234, v225
  v_cvt_pk_bf16_f32 v218, v224, v225
  v_exp_f32 v227, v103
  v_add_f32 v234, v234, v226
  v_exp_f32 v224, v104
  v_add_f32 v234, v234, v227
  v_cvt_pk_bf16_f32 v219, v226, v227
  v_exp_f32 v225, v105
  v_add_f32 v234, v234, v224
  v_exp_f32 v226, v106
  v_add_f32 v234, v234, v225
  v_cvt_pk_bf16_f32 v220, v224, v225
  v_exp_f32 v227, v107
  v_add_f32 v234, v234, v226
  v_exp_f32 v224, v108
  v_add_f32 v234, v234, v227
  v_cvt_pk_bf16_f32 v221, v226, v227
  v_exp_f32 v225, v109
  v_add_f32 v234, v234, v224
  v_exp_f32 v226, v110
  v_add_f32 v234, v234, v225
  v_cvt_pk_bf16_f32 v222, v224, v225
  v_exp_f32 v227, v111
  v_add_f32 v234, v234, v226
  v_add_f32 v234, v234, v227
  v_cvt_pk_bf16_f32 v223, v226, v227
  s_mov_b32 s77, 0x45800000
  s_mov_b32 s79, 0
  s_setpc_b64 s[80:81]
at_fix001:
  s_nop 15
  v_max3_f32 v2, v80, v81, v82
  v_max3_f32 v2, v2, v83, v84
  v_max3_f32 v2, v2, v85, v86
  v_max3_f32 v2, v2, v87, v88
  v_max3_f32 v2, v2, v89, v90
  v_max3_f32 v2, v2, v91, v92
  v_max3_f32 v2, v2, v93, v94
  v_max_f32 v2, v2, v95
  v_mov_b32 v3, v2
  s_nop 1
  v_permlane32_swap_b32 v2, v3
  s_nop 1
  v_max_f32 v2, v2, v3
  v_max_f32 v2, s78, v2
  v_sub_f32 v112, v112, v2
  v_sub_f32 v80, v80, v2
  v_sub_f32 v113, v113, v2
  v_sub_f32 v81, v81, v2
  v_sub_f32 v114, v114, v2
  v_sub_f32 v82, v82, v2
  v_sub_f32 v115, v115, v2
  v_sub_f32 v83, v83, v2
  v_sub_f32 v116, v116, v2
  v_sub_f32 v84, v84, v2
  v_sub_f32 v117, v117, v2
  v_sub_f32 v85, v85, v2
  v_sub_f32 v118, v118, v2
  v_sub_f32 v86, v86, v2
  v_sub_f32 v119, v119, v2
  v_sub_f32 v87, v87, v2
  v_sub_f32 v120, v120, v2
  v_sub_f32 v88, v88, v2
  v_sub_f32 v121, v121, v2
  v_sub_f32 v89, v89, v2
  v_sub_f32 v122, v122, v2
  v_sub_f32 v90, v90, v2
  v_sub_f32 v123, v123, v2
  v_sub_f32 v91, v91, v2
  v_sub_f32 v124, v124, v2
  v_sub_f32 v92, v92, v2
  v_sub_f32 v125, v125, v2
  v_sub_f32 v93, v93, v2
  v_sub_f32 v126, v126, v2
  v_sub_f32 v94, v94, v2
  v_sub_f32 v127, v127, v2
  v_sub_f32 v95, v95, v2
  v_sub_f32 v96, v96, v2
  v_sub_f32 v97, v97, v2
  v_sub_f32 v98, v98, v2
  v_sub_f32 v99, v99, v2
  v_sub_f32 v100, v100, v2
  v_sub_f32 v101, v101, v2
  v_sub_f32 v102, v102, v2
  v_sub_f32 v103, v103, v2
  v_sub_f32 v104, v104, v2
  v_sub_f32 v105, v105, v2
  v_sub_f32 v106, v106, v2
  v_sub_f32 v107, v107, v2
  v_sub_f32 v108, v108, v2
  v_sub_f32 v109, v109, v2
  v_sub_f32 v110, v110, v2
  v_sub_f32 v111, v111, v2
  s_cmp_lg_u32 s78, 0
  s_cbranch_scc1 at_fx001
  v_sub_f32 v3, 0, v2
  v_exp_f32 v3, v3
  s_nop 0
  v_mul_f32 v232, v232, v3
  v_accvgpr_read_b32 v4, a0
  v_accvgpr_read_b32 v5, a1
  v_mul_f32 v4, v4, v3
  v_mul_f32 v5, v5, v3
  v_accvgpr_write_b32 a0, v4
  v_accvgpr_write_b32 a1, v5
  v_accvgpr_read_b32 v4, a2
  v_accvgpr_read_b32 v5, a3
  v_mul_f32 v4, v4, v3
  v_mul_f32 v5, v5, v3
  v_accvgpr_write_b32 a2, v4
  v_accvgpr_write_b32 a3, v5
  v_accvgpr_read_b32 v4, a4
  v_accvgpr_read_b32 v5, a5
  v_mul_f32 v4, v4, v3
  v_mul_f32 v5, v5, v3
  v_accvgpr_write_b32 a4, v4
  v_accvgpr_write_b32 a5, v5
  v_accvgpr_read_b32 v4, a6
  v_accvgpr_read_b32 v5, a7
  v_mul_f32 v4, v4, v3
  v_mul_f32 v5, v5, v3
  v_accvgpr_write_b32 a6, v4
  v_accvgpr_write_b32 a7, v5
  v_accvgpr_read_b32 v4, a8
  v_accvgpr_read_b32 v5, a9
  v_mul_f32 v4, v4, v3
  v_mul_f32 v5, v5, v3
  v_accvgpr_write_b32 a8, v4
  v_accvgpr_write_b32 a9, v5
  v_accvgpr_read_b32 v4, a10
  v_accvgpr_read_b32 v5, a11
  v_mul_f32 v4, v4, v3
  v_mul_f32 v5, v5, v3
  v_accvgpr_write_b32 a10, v4
  v_accvgpr_write_b32 a11, v5
  v_accvgpr_read_b32 v4, a12
  v_accvgpr_read_b32 v5, a13
  v_mul_f32 v4, v4, v3
  v_mul_f32 v5, v5, v3
  v_accvgpr_write_b32 a12, v4
  v_accvgpr_write_b32 a13, v5
  v_accvgpr_read_b32 v4, a14
  v_accvgpr_read_b32 v5, a15
  v_mul_f32 v4, v4, v3
  v_mul_f32 v5, v5, v3
  v_accvgpr_write_b32 a14, v4
  v_accvgpr_write_b32 a15, v5
  v_accvgpr_read_b32 v4, a16
  v_accvgpr_read_b32 v5, a17
  v_mul_f32 v4, v4, v3
  v_mul_f32 v5, v5, v3
  v_accvgpr_write_b32 a16, v4
  v_accvgpr_write_b32 a17, v5
  v_accvgpr_read_b32 v4, a18
  v_accvgpr_read_b32 v5, a19
  v_mul_f32 v4, v4, v3
  v_mul_f32 v5, v5, v3
  v_accvgpr_write_b32 a18, v4
  v_accvgpr_write_b32 a19, v5
  v_accvgpr_read_b32 v4, a20
  v_accvgpr_read_b32 v5, a21
  v_mul_f32 v4, v4, v3
  v_mul_f32 v5, v5, v3
  v_accvgpr_write_b32 a20, v4
  v_accvgpr_write_b32 a21, v5
  v_accvgpr_read_b32 v4, a22
  v_accvgpr_read_b32 v5, a23
  v_mul_f32 v4, v4, v3
  v_mul_f32 v5, v5, v3
  v_accvgpr_write_b32 a22, v4
  v_accvgpr_write_b32 a23, v5
  v_accvgpr_read_b32 v4, a24
  v_accvgpr_read_b32 v5, a25
  v_mul_f32 v4, v4, v3
  v_mul_f32 v5, v5, v3
  v_accvgpr_write_b32 a24, v4
  v_accvgpr_write_b32 a25, v5
  v_accvgpr_read_b32 v4, a26
  v_accvgpr_read_b32 v5, a27
  v_mul_f32 v4, v4, v3
  v_mul_f32 v5, v5, v3
  v_accvgpr_write_b32 a26, v4
  v_accvgpr_write_b32 a27, v5
  v_accvgpr_read_b32 v4, a28
  v_accvgpr_read_b32 v5, a29
  v_mul_f32 v4, v4, v3
  v_mul_f32 v5, v5, v3
  v_accvgpr_write_b32 a28, v4
  v_accvgpr_write_b32 a29, v5
  v_accvgpr_read_b32 v4, a30
  v_accvgpr_read_b32 v5, a31
  v_mul_f32 v4, v4, v3
  v_mul_f32 v5, v5, v3
  v_accvgpr_write_b32 a30, v4
  v_accvgpr_write_b32 a31, v5
  v_accvgpr_read_b32 v4, a32
  v_accvgpr_read_b32 v5, a33
  v_mul_f32 v4, v4, v3
  v_mul_f32 v5, v5, v3
  v_accvgpr_write_b32 a32, v4
  v_accvgpr_write_b32 a33, v5
  v_accvgpr_read_b32 v4, a34
  v_accvgpr_read_b32 v5, a35
  v_mul_f32 v4, v4, v3
  v_mul_f32 v5, v5, v3
  v_accvgpr_write_b32 a34, v4
  v_accvgpr_write_b32 a35, v5
  v_accvgpr_read_b32 v4, a36
  v_accvgpr_read_b32 v5, a37
  v_mul_f32 v4, v4, v3
  v_mul_f32 v5, v5, v3
  v_accvgpr_write_b32 a36, v4
  v_accvgpr_write_b32 a37, v5
  v_accvgpr_read_b32 v4, a38
  v_accvgpr_read_b32 v5, a39
  v_mul_f32 v4, v4, v3
  v_mul_f32 v5, v5, v3
  v_accvgpr_write_b32 a38, v4
  v_accvgpr_write_b32 a39, v5
  v_accvgpr_read_b32 v4, a40
  v_accvgpr_read_b32 v5, a41
  v_mul_f32 v4, v4, v3
  v_mul_f32 v5, v5, v3
  v_accvgpr_write_b32 a40, v4
  v_accvgpr_write_b32 a41, v5
  v_accvgpr_read_b32 v4, a42
  v_accvgpr_read_b32 v5, a43
  v_mul_f32 v4, v4, v3
  v_mul_f32 v5, v5, v3
  v_accvgpr_write_b32 a42, v4
  v_accvgpr_write_b32 a43, v5
  v_accvgpr_read_b32 v4, a44
  v_accvgpr_read_b32 v5, a45
  v_mul_f32 v4, v4, v3
  v_mul_f32 v5, v5, v3
  v_accvgpr_write_b32 a44, v4
  v_accvgpr_write_b32 a45, v5
  v_accvgpr_read_b32 v4, a46
  v_accvgpr_read_b32 v5, a47
  v_mul_f32 v4, v4, v3
  v_mul_f32 v5, v5, v3
  v_accvgpr_write_b32 a46, v4
  v_accvgpr_write_b32 a47, v5
  v_accvgpr_read_b32 v4, a48
  v_accvgpr_read_b32 v5, a49
  v_mul_f32 v4, v4, v3
  v_mul_f32 v5, v5, v3
  v_accvgpr_write_b32 a48, v4
  v_accvgpr_write_b32 a49, v5
  v_accvgpr_read_b32 v4, a50
  v_accvgpr_read_b32 v5, a51
  v_mul_f32 v4, v4, v3
  v_mul_f32 v5, v5, v3
  v_accvgpr_write_b32 a50, v4
  v_accvgpr_write_b32 a51, v5
  v_accvgpr_read_b32 v4, a52
  v_accvgpr_read_b32 v5, a53
  v_mul_f32 v4, v4, v3
  v_mul_f32 v5, v5, v3
  v_accvgpr_write_b32 a52, v4
  v_accvgpr_write_b32 a53, v5
  v_accvgpr_read_b32 v4, a54
  v_accvgpr_read_b32 v5, a55
  v_mul_f32 v4, v4, v3
  v_mul_f32 v5, v5, v3
  v_accvgpr_write_b32 a54, v4
  v_accvgpr_write_b32 a55, v5
  v_accvgpr_read_b32 v4, a56
  v_accvgpr_read_b32 v5, a57
  v_mul_f32 v4, v4, v3
  v_mul_f32 v5, v5, v3
  v_accvgpr_write_b32 a56, v4
  v_accvgpr_write_b32 a57, v5
  v_accvgpr_read_b32 v4, a58
  v_accvgpr_read_b32 v5, a59
  v_mul_f32 v4, v4, v3
  v_mul_f32 v5, v5, v3
  v_accvgpr_write_b32 a58, v4
  v_accvgpr_write_b32 a59, v5
  v_accvgpr_read_b32 v4, a60
  v_accvgpr_read_b32 v5, a61
  v_mul_f32 v4, v4, v3
  v_mul_f32 v5, v5, v3
  v_accvgpr_write_b32 a60, v4
  v_accvgpr_write_b32 a61, v5
  v_accvgpr_read_b32 v4, a62
  v_accvgpr_read_b32 v5, a63
  v_mul_f32 v4, v4, v3
  v_mul_f32 v5, v5, v3
  v_accvgpr_write_b32 a62, v4
  v_accvgpr_write_b32 a63, v5
at_fx001:
  v_exp_f32 v224, v80
  v_exp_f32 v225, v81
  v_exp_f32 v226, v82
  v_add_f32 v234, v224, v225
  v_cvt_pk_bf16_f32 v208, v224, v225
  v_exp_f32 v227, v83
  v_add_f32 v234, v234, v226
  v_exp_f32 v224, v84
  v_add_f32 v234, v234, v227
  v_cvt_pk_bf16_f32 v209, v226, v227
  v_exp_f32 v225, v85
  v_add_f32 v234, v234, v224
  v_exp_f32 v226, v86
  v_add_f32 v234, v234, v225
  v_cvt_pk_bf16_f32 v210, v224, v225
  v_exp_f32 v227, v87
  v_add_f32 v234, v234, v226
  v_exp_f32 v224, v88
  v_add_f32 v234, v234, v227
  v_cvt_pk_bf16_f32 v211, v226, v227
  v_exp_f32 v225, v89
  v_add_f32 v234, v234, v224
  v_exp_f32 v226, v90
  v_add_f32 v234, v234, v225
  v_cvt_pk_bf16_f32 v212, v224, v225
  v_exp_f32 v227, v91
  v_add_f32 v234, v234, v226
  v_exp_f32 v224, v92
  v_add_f32 v234, v234, v227
  v_cvt_pk_bf16_f32 v213, v226, v227
  v_exp_f32 v225, v93
  v_add_f32 v234, v234, v224
  v_exp_f32 v226, v94
  v_add_f32 v234, v234, v225
  v_cvt_pk_bf16_f32 v214, v224, v225
  v_exp_f32 v227, v95
  v_add_f32 v234, v234, v226
  v_add_f32 v234, v234, v227
  v_cvt_pk_bf16_f32 v215, v226, v227
  s_mov_b32 s76, 0x45800000
  s_mov_b32 s78, 0
  s_setpc_b64 s[80:81]
at_fix011:
  s_nop 15
  v_max3_f32 v2, v96, v97, v98
  v_max3_f32 v2, v2, v99, v100
  v_max3_f32 v2, v2, v101, v102
  v_max3_f32 v2, v2, v103, v104
  v_max3_f32 v2, v2, v105, v106
  v_max3_f32 v2, v2, v107, v108
  v_max3_f32 v2, v2, v109, v110
  v_max_f32 v2, v2, v111
  v_mov_b32 v3, v2
  s_nop 1
  v_permlane32_swap_b32 v2, v3
  s_nop 1
  v_max_f32 v2, v2, v3
  v_max_f32 v2, s78, v2
  v_sub_f32 v112, v112, v2
  v_sub_f32 v96, v96, v2
  v_sub_f32 v113, v113, v2
  v_sub_f32 v97, v97, v2
  v_sub_f32 v114, v114, v2
  v_sub_f32 v98, v98, v2
  v_sub_f32 v115, v115, v2
  v_sub_f32 v99, v99, v2
  v_sub_f32 v116, v116, v2
  v_sub_f32 v100, v100, v2
  v_sub_f32 v117, v117, v2
  v_sub_f32 v101, v101, v2
  v_sub_f32 v118, v118, v2
  v_sub_f32 v102, v102, v2
  v_sub_f32 v119, v119, v2
  v_sub_f32 v103, v103, v2
  v_sub_f32 v120, v120, v2
  v_sub_f32 v104, v104, v2
  v_sub_f32 v121, v121, v2
  v_sub_f32 v105, v105, v2
  v_sub_f32 v122, v122, v2
  v_sub_f32 v106, v106, v2
  v_sub_f32 v123, v123, v2
  v_sub_f32 v107, v107, v2
  v_sub_f32 v124, v124, v2
  v_sub_f32 v108, v108, v2
  v_sub_f32 v125, v125, v2
  v_sub_f32 v109, v109, v2
  v_sub_f32 v126, v126, v2
  v_sub_f32 v110, v110, v2
  v_sub_f32 v127, v127, v2
  v_sub_f32 v111, v111, v2
  v_sub_f32 v80, v80, v2
  v_sub_f32 v81, v81, v2
  v_sub_f32 v82, v82, v2
  v_sub_f32 v83, v83, v2
  v_sub_f32 v84, v84, v2
  v_sub_f32 v85, v85, v2
  v_sub_f32 v86, v86, v2
  v_sub_f32 v87, v87, v2
  v_sub_f32 v88, v88, v2
  v_sub_f32 v89, v89, v2
  v_sub_f32 v90, v90, v2
  v_sub_f32 v91, v91, v2
  v_sub_f32 v92, v92, v2
  v_sub_f32 v93, v93, v2
  v_sub_f32 v94, v94, v2
  v_sub_f32 v95, v95, v2
  s_cmp_lg_u32 s78, 0
  s_cbranch_scc1 at_fx011
  v_sub_f32 v3, 0, v2
  v_exp_f32 v3, v3
  s_nop 0
  v_mul_f32 v232, v232, v3
  v_accvgpr_read_b32 v4, a0
  v_accvgpr_read_b32 v5, a1
  v_mul_f32 v4, v4, v3
  v_mul_f32 v5, v5, v3
  v_accvgpr_write_b32 a0, v4
  v_accvgpr_write_b32 a1, v5
  v_accvgpr_read_b32 v4, a2
  v_accvgpr_read_b32 v5, a3
  v_mul_f32 v4, v4, v3
  v_mul_f32 v5, v5, v3
  v_accvgpr_write_b32 a2, v4
  v_accvgpr_write_b32 a3, v5
  v_accvgpr_read_b32 v4, a4
  v_accvgpr_read_b32 v5, a5
  v_mul_f32 v4, v4, v3
  v_mul_f32 v5, v5, v3
  v_accvgpr_write_b32 a4, v4
  v_accvgpr_write_b32 a5, v5
  v_accvgpr_read_b32 v4, a6
  v_accvgpr_read_b32 v5, a7
  v_mul_f32 v4, v4, v3
  v_mul_f32 v5, v5, v3
  v_accvgpr_write_b32 a6, v4
  v_accvgpr_write_b32 a7, v5
  v_accvgpr_read_b32 v4, a8
  v_accvgpr_read_b32 v5, a9
  v_mul_f32 v4, v4, v3
  v_mul_f32 v5, v5, v3
  v_accvgpr_write_b32 a8, v4
  v_accvgpr_write_b32 a9, v5
  v_accvgpr_read_b32 v4, a10
  v_accvgpr_read_b32 v5, a11
  v_mul_f32 v4, v4, v3
  v_mul_f32 v5, v5, v3
  v_accvgpr_write_b32 a10, v4
  v_accvgpr_write_b32 a11, v5
  v_accvgpr_read_b32 v4, a12
  v_accvgpr_read_b32 v5, a13
  v_mul_f32 v4, v4, v3
  v_mul_f32 v5, v5, v3
  v_accvgpr_write_b32 a12, v4
  v_accvgpr_write_b32 a13, v5
  v_accvgpr_read_b32 v4, a14
  v_accvgpr_read_b32 v5, a15
  v_mul_f32 v4, v4, v3
  v_mul_f32 v5, v5, v3
  v_accvgpr_write_b32 a14, v4
  v_accvgpr_write_b32 a15, v5
  v_accvgpr_read_b32 v4, a16
  v_accvgpr_read_b32 v5, a17
  v_mul_f32 v4, v4, v3
  v_mul_f32 v5, v5, v3
  v_accvgpr_write_b32 a16, v4
  v_accvgpr_write_b32 a17, v5
  v_accvgpr_read_b32 v4, a18
  v_accvgpr_read_b32 v5, a19
  v_mul_f32 v4, v4, v3
  v_mul_f32 v5, v5, v3
  v_accvgpr_write_b32 a18, v4
  v_accvgpr_write_b32 a19, v5
  v_accvgpr_read_b32 v4, a20
  v_accvgpr_read_b32 v5, a21
  v_mul_f32 v4, v4, v3
  v_mul_f32 v5, v5, v3
  v_accvgpr_write_b32 a20, v4
  v_accvgpr_write_b32 a21, v5
  v_accvgpr_read_b32 v4, a22
  v_accvgpr_read_b32 v5, a23
  v_mul_f32 v4, v4, v3
  v_mul_f32 v5, v5, v3
  v_accvgpr_write_b32 a22, v4
  v_accvgpr_write_b32 a23, v5
  v_accvgpr_read_b32 v4, a24
  v_accvgpr_read_b32 v5, a25
  v_mul_f32 v4, v4, v3
  v_mul_f32 v5, v5, v3
  v_accvgpr_write_b32 a24, v4
  v_accvgpr_write_b32 a25, v5
  v_accvgpr_read_b32 v4, a26
  v_accvgpr_read_b32 v5, a27
  v_mul_f32 v4, v4, v3
  v_mul_f32 v5, v5, v3
  v_accvgpr_write_b32 a26, v4
  v_accvgpr_write_b32 a27, v5
  v_accvgpr_read_b32 v4, a28
  v_accvgpr_read_b32 v5, a29
  v_mul_f32 v4, v4, v3
  v_mul_f32 v5, v5, v3
  v_accvgpr_write_b32 a28, v4
  v_accvgpr_write_b32 a29, v5
  v_accvgpr_read_b32 v4, a30
  v_accvgpr_read_b32 v5, a31
  v_mul_f32 v4, v4, v3
  v_mul_f32 v5, v5, v3
  v_accvgpr_write_b32 a30, v4
  v_accvgpr_write_b32 a31, v5
  v_accvgpr_read_b32 v4, a32
  v_accvgpr_read_b32 v5, a33
  v_mul_f32 v4, v4, v3
  v_mul_f32 v5, v5, v3
  v_accvgpr_write_b32 a32, v4
  v_accvgpr_write_b32 a33, v5
  v_accvgpr_read_b32 v4, a34
  v_accvgpr_read_b32 v5, a35
  v_mul_f32 v4, v4, v3
  v_mul_f32 v5, v5, v3
  v_accvgpr_write_b32 a34, v4
  v_accvgpr_write_b32 a35, v5
  v_accvgpr_read_b32 v4, a36
  v_accvgpr_read_b32 v5, a37
  v_mul_f32 v4, v4, v3
  v_mul_f32 v5, v5, v3
  v_accvgpr_write_b32 a36, v4
  v_accvgpr_write_b32 a37, v5
  v_accvgpr_read_b32 v4, a38
  v_accvgpr_read_b32 v5, a39
  v_mul_f32 v4, v4, v3
  v_mul_f32 v5, v5, v3
  v_accvgpr_write_b32 a38, v4
  v_accvgpr_write_b32 a39, v5
  v_accvgpr_read_b32 v4, a40
  v_accvgpr_read_b32 v5, a41
  v_mul_f32 v4, v4, v3
  v_mul_f32 v5, v5, v3
  v_accvgpr_write_b32 a40, v4
  v_accvgpr_write_b32 a41, v5
  v_accvgpr_read_b32 v4, a42
  v_accvgpr_read_b32 v5, a43
  v_mul_f32 v4, v4, v3
  v_mul_f32 v5, v5, v3
  v_accvgpr_write_b32 a42, v4
  v_accvgpr_write_b32 a43, v5
  v_accvgpr_read_b32 v4, a44
  v_accvgpr_read_b32 v5, a45
  v_mul_f32 v4, v4, v3
  v_mul_f32 v5, v5, v3
  v_accvgpr_write_b32 a44, v4
  v_accvgpr_write_b32 a45, v5
  v_accvgpr_read_b32 v4, a46
  v_accvgpr_read_b32 v5, a47
  v_mul_f32 v4, v4, v3
  v_mul_f32 v5, v5, v3
  v_accvgpr_write_b32 a46, v4
  v_accvgpr_write_b32 a47, v5
  v_accvgpr_read_b32 v4, a48
  v_accvgpr_read_b32 v5, a49
  v_mul_f32 v4, v4, v3
  v_mul_f32 v5, v5, v3
  v_accvgpr_write_b32 a48, v4
  v_accvgpr_write_b32 a49, v5
  v_accvgpr_read_b32 v4, a50
  v_accvgpr_read_b32 v5, a51
  v_mul_f32 v4, v4, v3
  v_mul_f32 v5, v5, v3
  v_accvgpr_write_b32 a50, v4
  v_accvgpr_write_b32 a51, v5
  v_accvgpr_read_b32 v4, a52
  v_accvgpr_read_b32 v5, a53
  v_mul_f32 v4, v4, v3
  v_mul_f32 v5, v5, v3
  v_accvgpr_write_b32 a52, v4
  v_accvgpr_write_b32 a53, v5
  v_accvgpr_read_b32 v4, a54
  v_accvgpr_read_b32 v5, a55
  v_mul_f32 v4, v4, v3
  v_mul_f32 v5, v5, v3
  v_accvgpr_write_b32 a54, v4
  v_accvgpr_write_b32 a55, v5
  v_accvgpr_read_b32 v4, a56
  v_accvgpr_read_b32 v5, a57
  v_mul_f32 v4, v4, v3
  v_mul_f32 v5, v5, v3
  v_accvgpr_write_b32 a56, v4
  v_accvgpr_write_b32 a57, v5
  v_accvgpr_read_b32 v4, a58
  v_accvgpr_read_b32 v5, a59
  v_mul_f32 v4, v4, v3
  v_mul_f32 v5, v5, v3
  v_accvgpr_write_b32 a58, v4
  v_accvgpr_write_b32 a59, v5
  v_accvgpr_read_b32 v4, a60
  v_accvgpr_read_b32 v5, a61
  v_mul_f32 v4, v4, v3
  v_mul_f32 v5, v5, v3
  v_accvgpr_write_b32 a60, v4
  v_accvgpr_write_b32 a61, v5
  v_accvgpr_read_b32 v4, a62
  v_accvgpr_read_b32 v5, a63
  v_mul_f32 v4, v4, v3
  v_mul_f32 v5, v5, v3
  v_accvgpr_write_b32 a62, v4
  v_accvgpr_write_b32 a63, v5
at_fx011:
  v_exp_f32 v224, v96
  v_exp_f32 v225, v97
  v_exp_f32 v226, v98
  v_add_f32 v234, v224, v225
  v_cvt_pk_bf16_f32 v216, v224, v225
  v_exp_f32 v227, v99
  v_add_f32 v234, v234, v226
  v_exp_f32 v224, v100
  v_add_f32 v234, v234, v227
  v_cvt_pk_bf16_f32 v217, v226, v227
  v_exp_f32 v225, v101
  v_add_f32 v234, v234, v224
  v_exp_f32 v226, v102
  v_add_f32 v234, v234, v225
  v_cvt_pk_bf16_f32 v218, v224, v225
  v_exp_f32 v227, v103
  v_add_f32 v234, v234, v226
  v_exp_f32 v224, v104
  v_add_f32 v234, v234, v227
  v_cvt_pk_bf16_f32 v219, v226, v227
  v_exp_f32 v225, v105
  v_add_f32 v234, v234, v224
  v_exp_f32 v226, v106
  v_add_f32 v234, v234, v225
  v_cvt_pk_bf16_f32 v220, v224, v225
  v_exp_f32 v227, v107
  v_add_f32 v234, v234, v226
  v_exp_f32 v224, v108
  v_add_f32 v234, v234, v227
  v_cvt_pk_bf16_f32 v221, v226, v227
  v_exp_f32 v225, v109
  v_add_f32 v234, v234, v224
  v_exp_f32 v226, v110
  v_add_f32 v234, v234, v225
  v_cvt_pk_bf16_f32 v222, v224, v225
  v_exp_f32 v227, v111
  v_add_f32 v234, v234, v226
  v_add_f32 v234, v234, v227
  v_cvt_pk_bf16_f32 v223, v226, v227
  s_mov_b32 s76, 0x45800000
  s_mov_b32 s78, 0
  s_setpc_b64 s[80:81]
op_w_sp:
  buffer_load_dword v250, v251, s[68:71], 0 offen sc1
  s_waitcnt vmcnt(0)
  v_cmp_ne_u32 vcc, 1, v250
  s_add_u32 s97, s97, 1
  s_cmp_gt_u32 s97, 400000
  s_cbranch_scc1 op_w_ok
  s_cbranch_vccnz op_w_sp
  s_branch op_w_ok
op_m_sp:
  buffer_load_dword v250, v251, s[68:71], 0 offen sc1
  s_waitcnt vmcnt(0)
  v_cmp_ne_u32 vcc, 0x01010101, v250
  s_add_u32 s97, s97, 1
  s_cmp_gt_u32 s97, 400000
  s_cbranch_scc1 op_m_ok
  s_cbranch_vccnz op_m_sp
  s_branch op_m_ok
f1_w_sp:
  buffer_load_dword v250, v251, s[68:71], 0 offen sc1
  s_waitcnt vmcnt(0)
  v_cmp_ne_u32 vcc, 1, v250
  s_add_u32 s97, s97, 1
  s_cmp_gt_u32 s97, 400000
  s_cbranch_scc1 f1_w_ok
  s_cbranch_vccnz f1_w_sp
  s_branch f1_w_ok
f2_w_sp:
  buffer_load_dword v250, v251, s[68:71], 0 offen sc1
  s_waitcnt vmcnt(0)
  v_cmp_ne_u32 vcc, 1, v250
  s_add_u32 s97, s97, 1
  s_cmp_gt_u32 s97, 400000
  s_cbranch_scc1 f2_w_ok
  s_cbranch_vccnz f2_w_sp
  s_branch f2_w_ok
kn_ce:
.section .rodata,"a"
.p2align 6
.amdhsa_kernel adaLN_cond__compressed_kv_cla__dense_activation_relu__prompt_kernel
  .amdhsa_next_free_vgpr 512
  .amdhsa_next_free_sgpr 102
  .amdhsa_accum_offset 256
  .amdhsa_group_segment_fixed_size 0
  .amdhsa_kernarg_size 112
  .amdhsa_user_sgpr_count 2
  .amdhsa_user_sgpr_kernarg_segment_ptr 1
  .amdhsa_system_sgpr_workgroup_id_x 1
.end_amdhsa_kernel
```
